```python
import torch

def _softmax(x, axis=-1):
    return torch.softmax(x, dim=axis)

def _gelu(x):
    return torch.nn.functional.gelu(x, approximate='tanh')

def _silu(x):
    return torch.nn.functional.silu(x)

def _sigmoid(x):
    return torch.sigmoid(x)

def _layernorm(x, axis=-1, eps=1e-05):
    m = x.mean(dim=axis, keepdim=True)
    v = x.var(dim=axis, keepdim=True, unbiased=False)
    return (x - m) / torch.sqrt(v + eps)

def _scatter_add(tgt, idx, src, axis=0):
    return tgt.clone().index_add_(axis, idx, src)

def _segment_sum(src, seg, n):
    out = torch.zeros((n,) + src.shape[1:], dtype=src.dtype)
    return out.index_add_(0, seg, src)

def _pad(x, pw):
    flat = tuple((v for pair in reversed(pw) for v in pair))
    return torch.nn.functional.pad(x, flat)
kernel_name = 'gated_mix__sliding_block__memory_aug_recurrent_mem_tr__prompt'

def setup_inputs():

    _w = lambda a: (lambda t: t.to(torch.bfloat16) if t.is_floating_point() else t)(torch.as_tensor(a))

    def _A_setup():
        B, S, D = (1, 2048, 448)
        return {'x': _w((lambda *s: torch.randn(*s, dtype=torch.bfloat16) * 0.05)(B, S, D)), 'wqkv': _w((lambda *s: torch.randn(*s, dtype=torch.bfloat16) * 1.6)(D, 3 * D)), 'wo': _w((lambda *s: torch.randn(*s, dtype=torch.bfloat16) * 0.05)(D, D))}
    _A_in = _A_setup()

    def _B_setup():
        B, S, Dm = (1, 2048, 448)
        H, Dh = (16, 256)
        M, seg = (8, 32)
        seg = min(seg, S)
        S = S // seg * seg
        return {'x': _w((lambda *s: torch.randn(*s, dtype=torch.bfloat16) * 0.05)(B, S, Dm)), 'mem0': _w((lambda *s: torch.randn(*s, dtype=torch.bfloat16) * 1.6)(B, M, Dm)), 'Wq': _w((lambda *s: torch.randn(*s, dtype=torch.bfloat16) * 0.8)(Dm, H, Dh) * Dm ** (-0.5)), 'Wk': _w((lambda *s: torch.randn(*s, dtype=torch.bfloat16) * 0.8)(Dm, H, Dh) * Dm ** (-0.5)), 'Wv': _w((lambda *s: torch.randn(*s, dtype=torch.bfloat16) * 1.6)(Dm, H, Dh) * Dm ** (-0.5)), 'Wo': _w((lambda *s: torch.randn(*s, dtype=torch.bfloat16) * 1.6)(H, Dh, Dm) * (H * Dh) ** (-0.5)), 'seg_len': seg}
    _B_in = _B_setup()
    return {'A_x': _A_in['x'], 'A_wqkv': _A_in['wqkv'], 'A_wo': _A_in['wo'], 'B_x': _B_in['x'], 'B_mem0': _B_in['mem0'], 'B_Wq': _B_in['Wq'], 'B_Wk': _B_in['Wk'], 'B_Wv': _B_in['Wv'], 'B_Wo': _B_in['Wo'], 'B_seg_len': _B_in['seg_len'], 'gate_w': _w((lambda *s: torch.randn(*s, dtype=torch.bfloat16) * 0.05)(448) * 16.0)}

def reference(A_x, A_wqkv, A_wo, B_x, B_mem0, B_Wq, B_Wk, B_Wv, B_Wo, B_seg_len, gate_w):

    def _A_ref(x, wqkv, wo):
        B, S, D = x.shape
        H = 16
        Dh = D // H
        W = 256
        qkv = (lambda x, *d: x.permute(*d))((x @ wqkv).reshape(B, S, 3, H, Dh), 2, 0, 3, 1, 4)
        q, k, v = (qkv[0], qkv[1], qkv[2])
        scores = torch.einsum('bhqd,bhkd->bhqk', q, k) * Dh ** (-0.5)
        idx = torch.arange(S)
        mask = (idx[:, None] - idx[None, :] >= 0) & (idx[:, None] - idx[None, :] < W)
        scores = torch.where(mask[None, None], scores, -1000000000.0)
        p = _softmax(scores, axis=-1)
        o = torch.einsum('bhqk,bhkd->bhqd', p, v)
        return (lambda x, *d: x.permute(*d))(o, 0, 2, 1, 3).reshape(B, S, D) @ wo

    def _B_ref(x, mem0, Wq, Wk, Wv, Wo, seg_len):
        B, S, Dm = x.shape
        H, Dh = (Wq.shape[1], Wq.shape[2])
        M = mem0.shape[1]
        scale = Dh ** (-0.5)
        n_seg = S // seg_len
        L = M + seg_len
        idx = torch.arange(L)
        mask = (idx[:, None] < M) | (idx[:, None] >= idx[None, :])
        mem = mem0
        outs = []
        for s in range(n_seg):
            xs = x[:, s * seg_len:(s + 1) * seg_len, :].clone()
            h = torch.concatenate([mem, xs], axis=1)
            q = torch.einsum('btd,dhe->bhte', h, Wq)
            k = torch.einsum('btd,dhe->bhte', h, Wk)
            v = torch.einsum('btd,dhe->bhte', h, Wv)
            scores = torch.einsum('bhqe,bhke->bhqk', q, k) * scale
            scores = torch.where(mask[None, None], scores, -1000000000.0)
            p = _softmax(scores, axis=-1)
            o = torch.einsum('bhqk,bhke->bhqe', p, v)
            o = torch.einsum('bhte,hed->btd', o, Wo)
            mem = o[:, :M, :].clone()
            outs.append(o[:, M:, :])
        return torch.concatenate(outs, axis=1)
    x = A_x
    g = _sigmoid((x * gate_w).sum(-1, keepdims=True))
    a = _A_ref(x, A_wqkv, A_wo)
    b = _B_ref(x, B_mem0, B_Wq, B_Wk, B_Wv, B_Wo, B_seg_len)
    return g * a + (1 - g) * b
```

```asm
; @launch kernel=gated_mix__sliding_block__memory_aug_recurrent_mem_tr__prompt_kernel grid=(256,1,1) block=(256,1,1) lds=65536
.amdgcn_target "amdgcn-amd-amdhsa--gfx950"
.text
.globl gated_mix__sliding_block__memory_aug_recurrent_mem_tr__prompt_kernel
.p2align 8
.type gated_mix__sliding_block__memory_aug_recurrent_mem_tr__prompt_kernel,@function
gated_mix__sliding_block__memory_aug_recurrent_mem_tr__prompt_kernel:
    s_cmp_ge_u32 s2, 256
    s_cbranch_scc1 .m_end
    s_load_dwordx2 s[8:9], s[0:1], 104
    s_load_dwordx2 s[12:13], s[0:1], 0
    s_load_dwordx2 s[16:17], s[0:1], 88
    s_load_dwordx2 s[20:21], s[0:1], 96
    v_lshrrev_b32 v1, 6, v0
    v_and_b32 v0, 63, v0
    v_readfirstlane_b32 s3, v1
    v_lshrrev_b32 v1, 4, v0
    v_and_b32 v2, 15, v0
    v_lshlrev_b32 v3, 4, v0
    s_getreg_b32 s4, hwreg(HW_REG_XCC_ID)
    s_and_b32 s4, s4, 15
    s_cmp_lg_u32 s4, 0
    s_cselect_b32 s4, 1, 2
    v_mov_b32 v14, 0
    s_waitcnt lgkmcnt(0)
    s_and_b32 s9, s9, 0xffff
    s_mov_b32 s10, 268435456
    s_mov_b32 s11, 0x00020000
    s_and_b32 s13, s13, 0xffff
    s_mov_b32 s14, 1835008
    s_mov_b32 s15, 0x00020000
    s_and_b32 s17, s17, 0xffff
    s_mov_b32 s18, 1835008
    s_mov_b32 s19, 0x00020000
    s_and_b32 s21, s21, 0xffff
    s_mov_b32 s22, 256
    s_mov_b32 s23, 0x00020000
    s_mov_b32 s33, 255
    s_cmp_lg_u32 s4, 2
    s_cbranch_scc1 .m_a0
    s_cmp_lg_u32 s3, 0
    s_cbranch_scc1 .m_a0
    v_mov_b32 v15, 1
    s_mov_b64 exec, 1
    buffer_atomic_add v15, v14, s[20:23], 0 offen offset:128 sc0
    s_mov_b64 exec, -1
    s_waitcnt vmcnt(0)
    v_readfirstlane_b32 s33, v15
.m_a0:
    s_lshl_b32 s100, s33, 8
    s_or_b32 s100, s100, s4
    s_mov_b32 s101, s33
    s_lshr_b32 s36, s2, 6
    s_lshl_b32 s37, s36, 3
    s_add_u32 s38, s0, s37
    s_addc_u32 s39, s1, 0
    s_load_dwordx2 s[32:33], s[38:39], 40
    s_bfe_u32 s37, s2, 0x30003
    s_lshl_b32 s37, s37, 2
    s_add_u32 s37, s37, s3
    s_and_b32 s38, s2, 7
    s_mul_i32 s39, s37, 114688
    s_lshl_b32 s40, s38, 10
    s_add_u32 s39, s39, s40
    s_mul_i32 s40, s38, 458752
    s_mul_i32 s41, s37, 14336
    s_add_u32 s40, s40, s41
    s_cmp_lt_u32 s36, 3
    s_cselect_b32 s39, s39, s40
    s_cselect_b32 s40, 13, 10
    s_lshl_b32 s41, 7, s40
    s_add_u32 s41, s41, s39
    v_lshrrev_b32 v4, 3, v0
    v_min_u32 v4, 6, v4
    v_lshlrev_b32 v4, s40, v4
    v_and_b32 v5, 7, v0
    v_lshl_add_u32 v4, v5, 7, v4
    s_waitcnt lgkmcnt(0)
    s_and_b32 s33, s33, 0xffff
    s_mov_b32 s34, 3670016
    s_mov_b32 s35, 0x00020000
    buffer_load_dword v240, v4, s[32:35], s39 offen
    buffer_load_dword v241, v4, s[32:35], s41 offen
    s_and_b32 s36, s2, 7
    s_lshr_b32 s37, s2, 3
    s_cmp_ge_u32 s37, 28
    s_cbranch_scc1 .pp_x
    s_mul_i32 s38, s37, 37
    s_lshr_b32 s38, s38, 8
    s_mul_i32 s6, s38, 7
    s_sub_u32 s6, s37, s6
    s_lshl_b32 s36, s36, 2
    s_add_u32 s36, s36, s38
    s_lshr_b32 s5, s36, 1
    s_and_b32 s7, s36, 1
    s_add_u32 s39, s36, 16
    s_mul_i32 s40, s36, 7
    s_add_u32 s40, s40, s6
    s_lshl_b32 s40, s40, 2
    s_add_u32 s40, s40, s3
    s_lshl_b32 s36, s7, 4
    s_add_u32 s36, s36, s0
    s_addc_u32 s37, s1, 0
    s_load_dwordx2 s[24:25], s[36:37], 40
    s_load_dwordx2 s[28:29], s[36:37], 48
    s_waitcnt lgkmcnt(0)
    s_and_b32 s25, s25, 0xffff
    s_mov_b32 s26, 3670016
    s_mov_b32 s27, 0x00020000
    s_and_b32 s29, s29, 0xffff
    s_mov_b32 s30, 3670016
    s_mov_b32 s31, 0x00020000
    v_lshrrev_b32 v7, 2, v0
    v_and_b32 v8, 3, v0
    v_xor_b32 v8, v8, v1
    v_lshlrev_b32 v8, 4, v8
    v_lshrrev_b32 v9, 2, v2
    v_xor_b32 v9, v9, v1
    v_lshl_add_u32 v9, v2, 2, v9
    v_lshlrev_b32 v9, 4, v9
    v_lshrrev_b32 v5, 3, v7
    v_lshlrev_b32 v4, 4, v5
    v_bfe_u32 v5, v7, 1, 1
    v_lshl_add_u32 v4, v5, 3, v4
    v_bfe_u32 v5, v7, 2, 1
    v_lshl_add_u32 v4, v5, 2, v4
    v_and_b32 v5, 1, v7
    v_add_u32 v4, v4, v5
    v_lshlrev_b32 v4, 13, v4
    v_add_u32 v4, v4, v8
    s_lshl_b32 s42, s5, 9
    s_lshl_b32 s43, s6, 19
    s_add_u32 s43, s43, s42
    s_lshr_b32 s44, s3, 1
    s_lshl_b32 s44, s44, 18
    s_add_u32 s43, s43, s44
    s_and_b32 s44, s3, 1
    s_lshl_b32 s44, s44, 14
    s_add_u32 s43, s43, s44
    s_lshl_b32 s44, s3, 10
    s_add_u32 s44, s44, 64
    v_add_u32 v10, s44, v3
    v_add_u32 v11, 64, v9
    s_mul_i32 s44, s3, 7168
    s_add_u32 s44, s44, 32832
    v_add_u32 v12, s44, v3
    v_add_u32 v13, s44, v9
    s_and_b32 s49, s6, 3
    s_lshl_b32 s49, s49, 7
    s_lshl_b32 s36, s6, 6
    s_cmp_lg_u32 s7, 0
    s_cselect_b32 s49, s36, s49
    s_mov_b32 s36, s49
    s_add_u32 s37, s43, s36
    buffer_load_dwordx4 a[224:227], v4, s[24:27], s37 offen
    s_add_u32 s36, s36, 64
    s_and_b32 s36, s36, 511
    s_add_u32 s37, s43, s36
    buffer_load_dwordx4 a[228:231], v4, s[24:27], s37 offen
    s_add_u32 s36, s36, 64
    s_and_b32 s36, s36, 511
    s_add_u32 s37, s43, s36
    buffer_load_dwordx4 a[232:235], v4, s[24:27], s37 offen
    s_add_u32 s36, s36, 64
    s_and_b32 s36, s36, 511
    s_add_u32 s37, s43, s36
    buffer_load_dwordx4 a[236:239], v4, s[24:27], s37 offen
    s_add_u32 s36, s36, 64
    s_and_b32 s36, s36, 511
    s_add_u32 s37, s43, s36
    buffer_load_dwordx4 a[240:243], v4, s[24:27], s37 offen
    s_add_u32 s36, s36, 64
    s_and_b32 s36, s36, 511
    s_add_u32 s37, s43, s36
    buffer_load_dwordx4 a[244:247], v4, s[24:27], s37 offen
    s_add_u32 s36, s36, 64
    s_and_b32 s36, s36, 511
    s_add_u32 s37, s43, s36
    buffer_load_dwordx4 a[248:251], v4, s[24:27], s37 offen
    s_add_u32 s36, s36, 64
    s_and_b32 s36, s36, 511
    s_add_u32 s37, s43, s36
    buffer_load_dwordx4 a[252:255], v4, s[24:27], s37 offen
    s_add_u32 s36, s36, 64
    s_and_b32 s36, s36, 511
    s_cmp_lg_u32 s7, 0
    s_cbranch_scc1 .pp_b
    v_lshrrev_b32 v5, 2, v7
    v_lshlrev_b32 v6, 4, v5
    v_and_b32 v5, 1, v7
    v_lshl_add_u32 v6, v5, 3, v6
    v_bfe_u32 v5, v7, 1, 1
    v_lshl_add_u32 v6, v5, 1, v6
    v_lshlrev_b32 v6, 13, v6
    v_add_u32 v6, v6, v8
    v_lshl_add_u32 v5, v7, 14, v8
    v_lshl_add_u32 v4, v7, 13, v8
    s_mul_i32 s43, s3, 917504
    s_add_u32 s43, s43, s42
    s_add_u32 s44, s43, s36
    s_add_u32 s36, s36, 128
    s_and_b32 s36, s36, 511
    s_add_u32 s37, s44, 0
    buffer_load_dwordx4 a[0:3], v6, s[28:31], s37 offen offset:0
    s_add_u32 s37, s44, 8192
    buffer_load_dwordx4 a[4:7], v6, s[28:31], s37 offen offset:0
    s_add_u32 s37, s44, 32768
    buffer_load_dwordx4 a[8:11], v6, s[28:31], s37 offen offset:0
    s_add_u32 s37, s44, 40960
    buffer_load_dwordx4 a[12:15], v6, s[28:31], s37 offen offset:0
    s_add_u32 s37, s44, 524288
    buffer_load_dwordx4 a[16:19], v5, s[28:31], s37 offen offset:0
    s_add_u32 s37, s44, 532480
    buffer_load_dwordx4 a[20:23], v5, s[28:31], s37 offen offset:0
    s_add_u32 s37, s44, 786432
    buffer_load_dwordx4 a[24:27], v4, s[28:31], s37 offen offset:0
    s_add_u32 s37, s44, 0
    buffer_load_dwordx4 a[28:31], v6, s[28:31], s37 offen offset:64
    s_add_u32 s37, s44, 8192
    buffer_load_dwordx4 a[32:35], v6, s[28:31], s37 offen offset:64
    s_add_u32 s37, s44, 32768
    buffer_load_dwordx4 a[36:39], v6, s[28:31], s37 offen offset:64
    s_add_u32 s37, s44, 40960
    buffer_load_dwordx4 a[40:43], v6, s[28:31], s37 offen offset:64
    s_add_u32 s37, s44, 524288
    buffer_load_dwordx4 a[44:47], v5, s[28:31], s37 offen offset:64
    s_add_u32 s37, s44, 532480
    buffer_load_dwordx4 a[48:51], v5, s[28:31], s37 offen offset:64
    s_add_u32 s37, s44, 786432
    buffer_load_dwordx4 a[52:55], v4, s[28:31], s37 offen offset:64
    s_add_u32 s44, s43, s36
    s_add_u32 s36, s36, 128
    s_and_b32 s36, s36, 511
    s_add_u32 s37, s44, 0
    buffer_load_dwordx4 a[56:59], v6, s[28:31], s37 offen offset:0
    s_add_u32 s37, s44, 8192
    buffer_load_dwordx4 a[60:63], v6, s[28:31], s37 offen offset:0
    s_add_u32 s37, s44, 32768
    buffer_load_dwordx4 a[64:67], v6, s[28:31], s37 offen offset:0
    s_add_u32 s37, s44, 40960
    buffer_load_dwordx4 a[68:71], v6, s[28:31], s37 offen offset:0
    s_add_u32 s37, s44, 524288
    buffer_load_dwordx4 a[72:75], v5, s[28:31], s37 offen offset:0
    s_add_u32 s37, s44, 532480
    buffer_load_dwordx4 a[76:79], v5, s[28:31], s37 offen offset:0
    s_add_u32 s37, s44, 786432
    buffer_load_dwordx4 a[80:83], v4, s[28:31], s37 offen offset:0
    s_waitcnt vmcnt(21)
    ds_write_b128 v10, a[224:227] offset:0
    ds_write_b128 v10, a[228:231] offset:4096
    ds_write_b128 v10, a[232:235] offset:8192
    ds_write_b128 v10, a[236:239] offset:12288
    ds_write_b128 v10, a[240:243] offset:16384
    ds_write_b128 v10, a[244:247] offset:20480
    ds_write_b128 v10, a[248:251] offset:24576
    ds_write_b128 v10, a[252:255] offset:28672
    s_waitcnt lgkmcnt(0)
    s_barrier
    s_add_u32 s37, s44, 0
    buffer_load_dwordx4 a[84:87], v6, s[28:31], s37 offen offset:64
    s_add_u32 s37, s44, 8192
    buffer_load_dwordx4 a[88:91], v6, s[28:31], s37 offen offset:64
    s_add_u32 s37, s44, 32768
    buffer_load_dwordx4 a[92:95], v6, s[28:31], s37 offen offset:64
    s_add_u32 s37, s44, 40960
    buffer_load_dwordx4 a[96:99], v6, s[28:31], s37 offen offset:64
    s_add_u32 s37, s44, 524288
    buffer_load_dwordx4 a[100:103], v5, s[28:31], s37 offen offset:64
    s_add_u32 s37, s44, 532480
    buffer_load_dwordx4 a[104:107], v5, s[28:31], s37 offen offset:64
    s_add_u32 s37, s44, 786432
    buffer_load_dwordx4 a[108:111], v4, s[28:31], s37 offen offset:64
    s_waitcnt vmcnt(21)
    ds_write_b128 v12, a[0:3] offset:0
    ds_write_b128 v12, a[4:7] offset:1024
    ds_write_b128 v12, a[8:11] offset:2048
    ds_write_b128 v12, a[12:15] offset:3072
    ds_write_b128 v12, a[16:19] offset:4096
    ds_write_b128 v12, a[20:23] offset:5120
    ds_write_b128 v12, a[24:27] offset:6144
    ds_read_b128 a[224:227], v11 offset:0
    ds_read_b128 a[228:231], v11 offset:1024
    ds_read_b128 a[232:235], v11 offset:2048
    ds_read_b128 a[236:239], v11 offset:3072
    ds_read_b128 a[0:3], v13 offset:0
    ds_read_b128 a[4:7], v13 offset:1024
    ds_read_b128 a[8:11], v13 offset:2048
    ds_read_b128 a[12:15], v13 offset:3072
    ds_read_b128 a[16:19], v13 offset:4096
    ds_read_b128 a[20:23], v13 offset:5120
    ds_read_b128 a[24:27], v13 offset:6144
    s_waitcnt lgkmcnt(0)
    v_mfma_f32_16x16x32_bf16 v[16:19], a[224:227], a[0:3], 0
    s_add_u32 s44, s43, s36
    s_add_u32 s36, s36, 128
    s_and_b32 s36, s36, 511
    v_mfma_f32_16x16x32_bf16 v[20:23], a[228:231], a[0:3], 0
    s_add_u32 s37, s44, 0
    buffer_load_dwordx4 a[112:115], v6, s[28:31], s37 offen offset:0
    v_mfma_f32_16x16x32_bf16 v[24:27], a[232:235], a[0:3], 0
    s_add_u32 s37, s44, 8192
    buffer_load_dwordx4 a[116:119], v6, s[28:31], s37 offen offset:0
    v_mfma_f32_16x16x32_bf16 v[28:31], a[236:239], a[0:3], 0
    s_add_u32 s37, s44, 32768
    buffer_load_dwordx4 a[120:123], v6, s[28:31], s37 offen offset:0
    v_mfma_f32_16x16x32_bf16 v[32:35], a[224:227], a[4:7], 0
    s_add_u32 s37, s44, 40960
    buffer_load_dwordx4 a[124:127], v6, s[28:31], s37 offen offset:0
    v_mfma_f32_16x16x32_bf16 v[36:39], a[228:231], a[4:7], 0
    s_add_u32 s37, s44, 524288
    buffer_load_dwordx4 a[128:131], v5, s[28:31], s37 offen offset:0
    v_mfma_f32_16x16x32_bf16 v[40:43], a[232:235], a[4:7], 0
    s_add_u32 s37, s44, 532480
    buffer_load_dwordx4 a[132:135], v5, s[28:31], s37 offen offset:0
    v_mfma_f32_16x16x32_bf16 v[44:47], a[236:239], a[4:7], 0
    s_add_u32 s37, s44, 786432
    buffer_load_dwordx4 a[136:139], v4, s[28:31], s37 offen offset:0
    v_mfma_f32_16x16x32_bf16 v[48:51], a[224:227], a[8:11], 0
    s_waitcnt vmcnt(21)
    v_mfma_f32_16x16x32_bf16 v[52:55], a[228:231], a[8:11], 0
    ds_write_b128 v12, a[28:31] offset:0
    v_mfma_f32_16x16x32_bf16 v[56:59], a[232:235], a[8:11], 0
    ds_write_b128 v12, a[32:35] offset:1024
    v_mfma_f32_16x16x32_bf16 v[60:63], a[236:239], a[8:11], 0
    ds_write_b128 v12, a[36:39] offset:2048
    v_mfma_f32_16x16x32_bf16 v[64:67], a[224:227], a[12:15], 0
    ds_write_b128 v12, a[40:43] offset:3072
    v_mfma_f32_16x16x32_bf16 v[68:71], a[228:231], a[12:15], 0
    ds_write_b128 v12, a[44:47] offset:4096
    v_mfma_f32_16x16x32_bf16 v[72:75], a[232:235], a[12:15], 0
    ds_write_b128 v12, a[48:51] offset:5120
    v_mfma_f32_16x16x32_bf16 v[76:79], a[236:239], a[12:15], 0
    ds_write_b128 v12, a[52:55] offset:6144
    v_mfma_f32_16x16x32_bf16 v[80:83], a[224:227], a[16:19], 0
    ds_read_b128 a[240:243], v11 offset:4096
    v_mfma_f32_16x16x32_bf16 v[84:87], a[228:231], a[16:19], 0
    ds_read_b128 a[244:247], v11 offset:5120
    v_mfma_f32_16x16x32_bf16 v[88:91], a[232:235], a[16:19], 0
    ds_read_b128 a[248:251], v11 offset:6144
    v_mfma_f32_16x16x32_bf16 v[92:95], a[236:239], a[16:19], 0
    ds_read_b128 a[252:255], v11 offset:7168
    v_mfma_f32_16x16x32_bf16 v[96:99], a[224:227], a[20:23], 0
    ds_read_b128 a[28:31], v13 offset:0
    v_mfma_f32_16x16x32_bf16 v[100:103], a[228:231], a[20:23], 0
    ds_read_b128 a[32:35], v13 offset:1024
    v_mfma_f32_16x16x32_bf16 v[104:107], a[232:235], a[20:23], 0
    ds_read_b128 a[36:39], v13 offset:2048
    v_mfma_f32_16x16x32_bf16 v[108:111], a[236:239], a[20:23], 0
    ds_read_b128 a[40:43], v13 offset:3072
    v_mfma_f32_16x16x32_bf16 v[112:115], a[224:227], a[24:27], 0
    ds_read_b128 a[44:47], v13 offset:4096
    v_mfma_f32_16x16x32_bf16 v[116:119], a[228:231], a[24:27], 0
    ds_read_b128 a[48:51], v13 offset:5120
    v_mfma_f32_16x16x32_bf16 v[120:123], a[232:235], a[24:27], 0
    ds_read_b128 a[52:55], v13 offset:6144
    v_mfma_f32_16x16x32_bf16 v[124:127], a[236:239], a[24:27], 0
    s_waitcnt lgkmcnt(0)
    v_mfma_f32_16x16x32_bf16 v[16:19], a[240:243], a[28:31], v[16:19]
    s_add_u32 s37, s44, 0
    buffer_load_dwordx4 a[140:143], v6, s[28:31], s37 offen offset:64
    v_mfma_f32_16x16x32_bf16 v[20:23], a[244:247], a[28:31], v[20:23]
    s_add_u32 s37, s44, 8192
    buffer_load_dwordx4 a[144:147], v6, s[28:31], s37 offen offset:64
    v_mfma_f32_16x16x32_bf16 v[24:27], a[248:251], a[28:31], v[24:27]
    s_add_u32 s37, s44, 32768
    buffer_load_dwordx4 a[148:151], v6, s[28:31], s37 offen offset:64
    v_mfma_f32_16x16x32_bf16 v[28:31], a[252:255], a[28:31], v[28:31]
    s_add_u32 s37, s44, 40960
    buffer_load_dwordx4 a[152:155], v6, s[28:31], s37 offen offset:64
    v_mfma_f32_16x16x32_bf16 v[32:35], a[240:243], a[32:35], v[32:35]
    s_add_u32 s37, s44, 524288
    buffer_load_dwordx4 a[156:159], v5, s[28:31], s37 offen offset:64
    v_mfma_f32_16x16x32_bf16 v[36:39], a[244:247], a[32:35], v[36:39]
    s_add_u32 s37, s44, 532480
    buffer_load_dwordx4 a[160:163], v5, s[28:31], s37 offen offset:64
    v_mfma_f32_16x16x32_bf16 v[40:43], a[248:251], a[32:35], v[40:43]
    s_add_u32 s37, s44, 786432
    buffer_load_dwordx4 a[164:167], v4, s[28:31], s37 offen offset:64
    v_mfma_f32_16x16x32_bf16 v[44:47], a[252:255], a[32:35], v[44:47]
    s_waitcnt vmcnt(21)
    v_mfma_f32_16x16x32_bf16 v[48:51], a[240:243], a[36:39], v[48:51]
    ds_write_b128 v12, a[56:59] offset:0
    v_mfma_f32_16x16x32_bf16 v[52:55], a[244:247], a[36:39], v[52:55]
    ds_write_b128 v12, a[60:63] offset:1024
    v_mfma_f32_16x16x32_bf16 v[56:59], a[248:251], a[36:39], v[56:59]
    ds_write_b128 v12, a[64:67] offset:2048
    v_mfma_f32_16x16x32_bf16 v[60:63], a[252:255], a[36:39], v[60:63]
    ds_write_b128 v12, a[68:71] offset:3072
    v_mfma_f32_16x16x32_bf16 v[64:67], a[240:243], a[40:43], v[64:67]
    ds_write_b128 v12, a[72:75] offset:4096
    v_mfma_f32_16x16x32_bf16 v[68:71], a[244:247], a[40:43], v[68:71]
    ds_write_b128 v12, a[76:79] offset:5120
    v_mfma_f32_16x16x32_bf16 v[72:75], a[248:251], a[40:43], v[72:75]
    ds_write_b128 v12, a[80:83] offset:6144
    v_mfma_f32_16x16x32_bf16 v[76:79], a[252:255], a[40:43], v[76:79]
    ds_read_b128 a[224:227], v11 offset:8192
    v_mfma_f32_16x16x32_bf16 v[80:83], a[240:243], a[44:47], v[80:83]
    ds_read_b128 a[228:231], v11 offset:9216
    v_mfma_f32_16x16x32_bf16 v[84:87], a[244:247], a[44:47], v[84:87]
    ds_read_b128 a[232:235], v11 offset:10240
    v_mfma_f32_16x16x32_bf16 v[88:91], a[248:251], a[44:47], v[88:91]
    ds_read_b128 a[236:239], v11 offset:11264
    v_mfma_f32_16x16x32_bf16 v[92:95], a[252:255], a[44:47], v[92:95]
    ds_read_b128 a[56:59], v13 offset:0
    v_mfma_f32_16x16x32_bf16 v[96:99], a[240:243], a[48:51], v[96:99]
    ds_read_b128 a[60:63], v13 offset:1024
    v_mfma_f32_16x16x32_bf16 v[100:103], a[244:247], a[48:51], v[100:103]
    ds_read_b128 a[64:67], v13 offset:2048
    v_mfma_f32_16x16x32_bf16 v[104:107], a[248:251], a[48:51], v[104:107]
    ds_read_b128 a[68:71], v13 offset:3072
    v_mfma_f32_16x16x32_bf16 v[108:111], a[252:255], a[48:51], v[108:111]
    ds_read_b128 a[72:75], v13 offset:4096
    v_mfma_f32_16x16x32_bf16 v[112:115], a[240:243], a[52:55], v[112:115]
    ds_read_b128 a[76:79], v13 offset:5120
    v_mfma_f32_16x16x32_bf16 v[116:119], a[244:247], a[52:55], v[116:119]
    ds_read_b128 a[80:83], v13 offset:6144
    v_mfma_f32_16x16x32_bf16 v[120:123], a[248:251], a[52:55], v[120:123]
    v_mfma_f32_16x16x32_bf16 v[124:127], a[252:255], a[52:55], v[124:127]
    s_waitcnt lgkmcnt(0)
    v_mfma_f32_16x16x32_bf16 v[16:19], a[224:227], a[56:59], v[16:19]
    s_add_u32 s44, s43, s36
    s_add_u32 s36, s36, 128
    s_and_b32 s36, s36, 511
    v_mfma_f32_16x16x32_bf16 v[20:23], a[228:231], a[56:59], v[20:23]
    s_add_u32 s37, s44, 0
    buffer_load_dwordx4 a[168:171], v6, s[28:31], s37 offen offset:0
    v_mfma_f32_16x16x32_bf16 v[24:27], a[232:235], a[56:59], v[24:27]
    s_add_u32 s37, s44, 8192
    buffer_load_dwordx4 a[172:175], v6, s[28:31], s37 offen offset:0
    v_mfma_f32_16x16x32_bf16 v[28:31], a[236:239], a[56:59], v[28:31]
    s_add_u32 s37, s44, 32768
    buffer_load_dwordx4 a[176:179], v6, s[28:31], s37 offen offset:0
    v_mfma_f32_16x16x32_bf16 v[32:35], a[224:227], a[60:63], v[32:35]
    s_add_u32 s37, s44, 40960
    buffer_load_dwordx4 a[180:183], v6, s[28:31], s37 offen offset:0
    v_mfma_f32_16x16x32_bf16 v[36:39], a[228:231], a[60:63], v[36:39]
    s_add_u32 s37, s44, 524288
    buffer_load_dwordx4 a[184:187], v5, s[28:31], s37 offen offset:0
    v_mfma_f32_16x16x32_bf16 v[40:43], a[232:235], a[60:63], v[40:43]
    s_add_u32 s37, s44, 532480
    buffer_load_dwordx4 a[188:191], v5, s[28:31], s37 offen offset:0
    v_mfma_f32_16x16x32_bf16 v[44:47], a[236:239], a[60:63], v[44:47]
    s_add_u32 s37, s44, 786432
    buffer_load_dwordx4 a[192:195], v4, s[28:31], s37 offen offset:0
    v_mfma_f32_16x16x32_bf16 v[48:51], a[224:227], a[64:67], v[48:51]
    s_waitcnt vmcnt(21)
    v_mfma_f32_16x16x32_bf16 v[52:55], a[228:231], a[64:67], v[52:55]
    ds_write_b128 v12, a[84:87] offset:0
    v_mfma_f32_16x16x32_bf16 v[56:59], a[232:235], a[64:67], v[56:59]
    ds_write_b128 v12, a[88:91] offset:1024
    v_mfma_f32_16x16x32_bf16 v[60:63], a[236:239], a[64:67], v[60:63]
    ds_write_b128 v12, a[92:95] offset:2048
    v_mfma_f32_16x16x32_bf16 v[64:67], a[224:227], a[68:71], v[64:67]
    ds_write_b128 v12, a[96:99] offset:3072
    v_mfma_f32_16x16x32_bf16 v[68:71], a[228:231], a[68:71], v[68:71]
    ds_write_b128 v12, a[100:103] offset:4096
    v_mfma_f32_16x16x32_bf16 v[72:75], a[232:235], a[68:71], v[72:75]
    ds_write_b128 v12, a[104:107] offset:5120
    v_mfma_f32_16x16x32_bf16 v[76:79], a[236:239], a[68:71], v[76:79]
    ds_write_b128 v12, a[108:111] offset:6144
    v_mfma_f32_16x16x32_bf16 v[80:83], a[224:227], a[72:75], v[80:83]
    ds_read_b128 a[240:243], v11 offset:12288
    v_mfma_f32_16x16x32_bf16 v[84:87], a[228:231], a[72:75], v[84:87]
    ds_read_b128 a[244:247], v11 offset:13312
    v_mfma_f32_16x16x32_bf16 v[88:91], a[232:235], a[72:75], v[88:91]
    ds_read_b128 a[248:251], v11 offset:14336
    v_mfma_f32_16x16x32_bf16 v[92:95], a[236:239], a[72:75], v[92:95]
    ds_read_b128 a[252:255], v11 offset:15360
    v_mfma_f32_16x16x32_bf16 v[96:99], a[224:227], a[76:79], v[96:99]
    ds_read_b128 a[84:87], v13 offset:0
    v_mfma_f32_16x16x32_bf16 v[100:103], a[228:231], a[76:79], v[100:103]
    ds_read_b128 a[88:91], v13 offset:1024
    v_mfma_f32_16x16x32_bf16 v[104:107], a[232:235], a[76:79], v[104:107]
    ds_read_b128 a[92:95], v13 offset:2048
    v_mfma_f32_16x16x32_bf16 v[108:111], a[236:239], a[76:79], v[108:111]
    ds_read_b128 a[96:99], v13 offset:3072
    v_mfma_f32_16x16x32_bf16 v[112:115], a[224:227], a[80:83], v[112:115]
    ds_read_b128 a[100:103], v13 offset:4096
    v_mfma_f32_16x16x32_bf16 v[116:119], a[228:231], a[80:83], v[116:119]
    ds_read_b128 a[104:107], v13 offset:5120
    v_mfma_f32_16x16x32_bf16 v[120:123], a[232:235], a[80:83], v[120:123]
    ds_read_b128 a[108:111], v13 offset:6144
    v_mfma_f32_16x16x32_bf16 v[124:127], a[236:239], a[80:83], v[124:127]
    s_waitcnt lgkmcnt(0)
    v_mfma_f32_16x16x32_bf16 v[16:19], a[240:243], a[84:87], v[16:19]
    s_add_u32 s37, s44, 0
    buffer_load_dwordx4 a[196:199], v6, s[28:31], s37 offen offset:64
    v_mfma_f32_16x16x32_bf16 v[20:23], a[244:247], a[84:87], v[20:23]
    s_add_u32 s37, s44, 8192
    buffer_load_dwordx4 a[200:203], v6, s[28:31], s37 offen offset:64
    v_mfma_f32_16x16x32_bf16 v[24:27], a[248:251], a[84:87], v[24:27]
    s_add_u32 s37, s44, 32768
    buffer_load_dwordx4 a[204:207], v6, s[28:31], s37 offen offset:64
    v_mfma_f32_16x16x32_bf16 v[28:31], a[252:255], a[84:87], v[28:31]
    s_add_u32 s37, s44, 40960
    buffer_load_dwordx4 a[208:211], v6, s[28:31], s37 offen offset:64
    v_mfma_f32_16x16x32_bf16 v[32:35], a[240:243], a[88:91], v[32:35]
    s_add_u32 s37, s44, 524288
    buffer_load_dwordx4 a[212:215], v5, s[28:31], s37 offen offset:64
    v_mfma_f32_16x16x32_bf16 v[36:39], a[244:247], a[88:91], v[36:39]
    s_add_u32 s37, s44, 532480
    buffer_load_dwordx4 a[216:219], v5, s[28:31], s37 offen offset:64
    v_mfma_f32_16x16x32_bf16 v[40:43], a[248:251], a[88:91], v[40:43]
    s_add_u32 s37, s44, 786432
    buffer_load_dwordx4 a[220:223], v4, s[28:31], s37 offen offset:64
    v_mfma_f32_16x16x32_bf16 v[44:47], a[252:255], a[88:91], v[44:47]
    s_waitcnt vmcnt(21)
    v_mfma_f32_16x16x32_bf16 v[48:51], a[240:243], a[92:95], v[48:51]
    ds_write_b128 v12, a[112:115] offset:0
    v_mfma_f32_16x16x32_bf16 v[52:55], a[244:247], a[92:95], v[52:55]
    ds_write_b128 v12, a[116:119] offset:1024
    v_mfma_f32_16x16x32_bf16 v[56:59], a[248:251], a[92:95], v[56:59]
    ds_write_b128 v12, a[120:123] offset:2048
    v_mfma_f32_16x16x32_bf16 v[60:63], a[252:255], a[92:95], v[60:63]
    ds_write_b128 v12, a[124:127] offset:3072
    v_mfma_f32_16x16x32_bf16 v[64:67], a[240:243], a[96:99], v[64:67]
    ds_write_b128 v12, a[128:131] offset:4096
    v_mfma_f32_16x16x32_bf16 v[68:71], a[244:247], a[96:99], v[68:71]
    ds_write_b128 v12, a[132:135] offset:5120
    v_mfma_f32_16x16x32_bf16 v[72:75], a[248:251], a[96:99], v[72:75]
    ds_write_b128 v12, a[136:139] offset:6144
    v_mfma_f32_16x16x32_bf16 v[76:79], a[252:255], a[96:99], v[76:79]
    ds_read_b128 a[224:227], v11 offset:16384
    v_mfma_f32_16x16x32_bf16 v[80:83], a[240:243], a[100:103], v[80:83]
    ds_read_b128 a[228:231], v11 offset:17408
    v_mfma_f32_16x16x32_bf16 v[84:87], a[244:247], a[100:103], v[84:87]
    ds_read_b128 a[232:235], v11 offset:18432
    v_mfma_f32_16x16x32_bf16 v[88:91], a[248:251], a[100:103], v[88:91]
    ds_read_b128 a[236:239], v11 offset:19456
    v_mfma_f32_16x16x32_bf16 v[92:95], a[252:255], a[100:103], v[92:95]
    ds_read_b128 a[112:115], v13 offset:0
    v_mfma_f32_16x16x32_bf16 v[96:99], a[240:243], a[104:107], v[96:99]
    ds_read_b128 a[116:119], v13 offset:1024
    v_mfma_f32_16x16x32_bf16 v[100:103], a[244:247], a[104:107], v[100:103]
    ds_read_b128 a[120:123], v13 offset:2048
    v_mfma_f32_16x16x32_bf16 v[104:107], a[248:251], a[104:107], v[104:107]
    ds_read_b128 a[124:127], v13 offset:3072
    v_mfma_f32_16x16x32_bf16 v[108:111], a[252:255], a[104:107], v[108:111]
    ds_read_b128 a[128:131], v13 offset:4096
    v_mfma_f32_16x16x32_bf16 v[112:115], a[240:243], a[108:111], v[112:115]
    ds_read_b128 a[132:135], v13 offset:5120
    v_mfma_f32_16x16x32_bf16 v[116:119], a[244:247], a[108:111], v[116:119]
    ds_read_b128 a[136:139], v13 offset:6144
    v_mfma_f32_16x16x32_bf16 v[120:123], a[248:251], a[108:111], v[120:123]
    v_mfma_f32_16x16x32_bf16 v[124:127], a[252:255], a[108:111], v[124:127]
    v_mov_b32 v240, 0
    v_mov_b32 v241, 0
    v_mov_b32 v242, 0
    v_mov_b32 v243, 0
    v_mov_b32 v244, 0
    v_mov_b32 v245, 0
    v_mov_b32 v246, 0
    v_mov_b32 v247, 0
    v_mov_b32 v248, 0
    v_mov_b32 v249, 0
    v_mov_b32 v250, 0
    v_mov_b32 v251, 0
    v_mov_b32 v252, 0
    v_mov_b32 v253, 0
    v_mov_b32 v254, 0
    v_mov_b32 v255, 0
    s_cmp_ge_u32 s40, 672
    s_cbranch_scc1 .ppo_1
    s_load_dwordx2 s[32:33], s[0:1], 8
    s_mul_i32 s42, s40, 293
    s_lshr_b32 s42, s42, 11
    s_mul_i32 s43, s42, 7
    s_sub_u32 s43, s40, s43
    s_mul_i32 s44, s42, 43
    s_lshr_b32 s44, s44, 8
    s_mul_i32 s45, s44, 6
    s_sub_u32 s45, s42, s45
    s_lshr_b32 s46, s45, 1
    s_mul_i32 s46, s46, 896
    s_mul_i32 s47, s44, 56
    s_add_u32 s46, s46, s47
    s_and_b32 s47, s45, 1
    s_lshl_b32 s48, s47, 5
    s_add_u32 s46, s46, s48
    s_mul_i32 s48, s43, 172032
    s_add_u32 s46, s46, s48
    v_lshrrev_b32 v5, 1, v1
    v_lshlrev_b32 v5, 4, v5
    v_and_b32 v6, 1, v1
    v_lshl_add_u32 v5, v6, 2, v5
    v_mul_u32_u24 v5, 2688, v5
    v_lshl_add_u32 v5, v2, 1, v5
    s_lshl_b32 s48, s47, 4
    v_add_u32 v6, s48, v2
    s_lshl_b32 s41, s40, 11
    s_add_u32 s41, s41, 14680064
    s_waitcnt lgkmcnt(0)
    s_and_b32 s33, s33, 0xffff
    s_mov_b32 s34, 1204224
    s_mov_b32 s35, 0x00020000
    v_cmp_gt_u32 vcc, 28, v6
    s_and_saveexec_b64 s[50:51], vcc
    s_add_u32 s48, s46, 0
    buffer_load_ushort v240, v5, s[32:35], s48 offen
    s_add_u32 s48, s46, 2688
    buffer_load_ushort v241, v5, s[32:35], s48 offen
    s_add_u32 s48, s46, 21504
    buffer_load_ushort v242, v5, s[32:35], s48 offen
    s_add_u32 s48, s46, 24192
    buffer_load_ushort v243, v5, s[32:35], s48 offen
    s_add_u32 s48, s46, 5376
    buffer_load_ushort v244, v5, s[32:35], s48 offen
    s_add_u32 s48, s46, 8064
    buffer_load_ushort v245, v5, s[32:35], s48 offen
    s_add_u32 s48, s46, 26880
    buffer_load_ushort v246, v5, s[32:35], s48 offen
    s_add_u32 s48, s46, 29568
    buffer_load_ushort v247, v5, s[32:35], s48 offen
    s_add_u32 s48, s46, 86016
    buffer_load_ushort v248, v5, s[32:35], s48 offen
    s_add_u32 s48, s46, 88704
    buffer_load_ushort v249, v5, s[32:35], s48 offen
    s_add_u32 s48, s46, 107520
    buffer_load_ushort v250, v5, s[32:35], s48 offen
    s_add_u32 s48, s46, 110208
    buffer_load_ushort v251, v5, s[32:35], s48 offen
    s_add_u32 s48, s46, 91392
    buffer_load_ushort v252, v5, s[32:35], s48 offen
    s_add_u32 s48, s46, 94080
    buffer_load_ushort v253, v5, s[32:35], s48 offen
    s_add_u32 s48, s46, 112896
    buffer_load_ushort v254, v5, s[32:35], s48 offen
    s_add_u32 s48, s46, 115584
    buffer_load_ushort v255, v5, s[32:35], s48 offen
    s_mov_b64 exec, s[50:51]
    s_branch .pps_2
.ppo_1:
    s_load_dwordx2 s[32:33], s[0:1], 16
    s_sub_u32 s40, s40, 672
    s_mul_i32 s42, s40, 293
    s_lshr_b32 s42, s42, 12
    s_mul_i32 s43, s42, 14
    s_sub_u32 s43, s40, s43
    s_mul_i32 s46, s42, 25088
    s_lshl_b32 s47, s43, 6
    s_add_u32 s46, s46, s47
    v_lshrrev_b32 v5, 2, v2
    v_lshlrev_b32 v5, 3, v5
    v_and_b32 v6, 3, v2
    v_add_u32 v5, v5, v6
    v_lshlrev_b32 v5, 1, v5
    v_mul_u32_u24 v6, 3584, v1
    v_add_u32 v5, v5, v6
    s_lshl_b32 s41, s40, 11
    s_add_u32 s41, s41, 16056320
    s_waitcnt lgkmcnt(0)
    s_and_b32 s33, s33, 0xffff
    s_mov_b32 s34, 401408
    s_mov_b32 s35, 0x00020000
    s_add_u32 s48, s46, 0
    buffer_load_ushort v240, v5, s[32:35], s48 offen offset:0
    s_add_u32 s48, s46, 896
    buffer_load_ushort v241, v5, s[32:35], s48 offen offset:0
    s_add_u32 s48, s46, 1792
    buffer_load_ushort v242, v5, s[32:35], s48 offen offset:0
    s_add_u32 s48, s46, 2688
    buffer_load_ushort v243, v5, s[32:35], s48 offen offset:0
    s_add_u32 s48, s46, 0
    buffer_load_ushort v248, v5, s[32:35], s48 offen offset:8
    s_add_u32 s48, s46, 896
    buffer_load_ushort v249, v5, s[32:35], s48 offen offset:8
    s_add_u32 s48, s46, 1792
    buffer_load_ushort v250, v5, s[32:35], s48 offen offset:8
    s_add_u32 s48, s46, 2688
    buffer_load_ushort v251, v5, s[32:35], s48 offen offset:8
    v_cmp_gt_u32 vcc, 3, v1
    s_and_saveexec_b64 s[50:51], vcc
    s_add_u32 s48, s46, 14336
    buffer_load_ushort v244, v5, s[32:35], s48 offen offset:0
    s_add_u32 s48, s46, 15232
    buffer_load_ushort v245, v5, s[32:35], s48 offen offset:0
    s_add_u32 s48, s46, 16128
    buffer_load_ushort v246, v5, s[32:35], s48 offen offset:0
    s_add_u32 s48, s46, 17024
    buffer_load_ushort v247, v5, s[32:35], s48 offen offset:0
    s_add_u32 s48, s46, 14336
    buffer_load_ushort v252, v5, s[32:35], s48 offen offset:8
    s_add_u32 s48, s46, 15232
    buffer_load_ushort v253, v5, s[32:35], s48 offen offset:8
    s_add_u32 s48, s46, 16128
    buffer_load_ushort v254, v5, s[32:35], s48 offen offset:8
    s_add_u32 s48, s46, 17024
    buffer_load_ushort v255, v5, s[32:35], s48 offen offset:8
    s_mov_b64 exec, s[50:51]
.pps_2:
    s_waitcnt lgkmcnt(0)
    v_mfma_f32_16x16x32_bf16 v[16:19], a[224:227], a[112:115], v[16:19]
    s_waitcnt vmcnt(30)
    v_mfma_f32_16x16x32_bf16 v[20:23], a[228:231], a[112:115], v[20:23]
    ds_write_b128 v12, a[140:143] offset:0
    v_mfma_f32_16x16x32_bf16 v[24:27], a[232:235], a[112:115], v[24:27]
    ds_write_b128 v12, a[144:147] offset:1024
    v_mfma_f32_16x16x32_bf16 v[28:31], a[236:239], a[112:115], v[28:31]
    ds_write_b128 v12, a[148:151] offset:2048
    v_mfma_f32_16x16x32_bf16 v[32:35], a[224:227], a[116:119], v[32:35]
    ds_write_b128 v12, a[152:155] offset:3072
    v_mfma_f32_16x16x32_bf16 v[36:39], a[228:231], a[116:119], v[36:39]
    ds_write_b128 v12, a[156:159] offset:4096
    v_mfma_f32_16x16x32_bf16 v[40:43], a[232:235], a[116:119], v[40:43]
    ds_write_b128 v12, a[160:163] offset:5120
    v_mfma_f32_16x16x32_bf16 v[44:47], a[236:239], a[116:119], v[44:47]
    ds_write_b128 v12, a[164:167] offset:6144
    v_mfma_f32_16x16x32_bf16 v[48:51], a[224:227], a[120:123], v[48:51]
    ds_read_b128 a[240:243], v11 offset:20480
    v_mfma_f32_16x16x32_bf16 v[52:55], a[228:231], a[120:123], v[52:55]
    ds_read_b128 a[244:247], v11 offset:21504
    v_mfma_f32_16x16x32_bf16 v[56:59], a[232:235], a[120:123], v[56:59]
    ds_read_b128 a[248:251], v11 offset:22528
    v_mfma_f32_16x16x32_bf16 v[60:63], a[236:239], a[120:123], v[60:63]
    ds_read_b128 a[252:255], v11 offset:23552
    v_mfma_f32_16x16x32_bf16 v[64:67], a[224:227], a[124:127], v[64:67]
    ds_read_b128 a[140:143], v13 offset:0
    v_mfma_f32_16x16x32_bf16 v[68:71], a[228:231], a[124:127], v[68:71]
    ds_read_b128 a[144:147], v13 offset:1024
    v_mfma_f32_16x16x32_bf16 v[72:75], a[232:235], a[124:127], v[72:75]
    ds_read_b128 a[148:151], v13 offset:2048
    v_mfma_f32_16x16x32_bf16 v[76:79], a[236:239], a[124:127], v[76:79]
    ds_read_b128 a[152:155], v13 offset:3072
    v_mfma_f32_16x16x32_bf16 v[80:83], a[224:227], a[128:131], v[80:83]
    ds_read_b128 a[156:159], v13 offset:4096
    v_mfma_f32_16x16x32_bf16 v[84:87], a[228:231], a[128:131], v[84:87]
    ds_read_b128 a[160:163], v13 offset:5120
    v_mfma_f32_16x16x32_bf16 v[88:91], a[232:235], a[128:131], v[88:91]
    ds_read_b128 a[164:167], v13 offset:6144
    v_mfma_f32_16x16x32_bf16 v[92:95], a[236:239], a[128:131], v[92:95]
    v_mfma_f32_16x16x32_bf16 v[96:99], a[224:227], a[132:135], v[96:99]
    v_mfma_f32_16x16x32_bf16 v[100:103], a[228:231], a[132:135], v[100:103]
    v_mfma_f32_16x16x32_bf16 v[104:107], a[232:235], a[132:135], v[104:107]
    v_mfma_f32_16x16x32_bf16 v[108:111], a[236:239], a[132:135], v[108:111]
    v_mfma_f32_16x16x32_bf16 v[112:115], a[224:227], a[136:139], v[112:115]
    v_mfma_f32_16x16x32_bf16 v[116:119], a[228:231], a[136:139], v[116:119]
    v_mfma_f32_16x16x32_bf16 v[120:123], a[232:235], a[136:139], v[120:123]
    v_mfma_f32_16x16x32_bf16 v[124:127], a[236:239], a[136:139], v[124:127]
    s_waitcnt lgkmcnt(0)
    v_mfma_f32_16x16x32_bf16 v[16:19], a[240:243], a[140:143], v[16:19]
    s_waitcnt vmcnt(23)
    v_mfma_f32_16x16x32_bf16 v[20:23], a[244:247], a[140:143], v[20:23]
    ds_write_b128 v12, a[168:171] offset:0
    v_mfma_f32_16x16x32_bf16 v[24:27], a[248:251], a[140:143], v[24:27]
    ds_write_b128 v12, a[172:175] offset:1024
    v_mfma_f32_16x16x32_bf16 v[28:31], a[252:255], a[140:143], v[28:31]
    ds_write_b128 v12, a[176:179] offset:2048
    v_mfma_f32_16x16x32_bf16 v[32:35], a[240:243], a[144:147], v[32:35]
    ds_write_b128 v12, a[180:183] offset:3072
    v_mfma_f32_16x16x32_bf16 v[36:39], a[244:247], a[144:147], v[36:39]
    ds_write_b128 v12, a[184:187] offset:4096
    v_mfma_f32_16x16x32_bf16 v[40:43], a[248:251], a[144:147], v[40:43]
    ds_write_b128 v12, a[188:191] offset:5120
    v_mfma_f32_16x16x32_bf16 v[44:47], a[252:255], a[144:147], v[44:47]
    ds_write_b128 v12, a[192:195] offset:6144
    v_mfma_f32_16x16x32_bf16 v[48:51], a[240:243], a[148:151], v[48:51]
    ds_read_b128 a[224:227], v11 offset:24576
    v_mfma_f32_16x16x32_bf16 v[52:55], a[244:247], a[148:151], v[52:55]
    ds_read_b128 a[228:231], v11 offset:25600
    v_mfma_f32_16x16x32_bf16 v[56:59], a[248:251], a[148:151], v[56:59]
    ds_read_b128 a[232:235], v11 offset:26624
    v_mfma_f32_16x16x32_bf16 v[60:63], a[252:255], a[148:151], v[60:63]
    ds_read_b128 a[236:239], v11 offset:27648
    v_mfma_f32_16x16x32_bf16 v[64:67], a[240:243], a[152:155], v[64:67]
    ds_read_b128 a[168:171], v13 offset:0
    v_mfma_f32_16x16x32_bf16 v[68:71], a[244:247], a[152:155], v[68:71]
    ds_read_b128 a[172:175], v13 offset:1024
    v_mfma_f32_16x16x32_bf16 v[72:75], a[248:251], a[152:155], v[72:75]
    ds_read_b128 a[176:179], v13 offset:2048
    v_mfma_f32_16x16x32_bf16 v[76:79], a[252:255], a[152:155], v[76:79]
    ds_read_b128 a[180:183], v13 offset:3072
    v_mfma_f32_16x16x32_bf16 v[80:83], a[240:243], a[156:159], v[80:83]
    ds_read_b128 a[184:187], v13 offset:4096
    v_mfma_f32_16x16x32_bf16 v[84:87], a[244:247], a[156:159], v[84:87]
    ds_read_b128 a[188:191], v13 offset:5120
    v_mfma_f32_16x16x32_bf16 v[88:91], a[248:251], a[156:159], v[88:91]
    ds_read_b128 a[192:195], v13 offset:6144
    v_mfma_f32_16x16x32_bf16 v[92:95], a[252:255], a[156:159], v[92:95]
    v_mfma_f32_16x16x32_bf16 v[96:99], a[240:243], a[160:163], v[96:99]
    v_mfma_f32_16x16x32_bf16 v[100:103], a[244:247], a[160:163], v[100:103]
    v_mfma_f32_16x16x32_bf16 v[104:107], a[248:251], a[160:163], v[104:107]
    v_mfma_f32_16x16x32_bf16 v[108:111], a[252:255], a[160:163], v[108:111]
    v_mfma_f32_16x16x32_bf16 v[112:115], a[240:243], a[164:167], v[112:115]
    v_mfma_f32_16x16x32_bf16 v[116:119], a[244:247], a[164:167], v[116:119]
    v_mfma_f32_16x16x32_bf16 v[120:123], a[248:251], a[164:167], v[120:123]
    v_mfma_f32_16x16x32_bf16 v[124:127], a[252:255], a[164:167], v[124:127]
    s_waitcnt lgkmcnt(0)
    v_mfma_f32_16x16x32_bf16 v[16:19], a[224:227], a[168:171], v[16:19]
    s_waitcnt vmcnt(16)
    v_mfma_f32_16x16x32_bf16 v[20:23], a[228:231], a[168:171], v[20:23]
    ds_write_b128 v12, a[196:199] offset:0
    v_mfma_f32_16x16x32_bf16 v[24:27], a[232:235], a[168:171], v[24:27]
    ds_write_b128 v12, a[200:203] offset:1024
    v_mfma_f32_16x16x32_bf16 v[28:31], a[236:239], a[168:171], v[28:31]
    ds_write_b128 v12, a[204:207] offset:2048
    v_mfma_f32_16x16x32_bf16 v[32:35], a[224:227], a[172:175], v[32:35]
    ds_write_b128 v12, a[208:211] offset:3072
    v_mfma_f32_16x16x32_bf16 v[36:39], a[228:231], a[172:175], v[36:39]
    ds_write_b128 v12, a[212:215] offset:4096
    v_mfma_f32_16x16x32_bf16 v[40:43], a[232:235], a[172:175], v[40:43]
    ds_write_b128 v12, a[216:219] offset:5120
    v_mfma_f32_16x16x32_bf16 v[44:47], a[236:239], a[172:175], v[44:47]
    ds_write_b128 v12, a[220:223] offset:6144
    v_mfma_f32_16x16x32_bf16 v[48:51], a[224:227], a[176:179], v[48:51]
    ds_read_b128 a[240:243], v11 offset:28672
    v_mfma_f32_16x16x32_bf16 v[52:55], a[228:231], a[176:179], v[52:55]
    ds_read_b128 a[244:247], v11 offset:29696
    v_mfma_f32_16x16x32_bf16 v[56:59], a[232:235], a[176:179], v[56:59]
    ds_read_b128 a[248:251], v11 offset:30720
    v_mfma_f32_16x16x32_bf16 v[60:63], a[236:239], a[176:179], v[60:63]
    ds_read_b128 a[252:255], v11 offset:31744
    v_mfma_f32_16x16x32_bf16 v[64:67], a[224:227], a[180:183], v[64:67]
    ds_read_b128 a[196:199], v13 offset:0
    v_mfma_f32_16x16x32_bf16 v[68:71], a[228:231], a[180:183], v[68:71]
    ds_read_b128 a[200:203], v13 offset:1024
    v_mfma_f32_16x16x32_bf16 v[72:75], a[232:235], a[180:183], v[72:75]
    ds_read_b128 a[204:207], v13 offset:2048
    v_mfma_f32_16x16x32_bf16 v[76:79], a[236:239], a[180:183], v[76:79]
    ds_read_b128 a[208:211], v13 offset:3072
    v_mfma_f32_16x16x32_bf16 v[80:83], a[224:227], a[184:187], v[80:83]
    ds_read_b128 a[212:215], v13 offset:4096
    v_mfma_f32_16x16x32_bf16 v[84:87], a[228:231], a[184:187], v[84:87]
    ds_read_b128 a[216:219], v13 offset:5120
    v_mfma_f32_16x16x32_bf16 v[88:91], a[232:235], a[184:187], v[88:91]
    ds_read_b128 a[220:223], v13 offset:6144
    v_mfma_f32_16x16x32_bf16 v[92:95], a[236:239], a[184:187], v[92:95]
    v_mfma_f32_16x16x32_bf16 v[96:99], a[224:227], a[188:191], v[96:99]
    v_mfma_f32_16x16x32_bf16 v[100:103], a[228:231], a[188:191], v[100:103]
    v_mfma_f32_16x16x32_bf16 v[104:107], a[232:235], a[188:191], v[104:107]
    v_mfma_f32_16x16x32_bf16 v[108:111], a[236:239], a[188:191], v[108:111]
    v_mfma_f32_16x16x32_bf16 v[112:115], a[224:227], a[192:195], v[112:115]
    v_mfma_f32_16x16x32_bf16 v[116:119], a[228:231], a[192:195], v[116:119]
    v_mfma_f32_16x16x32_bf16 v[120:123], a[232:235], a[192:195], v[120:123]
    v_mfma_f32_16x16x32_bf16 v[124:127], a[236:239], a[192:195], v[124:127]
    s_waitcnt lgkmcnt(0)
    v_mfma_f32_16x16x32_bf16 v[16:19], a[240:243], a[196:199], v[16:19]
    v_mfma_f32_16x16x32_bf16 v[20:23], a[244:247], a[196:199], v[20:23]
    v_mfma_f32_16x16x32_bf16 v[24:27], a[248:251], a[196:199], v[24:27]
    v_mfma_f32_16x16x32_bf16 v[28:31], a[252:255], a[196:199], v[28:31]
    v_mfma_f32_16x16x32_bf16 v[32:35], a[240:243], a[200:203], v[32:35]
    v_mfma_f32_16x16x32_bf16 v[36:39], a[244:247], a[200:203], v[36:39]
    v_mfma_f32_16x16x32_bf16 v[40:43], a[248:251], a[200:203], v[40:43]
    v_mfma_f32_16x16x32_bf16 v[44:47], a[252:255], a[200:203], v[44:47]
    v_mfma_f32_16x16x32_bf16 v[48:51], a[240:243], a[204:207], v[48:51]
    v_mfma_f32_16x16x32_bf16 v[52:55], a[244:247], a[204:207], v[52:55]
    v_mfma_f32_16x16x32_bf16 v[56:59], a[248:251], a[204:207], v[56:59]
    v_mfma_f32_16x16x32_bf16 v[60:63], a[252:255], a[204:207], v[60:63]
    v_mfma_f32_16x16x32_bf16 v[64:67], a[240:243], a[208:211], v[64:67]
    v_mfma_f32_16x16x32_bf16 v[68:71], a[244:247], a[208:211], v[68:71]
    v_mfma_f32_16x16x32_bf16 v[72:75], a[248:251], a[208:211], v[72:75]
    v_mfma_f32_16x16x32_bf16 v[76:79], a[252:255], a[208:211], v[76:79]
    v_mfma_f32_16x16x32_bf16 v[80:83], a[240:243], a[212:215], v[80:83]
    v_mfma_f32_16x16x32_bf16 v[84:87], a[244:247], a[212:215], v[84:87]
    v_mfma_f32_16x16x32_bf16 v[88:91], a[248:251], a[212:215], v[88:91]
    v_mfma_f32_16x16x32_bf16 v[92:95], a[252:255], a[212:215], v[92:95]
    v_mfma_f32_16x16x32_bf16 v[96:99], a[240:243], a[216:219], v[96:99]
    v_mfma_f32_16x16x32_bf16 v[100:103], a[244:247], a[216:219], v[100:103]
    v_mfma_f32_16x16x32_bf16 v[104:107], a[248:251], a[216:219], v[104:107]
    v_mfma_f32_16x16x32_bf16 v[108:111], a[252:255], a[216:219], v[108:111]
    v_mfma_f32_16x16x32_bf16 v[112:115], a[240:243], a[220:223], v[112:115]
    v_mfma_f32_16x16x32_bf16 v[116:119], a[244:247], a[220:223], v[116:119]
    v_mfma_f32_16x16x32_bf16 v[120:123], a[248:251], a[220:223], v[120:123]
    v_mfma_f32_16x16x32_bf16 v[124:127], a[252:255], a[220:223], v[124:127]
    s_lshl_b32 s42, s5, 2
    s_add_u32 s42, s42, s3
    s_mul_i32 s42, s42, 100352
    s_lshl_b32 s43, s6, 11
    s_add_u32 s42, s42, s43
    s_add_u32 s42, s42, 0
    s_waitcnt vmcnt(0)
    buffer_load_dword v15, v14, s[20:23], 0 offen
    v_lshl_or_b32 v240, v241, 16, v240
    v_lshl_or_b32 v241, v243, 16, v242
    v_lshl_or_b32 v242, v245, 16, v244
    v_lshl_or_b32 v243, v247, 16, v246
    v_lshl_or_b32 v244, v249, 16, v248
    v_lshl_or_b32 v245, v251, 16, v250
    v_lshl_or_b32 v246, v253, 16, v252
    v_lshl_or_b32 v247, v255, 16, v254
    buffer_store_dwordx4 v[240:243], v3, s[8:11], s41 offen offset:0 sc1
    buffer_store_dwordx4 v[244:247], v3, s[8:11], s41 offen offset:1024 sc1
    v_cvt_pk_bf16_f32 v128, v16, v17
    v_cvt_pk_bf16_f32 v129, v18, v19
    v_cvt_pk_bf16_f32 v130, v20, v21
    v_cvt_pk_bf16_f32 v131, v22, v23
    buffer_store_dwordx4 v[128:131], v3, s[8:11], s42 offen offset:0 sc1
    v_cvt_pk_bf16_f32 v132, v24, v25
    v_cvt_pk_bf16_f32 v133, v26, v27
    v_cvt_pk_bf16_f32 v134, v28, v29
    v_cvt_pk_bf16_f32 v135, v30, v31
    buffer_store_dwordx4 v[132:135], v3, s[8:11], s42 offen offset:1024 sc1
    s_add_u32 s42, s42, 14336
    v_cvt_pk_bf16_f32 v136, v32, v33
    v_cvt_pk_bf16_f32 v137, v34, v35
    v_cvt_pk_bf16_f32 v138, v36, v37
    v_cvt_pk_bf16_f32 v139, v38, v39
    buffer_store_dwordx4 v[136:139], v3, s[8:11], s42 offen offset:0 sc1
    v_cvt_pk_bf16_f32 v140, v40, v41
    v_cvt_pk_bf16_f32 v141, v42, v43
    v_cvt_pk_bf16_f32 v142, v44, v45
    v_cvt_pk_bf16_f32 v143, v46, v47
    buffer_store_dwordx4 v[140:143], v3, s[8:11], s42 offen offset:1024 sc1
    s_add_u32 s42, s42, 14336
    v_cvt_pk_bf16_f32 v144, v48, v49
    v_cvt_pk_bf16_f32 v145, v50, v51
    v_cvt_pk_bf16_f32 v146, v52, v53
    v_cvt_pk_bf16_f32 v147, v54, v55
    buffer_store_dwordx4 v[144:147], v3, s[8:11], s42 offen offset:0 sc1
    v_cvt_pk_bf16_f32 v148, v56, v57
    v_cvt_pk_bf16_f32 v149, v58, v59
    v_cvt_pk_bf16_f32 v150, v60, v61
    v_cvt_pk_bf16_f32 v151, v62, v63
    buffer_store_dwordx4 v[148:151], v3, s[8:11], s42 offen offset:1024 sc1
    s_add_u32 s42, s42, 14336
    v_cvt_pk_bf16_f32 v152, v64, v65
    v_cvt_pk_bf16_f32 v153, v66, v67
    v_cvt_pk_bf16_f32 v154, v68, v69
    v_cvt_pk_bf16_f32 v155, v70, v71
    buffer_store_dwordx4 v[152:155], v3, s[8:11], s42 offen offset:0 sc1
    v_cvt_pk_bf16_f32 v156, v72, v73
    v_cvt_pk_bf16_f32 v157, v74, v75
    v_cvt_pk_bf16_f32 v158, v76, v77
    v_cvt_pk_bf16_f32 v159, v78, v79
    buffer_store_dwordx4 v[156:159], v3, s[8:11], s42 offen offset:1024 sc1
    s_add_u32 s42, s42, 14336
    v_cvt_pk_bf16_f32 v160, v80, v81
    v_cvt_pk_bf16_f32 v161, v82, v83
    v_cvt_pk_bf16_f32 v162, v84, v85
    v_cvt_pk_bf16_f32 v163, v86, v87
    buffer_store_dwordx4 v[160:163], v3, s[8:11], s42 offen offset:0 sc1
    v_cvt_pk_bf16_f32 v164, v88, v89
    v_cvt_pk_bf16_f32 v165, v90, v91
    v_cvt_pk_bf16_f32 v166, v92, v93
    v_cvt_pk_bf16_f32 v167, v94, v95
    buffer_store_dwordx4 v[164:167], v3, s[8:11], s42 offen offset:1024 sc1
    s_add_u32 s42, s42, 14336
    v_cvt_pk_bf16_f32 v168, v96, v97
    v_cvt_pk_bf16_f32 v169, v98, v99
    v_cvt_pk_bf16_f32 v170, v100, v101
    v_cvt_pk_bf16_f32 v171, v102, v103
    buffer_store_dwordx4 v[168:171], v3, s[8:11], s42 offen offset:0 sc1
    v_cvt_pk_bf16_f32 v172, v104, v105
    v_cvt_pk_bf16_f32 v173, v106, v107
    v_cvt_pk_bf16_f32 v174, v108, v109
    v_cvt_pk_bf16_f32 v175, v110, v111
    buffer_store_dwordx4 v[172:175], v3, s[8:11], s42 offen offset:1024 sc1
    s_add_u32 s42, s42, 14336
    v_cvt_pk_bf16_f32 v176, v112, v113
    v_cvt_pk_bf16_f32 v177, v114, v115
    v_cvt_pk_bf16_f32 v178, v116, v117
    v_cvt_pk_bf16_f32 v179, v118, v119
    buffer_store_dwordx4 v[176:179], v3, s[8:11], s42 offen offset:0 sc1
    v_cvt_pk_bf16_f32 v180, v120, v121
    v_cvt_pk_bf16_f32 v181, v122, v123
    v_cvt_pk_bf16_f32 v182, v124, v125
    v_cvt_pk_bf16_f32 v183, v126, v127
    buffer_store_dwordx4 v[180:183], v3, s[8:11], s42 offen offset:1024 sc1
    s_branch .pp_done
.pp_b:
    v_mul_u32_u24 v6, 7168, v1
    v_lshl_add_u32 v6, v2, 4, v6
    v_add_u32 v5, 3584, v6
    s_mul_i32 s44, s5, 229376
    s_lshl_b32 s43, s3, 8
    s_add_u32 s44, s44, s43
    s_mov_b32 s38, 0x05040100
    s_mov_b32 s39, 0x07060302
    s_mul_i32 s36, s6, 28672
    s_add_u32 s37, s44, s36
    buffer_load_dwordx4 v[16:19], v6, s[28:31], s37 offen offset:0
    buffer_load_dwordx4 v[20:23], v6, s[28:31], s37 offen offset:896
    buffer_load_dwordx4 v[24:27], v6, s[28:31], s37 offen offset:1792
    buffer_load_dwordx4 v[28:31], v6, s[28:31], s37 offen offset:2688
    buffer_load_dwordx4 v[32:35], v5, s[28:31], s37 offen offset:0
    buffer_load_dwordx4 v[36:39], v5, s[28:31], s37 offen offset:896
    buffer_load_dwordx4 v[40:43], v5, s[28:31], s37 offen offset:1792
    buffer_load_dwordx4 v[44:47], v5, s[28:31], s37 offen offset:2688
    s_add_u32 s36, s36, 28672
    s_cmp_ge_u32 s36, 229376
    s_cselect_b32 s36, 0, s36
    s_add_u32 s37, s44, s36
    buffer_load_dwordx4 v[48:51], v6, s[28:31], s37 offen offset:0
    buffer_load_dwordx4 v[52:55], v6, s[28:31], s37 offen offset:896
    buffer_load_dwordx4 v[56:59], v6, s[28:31], s37 offen offset:1792
    buffer_load_dwordx4 v[60:63], v6, s[28:31], s37 offen offset:2688
    buffer_load_dwordx4 v[64:67], v5, s[28:31], s37 offen offset:0
    buffer_load_dwordx4 v[68:71], v5, s[28:31], s37 offen offset:896
    buffer_load_dwordx4 v[72:75], v5, s[28:31], s37 offen offset:1792
    buffer_load_dwordx4 v[76:79], v5, s[28:31], s37 offen offset:2688
    s_add_u32 s36, s36, 28672
    s_cmp_ge_u32 s36, 229376
    s_cselect_b32 s36, 0, s36
    s_add_u32 s37, s44, s36
    buffer_load_dwordx4 v[80:83], v6, s[28:31], s37 offen offset:0
    buffer_load_dwordx4 v[84:87], v6, s[28:31], s37 offen offset:896
    buffer_load_dwordx4 v[88:91], v6, s[28:31], s37 offen offset:1792
    buffer_load_dwordx4 v[92:95], v6, s[28:31], s37 offen offset:2688
    buffer_load_dwordx4 v[96:99], v5, s[28:31], s37 offen offset:0
    buffer_load_dwordx4 v[100:103], v5, s[28:31], s37 offen offset:896
    buffer_load_dwordx4 v[104:107], v5, s[28:31], s37 offen offset:1792
    buffer_load_dwordx4 v[108:111], v5, s[28:31], s37 offen offset:2688
    s_add_u32 s36, s36, 28672
    s_cmp_ge_u32 s36, 229376
    s_cselect_b32 s36, 0, s36
    s_waitcnt vmcnt(24)
    ds_write_b128 v10, a[224:227] offset:0
    ds_write_b128 v10, a[228:231] offset:4096
    ds_write_b128 v10, a[232:235] offset:8192
    ds_write_b128 v10, a[236:239] offset:12288
    ds_write_b128 v10, a[240:243] offset:16384
    ds_write_b128 v10, a[244:247] offset:20480
    ds_write_b128 v10, a[248:251] offset:24576
    ds_write_b128 v10, a[252:255] offset:28672
    s_waitcnt lgkmcnt(0)
    s_barrier
    s_add_u32 s37, s44, s36
    buffer_load_dwordx4 v[112:115], v6, s[28:31], s37 offen offset:0
    buffer_load_dwordx4 v[116:119], v6, s[28:31], s37 offen offset:896
    buffer_load_dwordx4 v[120:123], v6, s[28:31], s37 offen offset:1792
    buffer_load_dwordx4 v[124:127], v6, s[28:31], s37 offen offset:2688
    buffer_load_dwordx4 v[128:131], v5, s[28:31], s37 offen offset:0
    buffer_load_dwordx4 v[132:135], v5, s[28:31], s37 offen offset:896
    buffer_load_dwordx4 v[136:139], v5, s[28:31], s37 offen offset:1792
    buffer_load_dwordx4 v[140:143], v5, s[28:31], s37 offen offset:2688
    s_add_u32 s36, s36, 28672
    s_cmp_ge_u32 s36, 229376
    s_cselect_b32 s36, 0, s36
    ds_read_b128 a[224:227], v11 offset:0
    ds_read_b128 a[228:231], v11 offset:1024
    ds_read_b128 a[232:235], v11 offset:2048
    ds_read_b128 a[236:239], v11 offset:3072
    s_waitcnt vmcnt(24)
    v_perm_b32 v208, v20, v16, s38
    v_perm_b32 v209, v28, v24, s38
    v_perm_b32 v210, v36, v32, s38
    v_perm_b32 v211, v44, v40, s38
    v_perm_b32 v212, v20, v16, s39
    v_perm_b32 v213, v28, v24, s39
    v_perm_b32 v214, v36, v32, s39
    v_perm_b32 v215, v44, v40, s39
    v_perm_b32 v216, v21, v17, s38
    v_perm_b32 v217, v29, v25, s38
    v_perm_b32 v218, v37, v33, s38
    v_perm_b32 v219, v45, v41, s38
    v_perm_b32 v220, v21, v17, s39
    v_perm_b32 v221, v29, v25, s39
    v_perm_b32 v222, v37, v33, s39
    v_perm_b32 v223, v45, v41, s39
    v_perm_b32 v224, v22, v18, s38
    v_perm_b32 v225, v30, v26, s38
    v_perm_b32 v226, v38, v34, s38
    v_perm_b32 v227, v46, v42, s38
    v_perm_b32 v228, v22, v18, s39
    v_perm_b32 v229, v30, v26, s39
    v_perm_b32 v230, v38, v34, s39
    v_perm_b32 v231, v46, v42, s39
    v_perm_b32 v232, v23, v19, s38
    v_perm_b32 v233, v31, v27, s38
    v_perm_b32 v234, v39, v35, s38
    v_perm_b32 v235, v47, v43, s38
    v_perm_b32 v236, v23, v19, s39
    v_perm_b32 v237, v31, v27, s39
    v_perm_b32 v238, v39, v35, s39
    v_perm_b32 v239, v47, v43, s39
    s_waitcnt lgkmcnt(0)
    s_add_u32 s37, s44, s36
    buffer_load_dwordx4 v[144:147], v6, s[28:31], s37 offen offset:0
    buffer_load_dwordx4 v[148:151], v6, s[28:31], s37 offen offset:896
    buffer_load_dwordx4 v[152:155], v6, s[28:31], s37 offen offset:1792
    buffer_load_dwordx4 v[156:159], v6, s[28:31], s37 offen offset:2688
    buffer_load_dwordx4 v[160:163], v5, s[28:31], s37 offen offset:0
    buffer_load_dwordx4 v[164:167], v5, s[28:31], s37 offen offset:896
    buffer_load_dwordx4 v[168:171], v5, s[28:31], s37 offen offset:1792
    buffer_load_dwordx4 v[172:175], v5, s[28:31], s37 offen offset:2688
    s_add_u32 s36, s36, 28672
    s_cmp_ge_u32 s36, 229376
    s_cselect_b32 s36, 0, s36
    ds_read_b128 a[240:243], v11 offset:4096
    ds_read_b128 a[244:247], v11 offset:5120
    ds_read_b128 a[248:251], v11 offset:6144
    ds_read_b128 a[252:255], v11 offset:7168
    v_mfma_f32_16x16x32_bf16 a[0:3], a[224:227], v[208:211], 0
    v_mfma_f32_16x16x32_bf16 a[4:7], a[228:231], v[208:211], 0
    v_mfma_f32_16x16x32_bf16 a[8:11], a[232:235], v[208:211], 0
    v_mfma_f32_16x16x32_bf16 a[12:15], a[236:239], v[208:211], 0
    s_waitcnt vmcnt(24)
    v_mfma_f32_16x16x32_bf16 a[16:19], a[224:227], v[212:215], 0
    v_perm_b32 v208, v52, v48, s38
    v_mfma_f32_16x16x32_bf16 a[20:23], a[228:231], v[212:215], 0
    v_perm_b32 v209, v60, v56, s38
    v_mfma_f32_16x16x32_bf16 a[24:27], a[232:235], v[212:215], 0
    v_perm_b32 v210, v68, v64, s38
    v_mfma_f32_16x16x32_bf16 a[28:31], a[236:239], v[212:215], 0
    v_perm_b32 v211, v76, v72, s38
    v_mfma_f32_16x16x32_bf16 a[32:35], a[224:227], v[216:219], 0
    v_perm_b32 v212, v52, v48, s39
    v_mfma_f32_16x16x32_bf16 a[36:39], a[228:231], v[216:219], 0
    v_perm_b32 v213, v60, v56, s39
    v_mfma_f32_16x16x32_bf16 a[40:43], a[232:235], v[216:219], 0
    v_perm_b32 v214, v68, v64, s39
    v_mfma_f32_16x16x32_bf16 a[44:47], a[236:239], v[216:219], 0
    v_perm_b32 v215, v76, v72, s39
    v_mfma_f32_16x16x32_bf16 a[48:51], a[224:227], v[220:223], 0
    v_perm_b32 v216, v53, v49, s38
    v_mfma_f32_16x16x32_bf16 a[52:55], a[228:231], v[220:223], 0
    v_perm_b32 v217, v61, v57, s38
    v_mfma_f32_16x16x32_bf16 a[56:59], a[232:235], v[220:223], 0
    v_perm_b32 v218, v69, v65, s38
    v_mfma_f32_16x16x32_bf16 a[60:63], a[236:239], v[220:223], 0
    v_perm_b32 v219, v77, v73, s38
    v_mfma_f32_16x16x32_bf16 a[64:67], a[224:227], v[224:227], 0
    v_perm_b32 v220, v53, v49, s39
    v_mfma_f32_16x16x32_bf16 a[68:71], a[228:231], v[224:227], 0
    v_perm_b32 v221, v61, v57, s39
    v_mfma_f32_16x16x32_bf16 a[72:75], a[232:235], v[224:227], 0
    v_perm_b32 v222, v69, v65, s39
    v_mfma_f32_16x16x32_bf16 a[76:79], a[236:239], v[224:227], 0
    v_perm_b32 v223, v77, v73, s39
    v_mfma_f32_16x16x32_bf16 a[80:83], a[224:227], v[228:231], 0
    v_perm_b32 v224, v54, v50, s38
    v_mfma_f32_16x16x32_bf16 a[84:87], a[228:231], v[228:231], 0
    v_perm_b32 v225, v62, v58, s38
    v_mfma_f32_16x16x32_bf16 a[88:91], a[232:235], v[228:231], 0
    v_perm_b32 v226, v70, v66, s38
    v_mfma_f32_16x16x32_bf16 a[92:95], a[236:239], v[228:231], 0
    v_perm_b32 v227, v78, v74, s38
    v_mfma_f32_16x16x32_bf16 a[96:99], a[224:227], v[232:235], 0
    v_perm_b32 v228, v54, v50, s39
    v_mfma_f32_16x16x32_bf16 a[100:103], a[228:231], v[232:235], 0
    v_perm_b32 v229, v62, v58, s39
    v_mfma_f32_16x16x32_bf16 a[104:107], a[232:235], v[232:235], 0
    v_perm_b32 v230, v70, v66, s39
    v_mfma_f32_16x16x32_bf16 a[108:111], a[236:239], v[232:235], 0
    v_perm_b32 v231, v78, v74, s39
    v_mfma_f32_16x16x32_bf16 a[112:115], a[224:227], v[236:239], 0
    v_perm_b32 v232, v55, v51, s38
    v_mfma_f32_16x16x32_bf16 a[116:119], a[228:231], v[236:239], 0
    v_perm_b32 v233, v63, v59, s38
    v_mfma_f32_16x16x32_bf16 a[120:123], a[232:235], v[236:239], 0
    v_perm_b32 v234, v71, v67, s38
    v_mfma_f32_16x16x32_bf16 a[124:127], a[236:239], v[236:239], 0
    v_perm_b32 v235, v79, v75, s38
    s_nop 1
    v_perm_b32 v236, v55, v51, s39
    v_perm_b32 v237, v63, v59, s39
    v_perm_b32 v238, v71, v67, s39
    v_perm_b32 v239, v79, v75, s39
    s_nop 1
    s_waitcnt lgkmcnt(0)
    s_add_u32 s37, s44, s36
    buffer_load_dwordx4 v[176:179], v6, s[28:31], s37 offen offset:0
    buffer_load_dwordx4 v[180:183], v6, s[28:31], s37 offen offset:896
    buffer_load_dwordx4 v[184:187], v6, s[28:31], s37 offen offset:1792
    buffer_load_dwordx4 v[188:191], v6, s[28:31], s37 offen offset:2688
    buffer_load_dwordx4 v[192:195], v5, s[28:31], s37 offen offset:0
    buffer_load_dwordx4 v[196:199], v5, s[28:31], s37 offen offset:896
    buffer_load_dwordx4 v[200:203], v5, s[28:31], s37 offen offset:1792
    buffer_load_dwordx4 v[204:207], v5, s[28:31], s37 offen offset:2688
    s_add_u32 s36, s36, 28672
    s_cmp_ge_u32 s36, 229376
    s_cselect_b32 s36, 0, s36
    ds_read_b128 a[224:227], v11 offset:8192
    ds_read_b128 a[228:231], v11 offset:9216
    ds_read_b128 a[232:235], v11 offset:10240
    ds_read_b128 a[236:239], v11 offset:11264
    v_mfma_f32_16x16x32_bf16 a[0:3], a[240:243], v[208:211], a[0:3]
    v_mfma_f32_16x16x32_bf16 a[4:7], a[244:247], v[208:211], a[4:7]
    v_mfma_f32_16x16x32_bf16 a[8:11], a[248:251], v[208:211], a[8:11]
    v_mfma_f32_16x16x32_bf16 a[12:15], a[252:255], v[208:211], a[12:15]
    s_waitcnt vmcnt(24)
    v_mfma_f32_16x16x32_bf16 a[16:19], a[240:243], v[212:215], a[16:19]
    v_perm_b32 v208, v84, v80, s38
    v_mfma_f32_16x16x32_bf16 a[20:23], a[244:247], v[212:215], a[20:23]
    v_perm_b32 v209, v92, v88, s38
    v_mfma_f32_16x16x32_bf16 a[24:27], a[248:251], v[212:215], a[24:27]
    v_perm_b32 v210, v100, v96, s38
    v_mfma_f32_16x16x32_bf16 a[28:31], a[252:255], v[212:215], a[28:31]
    v_perm_b32 v211, v108, v104, s38
    v_mfma_f32_16x16x32_bf16 a[32:35], a[240:243], v[216:219], a[32:35]
    v_perm_b32 v212, v84, v80, s39
    v_mfma_f32_16x16x32_bf16 a[36:39], a[244:247], v[216:219], a[36:39]
    v_perm_b32 v213, v92, v88, s39
    v_mfma_f32_16x16x32_bf16 a[40:43], a[248:251], v[216:219], a[40:43]
    v_perm_b32 v214, v100, v96, s39
    v_mfma_f32_16x16x32_bf16 a[44:47], a[252:255], v[216:219], a[44:47]
    v_perm_b32 v215, v108, v104, s39
    v_mfma_f32_16x16x32_bf16 a[48:51], a[240:243], v[220:223], a[48:51]
    v_perm_b32 v216, v85, v81, s38
    v_mfma_f32_16x16x32_bf16 a[52:55], a[244:247], v[220:223], a[52:55]
    v_perm_b32 v217, v93, v89, s38
    v_mfma_f32_16x16x32_bf16 a[56:59], a[248:251], v[220:223], a[56:59]
    v_perm_b32 v218, v101, v97, s38
    v_mfma_f32_16x16x32_bf16 a[60:63], a[252:255], v[220:223], a[60:63]
    v_perm_b32 v219, v109, v105, s38
    v_mfma_f32_16x16x32_bf16 a[64:67], a[240:243], v[224:227], a[64:67]
    v_perm_b32 v220, v85, v81, s39
    v_mfma_f32_16x16x32_bf16 a[68:71], a[244:247], v[224:227], a[68:71]
    v_perm_b32 v221, v93, v89, s39
    v_mfma_f32_16x16x32_bf16 a[72:75], a[248:251], v[224:227], a[72:75]
    v_perm_b32 v222, v101, v97, s39
    v_mfma_f32_16x16x32_bf16 a[76:79], a[252:255], v[224:227], a[76:79]
    v_perm_b32 v223, v109, v105, s39
    v_mfma_f32_16x16x32_bf16 a[80:83], a[240:243], v[228:231], a[80:83]
    v_perm_b32 v224, v86, v82, s38
    v_mfma_f32_16x16x32_bf16 a[84:87], a[244:247], v[228:231], a[84:87]
    v_perm_b32 v225, v94, v90, s38
    v_mfma_f32_16x16x32_bf16 a[88:91], a[248:251], v[228:231], a[88:91]
    v_perm_b32 v226, v102, v98, s38
    v_mfma_f32_16x16x32_bf16 a[92:95], a[252:255], v[228:231], a[92:95]
    v_perm_b32 v227, v110, v106, s38
    v_mfma_f32_16x16x32_bf16 a[96:99], a[240:243], v[232:235], a[96:99]
    v_perm_b32 v228, v86, v82, s39
    v_mfma_f32_16x16x32_bf16 a[100:103], a[244:247], v[232:235], a[100:103]
    v_perm_b32 v229, v94, v90, s39
    v_mfma_f32_16x16x32_bf16 a[104:107], a[248:251], v[232:235], a[104:107]
    v_perm_b32 v230, v102, v98, s39
    v_mfma_f32_16x16x32_bf16 a[108:111], a[252:255], v[232:235], a[108:111]
    v_perm_b32 v231, v110, v106, s39
    v_mfma_f32_16x16x32_bf16 a[112:115], a[240:243], v[236:239], a[112:115]
    v_perm_b32 v232, v87, v83, s38
    v_mfma_f32_16x16x32_bf16 a[116:119], a[244:247], v[236:239], a[116:119]
    v_perm_b32 v233, v95, v91, s38
    v_mfma_f32_16x16x32_bf16 a[120:123], a[248:251], v[236:239], a[120:123]
    v_perm_b32 v234, v103, v99, s38
    v_mfma_f32_16x16x32_bf16 a[124:127], a[252:255], v[236:239], a[124:127]
    v_perm_b32 v235, v111, v107, s38
    s_nop 1
    v_perm_b32 v236, v87, v83, s39
    v_perm_b32 v237, v95, v91, s39
    v_perm_b32 v238, v103, v99, s39
    v_perm_b32 v239, v111, v107, s39
    s_nop 1
    s_waitcnt lgkmcnt(0)
    s_add_u32 s37, s44, s36
    buffer_load_dwordx4 v[16:19], v6, s[28:31], s37 offen offset:0
    buffer_load_dwordx4 v[20:23], v6, s[28:31], s37 offen offset:896
    buffer_load_dwordx4 v[24:27], v6, s[28:31], s37 offen offset:1792
    buffer_load_dwordx4 v[28:31], v6, s[28:31], s37 offen offset:2688
    buffer_load_dwordx4 v[32:35], v5, s[28:31], s37 offen offset:0
    buffer_load_dwordx4 v[36:39], v5, s[28:31], s37 offen offset:896
    buffer_load_dwordx4 v[40:43], v5, s[28:31], s37 offen offset:1792
    buffer_load_dwordx4 v[44:47], v5, s[28:31], s37 offen offset:2688
    s_add_u32 s36, s36, 28672
    s_cmp_ge_u32 s36, 229376
    s_cselect_b32 s36, 0, s36
    ds_read_b128 a[240:243], v11 offset:12288
    ds_read_b128 a[244:247], v11 offset:13312
    ds_read_b128 a[248:251], v11 offset:14336
    ds_read_b128 a[252:255], v11 offset:15360
    v_mfma_f32_16x16x32_bf16 a[0:3], a[224:227], v[208:211], a[0:3]
    v_mfma_f32_16x16x32_bf16 a[4:7], a[228:231], v[208:211], a[4:7]
    v_mfma_f32_16x16x32_bf16 a[8:11], a[232:235], v[208:211], a[8:11]
    v_mfma_f32_16x16x32_bf16 a[12:15], a[236:239], v[208:211], a[12:15]
    s_waitcnt vmcnt(24)
    v_mfma_f32_16x16x32_bf16 a[16:19], a[224:227], v[212:215], a[16:19]
    v_perm_b32 v208, v116, v112, s38
    v_mfma_f32_16x16x32_bf16 a[20:23], a[228:231], v[212:215], a[20:23]
    v_perm_b32 v209, v124, v120, s38
    v_mfma_f32_16x16x32_bf16 a[24:27], a[232:235], v[212:215], a[24:27]
    v_perm_b32 v210, v132, v128, s38
    v_mfma_f32_16x16x32_bf16 a[28:31], a[236:239], v[212:215], a[28:31]
    v_perm_b32 v211, v140, v136, s38
    v_mfma_f32_16x16x32_bf16 a[32:35], a[224:227], v[216:219], a[32:35]
    v_perm_b32 v212, v116, v112, s39
    v_mfma_f32_16x16x32_bf16 a[36:39], a[228:231], v[216:219], a[36:39]
    v_perm_b32 v213, v124, v120, s39
    v_mfma_f32_16x16x32_bf16 a[40:43], a[232:235], v[216:219], a[40:43]
    v_perm_b32 v214, v132, v128, s39
    v_mfma_f32_16x16x32_bf16 a[44:47], a[236:239], v[216:219], a[44:47]
    v_perm_b32 v215, v140, v136, s39
    v_mfma_f32_16x16x32_bf16 a[48:51], a[224:227], v[220:223], a[48:51]
    v_perm_b32 v216, v117, v113, s38
    v_mfma_f32_16x16x32_bf16 a[52:55], a[228:231], v[220:223], a[52:55]
    v_perm_b32 v217, v125, v121, s38
    v_mfma_f32_16x16x32_bf16 a[56:59], a[232:235], v[220:223], a[56:59]
    v_perm_b32 v218, v133, v129, s38
    v_mfma_f32_16x16x32_bf16 a[60:63], a[236:239], v[220:223], a[60:63]
    v_perm_b32 v219, v141, v137, s38
    v_mfma_f32_16x16x32_bf16 a[64:67], a[224:227], v[224:227], a[64:67]
    v_perm_b32 v220, v117, v113, s39
    v_mfma_f32_16x16x32_bf16 a[68:71], a[228:231], v[224:227], a[68:71]
    v_perm_b32 v221, v125, v121, s39
    v_mfma_f32_16x16x32_bf16 a[72:75], a[232:235], v[224:227], a[72:75]
    v_perm_b32 v222, v133, v129, s39
    v_mfma_f32_16x16x32_bf16 a[76:79], a[236:239], v[224:227], a[76:79]
    v_perm_b32 v223, v141, v137, s39
    v_mfma_f32_16x16x32_bf16 a[80:83], a[224:227], v[228:231], a[80:83]
    v_perm_b32 v224, v118, v114, s38
    v_mfma_f32_16x16x32_bf16 a[84:87], a[228:231], v[228:231], a[84:87]
    v_perm_b32 v225, v126, v122, s38
    v_mfma_f32_16x16x32_bf16 a[88:91], a[232:235], v[228:231], a[88:91]
    v_perm_b32 v226, v134, v130, s38
    v_mfma_f32_16x16x32_bf16 a[92:95], a[236:239], v[228:231], a[92:95]
    v_perm_b32 v227, v142, v138, s38
    v_mfma_f32_16x16x32_bf16 a[96:99], a[224:227], v[232:235], a[96:99]
    v_perm_b32 v228, v118, v114, s39
    v_mfma_f32_16x16x32_bf16 a[100:103], a[228:231], v[232:235], a[100:103]
    v_perm_b32 v229, v126, v122, s39
    v_mfma_f32_16x16x32_bf16 a[104:107], a[232:235], v[232:235], a[104:107]
    v_perm_b32 v230, v134, v130, s39
    v_mfma_f32_16x16x32_bf16 a[108:111], a[236:239], v[232:235], a[108:111]
    v_perm_b32 v231, v142, v138, s39
    v_mfma_f32_16x16x32_bf16 a[112:115], a[224:227], v[236:239], a[112:115]
    v_perm_b32 v232, v119, v115, s38
    v_mfma_f32_16x16x32_bf16 a[116:119], a[228:231], v[236:239], a[116:119]
    v_perm_b32 v233, v127, v123, s38
    v_mfma_f32_16x16x32_bf16 a[120:123], a[232:235], v[236:239], a[120:123]
    v_perm_b32 v234, v135, v131, s38
    v_mfma_f32_16x16x32_bf16 a[124:127], a[236:239], v[236:239], a[124:127]
    v_perm_b32 v235, v143, v139, s38
    s_nop 1
    v_perm_b32 v236, v119, v115, s39
    v_perm_b32 v237, v127, v123, s39
    v_perm_b32 v238, v135, v131, s39
    v_perm_b32 v239, v143, v139, s39
    s_nop 1
    s_waitcnt lgkmcnt(0)
    s_add_u32 s37, s44, s36
    buffer_load_dwordx4 v[48:51], v6, s[28:31], s37 offen offset:0
    buffer_load_dwordx4 v[52:55], v6, s[28:31], s37 offen offset:896
    buffer_load_dwordx4 v[56:59], v6, s[28:31], s37 offen offset:1792
    buffer_load_dwordx4 v[60:63], v6, s[28:31], s37 offen offset:2688
    buffer_load_dwordx4 v[64:67], v5, s[28:31], s37 offen offset:0
    buffer_load_dwordx4 v[68:71], v5, s[28:31], s37 offen offset:896
    buffer_load_dwordx4 v[72:75], v5, s[28:31], s37 offen offset:1792
    buffer_load_dwordx4 v[76:79], v5, s[28:31], s37 offen offset:2688
    s_add_u32 s36, s36, 28672
    s_cmp_ge_u32 s36, 229376
    s_cselect_b32 s36, 0, s36
    ds_read_b128 a[224:227], v11 offset:16384
    ds_read_b128 a[228:231], v11 offset:17408
    ds_read_b128 a[232:235], v11 offset:18432
    ds_read_b128 a[236:239], v11 offset:19456
    v_mfma_f32_16x16x32_bf16 a[0:3], a[240:243], v[208:211], a[0:3]
    v_mfma_f32_16x16x32_bf16 a[4:7], a[244:247], v[208:211], a[4:7]
    v_mfma_f32_16x16x32_bf16 a[8:11], a[248:251], v[208:211], a[8:11]
    v_mfma_f32_16x16x32_bf16 a[12:15], a[252:255], v[208:211], a[12:15]
    s_waitcnt vmcnt(24)
    v_mfma_f32_16x16x32_bf16 a[16:19], a[240:243], v[212:215], a[16:19]
    v_perm_b32 v208, v148, v144, s38
    v_mfma_f32_16x16x32_bf16 a[20:23], a[244:247], v[212:215], a[20:23]
    v_perm_b32 v209, v156, v152, s38
    v_mfma_f32_16x16x32_bf16 a[24:27], a[248:251], v[212:215], a[24:27]
    v_perm_b32 v210, v164, v160, s38
    v_mfma_f32_16x16x32_bf16 a[28:31], a[252:255], v[212:215], a[28:31]
    v_perm_b32 v211, v172, v168, s38
    v_mfma_f32_16x16x32_bf16 a[32:35], a[240:243], v[216:219], a[32:35]
    v_perm_b32 v212, v148, v144, s39
    v_mfma_f32_16x16x32_bf16 a[36:39], a[244:247], v[216:219], a[36:39]
    v_perm_b32 v213, v156, v152, s39
    v_mfma_f32_16x16x32_bf16 a[40:43], a[248:251], v[216:219], a[40:43]
    v_perm_b32 v214, v164, v160, s39
    v_mfma_f32_16x16x32_bf16 a[44:47], a[252:255], v[216:219], a[44:47]
    v_perm_b32 v215, v172, v168, s39
    v_mfma_f32_16x16x32_bf16 a[48:51], a[240:243], v[220:223], a[48:51]
    v_perm_b32 v216, v149, v145, s38
    v_mfma_f32_16x16x32_bf16 a[52:55], a[244:247], v[220:223], a[52:55]
    v_perm_b32 v217, v157, v153, s38
    v_mfma_f32_16x16x32_bf16 a[56:59], a[248:251], v[220:223], a[56:59]
    v_perm_b32 v218, v165, v161, s38
    v_mfma_f32_16x16x32_bf16 a[60:63], a[252:255], v[220:223], a[60:63]
    v_perm_b32 v219, v173, v169, s38
    v_mfma_f32_16x16x32_bf16 a[64:67], a[240:243], v[224:227], a[64:67]
    v_perm_b32 v220, v149, v145, s39
    v_mfma_f32_16x16x32_bf16 a[68:71], a[244:247], v[224:227], a[68:71]
    v_perm_b32 v221, v157, v153, s39
    v_mfma_f32_16x16x32_bf16 a[72:75], a[248:251], v[224:227], a[72:75]
    v_perm_b32 v222, v165, v161, s39
    v_mfma_f32_16x16x32_bf16 a[76:79], a[252:255], v[224:227], a[76:79]
    v_perm_b32 v223, v173, v169, s39
    v_mfma_f32_16x16x32_bf16 a[80:83], a[240:243], v[228:231], a[80:83]
    v_perm_b32 v224, v150, v146, s38
    v_mfma_f32_16x16x32_bf16 a[84:87], a[244:247], v[228:231], a[84:87]
    v_perm_b32 v225, v158, v154, s38
    v_mfma_f32_16x16x32_bf16 a[88:91], a[248:251], v[228:231], a[88:91]
    v_perm_b32 v226, v166, v162, s38
    v_mfma_f32_16x16x32_bf16 a[92:95], a[252:255], v[228:231], a[92:95]
    v_perm_b32 v227, v174, v170, s38
    v_mfma_f32_16x16x32_bf16 a[96:99], a[240:243], v[232:235], a[96:99]
    v_perm_b32 v228, v150, v146, s39
    v_mfma_f32_16x16x32_bf16 a[100:103], a[244:247], v[232:235], a[100:103]
    v_perm_b32 v229, v158, v154, s39
    v_mfma_f32_16x16x32_bf16 a[104:107], a[248:251], v[232:235], a[104:107]
    v_perm_b32 v230, v166, v162, s39
    v_mfma_f32_16x16x32_bf16 a[108:111], a[252:255], v[232:235], a[108:111]
    v_perm_b32 v231, v174, v170, s39
    v_mfma_f32_16x16x32_bf16 a[112:115], a[240:243], v[236:239], a[112:115]
    v_perm_b32 v232, v151, v147, s38
    v_mfma_f32_16x16x32_bf16 a[116:119], a[244:247], v[236:239], a[116:119]
    v_perm_b32 v233, v159, v155, s38
    v_mfma_f32_16x16x32_bf16 a[120:123], a[248:251], v[236:239], a[120:123]
    v_perm_b32 v234, v167, v163, s38
    v_mfma_f32_16x16x32_bf16 a[124:127], a[252:255], v[236:239], a[124:127]
    v_perm_b32 v235, v175, v171, s38
    s_nop 1
    v_perm_b32 v236, v151, v147, s39
    v_perm_b32 v237, v159, v155, s39
    v_perm_b32 v238, v167, v163, s39
    v_perm_b32 v239, v175, v171, s39
    s_nop 1
    v_mov_b32 v240, 0
    v_mov_b32 v241, 0
    v_mov_b32 v242, 0
    v_mov_b32 v243, 0
    v_mov_b32 v244, 0
    v_mov_b32 v245, 0
    v_mov_b32 v246, 0
    v_mov_b32 v247, 0
    v_mov_b32 v248, 0
    v_mov_b32 v249, 0
    v_mov_b32 v250, 0
    v_mov_b32 v251, 0
    v_mov_b32 v252, 0
    v_mov_b32 v253, 0
    v_mov_b32 v254, 0
    v_mov_b32 v255, 0
    s_cmp_ge_u32 s40, 672
    s_cbranch_scc1 .ppo_3
    s_load_dwordx2 s[32:33], s[0:1], 8
    s_mul_i32 s42, s40, 293
    s_lshr_b32 s42, s42, 11
    s_mul_i32 s43, s42, 7
    s_sub_u32 s43, s40, s43
    s_mul_i32 s44, s42, 43
    s_lshr_b32 s44, s44, 8
    s_mul_i32 s45, s44, 6
    s_sub_u32 s45, s42, s45
    s_lshr_b32 s46, s45, 1
    s_mul_i32 s46, s46, 896
    s_mul_i32 s47, s44, 56
    s_add_u32 s46, s46, s47
    s_and_b32 s47, s45, 1
    s_lshl_b32 s48, s47, 5
    s_add_u32 s46, s46, s48
    s_mul_i32 s48, s43, 172032
    s_add_u32 s46, s46, s48
    v_lshrrev_b32 v5, 1, v1
    v_lshlrev_b32 v5, 4, v5
    v_and_b32 v6, 1, v1
    v_lshl_add_u32 v5, v6, 2, v5
    v_mul_u32_u24 v5, 2688, v5
    v_lshl_add_u32 v5, v2, 1, v5
    s_lshl_b32 s48, s47, 4
    v_add_u32 v6, s48, v2
    s_lshl_b32 s41, s40, 11
    s_add_u32 s41, s41, 14680064
    s_waitcnt lgkmcnt(0)
    s_and_b32 s33, s33, 0xffff
    s_mov_b32 s34, 1204224
    s_mov_b32 s35, 0x00020000
    v_cmp_gt_u32 vcc, 28, v6
    s_and_saveexec_b64 s[50:51], vcc
    s_add_u32 s48, s46, 0
    buffer_load_ushort v240, v5, s[32:35], s48 offen
    s_add_u32 s48, s46, 2688
    buffer_load_ushort v241, v5, s[32:35], s48 offen
    s_add_u32 s48, s46, 21504
    buffer_load_ushort v242, v5, s[32:35], s48 offen
    s_add_u32 s48, s46, 24192
    buffer_load_ushort v243, v5, s[32:35], s48 offen
    s_add_u32 s48, s46, 5376
    buffer_load_ushort v244, v5, s[32:35], s48 offen
    s_add_u32 s48, s46, 8064
    buffer_load_ushort v245, v5, s[32:35], s48 offen
    s_add_u32 s48, s46, 26880
    buffer_load_ushort v246, v5, s[32:35], s48 offen
    s_add_u32 s48, s46, 29568
    buffer_load_ushort v247, v5, s[32:35], s48 offen
    s_add_u32 s48, s46, 86016
    buffer_load_ushort v248, v5, s[32:35], s48 offen
    s_add_u32 s48, s46, 88704
    buffer_load_ushort v249, v5, s[32:35], s48 offen
    s_add_u32 s48, s46, 107520
    buffer_load_ushort v250, v5, s[32:35], s48 offen
    s_add_u32 s48, s46, 110208
    buffer_load_ushort v251, v5, s[32:35], s48 offen
    s_add_u32 s48, s46, 91392
    buffer_load_ushort v252, v5, s[32:35], s48 offen
    s_add_u32 s48, s46, 94080
    buffer_load_ushort v253, v5, s[32:35], s48 offen
    s_add_u32 s48, s46, 112896
    buffer_load_ushort v254, v5, s[32:35], s48 offen
    s_add_u32 s48, s46, 115584
    buffer_load_ushort v255, v5, s[32:35], s48 offen
    s_mov_b64 exec, s[50:51]
    s_branch .pps_4
.ppo_3:
    s_load_dwordx2 s[32:33], s[0:1], 16
    s_sub_u32 s40, s40, 672
    s_mul_i32 s42, s40, 293
    s_lshr_b32 s42, s42, 12
    s_mul_i32 s43, s42, 14
    s_sub_u32 s43, s40, s43
    s_mul_i32 s46, s42, 25088
    s_lshl_b32 s47, s43, 6
    s_add_u32 s46, s46, s47
    v_lshrrev_b32 v5, 2, v2
    v_lshlrev_b32 v5, 3, v5
    v_and_b32 v6, 3, v2
    v_add_u32 v5, v5, v6
    v_lshlrev_b32 v5, 1, v5
    v_mul_u32_u24 v6, 3584, v1
    v_add_u32 v5, v5, v6
    s_lshl_b32 s41, s40, 11
    s_add_u32 s41, s41, 16056320
    s_waitcnt lgkmcnt(0)
    s_and_b32 s33, s33, 0xffff
    s_mov_b32 s34, 401408
    s_mov_b32 s35, 0x00020000
    s_add_u32 s48, s46, 0
    buffer_load_ushort v240, v5, s[32:35], s48 offen offset:0
    s_add_u32 s48, s46, 896
    buffer_load_ushort v241, v5, s[32:35], s48 offen offset:0
    s_add_u32 s48, s46, 1792
    buffer_load_ushort v242, v5, s[32:35], s48 offen offset:0
    s_add_u32 s48, s46, 2688
    buffer_load_ushort v243, v5, s[32:35], s48 offen offset:0
    s_add_u32 s48, s46, 0
    buffer_load_ushort v248, v5, s[32:35], s48 offen offset:8
    s_add_u32 s48, s46, 896
    buffer_load_ushort v249, v5, s[32:35], s48 offen offset:8
    s_add_u32 s48, s46, 1792
    buffer_load_ushort v250, v5, s[32:35], s48 offen offset:8
    s_add_u32 s48, s46, 2688
    buffer_load_ushort v251, v5, s[32:35], s48 offen offset:8
    v_cmp_gt_u32 vcc, 3, v1
    s_and_saveexec_b64 s[50:51], vcc
    s_add_u32 s48, s46, 14336
    buffer_load_ushort v244, v5, s[32:35], s48 offen offset:0
    s_add_u32 s48, s46, 15232
    buffer_load_ushort v245, v5, s[32:35], s48 offen offset:0
    s_add_u32 s48, s46, 16128
    buffer_load_ushort v246, v5, s[32:35], s48 offen offset:0
    s_add_u32 s48, s46, 17024
    buffer_load_ushort v247, v5, s[32:35], s48 offen offset:0
    s_add_u32 s48, s46, 14336
    buffer_load_ushort v252, v5, s[32:35], s48 offen offset:8
    s_add_u32 s48, s46, 15232
    buffer_load_ushort v253, v5, s[32:35], s48 offen offset:8
    s_add_u32 s48, s46, 16128
    buffer_load_ushort v254, v5, s[32:35], s48 offen offset:8
    s_add_u32 s48, s46, 17024
    buffer_load_ushort v255, v5, s[32:35], s48 offen offset:8
    s_mov_b64 exec, s[50:51]
.pps_4:
    s_waitcnt lgkmcnt(0)
    ds_read_b128 a[240:243], v11 offset:20480
    ds_read_b128 a[244:247], v11 offset:21504
    ds_read_b128 a[248:251], v11 offset:22528
    ds_read_b128 a[252:255], v11 offset:23552
    v_mfma_f32_16x16x32_bf16 a[0:3], a[224:227], v[208:211], a[0:3]
    v_mfma_f32_16x16x32_bf16 a[4:7], a[228:231], v[208:211], a[4:7]
    v_mfma_f32_16x16x32_bf16 a[8:11], a[232:235], v[208:211], a[8:11]
    v_mfma_f32_16x16x32_bf16 a[12:15], a[236:239], v[208:211], a[12:15]
    s_waitcnt vmcnt(32)
    v_mfma_f32_16x16x32_bf16 a[16:19], a[224:227], v[212:215], a[16:19]
    v_perm_b32 v208, v180, v176, s38
    v_mfma_f32_16x16x32_bf16 a[20:23], a[228:231], v[212:215], a[20:23]
    v_perm_b32 v209, v188, v184, s38
    v_mfma_f32_16x16x32_bf16 a[24:27], a[232:235], v[212:215], a[24:27]
    v_perm_b32 v210, v196, v192, s38
    v_mfma_f32_16x16x32_bf16 a[28:31], a[236:239], v[212:215], a[28:31]
    v_perm_b32 v211, v204, v200, s38
    v_mfma_f32_16x16x32_bf16 a[32:35], a[224:227], v[216:219], a[32:35]
    v_perm_b32 v212, v180, v176, s39
    v_mfma_f32_16x16x32_bf16 a[36:39], a[228:231], v[216:219], a[36:39]
    v_perm_b32 v213, v188, v184, s39
    v_mfma_f32_16x16x32_bf16 a[40:43], a[232:235], v[216:219], a[40:43]
    v_perm_b32 v214, v196, v192, s39
    v_mfma_f32_16x16x32_bf16 a[44:47], a[236:239], v[216:219], a[44:47]
    v_perm_b32 v215, v204, v200, s39
    v_mfma_f32_16x16x32_bf16 a[48:51], a[224:227], v[220:223], a[48:51]
    v_perm_b32 v216, v181, v177, s38
    v_mfma_f32_16x16x32_bf16 a[52:55], a[228:231], v[220:223], a[52:55]
    v_perm_b32 v217, v189, v185, s38
    v_mfma_f32_16x16x32_bf16 a[56:59], a[232:235], v[220:223], a[56:59]
    v_perm_b32 v218, v197, v193, s38
    v_mfma_f32_16x16x32_bf16 a[60:63], a[236:239], v[220:223], a[60:63]
    v_perm_b32 v219, v205, v201, s38
    v_mfma_f32_16x16x32_bf16 a[64:67], a[224:227], v[224:227], a[64:67]
    v_perm_b32 v220, v181, v177, s39
    v_mfma_f32_16x16x32_bf16 a[68:71], a[228:231], v[224:227], a[68:71]
    v_perm_b32 v221, v189, v185, s39
    v_mfma_f32_16x16x32_bf16 a[72:75], a[232:235], v[224:227], a[72:75]
    v_perm_b32 v222, v197, v193, s39
    v_mfma_f32_16x16x32_bf16 a[76:79], a[236:239], v[224:227], a[76:79]
    v_perm_b32 v223, v205, v201, s39
    v_mfma_f32_16x16x32_bf16 a[80:83], a[224:227], v[228:231], a[80:83]
    v_perm_b32 v224, v182, v178, s38
    v_mfma_f32_16x16x32_bf16 a[84:87], a[228:231], v[228:231], a[84:87]
    v_perm_b32 v225, v190, v186, s38
    v_mfma_f32_16x16x32_bf16 a[88:91], a[232:235], v[228:231], a[88:91]
    v_perm_b32 v226, v198, v194, s38
    v_mfma_f32_16x16x32_bf16 a[92:95], a[236:239], v[228:231], a[92:95]
    v_perm_b32 v227, v206, v202, s38
    v_mfma_f32_16x16x32_bf16 a[96:99], a[224:227], v[232:235], a[96:99]
    v_perm_b32 v228, v182, v178, s39
    v_mfma_f32_16x16x32_bf16 a[100:103], a[228:231], v[232:235], a[100:103]
    v_perm_b32 v229, v190, v186, s39
    v_mfma_f32_16x16x32_bf16 a[104:107], a[232:235], v[232:235], a[104:107]
    v_perm_b32 v230, v198, v194, s39
    v_mfma_f32_16x16x32_bf16 a[108:111], a[236:239], v[232:235], a[108:111]
    v_perm_b32 v231, v206, v202, s39
    v_mfma_f32_16x16x32_bf16 a[112:115], a[224:227], v[236:239], a[112:115]
    v_perm_b32 v232, v183, v179, s38
    v_mfma_f32_16x16x32_bf16 a[116:119], a[228:231], v[236:239], a[116:119]
    v_perm_b32 v233, v191, v187, s38
    v_mfma_f32_16x16x32_bf16 a[120:123], a[232:235], v[236:239], a[120:123]
    v_perm_b32 v234, v199, v195, s38
    v_mfma_f32_16x16x32_bf16 a[124:127], a[236:239], v[236:239], a[124:127]
    v_perm_b32 v235, v207, v203, s38
    s_nop 1
    v_perm_b32 v236, v183, v179, s39
    v_perm_b32 v237, v191, v187, s39
    v_perm_b32 v238, v199, v195, s39
    v_perm_b32 v239, v207, v203, s39
    s_nop 1
    s_waitcnt lgkmcnt(0)
    ds_read_b128 a[224:227], v11 offset:24576
    ds_read_b128 a[228:231], v11 offset:25600
    ds_read_b128 a[232:235], v11 offset:26624
    ds_read_b128 a[236:239], v11 offset:27648
    v_mfma_f32_16x16x32_bf16 a[0:3], a[240:243], v[208:211], a[0:3]
    v_mfma_f32_16x16x32_bf16 a[4:7], a[244:247], v[208:211], a[4:7]
    v_mfma_f32_16x16x32_bf16 a[8:11], a[248:251], v[208:211], a[8:11]
    v_mfma_f32_16x16x32_bf16 a[12:15], a[252:255], v[208:211], a[12:15]
    s_waitcnt vmcnt(24)
    v_mfma_f32_16x16x32_bf16 a[16:19], a[240:243], v[212:215], a[16:19]
    v_perm_b32 v208, v20, v16, s38
    v_mfma_f32_16x16x32_bf16 a[20:23], a[244:247], v[212:215], a[20:23]
    v_perm_b32 v209, v28, v24, s38
    v_mfma_f32_16x16x32_bf16 a[24:27], a[248:251], v[212:215], a[24:27]
    v_perm_b32 v210, v36, v32, s38
    v_mfma_f32_16x16x32_bf16 a[28:31], a[252:255], v[212:215], a[28:31]
    v_perm_b32 v211, v44, v40, s38
    v_mfma_f32_16x16x32_bf16 a[32:35], a[240:243], v[216:219], a[32:35]
    v_perm_b32 v212, v20, v16, s39
    v_mfma_f32_16x16x32_bf16 a[36:39], a[244:247], v[216:219], a[36:39]
    v_perm_b32 v213, v28, v24, s39
    v_mfma_f32_16x16x32_bf16 a[40:43], a[248:251], v[216:219], a[40:43]
    v_perm_b32 v214, v36, v32, s39
    v_mfma_f32_16x16x32_bf16 a[44:47], a[252:255], v[216:219], a[44:47]
    v_perm_b32 v215, v44, v40, s39
    v_mfma_f32_16x16x32_bf16 a[48:51], a[240:243], v[220:223], a[48:51]
    v_perm_b32 v216, v21, v17, s38
    v_mfma_f32_16x16x32_bf16 a[52:55], a[244:247], v[220:223], a[52:55]
    v_perm_b32 v217, v29, v25, s38
    v_mfma_f32_16x16x32_bf16 a[56:59], a[248:251], v[220:223], a[56:59]
    v_perm_b32 v218, v37, v33, s38
    v_mfma_f32_16x16x32_bf16 a[60:63], a[252:255], v[220:223], a[60:63]
    v_perm_b32 v219, v45, v41, s38
    v_mfma_f32_16x16x32_bf16 a[64:67], a[240:243], v[224:227], a[64:67]
    v_perm_b32 v220, v21, v17, s39
    v_mfma_f32_16x16x32_bf16 a[68:71], a[244:247], v[224:227], a[68:71]
    v_perm_b32 v221, v29, v25, s39
    v_mfma_f32_16x16x32_bf16 a[72:75], a[248:251], v[224:227], a[72:75]
    v_perm_b32 v222, v37, v33, s39
    v_mfma_f32_16x16x32_bf16 a[76:79], a[252:255], v[224:227], a[76:79]
    v_perm_b32 v223, v45, v41, s39
    v_mfma_f32_16x16x32_bf16 a[80:83], a[240:243], v[228:231], a[80:83]
    v_perm_b32 v224, v22, v18, s38
    v_mfma_f32_16x16x32_bf16 a[84:87], a[244:247], v[228:231], a[84:87]
    v_perm_b32 v225, v30, v26, s38
    v_mfma_f32_16x16x32_bf16 a[88:91], a[248:251], v[228:231], a[88:91]
    v_perm_b32 v226, v38, v34, s38
    v_mfma_f32_16x16x32_bf16 a[92:95], a[252:255], v[228:231], a[92:95]
    v_perm_b32 v227, v46, v42, s38
    v_mfma_f32_16x16x32_bf16 a[96:99], a[240:243], v[232:235], a[96:99]
    v_perm_b32 v228, v22, v18, s39
    v_mfma_f32_16x16x32_bf16 a[100:103], a[244:247], v[232:235], a[100:103]
    v_perm_b32 v229, v30, v26, s39
    v_mfma_f32_16x16x32_bf16 a[104:107], a[248:251], v[232:235], a[104:107]
    v_perm_b32 v230, v38, v34, s39
    v_mfma_f32_16x16x32_bf16 a[108:111], a[252:255], v[232:235], a[108:111]
    v_perm_b32 v231, v46, v42, s39
    v_mfma_f32_16x16x32_bf16 a[112:115], a[240:243], v[236:239], a[112:115]
    v_perm_b32 v232, v23, v19, s38
    v_mfma_f32_16x16x32_bf16 a[116:119], a[244:247], v[236:239], a[116:119]
    v_perm_b32 v233, v31, v27, s38
    v_mfma_f32_16x16x32_bf16 a[120:123], a[248:251], v[236:239], a[120:123]
    v_perm_b32 v234, v39, v35, s38
    v_mfma_f32_16x16x32_bf16 a[124:127], a[252:255], v[236:239], a[124:127]
    v_perm_b32 v235, v47, v43, s38
    s_nop 1
    v_perm_b32 v236, v23, v19, s39
    v_perm_b32 v237, v31, v27, s39
    v_perm_b32 v238, v39, v35, s39
    v_perm_b32 v239, v47, v43, s39
    s_nop 1
    s_waitcnt lgkmcnt(0)
    ds_read_b128 a[240:243], v11 offset:28672
    ds_read_b128 a[244:247], v11 offset:29696
    ds_read_b128 a[248:251], v11 offset:30720
    ds_read_b128 a[252:255], v11 offset:31744
    v_mfma_f32_16x16x32_bf16 a[0:3], a[224:227], v[208:211], a[0:3]
    v_mfma_f32_16x16x32_bf16 a[4:7], a[228:231], v[208:211], a[4:7]
    v_mfma_f32_16x16x32_bf16 a[8:11], a[232:235], v[208:211], a[8:11]
    v_mfma_f32_16x16x32_bf16 a[12:15], a[236:239], v[208:211], a[12:15]
    s_waitcnt vmcnt(16)
    v_mfma_f32_16x16x32_bf16 a[16:19], a[224:227], v[212:215], a[16:19]
    v_perm_b32 v208, v52, v48, s38
    v_mfma_f32_16x16x32_bf16 a[20:23], a[228:231], v[212:215], a[20:23]
    v_perm_b32 v209, v60, v56, s38
    v_mfma_f32_16x16x32_bf16 a[24:27], a[232:235], v[212:215], a[24:27]
    v_perm_b32 v210, v68, v64, s38
    v_mfma_f32_16x16x32_bf16 a[28:31], a[236:239], v[212:215], a[28:31]
    v_perm_b32 v211, v76, v72, s38
    v_mfma_f32_16x16x32_bf16 a[32:35], a[224:227], v[216:219], a[32:35]
    v_perm_b32 v212, v52, v48, s39
    v_mfma_f32_16x16x32_bf16 a[36:39], a[228:231], v[216:219], a[36:39]
    v_perm_b32 v213, v60, v56, s39
    v_mfma_f32_16x16x32_bf16 a[40:43], a[232:235], v[216:219], a[40:43]
    v_perm_b32 v214, v68, v64, s39
    v_mfma_f32_16x16x32_bf16 a[44:47], a[236:239], v[216:219], a[44:47]
    v_perm_b32 v215, v76, v72, s39
    v_mfma_f32_16x16x32_bf16 a[48:51], a[224:227], v[220:223], a[48:51]
    v_perm_b32 v216, v53, v49, s38
    v_mfma_f32_16x16x32_bf16 a[52:55], a[228:231], v[220:223], a[52:55]
    v_perm_b32 v217, v61, v57, s38
    v_mfma_f32_16x16x32_bf16 a[56:59], a[232:235], v[220:223], a[56:59]
    v_perm_b32 v218, v69, v65, s38
    v_mfma_f32_16x16x32_bf16 a[60:63], a[236:239], v[220:223], a[60:63]
    v_perm_b32 v219, v77, v73, s38
    v_mfma_f32_16x16x32_bf16 a[64:67], a[224:227], v[224:227], a[64:67]
    v_perm_b32 v220, v53, v49, s39
    v_mfma_f32_16x16x32_bf16 a[68:71], a[228:231], v[224:227], a[68:71]
    v_perm_b32 v221, v61, v57, s39
    v_mfma_f32_16x16x32_bf16 a[72:75], a[232:235], v[224:227], a[72:75]
    v_perm_b32 v222, v69, v65, s39
    v_mfma_f32_16x16x32_bf16 a[76:79], a[236:239], v[224:227], a[76:79]
    v_perm_b32 v223, v77, v73, s39
    v_mfma_f32_16x16x32_bf16 a[80:83], a[224:227], v[228:231], a[80:83]
    v_perm_b32 v224, v54, v50, s38
    v_mfma_f32_16x16x32_bf16 a[84:87], a[228:231], v[228:231], a[84:87]
    v_perm_b32 v225, v62, v58, s38
    v_mfma_f32_16x16x32_bf16 a[88:91], a[232:235], v[228:231], a[88:91]
    v_perm_b32 v226, v70, v66, s38
    v_mfma_f32_16x16x32_bf16 a[92:95], a[236:239], v[228:231], a[92:95]
    v_perm_b32 v227, v78, v74, s38
    v_mfma_f32_16x16x32_bf16 a[96:99], a[224:227], v[232:235], a[96:99]
    v_perm_b32 v228, v54, v50, s39
    v_mfma_f32_16x16x32_bf16 a[100:103], a[228:231], v[232:235], a[100:103]
    v_perm_b32 v229, v62, v58, s39
    v_mfma_f32_16x16x32_bf16 a[104:107], a[232:235], v[232:235], a[104:107]
    v_perm_b32 v230, v70, v66, s39
    v_mfma_f32_16x16x32_bf16 a[108:111], a[236:239], v[232:235], a[108:111]
    v_perm_b32 v231, v78, v74, s39
    v_mfma_f32_16x16x32_bf16 a[112:115], a[224:227], v[236:239], a[112:115]
    v_perm_b32 v232, v55, v51, s38
    v_mfma_f32_16x16x32_bf16 a[116:119], a[228:231], v[236:239], a[116:119]
    v_perm_b32 v233, v63, v59, s38
    v_mfma_f32_16x16x32_bf16 a[120:123], a[232:235], v[236:239], a[120:123]
    v_perm_b32 v234, v71, v67, s38
    v_mfma_f32_16x16x32_bf16 a[124:127], a[236:239], v[236:239], a[124:127]
    v_perm_b32 v235, v79, v75, s38
    s_nop 1
    v_perm_b32 v236, v55, v51, s39
    v_perm_b32 v237, v63, v59, s39
    v_perm_b32 v238, v71, v67, s39
    v_perm_b32 v239, v79, v75, s39
    s_nop 1
    s_waitcnt lgkmcnt(0)
    v_mfma_f32_16x16x32_bf16 a[0:3], a[240:243], v[208:211], a[0:3]
    v_mfma_f32_16x16x32_bf16 a[4:7], a[244:247], v[208:211], a[4:7]
    v_mfma_f32_16x16x32_bf16 a[8:11], a[248:251], v[208:211], a[8:11]
    v_mfma_f32_16x16x32_bf16 a[12:15], a[252:255], v[208:211], a[12:15]
    v_mfma_f32_16x16x32_bf16 a[16:19], a[240:243], v[212:215], a[16:19]
    v_mfma_f32_16x16x32_bf16 a[20:23], a[244:247], v[212:215], a[20:23]
    v_mfma_f32_16x16x32_bf16 a[24:27], a[248:251], v[212:215], a[24:27]
    v_mfma_f32_16x16x32_bf16 a[28:31], a[252:255], v[212:215], a[28:31]
    v_mfma_f32_16x16x32_bf16 a[32:35], a[240:243], v[216:219], a[32:35]
    v_mfma_f32_16x16x32_bf16 a[36:39], a[244:247], v[216:219], a[36:39]
    v_mfma_f32_16x16x32_bf16 a[40:43], a[248:251], v[216:219], a[40:43]
    v_mfma_f32_16x16x32_bf16 a[44:47], a[252:255], v[216:219], a[44:47]
    v_mfma_f32_16x16x32_bf16 a[48:51], a[240:243], v[220:223], a[48:51]
    v_mfma_f32_16x16x32_bf16 a[52:55], a[244:247], v[220:223], a[52:55]
    v_mfma_f32_16x16x32_bf16 a[56:59], a[248:251], v[220:223], a[56:59]
    v_mfma_f32_16x16x32_bf16 a[60:63], a[252:255], v[220:223], a[60:63]
    v_mfma_f32_16x16x32_bf16 a[64:67], a[240:243], v[224:227], a[64:67]
    v_mfma_f32_16x16x32_bf16 a[68:71], a[244:247], v[224:227], a[68:71]
    v_mfma_f32_16x16x32_bf16 a[72:75], a[248:251], v[224:227], a[72:75]
    v_mfma_f32_16x16x32_bf16 a[76:79], a[252:255], v[224:227], a[76:79]
    v_mfma_f32_16x16x32_bf16 a[80:83], a[240:243], v[228:231], a[80:83]
    v_mfma_f32_16x16x32_bf16 a[84:87], a[244:247], v[228:231], a[84:87]
    v_mfma_f32_16x16x32_bf16 a[88:91], a[248:251], v[228:231], a[88:91]
    v_mfma_f32_16x16x32_bf16 a[92:95], a[252:255], v[228:231], a[92:95]
    v_mfma_f32_16x16x32_bf16 a[96:99], a[240:243], v[232:235], a[96:99]
    v_mfma_f32_16x16x32_bf16 a[100:103], a[244:247], v[232:235], a[100:103]
    v_mfma_f32_16x16x32_bf16 a[104:107], a[248:251], v[232:235], a[104:107]
    v_mfma_f32_16x16x32_bf16 a[108:111], a[252:255], v[232:235], a[108:111]
    v_mfma_f32_16x16x32_bf16 a[112:115], a[240:243], v[236:239], a[112:115]
    v_mfma_f32_16x16x32_bf16 a[116:119], a[244:247], v[236:239], a[116:119]
    v_mfma_f32_16x16x32_bf16 a[120:123], a[248:251], v[236:239], a[120:123]
    v_mfma_f32_16x16x32_bf16 a[124:127], a[252:255], v[236:239], a[124:127]
    s_nop 1
    s_barrier
    s_waitcnt vmcnt(0)
    buffer_load_dword v15, v14, s[20:23], 0 offen
    v_lshl_or_b32 v240, v241, 16, v240
    v_lshl_or_b32 v241, v243, 16, v242
    v_lshl_or_b32 v242, v245, 16, v244
    v_lshl_or_b32 v243, v247, 16, v246
    v_lshl_or_b32 v244, v249, 16, v248
    v_lshl_or_b32 v245, v251, 16, v250
    v_lshl_or_b32 v246, v253, 16, v252
    v_lshl_or_b32 v247, v255, 16, v254
    buffer_store_dwordx4 v[240:243], v3, s[8:11], s41 offen offset:0 sc1
    buffer_store_dwordx4 v[244:247], v3, s[8:11], s41 offen offset:1024 sc1
    s_lshl_b32 s44, s3, 7
    v_lshl_add_u32 v4, v2, 3, s44
    v_mul_u32_u24 v9, 448, v1
    v_cmp_gt_u32 vcc, 448, v4
    s_and_saveexec_b64 s[50:51], vcc
    v_add_u32 v5, 0, v4
    v_mul_u32_u24 v6, 2341, v5
    v_lshrrev_b32 v6, 16, v6
    v_mul_u32_u24 v7, 28, v6
    v_sub_u32 v7, v5, v7
    v_lshrrev_b32 v7, 1, v7
    v_mul_u32_u24 v6, 3584, v6
    v_lshl_add_u32 v7, v7, 4, v9
    v_add_u32 v8, v6, v7
    v_accvgpr_read_b32 v16, a0
    v_accvgpr_read_b32 v17, a1
    v_accvgpr_read_b32 v18, a2
    v_accvgpr_read_b32 v19, a3
    v_accvgpr_read_b32 v20, a4
    v_accvgpr_read_b32 v21, a5
    v_accvgpr_read_b32 v22, a6
    v_accvgpr_read_b32 v23, a7
    v_accvgpr_read_b32 v24, a8
    v_accvgpr_read_b32 v25, a9
    v_accvgpr_read_b32 v26, a10
    v_accvgpr_read_b32 v27, a11
    v_accvgpr_read_b32 v28, a12
    v_accvgpr_read_b32 v29, a13
    v_accvgpr_read_b32 v30, a14
    v_accvgpr_read_b32 v31, a15
    v_cvt_pk_bf16_f32 v64, v16, v17
    v_cvt_pk_bf16_f32 v65, v18, v19
    v_cvt_pk_bf16_f32 v66, v20, v21
    v_cvt_pk_bf16_f32 v67, v22, v23
    ds_write_b128 v8, v[64:67] offset:64
    v_cvt_pk_bf16_f32 v68, v24, v25
    v_cvt_pk_bf16_f32 v69, v26, v27
    v_cvt_pk_bf16_f32 v70, v28, v29
    v_cvt_pk_bf16_f32 v71, v30, v31
    ds_write_b128 v8, v[68:71] offset:1856
    v_add_u32 v5, 1, v4
    v_mul_u32_u24 v6, 2341, v5
    v_lshrrev_b32 v6, 16, v6
    v_mul_u32_u24 v7, 28, v6
    v_sub_u32 v7, v5, v7
    v_lshrrev_b32 v7, 1, v7
    v_mul_u32_u24 v6, 3584, v6
    v_lshl_add_u32 v7, v7, 4, v9
    v_add_u32 v8, v6, v7
    v_accvgpr_read_b32 v16, a16
    v_accvgpr_read_b32 v17, a17
    v_accvgpr_read_b32 v18, a18
    v_accvgpr_read_b32 v19, a19
    v_accvgpr_read_b32 v20, a20
    v_accvgpr_read_b32 v21, a21
    v_accvgpr_read_b32 v22, a22
    v_accvgpr_read_b32 v23, a23
    v_accvgpr_read_b32 v24, a24
    v_accvgpr_read_b32 v25, a25
    v_accvgpr_read_b32 v26, a26
    v_accvgpr_read_b32 v27, a27
    v_accvgpr_read_b32 v28, a28
    v_accvgpr_read_b32 v29, a29
    v_accvgpr_read_b32 v30, a30
    v_accvgpr_read_b32 v31, a31
    v_cvt_pk_bf16_f32 v72, v16, v17
    v_cvt_pk_bf16_f32 v73, v18, v19
    v_cvt_pk_bf16_f32 v74, v20, v21
    v_cvt_pk_bf16_f32 v75, v22, v23
    ds_write_b128 v8, v[72:75] offset:288
    v_cvt_pk_bf16_f32 v76, v24, v25
    v_cvt_pk_bf16_f32 v77, v26, v27
    v_cvt_pk_bf16_f32 v78, v28, v29
    v_cvt_pk_bf16_f32 v79, v30, v31
    ds_write_b128 v8, v[76:79] offset:2080
    v_add_u32 v5, 2, v4
    v_mul_u32_u24 v6, 2341, v5
    v_lshrrev_b32 v6, 16, v6
    v_mul_u32_u24 v7, 28, v6
    v_sub_u32 v7, v5, v7
    v_lshrrev_b32 v7, 1, v7
    v_mul_u32_u24 v6, 3584, v6
    v_lshl_add_u32 v7, v7, 4, v9
    v_add_u32 v8, v6, v7
    v_accvgpr_read_b32 v16, a32
    v_accvgpr_read_b32 v17, a33
    v_accvgpr_read_b32 v18, a34
    v_accvgpr_read_b32 v19, a35
    v_accvgpr_read_b32 v20, a36
    v_accvgpr_read_b32 v21, a37
    v_accvgpr_read_b32 v22, a38
    v_accvgpr_read_b32 v23, a39
    v_accvgpr_read_b32 v24, a40
    v_accvgpr_read_b32 v25, a41
    v_accvgpr_read_b32 v26, a42
    v_accvgpr_read_b32 v27, a43
    v_accvgpr_read_b32 v28, a44
    v_accvgpr_read_b32 v29, a45
    v_accvgpr_read_b32 v30, a46
    v_accvgpr_read_b32 v31, a47
    v_cvt_pk_bf16_f32 v80, v16, v17
    v_cvt_pk_bf16_f32 v81, v18, v19
    v_cvt_pk_bf16_f32 v82, v20, v21
    v_cvt_pk_bf16_f32 v83, v22, v23
    ds_write_b128 v8, v[80:83] offset:64
    v_cvt_pk_bf16_f32 v84, v24, v25
    v_cvt_pk_bf16_f32 v85, v26, v27
    v_cvt_pk_bf16_f32 v86, v28, v29
    v_cvt_pk_bf16_f32 v87, v30, v31
    ds_write_b128 v8, v[84:87] offset:1856
    v_add_u32 v5, 3, v4
    v_mul_u32_u24 v6, 2341, v5
    v_lshrrev_b32 v6, 16, v6
    v_mul_u32_u24 v7, 28, v6
    v_sub_u32 v7, v5, v7
    v_lshrrev_b32 v7, 1, v7
    v_mul_u32_u24 v6, 3584, v6
    v_lshl_add_u32 v7, v7, 4, v9
    v_add_u32 v8, v6, v7
    v_accvgpr_read_b32 v16, a48
    v_accvgpr_read_b32 v17, a49
    v_accvgpr_read_b32 v18, a50
    v_accvgpr_read_b32 v19, a51
    v_accvgpr_read_b32 v20, a52
    v_accvgpr_read_b32 v21, a53
    v_accvgpr_read_b32 v22, a54
    v_accvgpr_read_b32 v23, a55
    v_accvgpr_read_b32 v24, a56
    v_accvgpr_read_b32 v25, a57
    v_accvgpr_read_b32 v26, a58
    v_accvgpr_read_b32 v27, a59
    v_accvgpr_read_b32 v28, a60
    v_accvgpr_read_b32 v29, a61
    v_accvgpr_read_b32 v30, a62
    v_accvgpr_read_b32 v31, a63
    v_cvt_pk_bf16_f32 v88, v16, v17
    v_cvt_pk_bf16_f32 v89, v18, v19
    v_cvt_pk_bf16_f32 v90, v20, v21
    v_cvt_pk_bf16_f32 v91, v22, v23
    ds_write_b128 v8, v[88:91] offset:288
    v_cvt_pk_bf16_f32 v92, v24, v25
    v_cvt_pk_bf16_f32 v93, v26, v27
    v_cvt_pk_bf16_f32 v94, v28, v29
    v_cvt_pk_bf16_f32 v95, v30, v31
    ds_write_b128 v8, v[92:95] offset:2080
    v_add_u32 v5, 4, v4
    v_mul_u32_u24 v6, 2341, v5
    v_lshrrev_b32 v6, 16, v6
    v_mul_u32_u24 v7, 28, v6
    v_sub_u32 v7, v5, v7
    v_lshrrev_b32 v7, 1, v7
    v_mul_u32_u24 v6, 3584, v6
    v_lshl_add_u32 v7, v7, 4, v9
    v_add_u32 v8, v6, v7
    v_accvgpr_read_b32 v16, a64
    v_accvgpr_read_b32 v17, a65
    v_accvgpr_read_b32 v18, a66
    v_accvgpr_read_b32 v19, a67
    v_accvgpr_read_b32 v20, a68
    v_accvgpr_read_b32 v21, a69
    v_accvgpr_read_b32 v22, a70
    v_accvgpr_read_b32 v23, a71
    v_accvgpr_read_b32 v24, a72
    v_accvgpr_read_b32 v25, a73
    v_accvgpr_read_b32 v26, a74
    v_accvgpr_read_b32 v27, a75
    v_accvgpr_read_b32 v28, a76
    v_accvgpr_read_b32 v29, a77
    v_accvgpr_read_b32 v30, a78
    v_accvgpr_read_b32 v31, a79
    v_cvt_pk_bf16_f32 v96, v16, v17
    v_cvt_pk_bf16_f32 v97, v18, v19
    v_cvt_pk_bf16_f32 v98, v20, v21
    v_cvt_pk_bf16_f32 v99, v22, v23
    ds_write_b128 v8, v[96:99] offset:64
    v_cvt_pk_bf16_f32 v100, v24, v25
    v_cvt_pk_bf16_f32 v101, v26, v27
    v_cvt_pk_bf16_f32 v102, v28, v29
    v_cvt_pk_bf16_f32 v103, v30, v31
    ds_write_b128 v8, v[100:103] offset:1856
    v_add_u32 v5, 5, v4
    v_mul_u32_u24 v6, 2341, v5
    v_lshrrev_b32 v6, 16, v6
    v_mul_u32_u24 v7, 28, v6
    v_sub_u32 v7, v5, v7
    v_lshrrev_b32 v7, 1, v7
    v_mul_u32_u24 v6, 3584, v6
    v_lshl_add_u32 v7, v7, 4, v9
    v_add_u32 v8, v6, v7
    v_accvgpr_read_b32 v16, a80
    v_accvgpr_read_b32 v17, a81
    v_accvgpr_read_b32 v18, a82
    v_accvgpr_read_b32 v19, a83
    v_accvgpr_read_b32 v20, a84
    v_accvgpr_read_b32 v21, a85
    v_accvgpr_read_b32 v22, a86
    v_accvgpr_read_b32 v23, a87
    v_accvgpr_read_b32 v24, a88
    v_accvgpr_read_b32 v25, a89
    v_accvgpr_read_b32 v26, a90
    v_accvgpr_read_b32 v27, a91
    v_accvgpr_read_b32 v28, a92
    v_accvgpr_read_b32 v29, a93
    v_accvgpr_read_b32 v30, a94
    v_accvgpr_read_b32 v31, a95
    v_cvt_pk_bf16_f32 v104, v16, v17
    v_cvt_pk_bf16_f32 v105, v18, v19
    v_cvt_pk_bf16_f32 v106, v20, v21
    v_cvt_pk_bf16_f32 v107, v22, v23
    ds_write_b128 v8, v[104:107] offset:288
    v_cvt_pk_bf16_f32 v108, v24, v25
    v_cvt_pk_bf16_f32 v109, v26, v27
    v_cvt_pk_bf16_f32 v110, v28, v29
    v_cvt_pk_bf16_f32 v111, v30, v31
    ds_write_b128 v8, v[108:111] offset:2080
    v_add_u32 v5, 6, v4
    v_mul_u32_u24 v6, 2341, v5
    v_lshrrev_b32 v6, 16, v6
    v_mul_u32_u24 v7, 28, v6
    v_sub_u32 v7, v5, v7
    v_lshrrev_b32 v7, 1, v7
    v_mul_u32_u24 v6, 3584, v6
    v_lshl_add_u32 v7, v7, 4, v9
    v_add_u32 v8, v6, v7
    v_accvgpr_read_b32 v16, a96
    v_accvgpr_read_b32 v17, a97
    v_accvgpr_read_b32 v18, a98
    v_accvgpr_read_b32 v19, a99
    v_accvgpr_read_b32 v20, a100
    v_accvgpr_read_b32 v21, a101
    v_accvgpr_read_b32 v22, a102
    v_accvgpr_read_b32 v23, a103
    v_accvgpr_read_b32 v24, a104
    v_accvgpr_read_b32 v25, a105
    v_accvgpr_read_b32 v26, a106
    v_accvgpr_read_b32 v27, a107
    v_accvgpr_read_b32 v28, a108
    v_accvgpr_read_b32 v29, a109
    v_accvgpr_read_b32 v30, a110
    v_accvgpr_read_b32 v31, a111
    v_cvt_pk_bf16_f32 v112, v16, v17
    v_cvt_pk_bf16_f32 v113, v18, v19
    v_cvt_pk_bf16_f32 v114, v20, v21
    v_cvt_pk_bf16_f32 v115, v22, v23
    ds_write_b128 v8, v[112:115] offset:64
    v_cvt_pk_bf16_f32 v116, v24, v25
    v_cvt_pk_bf16_f32 v117, v26, v27
    v_cvt_pk_bf16_f32 v118, v28, v29
    v_cvt_pk_bf16_f32 v119, v30, v31
    ds_write_b128 v8, v[116:119] offset:1856
    v_add_u32 v5, 7, v4
    v_mul_u32_u24 v6, 2341, v5
    v_lshrrev_b32 v6, 16, v6
    v_mul_u32_u24 v7, 28, v6
    v_sub_u32 v7, v5, v7
    v_lshrrev_b32 v7, 1, v7
    v_mul_u32_u24 v6, 3584, v6
    v_lshl_add_u32 v7, v7, 4, v9
    v_add_u32 v8, v6, v7
    v_accvgpr_read_b32 v16, a112
    v_accvgpr_read_b32 v17, a113
    v_accvgpr_read_b32 v18, a114
    v_accvgpr_read_b32 v19, a115
    v_accvgpr_read_b32 v20, a116
    v_accvgpr_read_b32 v21, a117
    v_accvgpr_read_b32 v22, a118
    v_accvgpr_read_b32 v23, a119
    v_accvgpr_read_b32 v24, a120
    v_accvgpr_read_b32 v25, a121
    v_accvgpr_read_b32 v26, a122
    v_accvgpr_read_b32 v27, a123
    v_accvgpr_read_b32 v28, a124
    v_accvgpr_read_b32 v29, a125
    v_accvgpr_read_b32 v30, a126
    v_accvgpr_read_b32 v31, a127
    v_cvt_pk_bf16_f32 v120, v16, v17
    v_cvt_pk_bf16_f32 v121, v18, v19
    v_cvt_pk_bf16_f32 v122, v20, v21
    v_cvt_pk_bf16_f32 v123, v22, v23
    ds_write_b128 v8, v[120:123] offset:288
    v_cvt_pk_bf16_f32 v124, v24, v25
    v_cvt_pk_bf16_f32 v125, v26, v27
    v_cvt_pk_bf16_f32 v126, v28, v29
    v_cvt_pk_bf16_f32 v127, v30, v31
    ds_write_b128 v8, v[124:127] offset:2080
    s_mov_b64 exec, s[50:51]
    s_lshr_b32 s42, s5, 2
    s_lshl_b32 s43, s3, 4
    s_add_u32 s42, s42, s43
    s_mul_i32 s42, s42, 100352
    s_lshl_b32 s43, s6, 11
    s_add_u32 s42, s42, s43
    s_add_u32 s42, s42, 6422528
    s_and_b32 s43, s5, 3
    s_mul_i32 s43, s43, 28
    s_mul_i32 s44, s3, 14336
    v_cmp_lt_u32 vcc, 27, v0
    v_add_u32 v4, s44, v3
    v_subrev_u32 v5, 28, v0
    v_cndmask_b32 v5, v0, v5, vcc
    v_cndmask_b32 v6, 0, 1, vcc
    v_add_u32 v5, s43, v5
    v_lshrrev_b32 v7, 4, v5
    v_mul_u32_u24 v7, 14336, v7
    v_and_b32 v5, 15, v5
    v_lshl_add_u32 v5, v6, 4, v5
    v_lshl_add_u32 v5, v5, 4, v7
    s_mov_b32 exec_hi, 0xffffff
    s_waitcnt lgkmcnt(0)
    s_barrier
    ds_read_b128 v[128:131], v4 offset:64
    ds_read_b128 v[132:135], v4 offset:960
    ds_read_b128 v[136:139], v4 offset:1856
    ds_read_b128 v[140:143], v4 offset:2752
    ds_read_b128 v[144:147], v4 offset:3648
    ds_read_b128 v[148:151], v4 offset:4544
    ds_read_b128 v[152:155], v4 offset:5440
    ds_read_b128 v[156:159], v4 offset:6336
    ds_read_b128 v[160:163], v4 offset:7232
    ds_read_b128 v[164:167], v4 offset:8128
    ds_read_b128 v[168:171], v4 offset:9024
    ds_read_b128 v[172:175], v4 offset:9920
    ds_read_b128 v[176:179], v4 offset:10816
    ds_read_b128 v[180:183], v4 offset:11712
    ds_read_b128 v[184:187], v4 offset:12608
    ds_read_b128 v[188:191], v4 offset:13504
    s_waitcnt lgkmcnt(15)
    buffer_store_dwordx4 v[128:131], v5, s[8:11], s42 offen offset:0 sc1
    s_waitcnt lgkmcnt(14)
    buffer_store_dwordx4 v[132:135], v5, s[8:11], s42 offen offset:512 sc1
    s_waitcnt lgkmcnt(13)
    buffer_store_dwordx4 v[136:139], v5, s[8:11], s42 offen offset:1024 sc1
    s_waitcnt lgkmcnt(12)
    buffer_store_dwordx4 v[140:143], v5, s[8:11], s42 offen offset:1536 sc1
    s_add_u32 s42, s42, 401408
    s_waitcnt lgkmcnt(11)
    buffer_store_dwordx4 v[144:147], v5, s[8:11], s42 offen offset:0 sc1
    s_waitcnt lgkmcnt(10)
    buffer_store_dwordx4 v[148:151], v5, s[8:11], s42 offen offset:512 sc1
    s_waitcnt lgkmcnt(9)
    buffer_store_dwordx4 v[152:155], v5, s[8:11], s42 offen offset:1024 sc1
    s_waitcnt lgkmcnt(8)
    buffer_store_dwordx4 v[156:159], v5, s[8:11], s42 offen offset:1536 sc1
    s_add_u32 s42, s42, 401408
    s_waitcnt lgkmcnt(7)
    buffer_store_dwordx4 v[160:163], v5, s[8:11], s42 offen offset:0 sc1
    s_waitcnt lgkmcnt(6)
    buffer_store_dwordx4 v[164:167], v5, s[8:11], s42 offen offset:512 sc1
    s_waitcnt lgkmcnt(5)
    buffer_store_dwordx4 v[168:171], v5, s[8:11], s42 offen offset:1024 sc1
    s_waitcnt lgkmcnt(4)
    buffer_store_dwordx4 v[172:175], v5, s[8:11], s42 offen offset:1536 sc1
    s_add_u32 s42, s42, 401408
    s_waitcnt lgkmcnt(3)
    buffer_store_dwordx4 v[176:179], v5, s[8:11], s42 offen offset:0 sc1
    s_waitcnt lgkmcnt(2)
    buffer_store_dwordx4 v[180:183], v5, s[8:11], s42 offen offset:512 sc1
    s_waitcnt lgkmcnt(1)
    buffer_store_dwordx4 v[184:187], v5, s[8:11], s42 offen offset:1024 sc1
    s_waitcnt lgkmcnt(0)
    buffer_store_dwordx4 v[188:191], v5, s[8:11], s42 offen offset:1536 sc1
    s_add_u32 s42, s42, 401408
    s_mov_b64 exec, -1
    s_branch .pp_done
.pp_x:
    s_load_dwordx2 s[24:25], s[0:1], 80
    s_load_dwordx2 s[28:29], s[0:1], 32
    s_sub_u32 s37, s37, 28
    s_lshl_b32 s38, s37, 3
    s_add_u32 s38, s38, s36
    s_lshl_b32 s40, s38, 2
    s_add_u32 s40, s40, s3
    s_mov_b32 s39, 8
    s_mul_i32 s41, s40, 14336
    s_mul_i32 s42, s3, 14592
    s_add_u32 s42, s42, 64
    v_add_u32 v8, 0, v3
    v_add_u32 v9, 4096, v3
    v_add_u32 v10, 8192, v3
    v_add_u32 v11, 12288, v3
    s_cmp_lg_u32 s40, 127
    s_cbranch_scc1 .pp_x1
    s_mov_b32 s43, 68124672
    v_mov_b32 v192, 0
    v_mov_b32 v193, 0
    v_mov_b32 v194, 0
    v_mov_b32 v195, 0
    buffer_store_dwordx4 v[192:195], v8, s[8:11], s43 offen offset:0 sc1
    buffer_store_dwordx4 v[192:195], v8, s[8:11], s43 offen offset:1024 sc1
    buffer_store_dwordx4 v[192:195], v8, s[8:11], s43 offen offset:2048 sc1
    buffer_store_dwordx4 v[192:195], v8, s[8:11], s43 offen offset:3072 sc1
    buffer_store_dwordx4 v[192:195], v9, s[8:11], s43 offen offset:0 sc1
    buffer_store_dwordx4 v[192:195], v9, s[8:11], s43 offen offset:1024 sc1
    buffer_store_dwordx4 v[192:195], v9, s[8:11], s43 offen offset:2048 sc1
    buffer_store_dwordx4 v[192:195], v9, s[8:11], s43 offen offset:3072 sc1
    v_mov_b32 v196, 1
    s_waitcnt vmcnt(0)
    s_mov_b64 exec, 1
    buffer_store_dword v196, v14, s[20:23], 0 offen sc1
    s_mov_b64 exec, -1
.pp_x1:
    buffer_load_dwordx4 v[128:131], v8, s[12:15], s41 offen offset:0
    buffer_load_dwordx4 v[132:135], v8, s[12:15], s41 offen offset:1024
    buffer_load_dwordx4 v[136:139], v8, s[12:15], s41 offen offset:2048
    buffer_load_dwordx4 v[140:143], v8, s[12:15], s41 offen offset:3072
    buffer_load_dwordx4 v[144:147], v9, s[12:15], s41 offen offset:0
    buffer_load_dwordx4 v[148:151], v9, s[12:15], s41 offen offset:1024
    buffer_load_dwordx4 v[152:155], v9, s[12:15], s41 offen offset:2048
    buffer_load_dwordx4 v[156:159], v9, s[12:15], s41 offen offset:3072
    buffer_load_dwordx4 v[160:163], v10, s[12:15], s41 offen offset:0
    buffer_load_dwordx4 v[164:167], v10, s[12:15], s41 offen offset:1024
    buffer_load_dwordx4 v[168:171], v10, s[12:15], s41 offen offset:2048
    buffer_load_dwordx4 v[172:175], v10, s[12:15], s41 offen offset:3072
    buffer_load_dwordx4 v[176:179], v11, s[12:15], s41 offen offset:0
    buffer_load_dwordx4 v[180:183], v11, s[12:15], s41 offen offset:1024
    s_waitcnt lgkmcnt(0)
    s_and_b32 s25, s25, 0xffff
    s_mov_b32 s26, 896
    s_mov_b32 s27, 0x00020000
    s_and_b32 s29, s29, 0xffff
    s_mov_b32 s30, 7168
    s_mov_b32 s31, 0x00020000
    buffer_load_dwordx4 v[184:187], v3, s[24:27], 0 offen
    v_add_u32 v4, 0, v0
    v_mul_u32_u24 v5, 1171, v4
    v_lshrrev_b32 v5, 16, v5
    v_add_u32 v4, v4, v5
    v_lshl_add_u32 v16, v4, 4, s42
    v_add_u32 v4, 64, v0
    v_mul_u32_u24 v5, 1171, v4
    v_lshrrev_b32 v5, 16, v5
    v_add_u32 v4, v4, v5
    v_lshl_add_u32 v17, v4, 4, s42
    v_add_u32 v4, 128, v0
    v_mul_u32_u24 v5, 1171, v4
    v_lshrrev_b32 v5, 16, v5
    v_add_u32 v4, v4, v5
    v_lshl_add_u32 v18, v4, 4, s42
    v_add_u32 v4, 192, v0
    v_mul_u32_u24 v5, 1171, v4
    v_lshrrev_b32 v5, 16, v5
    v_add_u32 v4, v4, v5
    v_lshl_add_u32 v19, v4, 4, s42
    v_add_u32 v4, 256, v0
    v_mul_u32_u24 v5, 1171, v4
    v_lshrrev_b32 v5, 16, v5
    v_add_u32 v4, v4, v5
    v_lshl_add_u32 v20, v4, 4, s42
    v_add_u32 v4, 320, v0
    v_mul_u32_u24 v5, 1171, v4
    v_lshrrev_b32 v5, 16, v5
    v_add_u32 v4, v4, v5
    v_lshl_add_u32 v21, v4, 4, s42
    v_add_u32 v4, 384, v0
    v_mul_u32_u24 v5, 1171, v4
    v_lshrrev_b32 v5, 16, v5
    v_add_u32 v4, v4, v5
    v_lshl_add_u32 v22, v4, 4, s42
    v_add_u32 v4, 448, v0
    v_mul_u32_u24 v5, 1171, v4
    v_lshrrev_b32 v5, 16, v5
    v_add_u32 v4, v4, v5
    v_lshl_add_u32 v23, v4, 4, s42
    v_add_u32 v4, 512, v0
    v_mul_u32_u24 v5, 1171, v4
    v_lshrrev_b32 v5, 16, v5
    v_add_u32 v4, v4, v5
    v_lshl_add_u32 v24, v4, 4, s42
    v_add_u32 v4, 576, v0
    v_mul_u32_u24 v5, 1171, v4
    v_lshrrev_b32 v5, 16, v5
    v_add_u32 v4, v4, v5
    v_lshl_add_u32 v25, v4, 4, s42
    v_add_u32 v4, 640, v0
    v_mul_u32_u24 v5, 1171, v4
    v_lshrrev_b32 v5, 16, v5
    v_add_u32 v4, v4, v5
    v_lshl_add_u32 v26, v4, 4, s42
    v_add_u32 v4, 704, v0
    v_mul_u32_u24 v5, 1171, v4
    v_lshrrev_b32 v5, 16, v5
    v_add_u32 v4, v4, v5
    v_lshl_add_u32 v27, v4, 4, s42
    v_add_u32 v4, 768, v0
    v_mul_u32_u24 v5, 1171, v4
    v_lshrrev_b32 v5, 16, v5
    v_add_u32 v4, v4, v5
    v_lshl_add_u32 v28, v4, 4, s42
    v_add_u32 v4, 832, v0
    v_mul_u32_u24 v5, 1171, v4
    v_lshrrev_b32 v5, 16, v5
    v_add_u32 v4, v4, v5
    v_lshl_add_u32 v29, v4, 4, s42
    s_cmp_ge_u32 s40, 110
    s_cbranch_scc1 .pp_z
    s_mul_i32 s43, s40, 14336
    s_add_u32 s43, s43, 16523264
    v_mov_b32 v192, -1
    v_mov_b32 v193, -1
    v_mov_b32 v194, -1
    v_mov_b32 v195, -1
    v_mov_b32 v196, -1
    v_mov_b32 v197, -1
    v_mov_b32 v198, -1
    v_mov_b32 v199, -1
    v_mov_b32 v200, -1
    v_mov_b32 v201, -1
    v_mov_b32 v202, -1
    v_mov_b32 v203, -1
    v_mov_b32 v204, -1
    v_mov_b32 v205, -1
    v_mov_b32 v206, -1
    v_mov_b32 v207, -1
    v_mov_b32 v208, -1
    v_mov_b32 v209, -1
    v_mov_b32 v210, -1
    v_mov_b32 v211, -1
    v_mov_b32 v212, -1
    v_mov_b32 v213, -1
    v_mov_b32 v214, -1
    v_mov_b32 v215, -1
    v_mov_b32 v216, -1
    v_mov_b32 v217, -1
    v_mov_b32 v218, -1
    v_mov_b32 v219, -1
    v_mov_b32 v220, -1
    v_mov_b32 v221, -1
    v_mov_b32 v222, -1
    v_mov_b32 v223, -1
    s_and_b32 s44, s40, 31
    s_cmp_lg_u32 s44, 0
    s_cbranch_scc1 .pp_f1
    s_cmp_ge_u32 s40, 64
    s_cbranch_scc1 .pp_f1
    s_cmp_lg_u32 s40, 0
    s_cbranch_scc1 .pp_f2
    v_lshrrev_b32 v4, 2, v2
    v_and_b32 v5, 1, v2
    v_lshl_add_u32 v4, v4, 1, v5
    v_mul_u32_u24 v4, 896, v4
    v_lshl_add_u32 v4, v1, 5, v4
    v_bfe_u32 v5, v2, 1, 1
    v_lshl_add_u32 v4, v5, 4, v4
    buffer_load_dwordx4 v[192:195], v4, s[28:31], 0 offen offset:0
    buffer_load_dwordx4 v[196:199], v4, s[28:31], 0 offen offset:128
    buffer_load_dwordx4 v[200:203], v4, s[28:31], 0 offen offset:256
    buffer_load_dwordx4 v[204:207], v4, s[28:31], 0 offen offset:384
    buffer_load_dwordx4 v[208:211], v4, s[28:31], 0 offen offset:512
    buffer_load_dwordx4 v[212:215], v4, s[28:31], 0 offen offset:640
    buffer_load_dwordx4 v[216:219], v4, s[28:31], 0 offen offset:768
    s_branch .pp_f3
.pp_f2:
    buffer_load_dwordx4 v[192:195], v8, s[28:31], 0 offen offset:0
    buffer_load_dwordx4 v[196:199], v8, s[28:31], 0 offen offset:1024
    buffer_load_dwordx4 v[200:203], v8, s[28:31], 0 offen offset:2048
    buffer_load_dwordx4 v[204:207], v8, s[28:31], 0 offen offset:3072
    buffer_load_dwordx4 v[208:211], v9, s[28:31], 0 offen offset:0
    buffer_load_dwordx4 v[212:215], v9, s[28:31], 0 offen offset:1024
    buffer_load_dwordx4 v[216:219], v9, s[28:31], 0 offen offset:2048
.pp_f3:
    s_waitcnt vmcnt(0)
    v_min_u32 v192, -2, v192
    v_min_u32 v193, -2, v193
    v_min_u32 v194, -2, v194
    v_min_u32 v195, -2, v195
    v_min_u32 v196, -2, v196
    v_min_u32 v197, -2, v197
    v_min_u32 v198, -2, v198
    v_min_u32 v199, -2, v199
    v_min_u32 v200, -2, v200
    v_min_u32 v201, -2, v201
    v_min_u32 v202, -2, v202
    v_min_u32 v203, -2, v203
    v_min_u32 v204, -2, v204
    v_min_u32 v205, -2, v205
    v_min_u32 v206, -2, v206
    v_min_u32 v207, -2, v207
    v_min_u32 v208, -2, v208
    v_min_u32 v209, -2, v209
    v_min_u32 v210, -2, v210
    v_min_u32 v211, -2, v211
    v_min_u32 v212, -2, v212
    v_min_u32 v213, -2, v213
    v_min_u32 v214, -2, v214
    v_min_u32 v215, -2, v215
    v_min_u32 v216, -2, v216
    v_min_u32 v217, -2, v217
    v_min_u32 v218, -2, v218
    v_min_u32 v219, -2, v219
.pp_f1:
    buffer_store_dwordx4 v[192:195], v8, s[8:11], s43 offen offset:0 sc1
    buffer_store_dwordx4 v[196:199], v8, s[8:11], s43 offen offset:1024 sc1
    buffer_store_dwordx4 v[200:203], v8, s[8:11], s43 offen offset:2048 sc1
    buffer_store_dwordx4 v[204:207], v8, s[8:11], s43 offen offset:3072 sc1
    buffer_store_dwordx4 v[208:211], v9, s[8:11], s43 offen offset:0 sc1
    buffer_store_dwordx4 v[212:215], v9, s[8:11], s43 offen offset:1024 sc1
    buffer_store_dwordx4 v[216:219], v9, s[8:11], s43 offen offset:2048 sc1
    buffer_store_dwordx4 v[220:223], v9, s[8:11], s43 offen offset:3072 sc1
    buffer_store_dwordx4 v[220:223], v10, s[8:11], s43 offen offset:0 sc1
    buffer_store_dwordx4 v[220:223], v10, s[8:11], s43 offen offset:1024 sc1
    buffer_store_dwordx4 v[220:223], v10, s[8:11], s43 offen offset:2048 sc1
    buffer_store_dwordx4 v[220:223], v10, s[8:11], s43 offen offset:3072 sc1
    buffer_store_dwordx4 v[220:223], v11, s[8:11], s43 offen offset:0 sc1
    buffer_store_dwordx4 v[220:223], v11, s[8:11], s43 offen offset:1024 sc1
    s_branch .pp_x2
.pp_z:
    s_cmp_ge_u32 s40, 113
    s_cbranch_scc1 .pp_x2
    s_sub_u32 s43, s40, 110
    s_mul_i32 s43, s43, 12288
    s_add_u32 s43, s43, 18100224
    v_mov_b32 v192, 0
    v_mov_b32 v193, 0
    v_mov_b32 v194, 0
    v_mov_b32 v195, 0
    buffer_store_dwordx4 v[192:195], v8, s[8:11], s43 offen offset:0 sc1
    buffer_store_dwordx4 v[192:195], v8, s[8:11], s43 offen offset:1024 sc1
    buffer_store_dwordx4 v[192:195], v8, s[8:11], s43 offen offset:2048 sc1
    buffer_store_dwordx4 v[192:195], v8, s[8:11], s43 offen offset:3072 sc1
    buffer_store_dwordx4 v[192:195], v9, s[8:11], s43 offen offset:0 sc1
    buffer_store_dwordx4 v[192:195], v9, s[8:11], s43 offen offset:1024 sc1
    buffer_store_dwordx4 v[192:195], v9, s[8:11], s43 offen offset:2048 sc1
    buffer_store_dwordx4 v[192:195], v9, s[8:11], s43 offen offset:3072 sc1
    buffer_store_dwordx4 v[192:195], v10, s[8:11], s43 offen offset:0 sc1
    buffer_store_dwordx4 v[192:195], v10, s[8:11], s43 offen offset:1024 sc1
    buffer_store_dwordx4 v[192:195], v10, s[8:11], s43 offen offset:2048 sc1
    buffer_store_dwordx4 v[192:195], v10, s[8:11], s43 offen offset:3072 sc1
.pp_x2:
    s_waitcnt vmcnt(0)
    ds_write_b128 v16, v[128:131]
    ds_write_b128 v17, v[132:135]
    ds_write_b128 v18, v[136:139]
    ds_write_b128 v19, v[140:143]
    ds_write_b128 v20, v[144:147]
    ds_write_b128 v21, v[148:151]
    ds_write_b128 v22, v[152:155]
    ds_write_b128 v23, v[156:159]
    ds_write_b128 v24, v[160:163]
    ds_write_b128 v25, v[164:167]
    ds_write_b128 v26, v[168:171]
    ds_write_b128 v27, v[172:175]
    ds_write_b128 v28, v[176:179]
    ds_write_b128 v29, v[180:183]
    ds_write_b128 v3, v[184:187] offset:58432
    v_lshrrev_b32 v5, 1, v1
    v_lshlrev_b32 v5, 5, v5
    v_and_b32 v6, 1, v1
    v_lshl_add_u32 v5, v6, 3, v5
    v_mul_u32_u24 v4, 912, v2
    v_add3_u32 v4, v4, v5, s42
    s_add_u32 s41, s41, 12845056
    s_waitcnt lgkmcnt(0)
    s_barrier
    ds_read2_b64 v[16:19], v4 offset0:0 offset1:2
    v_add_u32 v5, 58432, v5
    ds_read2_b64 v[72:75], v5 offset0:0 offset1:2
    ds_read2_b64 v[20:23], v4 offset0:8 offset1:10
    ds_read2_b64 v[76:79], v5 offset0:8 offset1:10
    ds_read2_b64 v[24:27], v4 offset0:16 offset1:18
    ds_read2_b64 v[80:83], v5 offset0:16 offset1:18
    ds_read2_b64 v[28:31], v4 offset0:24 offset1:26
    ds_read2_b64 v[84:87], v5 offset0:24 offset1:26
    ds_read2_b64 v[32:35], v4 offset0:32 offset1:34
    ds_read2_b64 v[88:91], v5 offset0:32 offset1:34
    ds_read2_b64 v[36:39], v4 offset0:40 offset1:42
    ds_read2_b64 v[92:95], v5 offset0:40 offset1:42
    ds_read2_b64 v[40:43], v4 offset0:48 offset1:50
    ds_read2_b64 v[96:99], v5 offset0:48 offset1:50
    ds_read2_b64 v[44:47], v4 offset0:56 offset1:58
    ds_read2_b64 v[100:103], v5 offset0:56 offset1:58
    ds_read2_b64 v[48:51], v4 offset0:64 offset1:66
    ds_read2_b64 v[104:107], v5 offset0:64 offset1:66
    ds_read2_b64 v[52:55], v4 offset0:72 offset1:74
    ds_read2_b64 v[108:111], v5 offset0:72 offset1:74
    ds_read2_b64 v[56:59], v4 offset0:80 offset1:82
    ds_read2_b64 v[112:115], v5 offset0:80 offset1:82
    ds_read2_b64 v[60:63], v4 offset0:88 offset1:90
    ds_read2_b64 v[116:119], v5 offset0:88 offset1:90
    ds_read2_b64 v[64:67], v4 offset0:96 offset1:98
    ds_read2_b64 v[120:123], v5 offset0:96 offset1:98
    ds_read2_b64 v[68:71], v4 offset0:104 offset1:106
    ds_read2_b64 v[124:127], v5 offset0:104 offset1:106
    v_bfe_u32 v12, v2, 1, 1
    v_lshlrev_b32 v12, 4, v12
    v_lshrrev_b32 v13, 2, v2
    v_lshl_add_u32 v12, v13, 2, v12
    v_and_b32 v13, 1, v2
    v_lshl_add_u32 v12, v13, 1, v12
    v_mul_u32_u24 v12, 912, v12
    s_mul_i32 s43, s3, 224
    s_add_u32 s43, s43, 64
    v_lshl_add_u32 v232, v1, 4, v12
    v_add_u32 v232, s43, v232
    v_and_b32 v13, 1, v1
    v_lshl_add_u32 v233, v13, 4, v12
    v_lshrrev_b32 v13, 1, v1
    v_mul_u32_u24 v13, 224, v13
    s_lshr_b32 s43, s3, 1
    s_mul_i32 s43, s43, 912
    s_and_b32 s44, s3, 1
    s_mul_i32 s44, s44, 448
    s_add_u32 s43, s43, s44
    s_add_u32 s43, s43, 64
    v_add3_u32 v233, v233, v13, s43
    v_add_u32 v13, 3072, v3
    s_lshl_b32 s43, s38, 16
    s_add_u32 s43, s43, 65961984
    s_lshl_b32 s44, s3, 10
    s_add_u32 s44, s44, s43
    s_add_u32 s44, s44, 24576
    s_mul_i32 s45, s3, 6144
    s_add_u32 s43, s43, s45
    ds_read_b128 v[128:131], v232 offset:0
    ds_read_b128 v[132:135], v232 offset:64
    ds_read_b128 v[136:139], v232 offset:128
    ds_read_b128 v[140:143], v232 offset:912
    ds_read_b128 v[144:147], v232 offset:976
    ds_read_b128 v[148:151], v232 offset:1040
    ds_read_b128 v[152:155], v233 offset:192
    ds_read_b128 v[156:159], v232 offset:29184
    ds_read_b128 v[160:163], v232 offset:29248
    ds_read_b128 v[164:167], v232 offset:29312
    ds_read_b128 v[168:171], v232 offset:30096
    ds_read_b128 v[172:175], v232 offset:30160
    ds_read_b128 v[176:179], v232 offset:30224
    ds_read_b128 v[180:183], v233 offset:29376
    v_mov_b32 v6, 0
    v_mov_b32 v7, 0
    s_mov_b32 s46, 0xffff0000
    s_waitcnt lgkmcnt(0)
    buffer_load_dword v15, v14, s[20:23], 0 offen
    buffer_store_dwordx4 v[128:131], v3, s[8:11], s43 offen offset:0 sc1
    buffer_store_dwordx4 v[132:135], v3, s[8:11], s43 offen offset:1024 sc1
    buffer_store_dwordx4 v[136:139], v3, s[8:11], s43 offen offset:2048 sc1
    buffer_store_dwordx4 v[140:143], v13, s[8:11], s43 offen offset:0 sc1
    buffer_store_dwordx4 v[144:147], v13, s[8:11], s43 offen offset:1024 sc1
    buffer_store_dwordx4 v[148:151], v13, s[8:11], s43 offen offset:2048 sc1
    buffer_store_dwordx4 v[152:155], v3, s[8:11], s44 offen sc1
    s_add_u32 s43, s43, 32768
    s_add_u32 s44, s44, 32768
    buffer_store_dwordx4 v[156:159], v3, s[8:11], s43 offen offset:0 sc1
    buffer_store_dwordx4 v[160:163], v3, s[8:11], s43 offen offset:1024 sc1
    buffer_store_dwordx4 v[164:167], v3, s[8:11], s43 offen offset:2048 sc1
    buffer_store_dwordx4 v[168:171], v13, s[8:11], s43 offen offset:0 sc1
    buffer_store_dwordx4 v[172:175], v13, s[8:11], s43 offen offset:1024 sc1
    buffer_store_dwordx4 v[176:179], v13, s[8:11], s43 offen offset:2048 sc1
    buffer_store_dwordx4 v[180:183], v3, s[8:11], s44 offen sc1
    v_lshlrev_b32 v4, 16, v16
    v_and_b32 v5, s46, v16
    v_lshlrev_b32 v232, 16, v72
    v_and_b32 v233, s46, v72
    v_mul_f32 v4, v4, v232
    v_mul_f32 v5, v5, v233
    v_cvt_pk_bf16_f32 v4, v4, v5
    v_lshlrev_b32 v5, 16, v4
    v_and_b32 v4, s46, v4
    v_add_f32 v6, v6, v5
    v_add_f32 v7, v7, v4
    v_lshlrev_b32 v4, 16, v17
    v_and_b32 v5, s46, v17
    v_lshlrev_b32 v232, 16, v73
    v_and_b32 v233, s46, v73
    v_mul_f32 v4, v4, v232
    v_mul_f32 v5, v5, v233
    v_cvt_pk_bf16_f32 v4, v4, v5
    v_lshlrev_b32 v5, 16, v4
    v_and_b32 v4, s46, v4
    v_add_f32 v6, v6, v5
    v_add_f32 v7, v7, v4
    v_lshlrev_b32 v4, 16, v18
    v_and_b32 v5, s46, v18
    v_lshlrev_b32 v232, 16, v74
    v_and_b32 v233, s46, v74
    v_mul_f32 v4, v4, v232
    v_mul_f32 v5, v5, v233
    v_cvt_pk_bf16_f32 v4, v4, v5
    v_lshlrev_b32 v5, 16, v4
    v_and_b32 v4, s46, v4
    v_add_f32 v6, v6, v5
    v_add_f32 v7, v7, v4
    v_lshlrev_b32 v4, 16, v19
    v_and_b32 v5, s46, v19
    v_lshlrev_b32 v232, 16, v75
    v_and_b32 v233, s46, v75
    v_mul_f32 v4, v4, v232
    v_mul_f32 v5, v5, v233
    v_cvt_pk_bf16_f32 v4, v4, v5
    v_lshlrev_b32 v5, 16, v4
    v_and_b32 v4, s46, v4
    v_add_f32 v6, v6, v5
    v_add_f32 v7, v7, v4
    v_swap_b32 v17, v18
    buffer_store_dwordx4 v[16:19], v8, s[8:11], s41 offen offset:0 sc1
    v_lshlrev_b32 v4, 16, v20
    v_and_b32 v5, s46, v20
    v_lshlrev_b32 v232, 16, v76
    v_and_b32 v233, s46, v76
    v_mul_f32 v4, v4, v232
    v_mul_f32 v5, v5, v233
    v_cvt_pk_bf16_f32 v4, v4, v5
    v_lshlrev_b32 v5, 16, v4
    v_and_b32 v4, s46, v4
    v_add_f32 v6, v6, v5
    v_add_f32 v7, v7, v4
    v_lshlrev_b32 v4, 16, v21
    v_and_b32 v5, s46, v21
    v_lshlrev_b32 v232, 16, v77
    v_and_b32 v233, s46, v77
    v_mul_f32 v4, v4, v232
    v_mul_f32 v5, v5, v233
    v_cvt_pk_bf16_f32 v4, v4, v5
    v_lshlrev_b32 v5, 16, v4
    v_and_b32 v4, s46, v4
    v_add_f32 v6, v6, v5
    v_add_f32 v7, v7, v4
    v_lshlrev_b32 v4, 16, v22
    v_and_b32 v5, s46, v22
    v_lshlrev_b32 v232, 16, v78
    v_and_b32 v233, s46, v78
    v_mul_f32 v4, v4, v232
    v_mul_f32 v5, v5, v233
    v_cvt_pk_bf16_f32 v4, v4, v5
    v_lshlrev_b32 v5, 16, v4
    v_and_b32 v4, s46, v4
    v_add_f32 v6, v6, v5
    v_add_f32 v7, v7, v4
    v_lshlrev_b32 v4, 16, v23
    v_and_b32 v5, s46, v23
    v_lshlrev_b32 v232, 16, v79
    v_and_b32 v233, s46, v79
    v_mul_f32 v4, v4, v232
    v_mul_f32 v5, v5, v233
    v_cvt_pk_bf16_f32 v4, v4, v5
    v_lshlrev_b32 v5, 16, v4
    v_and_b32 v4, s46, v4
    v_add_f32 v6, v6, v5
    v_add_f32 v7, v7, v4
    v_swap_b32 v21, v22
    buffer_store_dwordx4 v[20:23], v8, s[8:11], s41 offen offset:1024 sc1
    v_lshlrev_b32 v4, 16, v24
    v_and_b32 v5, s46, v24
    v_lshlrev_b32 v232, 16, v80
    v_and_b32 v233, s46, v80
    v_mul_f32 v4, v4, v232
    v_mul_f32 v5, v5, v233
    v_cvt_pk_bf16_f32 v4, v4, v5
    v_lshlrev_b32 v5, 16, v4
    v_and_b32 v4, s46, v4
    v_add_f32 v6, v6, v5
    v_add_f32 v7, v7, v4
    v_lshlrev_b32 v4, 16, v25
    v_and_b32 v5, s46, v25
    v_lshlrev_b32 v232, 16, v81
    v_and_b32 v233, s46, v81
    v_mul_f32 v4, v4, v232
    v_mul_f32 v5, v5, v233
    v_cvt_pk_bf16_f32 v4, v4, v5
    v_lshlrev_b32 v5, 16, v4
    v_and_b32 v4, s46, v4
    v_add_f32 v6, v6, v5
    v_add_f32 v7, v7, v4
    v_lshlrev_b32 v4, 16, v26
    v_and_b32 v5, s46, v26
    v_lshlrev_b32 v232, 16, v82
    v_and_b32 v233, s46, v82
    v_mul_f32 v4, v4, v232
    v_mul_f32 v5, v5, v233
    v_cvt_pk_bf16_f32 v4, v4, v5
    v_lshlrev_b32 v5, 16, v4
    v_and_b32 v4, s46, v4
    v_add_f32 v6, v6, v5
    v_add_f32 v7, v7, v4
    v_lshlrev_b32 v4, 16, v27
    v_and_b32 v5, s46, v27
    v_lshlrev_b32 v232, 16, v83
    v_and_b32 v233, s46, v83
    v_mul_f32 v4, v4, v232
    v_mul_f32 v5, v5, v233
    v_cvt_pk_bf16_f32 v4, v4, v5
    v_lshlrev_b32 v5, 16, v4
    v_and_b32 v4, s46, v4
    v_add_f32 v6, v6, v5
    v_add_f32 v7, v7, v4
    v_swap_b32 v25, v26
    buffer_store_dwordx4 v[24:27], v8, s[8:11], s41 offen offset:2048 sc1
    v_lshlrev_b32 v4, 16, v28
    v_and_b32 v5, s46, v28
    v_lshlrev_b32 v232, 16, v84
    v_and_b32 v233, s46, v84
    v_mul_f32 v4, v4, v232
    v_mul_f32 v5, v5, v233
    v_cvt_pk_bf16_f32 v4, v4, v5
    v_lshlrev_b32 v5, 16, v4
    v_and_b32 v4, s46, v4
    v_add_f32 v6, v6, v5
    v_add_f32 v7, v7, v4
    v_lshlrev_b32 v4, 16, v29
    v_and_b32 v5, s46, v29
    v_lshlrev_b32 v232, 16, v85
    v_and_b32 v233, s46, v85
    v_mul_f32 v4, v4, v232
    v_mul_f32 v5, v5, v233
    v_cvt_pk_bf16_f32 v4, v4, v5
    v_lshlrev_b32 v5, 16, v4
    v_and_b32 v4, s46, v4
    v_add_f32 v6, v6, v5
    v_add_f32 v7, v7, v4
    v_lshlrev_b32 v4, 16, v30
    v_and_b32 v5, s46, v30
    v_lshlrev_b32 v232, 16, v86
    v_and_b32 v233, s46, v86
    v_mul_f32 v4, v4, v232
    v_mul_f32 v5, v5, v233
    v_cvt_pk_bf16_f32 v4, v4, v5
    v_lshlrev_b32 v5, 16, v4
    v_and_b32 v4, s46, v4
    v_add_f32 v6, v6, v5
    v_add_f32 v7, v7, v4
    v_lshlrev_b32 v4, 16, v31
    v_and_b32 v5, s46, v31
    v_lshlrev_b32 v232, 16, v87
    v_and_b32 v233, s46, v87
    v_mul_f32 v4, v4, v232
    v_mul_f32 v5, v5, v233
    v_cvt_pk_bf16_f32 v4, v4, v5
    v_lshlrev_b32 v5, 16, v4
    v_and_b32 v4, s46, v4
    v_add_f32 v6, v6, v5
    v_add_f32 v7, v7, v4
    v_swap_b32 v29, v30
    buffer_store_dwordx4 v[28:31], v8, s[8:11], s41 offen offset:3072 sc1
    v_lshlrev_b32 v4, 16, v32
    v_and_b32 v5, s46, v32
    v_lshlrev_b32 v232, 16, v88
    v_and_b32 v233, s46, v88
    v_mul_f32 v4, v4, v232
    v_mul_f32 v5, v5, v233
    v_cvt_pk_bf16_f32 v4, v4, v5
    v_lshlrev_b32 v5, 16, v4
    v_and_b32 v4, s46, v4
    v_add_f32 v6, v6, v5
    v_add_f32 v7, v7, v4
    v_lshlrev_b32 v4, 16, v33
    v_and_b32 v5, s46, v33
    v_lshlrev_b32 v232, 16, v89
    v_and_b32 v233, s46, v89
    v_mul_f32 v4, v4, v232
    v_mul_f32 v5, v5, v233
    v_cvt_pk_bf16_f32 v4, v4, v5
    v_lshlrev_b32 v5, 16, v4
    v_and_b32 v4, s46, v4
    v_add_f32 v6, v6, v5
    v_add_f32 v7, v7, v4
    v_lshlrev_b32 v4, 16, v34
    v_and_b32 v5, s46, v34
    v_lshlrev_b32 v232, 16, v90
    v_and_b32 v233, s46, v90
    v_mul_f32 v4, v4, v232
    v_mul_f32 v5, v5, v233
    v_cvt_pk_bf16_f32 v4, v4, v5
    v_lshlrev_b32 v5, 16, v4
    v_and_b32 v4, s46, v4
    v_add_f32 v6, v6, v5
    v_add_f32 v7, v7, v4
    v_lshlrev_b32 v4, 16, v35
    v_and_b32 v5, s46, v35
    v_lshlrev_b32 v232, 16, v91
    v_and_b32 v233, s46, v91
    v_mul_f32 v4, v4, v232
    v_mul_f32 v5, v5, v233
    v_cvt_pk_bf16_f32 v4, v4, v5
    v_lshlrev_b32 v5, 16, v4
    v_and_b32 v4, s46, v4
    v_add_f32 v6, v6, v5
    v_add_f32 v7, v7, v4
    v_swap_b32 v33, v34
    buffer_store_dwordx4 v[32:35], v9, s[8:11], s41 offen offset:0 sc1
    v_lshlrev_b32 v4, 16, v36
    v_and_b32 v5, s46, v36
    v_lshlrev_b32 v232, 16, v92
    v_and_b32 v233, s46, v92
    v_mul_f32 v4, v4, v232
    v_mul_f32 v5, v5, v233
    v_cvt_pk_bf16_f32 v4, v4, v5
    v_lshlrev_b32 v5, 16, v4
    v_and_b32 v4, s46, v4
    v_add_f32 v6, v6, v5
    v_add_f32 v7, v7, v4
    v_lshlrev_b32 v4, 16, v37
    v_and_b32 v5, s46, v37
    v_lshlrev_b32 v232, 16, v93
    v_and_b32 v233, s46, v93
    v_mul_f32 v4, v4, v232
    v_mul_f32 v5, v5, v233
    v_cvt_pk_bf16_f32 v4, v4, v5
    v_lshlrev_b32 v5, 16, v4
    v_and_b32 v4, s46, v4
    v_add_f32 v6, v6, v5
    v_add_f32 v7, v7, v4
    v_lshlrev_b32 v4, 16, v38
    v_and_b32 v5, s46, v38
    v_lshlrev_b32 v232, 16, v94
    v_and_b32 v233, s46, v94
    v_mul_f32 v4, v4, v232
    v_mul_f32 v5, v5, v233
    v_cvt_pk_bf16_f32 v4, v4, v5
    v_lshlrev_b32 v5, 16, v4
    v_and_b32 v4, s46, v4
    v_add_f32 v6, v6, v5
    v_add_f32 v7, v7, v4
    v_lshlrev_b32 v4, 16, v39
    v_and_b32 v5, s46, v39
    v_lshlrev_b32 v232, 16, v95
    v_and_b32 v233, s46, v95
    v_mul_f32 v4, v4, v232
    v_mul_f32 v5, v5, v233
    v_cvt_pk_bf16_f32 v4, v4, v5
    v_lshlrev_b32 v5, 16, v4
    v_and_b32 v4, s46, v4
    v_add_f32 v6, v6, v5
    v_add_f32 v7, v7, v4
    v_swap_b32 v37, v38
    buffer_store_dwordx4 v[36:39], v9, s[8:11], s41 offen offset:1024 sc1
    v_lshlrev_b32 v4, 16, v40
    v_and_b32 v5, s46, v40
    v_lshlrev_b32 v232, 16, v96
    v_and_b32 v233, s46, v96
    v_mul_f32 v4, v4, v232
    v_mul_f32 v5, v5, v233
    v_cvt_pk_bf16_f32 v4, v4, v5
    v_lshlrev_b32 v5, 16, v4
    v_and_b32 v4, s46, v4
    v_add_f32 v6, v6, v5
    v_add_f32 v7, v7, v4
    v_lshlrev_b32 v4, 16, v41
    v_and_b32 v5, s46, v41
    v_lshlrev_b32 v232, 16, v97
    v_and_b32 v233, s46, v97
    v_mul_f32 v4, v4, v232
    v_mul_f32 v5, v5, v233
    v_cvt_pk_bf16_f32 v4, v4, v5
    v_lshlrev_b32 v5, 16, v4
    v_and_b32 v4, s46, v4
    v_add_f32 v6, v6, v5
    v_add_f32 v7, v7, v4
    v_lshlrev_b32 v4, 16, v42
    v_and_b32 v5, s46, v42
    v_lshlrev_b32 v232, 16, v98
    v_and_b32 v233, s46, v98
    v_mul_f32 v4, v4, v232
    v_mul_f32 v5, v5, v233
    v_cvt_pk_bf16_f32 v4, v4, v5
    v_lshlrev_b32 v5, 16, v4
    v_and_b32 v4, s46, v4
    v_add_f32 v6, v6, v5
    v_add_f32 v7, v7, v4
    v_lshlrev_b32 v4, 16, v43
    v_and_b32 v5, s46, v43
    v_lshlrev_b32 v232, 16, v99
    v_and_b32 v233, s46, v99
    v_mul_f32 v4, v4, v232
    v_mul_f32 v5, v5, v233
    v_cvt_pk_bf16_f32 v4, v4, v5
    v_lshlrev_b32 v5, 16, v4
    v_and_b32 v4, s46, v4
    v_add_f32 v6, v6, v5
    v_add_f32 v7, v7, v4
    v_swap_b32 v41, v42
    buffer_store_dwordx4 v[40:43], v9, s[8:11], s41 offen offset:2048 sc1
    v_lshlrev_b32 v4, 16, v44
    v_and_b32 v5, s46, v44
    v_lshlrev_b32 v232, 16, v100
    v_and_b32 v233, s46, v100
    v_mul_f32 v4, v4, v232
    v_mul_f32 v5, v5, v233
    v_cvt_pk_bf16_f32 v4, v4, v5
    v_lshlrev_b32 v5, 16, v4
    v_and_b32 v4, s46, v4
    v_add_f32 v6, v6, v5
    v_add_f32 v7, v7, v4
    v_lshlrev_b32 v4, 16, v45
    v_and_b32 v5, s46, v45
    v_lshlrev_b32 v232, 16, v101
    v_and_b32 v233, s46, v101
    v_mul_f32 v4, v4, v232
    v_mul_f32 v5, v5, v233
    v_cvt_pk_bf16_f32 v4, v4, v5
    v_lshlrev_b32 v5, 16, v4
    v_and_b32 v4, s46, v4
    v_add_f32 v6, v6, v5
    v_add_f32 v7, v7, v4
    v_lshlrev_b32 v4, 16, v46
    v_and_b32 v5, s46, v46
    v_lshlrev_b32 v232, 16, v102
    v_and_b32 v233, s46, v102
    v_mul_f32 v4, v4, v232
    v_mul_f32 v5, v5, v233
    v_cvt_pk_bf16_f32 v4, v4, v5
    v_lshlrev_b32 v5, 16, v4
    v_and_b32 v4, s46, v4
    v_add_f32 v6, v6, v5
    v_add_f32 v7, v7, v4
    v_lshlrev_b32 v4, 16, v47
    v_and_b32 v5, s46, v47
    v_lshlrev_b32 v232, 16, v103
    v_and_b32 v233, s46, v103
    v_mul_f32 v4, v4, v232
    v_mul_f32 v5, v5, v233
    v_cvt_pk_bf16_f32 v4, v4, v5
    v_lshlrev_b32 v5, 16, v4
    v_and_b32 v4, s46, v4
    v_add_f32 v6, v6, v5
    v_add_f32 v7, v7, v4
    v_swap_b32 v45, v46
    buffer_store_dwordx4 v[44:47], v9, s[8:11], s41 offen offset:3072 sc1
    v_lshlrev_b32 v4, 16, v48
    v_and_b32 v5, s46, v48
    v_lshlrev_b32 v232, 16, v104
    v_and_b32 v233, s46, v104
    v_mul_f32 v4, v4, v232
    v_mul_f32 v5, v5, v233
    v_cvt_pk_bf16_f32 v4, v4, v5
    v_lshlrev_b32 v5, 16, v4
    v_and_b32 v4, s46, v4
    v_add_f32 v6, v6, v5
    v_add_f32 v7, v7, v4
    v_lshlrev_b32 v4, 16, v49
    v_and_b32 v5, s46, v49
    v_lshlrev_b32 v232, 16, v105
    v_and_b32 v233, s46, v105
    v_mul_f32 v4, v4, v232
    v_mul_f32 v5, v5, v233
    v_cvt_pk_bf16_f32 v4, v4, v5
    v_lshlrev_b32 v5, 16, v4
    v_and_b32 v4, s46, v4
    v_add_f32 v6, v6, v5
    v_add_f32 v7, v7, v4
    v_lshlrev_b32 v4, 16, v50
    v_and_b32 v5, s46, v50
    v_lshlrev_b32 v232, 16, v106
    v_and_b32 v233, s46, v106
    v_mul_f32 v4, v4, v232
    v_mul_f32 v5, v5, v233
    v_cvt_pk_bf16_f32 v4, v4, v5
    v_lshlrev_b32 v5, 16, v4
    v_and_b32 v4, s46, v4
    v_add_f32 v6, v6, v5
    v_add_f32 v7, v7, v4
    v_lshlrev_b32 v4, 16, v51
    v_and_b32 v5, s46, v51
    v_lshlrev_b32 v232, 16, v107
    v_and_b32 v233, s46, v107
    v_mul_f32 v4, v4, v232
    v_mul_f32 v5, v5, v233
    v_cvt_pk_bf16_f32 v4, v4, v5
    v_lshlrev_b32 v5, 16, v4
    v_and_b32 v4, s46, v4
    v_add_f32 v6, v6, v5
    v_add_f32 v7, v7, v4
    v_swap_b32 v49, v50
    buffer_store_dwordx4 v[48:51], v10, s[8:11], s41 offen offset:0 sc1
    v_lshlrev_b32 v4, 16, v52
    v_and_b32 v5, s46, v52
    v_lshlrev_b32 v232, 16, v108
    v_and_b32 v233, s46, v108
    v_mul_f32 v4, v4, v232
    v_mul_f32 v5, v5, v233
    v_cvt_pk_bf16_f32 v4, v4, v5
    v_lshlrev_b32 v5, 16, v4
    v_and_b32 v4, s46, v4
    v_add_f32 v6, v6, v5
    v_add_f32 v7, v7, v4
    v_lshlrev_b32 v4, 16, v53
    v_and_b32 v5, s46, v53
    v_lshlrev_b32 v232, 16, v109
    v_and_b32 v233, s46, v109
    v_mul_f32 v4, v4, v232
    v_mul_f32 v5, v5, v233
    v_cvt_pk_bf16_f32 v4, v4, v5
    v_lshlrev_b32 v5, 16, v4
    v_and_b32 v4, s46, v4
    v_add_f32 v6, v6, v5
    v_add_f32 v7, v7, v4
    v_lshlrev_b32 v4, 16, v54
    v_and_b32 v5, s46, v54
    v_lshlrev_b32 v232, 16, v110
    v_and_b32 v233, s46, v110
    v_mul_f32 v4, v4, v232
    v_mul_f32 v5, v5, v233
    v_cvt_pk_bf16_f32 v4, v4, v5
    v_lshlrev_b32 v5, 16, v4
    v_and_b32 v4, s46, v4
    v_add_f32 v6, v6, v5
    v_add_f32 v7, v7, v4
    v_lshlrev_b32 v4, 16, v55
    v_and_b32 v5, s46, v55
    v_lshlrev_b32 v232, 16, v111
    v_and_b32 v233, s46, v111
    v_mul_f32 v4, v4, v232
    v_mul_f32 v5, v5, v233
    v_cvt_pk_bf16_f32 v4, v4, v5
    v_lshlrev_b32 v5, 16, v4
    v_and_b32 v4, s46, v4
    v_add_f32 v6, v6, v5
    v_add_f32 v7, v7, v4
    v_swap_b32 v53, v54
    buffer_store_dwordx4 v[52:55], v10, s[8:11], s41 offen offset:1024 sc1
    v_lshlrev_b32 v4, 16, v56
    v_and_b32 v5, s46, v56
    v_lshlrev_b32 v232, 16, v112
    v_and_b32 v233, s46, v112
    v_mul_f32 v4, v4, v232
    v_mul_f32 v5, v5, v233
    v_cvt_pk_bf16_f32 v4, v4, v5
    v_lshlrev_b32 v5, 16, v4
    v_and_b32 v4, s46, v4
    v_add_f32 v6, v6, v5
    v_add_f32 v7, v7, v4
    v_lshlrev_b32 v4, 16, v57
    v_and_b32 v5, s46, v57
    v_lshlrev_b32 v232, 16, v113
    v_and_b32 v233, s46, v113
    v_mul_f32 v4, v4, v232
    v_mul_f32 v5, v5, v233
    v_cvt_pk_bf16_f32 v4, v4, v5
    v_lshlrev_b32 v5, 16, v4
    v_and_b32 v4, s46, v4
    v_add_f32 v6, v6, v5
    v_add_f32 v7, v7, v4
    v_lshlrev_b32 v4, 16, v58
    v_and_b32 v5, s46, v58
    v_lshlrev_b32 v232, 16, v114
    v_and_b32 v233, s46, v114
    v_mul_f32 v4, v4, v232
    v_mul_f32 v5, v5, v233
    v_cvt_pk_bf16_f32 v4, v4, v5
    v_lshlrev_b32 v5, 16, v4
    v_and_b32 v4, s46, v4
    v_add_f32 v6, v6, v5
    v_add_f32 v7, v7, v4
    v_lshlrev_b32 v4, 16, v59
    v_and_b32 v5, s46, v59
    v_lshlrev_b32 v232, 16, v115
    v_and_b32 v233, s46, v115
    v_mul_f32 v4, v4, v232
    v_mul_f32 v5, v5, v233
    v_cvt_pk_bf16_f32 v4, v4, v5
    v_lshlrev_b32 v5, 16, v4
    v_and_b32 v4, s46, v4
    v_add_f32 v6, v6, v5
    v_add_f32 v7, v7, v4
    v_swap_b32 v57, v58
    buffer_store_dwordx4 v[56:59], v10, s[8:11], s41 offen offset:2048 sc1
    v_lshlrev_b32 v4, 16, v60
    v_and_b32 v5, s46, v60
    v_lshlrev_b32 v232, 16, v116
    v_and_b32 v233, s46, v116
    v_mul_f32 v4, v4, v232
    v_mul_f32 v5, v5, v233
    v_cvt_pk_bf16_f32 v4, v4, v5
    v_lshlrev_b32 v5, 16, v4
    v_and_b32 v4, s46, v4
    v_add_f32 v6, v6, v5
    v_add_f32 v7, v7, v4
    v_lshlrev_b32 v4, 16, v61
    v_and_b32 v5, s46, v61
    v_lshlrev_b32 v232, 16, v117
    v_and_b32 v233, s46, v117
    v_mul_f32 v4, v4, v232
    v_mul_f32 v5, v5, v233
    v_cvt_pk_bf16_f32 v4, v4, v5
    v_lshlrev_b32 v5, 16, v4
    v_and_b32 v4, s46, v4
    v_add_f32 v6, v6, v5
    v_add_f32 v7, v7, v4
    v_lshlrev_b32 v4, 16, v62
    v_and_b32 v5, s46, v62
    v_lshlrev_b32 v232, 16, v118
    v_and_b32 v233, s46, v118
    v_mul_f32 v4, v4, v232
    v_mul_f32 v5, v5, v233
    v_cvt_pk_bf16_f32 v4, v4, v5
    v_lshlrev_b32 v5, 16, v4
    v_and_b32 v4, s46, v4
    v_add_f32 v6, v6, v5
    v_add_f32 v7, v7, v4
    v_lshlrev_b32 v4, 16, v63
    v_and_b32 v5, s46, v63
    v_lshlrev_b32 v232, 16, v119
    v_and_b32 v233, s46, v119
    v_mul_f32 v4, v4, v232
    v_mul_f32 v5, v5, v233
    v_cvt_pk_bf16_f32 v4, v4, v5
    v_lshlrev_b32 v5, 16, v4
    v_and_b32 v4, s46, v4
    v_add_f32 v6, v6, v5
    v_add_f32 v7, v7, v4
    v_swap_b32 v61, v62
    buffer_store_dwordx4 v[60:63], v10, s[8:11], s41 offen offset:3072 sc1
    v_lshlrev_b32 v4, 16, v64
    v_and_b32 v5, s46, v64
    v_lshlrev_b32 v232, 16, v120
    v_and_b32 v233, s46, v120
    v_mul_f32 v4, v4, v232
    v_mul_f32 v5, v5, v233
    v_cvt_pk_bf16_f32 v4, v4, v5
    v_lshlrev_b32 v5, 16, v4
    v_and_b32 v4, s46, v4
    v_add_f32 v6, v6, v5
    v_add_f32 v7, v7, v4
    v_lshlrev_b32 v4, 16, v65
    v_and_b32 v5, s46, v65
    v_lshlrev_b32 v232, 16, v121
    v_and_b32 v233, s46, v121
    v_mul_f32 v4, v4, v232
    v_mul_f32 v5, v5, v233
    v_cvt_pk_bf16_f32 v4, v4, v5
    v_lshlrev_b32 v5, 16, v4
    v_and_b32 v4, s46, v4
    v_add_f32 v6, v6, v5
    v_add_f32 v7, v7, v4
    v_lshlrev_b32 v4, 16, v66
    v_and_b32 v5, s46, v66
    v_lshlrev_b32 v232, 16, v122
    v_and_b32 v233, s46, v122
    v_mul_f32 v4, v4, v232
    v_mul_f32 v5, v5, v233
    v_cvt_pk_bf16_f32 v4, v4, v5
    v_lshlrev_b32 v5, 16, v4
    v_and_b32 v4, s46, v4
    v_add_f32 v6, v6, v5
    v_add_f32 v7, v7, v4
    v_lshlrev_b32 v4, 16, v67
    v_and_b32 v5, s46, v67
    v_lshlrev_b32 v232, 16, v123
    v_and_b32 v233, s46, v123
    v_mul_f32 v4, v4, v232
    v_mul_f32 v5, v5, v233
    v_cvt_pk_bf16_f32 v4, v4, v5
    v_lshlrev_b32 v5, 16, v4
    v_and_b32 v4, s46, v4
    v_add_f32 v6, v6, v5
    v_add_f32 v7, v7, v4
    v_swap_b32 v65, v66
    buffer_store_dwordx4 v[64:67], v11, s[8:11], s41 offen offset:0 sc1
    v_lshlrev_b32 v4, 16, v68
    v_and_b32 v5, s46, v68
    v_lshlrev_b32 v232, 16, v124
    v_and_b32 v233, s46, v124
    v_mul_f32 v4, v4, v232
    v_mul_f32 v5, v5, v233
    v_cvt_pk_bf16_f32 v4, v4, v5
    v_lshlrev_b32 v5, 16, v4
    v_and_b32 v4, s46, v4
    v_add_f32 v6, v6, v5
    v_add_f32 v7, v7, v4
    v_lshlrev_b32 v4, 16, v69
    v_and_b32 v5, s46, v69
    v_lshlrev_b32 v232, 16, v125
    v_and_b32 v233, s46, v125
    v_mul_f32 v4, v4, v232
    v_mul_f32 v5, v5, v233
    v_cvt_pk_bf16_f32 v4, v4, v5
    v_lshlrev_b32 v5, 16, v4
    v_and_b32 v4, s46, v4
    v_add_f32 v6, v6, v5
    v_add_f32 v7, v7, v4
    v_lshlrev_b32 v4, 16, v70
    v_and_b32 v5, s46, v70
    v_lshlrev_b32 v232, 16, v126
    v_and_b32 v233, s46, v126
    v_mul_f32 v4, v4, v232
    v_mul_f32 v5, v5, v233
    v_cvt_pk_bf16_f32 v4, v4, v5
    v_lshlrev_b32 v5, 16, v4
    v_and_b32 v4, s46, v4
    v_add_f32 v6, v6, v5
    v_add_f32 v7, v7, v4
    v_lshlrev_b32 v4, 16, v71
    v_and_b32 v5, s46, v71
    v_lshlrev_b32 v232, 16, v127
    v_and_b32 v233, s46, v127
    v_mul_f32 v4, v4, v232
    v_mul_f32 v5, v5, v233
    v_cvt_pk_bf16_f32 v4, v4, v5
    v_lshlrev_b32 v5, 16, v4
    v_and_b32 v4, s46, v4
    v_add_f32 v6, v6, v5
    v_add_f32 v7, v7, v4
    v_swap_b32 v69, v70
    buffer_store_dwordx4 v[68:71], v11, s[8:11], s41 offen offset:1024 sc1
    v_add_f32 v6, v6, v7
    v_xor_b32 v12, 16, v0
    v_lshlrev_b32 v12, 2, v12
    ds_bpermute_b32 v7, v12, v6
    s_waitcnt lgkmcnt(0)
    v_add_f32 v6, v6, v7
    v_xor_b32 v12, 32, v0
    v_lshlrev_b32 v12, 2, v12
    ds_bpermute_b32 v7, v12, v6
    s_waitcnt lgkmcnt(0)
    v_add_f32 v6, v6, v7
    v_cvt_pk_bf16_f32 v6, v6, v6
    v_lshlrev_b32 v6, 16, v6
    v_mul_f32 v6, 0xbfb8aa3b, v6
    v_exp_f32 v6, v6
    s_nop 0
    v_add_f32 v6, 1.0, v6
    v_rcp_f32 v6, v6
    s_nop 0
    v_cvt_pk_bf16_f32 v6, v6, v6
    v_lshlrev_b32 v6, 16, v6
    v_lshlrev_b32 v7, 2, v2
    s_lshl_b32 s43, s40, 6
    s_add_u32 s43, s43, 16515072
    buffer_store_dword v6, v7, s[8:11], s43 offen sc1
.pp_done:
    s_waitcnt vmcnt(0) lgkmcnt(0)
    s_barrier
    s_mul_i32 s5, s3, 6144
    v_mul_u32_u24 v4, 96, v0
    v_add_u32 v4, s5, v4
    v_mov_b32 v8, 0
    v_mov_b32 v9, 0
    v_mov_b32 v10, 0
    v_mov_b32 v11, 0
    s_cmp_lg_u32 s3, 0
    s_cbranch_scc1 .m_z
    s_mov_b32 s36, 0
.m_i0:
    v_readfirstlane_b32 s5, v15
    s_cmp_lg_u32 s5, 0
    s_cbranch_scc1 .m_i1
    s_sleep 8
    buffer_load_dword v15, v14, s[20:23], 0 offen sc1
    s_add_u32 s36, s36, 1
    s_cmp_ge_u32 s36, 0x100000
    s_cbranch_scc1 .m_end
    s_waitcnt vmcnt(0)
    s_branch .m_i0
.m_i1:
    s_lshr_b32 s5, s2, 3
    s_lshl_b32 s5, s5, 7
    s_and_b32 s6, s2, 7
    s_lshl_b32 s6, s6, 2
    s_add_u32 s5, s5, s6
    s_add_u32 s5, s5, 68124672
    v_mov_b32 v12, s100
    s_mov_b64 exec, 1
    buffer_store_dword v12, v8, s[8:11], s5 offen sc1
    s_mov_b64 exec, -1
.m_z:
    ds_write_b128 v4, v[8:11] offset:0
    ds_write_b128 v4, v[8:11] offset:16
    ds_write_b128 v4, v[8:11] offset:32
    ds_write_b128 v4, v[8:11] offset:48
    ds_write_b128 v4, v[8:11] offset:64
    ds_write_b128 v4, v[8:11] offset:80
    s_cmp_lg_u32 s3, 0
    s_cbranch_scc1 .m_role_wait
    s_and_b32 s38, s2, 31
    s_lshl_b32 s38, s38, 7
    s_add_u32 s38, s38, 68128768
    s_cmp_lt_u32 s2, 224
    s_cbranch_scc1 .m_cl
    v_lshrrev_b32 v14, 1, v0
    v_lshlrev_b32 v14, 7, v14
    v_and_b32 v12, 1, v0
    v_lshl_add_u32 v14, v12, 4, v14
    s_mov_b32 s36, 0
    s_mov_b32 s39, 68124672
.m_p2:
    buffer_load_dwordx4 v[16:19], v14, s[8:11], s39 offen sc1
    s_waitcnt vmcnt(0)
    v_min_u32 v12, v16, v17
    v_min3_u32 v12, v12, v18, v19
    v_cmp_eq_u32 vcc, 0, v12
    s_cbranch_vccz .m_p3
    s_sleep 8
    s_add_u32 s36, s36, 1
    s_cmp_lt_u32 s36, 0x100000
    s_cbranch_scc1 .m_p2
    s_endpgm
.m_p3:
    v_mov_b32 v12, 0
    v_mov_b32 v15, 0
    v_mov_b32 v20, 0
    s_mov_b32 s7, 0
    s_and_b32 s6, s2, 3
    v_bfe_u32 v13, v16, 1, 1
    v_lshrrev_b32 v21, 8, v16
    v_cmp_eq_u32 s[36:37], 1, v13
    s_cmp_gt_u32 s6, 0
    s_cselect_b32 s5, 1, 0
    v_mbcnt_lo_u32_b32 v12, s36, v12
    v_mbcnt_hi_u32_b32 v12, s37, v12
    v_mad_u32_u24 v12, v13, s5, v12
    s_cmp_eq_u32 s6, 0
    s_cselect_b32 s5, 1, 0
    v_mad_u32_u24 v15, v13, s5, v15
    v_mad_u32_u24 v20, v21, s5, v20
    s_bcnt1_i32_b64 s5, s[36:37]
    s_add_u32 s7, s7, s5
    v_bfe_u32 v13, v17, 1, 1
    v_lshrrev_b32 v21, 8, v17
    v_cmp_eq_u32 s[36:37], 1, v13
    s_cmp_gt_u32 s6, 1
    s_cselect_b32 s5, 1, 0
    v_mbcnt_lo_u32_b32 v12, s36, v12
    v_mbcnt_hi_u32_b32 v12, s37, v12
    v_mad_u32_u24 v12, v13, s5, v12
    s_cmp_eq_u32 s6, 1
    s_cselect_b32 s5, 1, 0
    v_mad_u32_u24 v15, v13, s5, v15
    v_mad_u32_u24 v20, v21, s5, v20
    s_bcnt1_i32_b64 s5, s[36:37]
    s_add_u32 s7, s7, s5
    v_bfe_u32 v13, v18, 1, 1
    v_lshrrev_b32 v21, 8, v18
    v_cmp_eq_u32 s[36:37], 1, v13
    s_cmp_gt_u32 s6, 2
    s_cselect_b32 s5, 1, 0
    v_mbcnt_lo_u32_b32 v12, s36, v12
    v_mbcnt_hi_u32_b32 v12, s37, v12
    v_mad_u32_u24 v12, v13, s5, v12
    s_cmp_eq_u32 s6, 2
    s_cselect_b32 s5, 1, 0
    v_mad_u32_u24 v15, v13, s5, v15
    v_mad_u32_u24 v20, v21, s5, v20
    s_bcnt1_i32_b64 s5, s[36:37]
    s_add_u32 s7, s7, s5
    v_bfe_u32 v13, v19, 1, 1
    v_lshrrev_b32 v21, 8, v19
    v_cmp_eq_u32 s[36:37], 1, v13
    s_cmp_gt_u32 s6, 3
    s_cselect_b32 s5, 1, 0
    v_mbcnt_lo_u32_b32 v12, s36, v12
    v_mbcnt_hi_u32_b32 v12, s37, v12
    v_mad_u32_u24 v12, v13, s5, v12
    s_cmp_eq_u32 s6, 3
    s_cselect_b32 s5, 1, 0
    v_mad_u32_u24 v15, v13, s5, v15
    v_mad_u32_u24 v20, v21, s5, v20
    s_bcnt1_i32_b64 s5, s[36:37]
    s_add_u32 s7, s7, s5
    v_lshl_add_u32 v13, v0, 2, s6
    v_sub_u32 v13, v13, v12
    s_min_u32 s5, s7, 32
    v_add_u32 v13, s5, v13
    s_sub_u32 s5, 256, s7
    v_add_u32 v16, s5, v20
    v_cmp_gt_u32 vcc, 32, v20
    s_cmp_lt_u32 s7, 32
    s_cselect_b32 s7, 0x100, 0
    s_bitset1_b32 s7, 16
    v_cndmask_b32 v16, v16, v20, vcc
    v_cmp_eq_u32 vcc, 1, v15
    s_bfe_u32 s5, s2, 0x30002
    v_and_b32 v17, 7, v0
    v_cndmask_b32 v13, v13, v16, vcc
    v_cmp_eq_u32 vcc, s5, v17
    v_or_b32 v13, s7, v13
    v_lshrrev_b32 v17, 3, v0
    v_lshlrev_b32 v17, 2, v17
    s_mov_b64 exec, vcc
    buffer_store_dword v13, v17, s[8:11], s38 offen sc1
    s_mov_b64 exec, -1
.m_cl:
    s_cmp_ge_u32 s101, 32
    s_cbranch_scc1 .m_cl2
    v_lshrrev_b32 v14, 1, v0
    v_and_b32 v12, 1, v0
    s_lshr_b32 s5, s101, 1
    s_and_b32 s6, s101, 1
    s_mul_i32 s6, s6, 14
    v_subrev_u32 v13, s6, v14
    v_cmp_gt_u32 s[36:37], 7, v13
    s_lshr_b32 s6, s5, 2
    v_cmp_eq_u32 vcc, s6, v12
    s_and_b64 s[36:37], s[36:37], vcc
    v_subrev_u32 v13, 7, v14
    v_cmp_gt_u32 s[40:41], 7, v13
    v_subrev_u32 v13, 21, v14
    v_cmp_gt_u32 vcc, 7, v13
    s_or_b64 s[40:41], s[40:41], vcc
    s_cmp_lt_u32 s101, 16
    s_cselect_b64 s[40:41], s[36:37], s[40:41]
    s_and_b32 s5, s5, 3
    s_cselect_b32 s6, 0, 0
    v_lshlrev_b32 v14, 7, v14
    v_lshl_add_u32 v14, v12, 4, v14
    s_mov_b32 s36, 0
    s_mov_b32 s39, 68124672
    s_mov_b64 exec, s[40:41]
.m_e2:
    buffer_load_dwordx4 v[16:19], v14, s[8:11], s39 offen sc1
    s_waitcnt vmcnt(0)
    v_min_u32 v12, v16, v17
    v_min3_u32 v12, v12, v18, v19
    s_cmp_ge_u32 s101, 16
    s_cbranch_scc1 .m_e3
    v_mov_b32 v12, v16
    s_cmp_eq_u32 s5, 0
    s_cbranch_scc1 .m_e3
    v_mov_b32 v12, v17
    s_cmp_eq_u32 s5, 1
    s_cbranch_scc1 .m_e3
    v_mov_b32 v12, v18
    s_cmp_eq_u32 s5, 2
    s_cbranch_scc1 .m_e3
    v_mov_b32 v12, v19
.m_e3:
    v_cmp_eq_u32 vcc, 0, v12
    s_cbranch_vccz .m_e4
    s_sleep 8
    s_add_u32 s36, s36, 1
    s_cmp_lt_u32 s36, 0x100000
    s_cbranch_scc1 .m_e2
    s_endpgm
.m_e4:
    s_mov_b64 exec, -1
    v_mov_b32 v12, s101
    v_mov_b32 v13, 2
    s_branch .m_p10
.m_cl2:
    s_lshr_b32 s5, s2, 5
    s_lshl_b32 s5, s5, 2
    s_add_u32 s38, s38, s5
    s_mov_b32 s36, 0
.m_c2:
    buffer_load_dword v12, v8, s[8:11], s38 offen sc1
    s_waitcnt vmcnt(0)
    v_readfirstlane_b32 s5, v12
    s_cmp_lg_u32 s5, 0
    s_cbranch_scc1 .m_p9
    s_sleep 4
    s_add_u32 s36, s36, 1
    s_cmp_lt_u32 s36, 0x100000
    s_cbranch_scc1 .m_c2
    s_endpgm
.m_p9:
    v_and_b32 v13, 0x100, v12
    v_and_b32 v12, 0xff, v12
.m_p10:
    ds_write_b64 v8, v[12:13]
.m_role_wait:
    s_waitcnt lgkmcnt(0)
    s_barrier
    ds_read_b64 v[12:13], v8
    s_waitcnt lgkmcnt(0)
    v_readfirstlane_b32 s4, v12
    v_readfirstlane_b32 s33, v13
    s_cmp_ge_u32 s4, 256
    s_cbranch_scc1 .m_end
    s_lshl_b32 s62, s4, 2
    s_add_u32 s62, s62, s3
    s_lshl_b32 s62, s62, 10
    s_add_u32 s62, s62, 68132864
    s_cmp_ge_u32 s4, 48
    s_cbranch_scc1 .w_start
    s_lshl_b32 s5, s3, 1
    v_bfe_u32 v17, v2, 1, 1
    v_mov_b32 v9, 0x4444
    v_mov_b32 v10, 0xeeee
    v_cmp_eq_u32 vcc, 1, v17
    v_lshrrev_b32 v11, 2, v2
    v_and_b32 v16, 1, v2
    v_lshl_add_u32 v16, v11, 1, v16
    v_lshlrev_b32 v12, 5, v1
    v_cndmask_b32 v4, v9, v10, vcc
    v_lshl_add_u32 v12, v17, 4, v12
    v_mul_u32_u24 v13, 896, v16
    v_add_u32 v6, v13, v12
    v_mul_u32_u24 v13, 928, v16
    v_add3_u32 v5, v13, v12, 64
    s_add_u32 s6, s5, 0
    s_sub_u32 s7, s6, 7
    s_cmp_ge_u32 s6, 7
    s_cselect_b32 s6, s7, s6
    s_lshl_b32 s24, s6, 7
    s_add_u32 s6, s5, 1
    s_sub_u32 s7, s6, 7
    s_cmp_ge_u32 s6, 7
    s_cselect_b32 s6, s7, s6
    s_lshl_b32 s25, s6, 7
    s_add_u32 s6, s5, 2
    s_sub_u32 s7, s6, 7
    s_cmp_ge_u32 s6, 7
    s_cselect_b32 s6, s7, s6
    s_lshl_b32 s26, s6, 7
    s_add_u32 s6, s5, 3
    s_sub_u32 s7, s6, 7
    s_cmp_ge_u32 s6, 7
    s_cselect_b32 s6, s7, s6
    s_lshl_b32 s27, s6, 7
    s_add_u32 s6, s5, 4
    s_sub_u32 s7, s6, 7
    s_cmp_ge_u32 s6, 7
    s_cselect_b32 s6, s7, s6
    s_lshl_b32 s28, s6, 7
    s_add_u32 s6, s5, 5
    s_sub_u32 s7, s6, 7
    s_cmp_ge_u32 s6, 7
    s_cselect_b32 s6, s7, s6
    s_lshl_b32 s29, s6, 7
    s_add_u32 s6, s5, 6
    s_sub_u32 s7, s6, 7
    s_cmp_ge_u32 s6, 7
    s_cselect_b32 s6, s7, s6
    s_lshl_b32 s30, s6, 7
    s_sub_u32 s5, s4, 16
    s_cmp_ge_u32 s4, 32
    s_cselect_b32 s5, s5, s4
    s_lshl_b32 s5, s5, 2
    s_add_u32 s5, s5, s3
    s_mul_i32 s5, s5, 100352
    s_add_u32 s5, s5, 0
    s_lshl_b32 s6, s24, 4
    s_add_u32 s6, s6, s5
    buffer_load_dwordx4 a[0:3], v3, s[8:11], s6 offen offset:0
    buffer_load_dwordx4 a[4:7], v3, s[8:11], s6 offen offset:1024
    s_add_u32 s6, s6, 14336
    buffer_load_dwordx4 a[56:59], v3, s[8:11], s6 offen offset:0
    buffer_load_dwordx4 a[60:63], v3, s[8:11], s6 offen offset:1024
    s_add_u32 s6, s6, 14336
    buffer_load_dwordx4 a[112:115], v3, s[8:11], s6 offen offset:0
    buffer_load_dwordx4 a[116:119], v3, s[8:11], s6 offen offset:1024
    s_add_u32 s6, s6, 14336
    buffer_load_dwordx4 a[168:171], v3, s[8:11], s6 offen offset:0
    buffer_load_dwordx4 a[172:175], v3, s[8:11], s6 offen offset:1024
    s_add_u32 s6, s6, 14336
    buffer_load_dwordx4 a[224:227], v3, s[8:11], s6 offen offset:0
    buffer_load_dwordx4 a[228:231], v3, s[8:11], s6 offen offset:1024
    s_add_u32 s6, s6, 14336
    buffer_load_dwordx4 v[144:147], v3, s[8:11], s6 offen offset:0
    buffer_load_dwordx4 v[148:151], v3, s[8:11], s6 offen offset:1024
    s_add_u32 s6, s6, 14336
    buffer_load_dwordx4 v[200:203], v3, s[8:11], s6 offen offset:0
    buffer_load_dwordx4 v[204:207], v3, s[8:11], s6 offen offset:1024
    s_lshl_b32 s6, s25, 4
    s_add_u32 s6, s6, s5
    buffer_load_dwordx4 a[8:11], v3, s[8:11], s6 offen offset:0
    buffer_load_dwordx4 a[12:15], v3, s[8:11], s6 offen offset:1024
    s_add_u32 s6, s6, 14336
    buffer_load_dwordx4 a[64:67], v3, s[8:11], s6 offen offset:0
    buffer_load_dwordx4 a[68:71], v3, s[8:11], s6 offen offset:1024
    s_add_u32 s6, s6, 14336
    buffer_load_dwordx4 a[120:123], v3, s[8:11], s6 offen offset:0
    buffer_load_dwordx4 a[124:127], v3, s[8:11], s6 offen offset:1024
    s_add_u32 s6, s6, 14336
    buffer_load_dwordx4 a[176:179], v3, s[8:11], s6 offen offset:0
    buffer_load_dwordx4 a[180:183], v3, s[8:11], s6 offen offset:1024
    s_add_u32 s6, s6, 14336
    buffer_load_dwordx4 a[232:235], v3, s[8:11], s6 offen offset:0
    buffer_load_dwordx4 a[236:239], v3, s[8:11], s6 offen offset:1024
    s_add_u32 s6, s6, 14336
    buffer_load_dwordx4 v[152:155], v3, s[8:11], s6 offen offset:0
    buffer_load_dwordx4 v[156:159], v3, s[8:11], s6 offen offset:1024
    s_add_u32 s6, s6, 14336
    buffer_load_dwordx4 v[208:211], v3, s[8:11], s6 offen offset:0
    buffer_load_dwordx4 v[212:215], v3, s[8:11], s6 offen offset:1024
    s_lshl_b32 s6, s26, 4
    s_add_u32 s6, s6, s5
    buffer_load_dwordx4 a[16:19], v3, s[8:11], s6 offen offset:0
    buffer_load_dwordx4 a[20:23], v3, s[8:11], s6 offen offset:1024
    s_add_u32 s6, s6, 14336
    buffer_load_dwordx4 a[72:75], v3, s[8:11], s6 offen offset:0
    buffer_load_dwordx4 a[76:79], v3, s[8:11], s6 offen offset:1024
    s_add_u32 s6, s6, 14336
    buffer_load_dwordx4 a[128:131], v3, s[8:11], s6 offen offset:0
    buffer_load_dwordx4 a[132:135], v3, s[8:11], s6 offen offset:1024
    s_add_u32 s6, s6, 14336
    buffer_load_dwordx4 a[184:187], v3, s[8:11], s6 offen offset:0
    buffer_load_dwordx4 a[188:191], v3, s[8:11], s6 offen offset:1024
    s_add_u32 s6, s6, 14336
    buffer_load_dwordx4 a[240:243], v3, s[8:11], s6 offen offset:0
    buffer_load_dwordx4 a[244:247], v3, s[8:11], s6 offen offset:1024
    s_add_u32 s6, s6, 14336
    buffer_load_dwordx4 v[160:163], v3, s[8:11], s6 offen offset:0
    buffer_load_dwordx4 v[164:167], v3, s[8:11], s6 offen offset:1024
    s_add_u32 s6, s6, 14336
    buffer_load_dwordx4 v[216:219], v3, s[8:11], s6 offen offset:0
    buffer_load_dwordx4 v[220:223], v3, s[8:11], s6 offen offset:1024
    s_lshl_b32 s6, s27, 4
    s_add_u32 s6, s6, s5
    buffer_load_dwordx4 a[24:27], v3, s[8:11], s6 offen offset:0
    buffer_load_dwordx4 a[28:31], v3, s[8:11], s6 offen offset:1024
    s_add_u32 s6, s6, 14336
    buffer_load_dwordx4 a[80:83], v3, s[8:11], s6 offen offset:0
    buffer_load_dwordx4 a[84:87], v3, s[8:11], s6 offen offset:1024
    s_add_u32 s6, s6, 14336
    buffer_load_dwordx4 a[136:139], v3, s[8:11], s6 offen offset:0
    buffer_load_dwordx4 a[140:143], v3, s[8:11], s6 offen offset:1024
    s_add_u32 s6, s6, 14336
    buffer_load_dwordx4 a[192:195], v3, s[8:11], s6 offen offset:0
    buffer_load_dwordx4 a[196:199], v3, s[8:11], s6 offen offset:1024
    s_add_u32 s6, s6, 14336
    buffer_load_dwordx4 a[248:251], v3, s[8:11], s6 offen offset:0
    buffer_load_dwordx4 a[252:255], v3, s[8:11], s6 offen offset:1024
    s_add_u32 s6, s6, 14336
    buffer_load_dwordx4 v[168:171], v3, s[8:11], s6 offen offset:0
    buffer_load_dwordx4 v[172:175], v3, s[8:11], s6 offen offset:1024
    s_add_u32 s6, s6, 14336
    buffer_load_dwordx4 v[224:227], v3, s[8:11], s6 offen offset:0
    buffer_load_dwordx4 v[228:231], v3, s[8:11], s6 offen offset:1024
    s_waitcnt vmcnt(42)
    s_lshl_b32 s6, s28, 4
    s_add_u32 s6, s6, s5
    buffer_load_dwordx4 a[32:35], v3, s[8:11], s6 offen offset:0
    buffer_load_dwordx4 a[36:39], v3, s[8:11], s6 offen offset:1024
    s_add_u32 s6, s6, 14336
    buffer_load_dwordx4 a[88:91], v3, s[8:11], s6 offen offset:0
    buffer_load_dwordx4 a[92:95], v3, s[8:11], s6 offen offset:1024
    s_add_u32 s6, s6, 14336
    buffer_load_dwordx4 a[144:147], v3, s[8:11], s6 offen offset:0
    buffer_load_dwordx4 a[148:151], v3, s[8:11], s6 offen offset:1024
    s_add_u32 s6, s6, 14336
    buffer_load_dwordx4 a[200:203], v3, s[8:11], s6 offen offset:0
    buffer_load_dwordx4 a[204:207], v3, s[8:11], s6 offen offset:1024
    s_add_u32 s6, s6, 14336
    buffer_load_dwordx4 v[120:123], v3, s[8:11], s6 offen offset:0
    buffer_load_dwordx4 v[124:127], v3, s[8:11], s6 offen offset:1024
    s_add_u32 s6, s6, 14336
    buffer_load_dwordx4 v[176:179], v3, s[8:11], s6 offen offset:0
    buffer_load_dwordx4 v[180:183], v3, s[8:11], s6 offen offset:1024
    s_add_u32 s6, s6, 14336
    buffer_load_dwordx4 v[232:235], v3, s[8:11], s6 offen offset:0
    buffer_load_dwordx4 v[236:239], v3, s[8:11], s6 offen offset:1024
    s_waitcnt vmcnt(42)
    s_lshl_b32 s6, s29, 4
    s_add_u32 s6, s6, s5
    buffer_load_dwordx4 a[40:43], v3, s[8:11], s6 offen offset:0
    buffer_load_dwordx4 a[44:47], v3, s[8:11], s6 offen offset:1024
    s_add_u32 s6, s6, 14336
    buffer_load_dwordx4 a[96:99], v3, s[8:11], s6 offen offset:0
    buffer_load_dwordx4 a[100:103], v3, s[8:11], s6 offen offset:1024
    s_add_u32 s6, s6, 14336
    buffer_load_dwordx4 a[152:155], v3, s[8:11], s6 offen offset:0
    buffer_load_dwordx4 a[156:159], v3, s[8:11], s6 offen offset:1024
    s_add_u32 s6, s6, 14336
    buffer_load_dwordx4 a[208:211], v3, s[8:11], s6 offen offset:0
    buffer_load_dwordx4 a[212:215], v3, s[8:11], s6 offen offset:1024
    s_add_u32 s6, s6, 14336
    buffer_load_dwordx4 v[128:131], v3, s[8:11], s6 offen offset:0
    buffer_load_dwordx4 v[132:135], v3, s[8:11], s6 offen offset:1024
    s_add_u32 s6, s6, 14336
    buffer_load_dwordx4 v[184:187], v3, s[8:11], s6 offen offset:0
    buffer_load_dwordx4 v[188:191], v3, s[8:11], s6 offen offset:1024
    s_add_u32 s6, s6, 14336
    buffer_load_dwordx4 v[240:243], v3, s[8:11], s6 offen offset:0
    buffer_load_dwordx4 v[244:247], v3, s[8:11], s6 offen offset:1024
    s_waitcnt vmcnt(42)
    s_lshl_b32 s6, s30, 4
    s_add_u32 s6, s6, s5
    buffer_load_dwordx4 a[48:51], v3, s[8:11], s6 offen offset:0
    buffer_load_dwordx4 a[52:55], v3, s[8:11], s6 offen offset:1024
    s_add_u32 s6, s6, 14336
    buffer_load_dwordx4 a[104:107], v3, s[8:11], s6 offen offset:0
    buffer_load_dwordx4 a[108:111], v3, s[8:11], s6 offen offset:1024
    s_add_u32 s6, s6, 14336
    buffer_load_dwordx4 a[160:163], v3, s[8:11], s6 offen offset:0
    buffer_load_dwordx4 a[164:167], v3, s[8:11], s6 offen offset:1024
    s_add_u32 s6, s6, 14336
    buffer_load_dwordx4 a[216:219], v3, s[8:11], s6 offen offset:0
    buffer_load_dwordx4 a[220:223], v3, s[8:11], s6 offen offset:1024
    s_add_u32 s6, s6, 14336
    buffer_load_dwordx4 v[136:139], v3, s[8:11], s6 offen offset:0
    buffer_load_dwordx4 v[140:143], v3, s[8:11], s6 offen offset:1024
    s_add_u32 s6, s6, 14336
    buffer_load_dwordx4 v[192:195], v3, s[8:11], s6 offen offset:0
    buffer_load_dwordx4 v[196:199], v3, s[8:11], s6 offen offset:1024
    s_add_u32 s6, s6, 14336
    buffer_load_dwordx4 v[248:251], v3, s[8:11], s6 offen offset:0
    buffer_load_dwordx4 v[252:255], v3, s[8:11], s6 offen offset:1024
    s_waitcnt vmcnt(42)

    s_cmp_lg_u32 s33, 2
    s_cbranch_scc1 .t_go
    s_and_b32 s38, s2, 31
    s_lshl_b32 s38, s38, 7
    s_lshr_b32 s5, s2, 5
    s_lshl_b32 s5, s5, 2
    s_add_u32 s38, s38, s5
    s_add_u32 s38, s38, 68128768
    v_mov_b32 v8, 0
    s_mov_b32 s36, 0
.t_g2:
    buffer_load_dword v12, v8, s[8:11], s38 offen sc1
    s_waitcnt vmcnt(0)
    v_readfirstlane_b32 s5, v12
    s_and_b32 s33, s5, 0x100
    s_cmp_lg_u32 s5, 0
    s_cbranch_scc1 .t_go
    s_sleep 4
    s_add_u32 s36, s36, 1
    s_cmp_lt_u32 s36, 0x100000
    s_cbranch_scc1 .t_g2
    s_endpgm
.t_go:
    s_mov_b32 s31, 0
    s_mov_b32 s32, 16523264
    s_cmp_ge_u32 s4, 32
    s_cbranch_scc1 .y_start
    s_cmp_ge_u32 s4, 16
    s_cbranch_scc1 .o_start
    s_mul_i32 s5, s3, 2304
    s_add_u32 s5, s5, 7552
    s_and_b32 s7, s3, 1
    v_mul_u32_u24 v8, 576, v1
    v_add_u32 v11, s5, v8
    v_lshl_add_u32 v112, v2, 3, v11
    v_lshrrev_b32 v9, 2, v2
    v_and_b32 v10, 1, v2
    v_bfe_u32 v12, v2, 1, 1
    v_lshl_add_u32 v13, v9, 4, v11
    v_lshl_add_u32 v13, v10, 3, v13
    v_lshl_add_u32 v13, v12, 2, v13
    v_add_u32 v113, 128, v13
    s_lshl_b32 s6, s3, 5
    s_add_u32 s6, s6, 16768
    v_add_u32 v13, s6, v8
    v_lshl_add_u32 v13, v12, 4, v13
    v_lshl_add_u32 v13, v9, 2, v13
    v_lshl_add_u32 v114, v10, 1, v13
    v_xor_b32 v13, s7, v16
    v_mul_u32_u24 v13, 288, v13
    v_add_u32 v13, s5, v13
    v_lshl_add_u32 v14, v1, 5, v13
    v_lshl_add_u32 v115, v17, 4, v14
    v_lshl_add_u32 v14, v1, 4, v13
    v_lshl_add_u32 v14, v17, 3, v14
    v_add_u32 v116, 128, v14
    s_sub_u32 s52, 16768, s5
    s_mul_i32 s6, s3, 224
    v_and_b32 v13, 7, v2
    v_mul_u32_u24 v13, 928, v13
    v_add_u32 v13, 64, v13
    v_lshl_add_u32 v14, v1, 4, v13
    v_add_u32 v117, s6, v14
    v_lshrrev_b32 v14, 1, v1
    v_mul_u32_u24 v14, 224, v14
    v_and_b32 v15, 1, v1
    v_lshl_add_u32 v14, v15, 4, v14
    v_add3_u32 v118, v13, v14, 64
    v_add_u32 v118, 128, v118
    v_lshrrev_b32 v13, 3, v2
    v_lshlrev_b32 v13, 8, v13
    v_lshl_add_u32 v13, v1, 6, v13
    v_lshl_add_u32 v13, v10, 5, v13
    v_bfe_u32 v14, v2, 1, 2
    v_lshl_add_u32 v13, v14, 2, v13
    s_lshl_b32 s6, s7, 4
    s_and_b32 s37, s4, 3
    s_lshl_b32 s37, s37, 9
    s_add_u32 s6, s6, s37
    v_add_u32 v7, s6, v13
    v_lshlrev_b32 v13, 5, v1
    v_lshl_add_u32 v13, v12, 4, v13
    v_bfe_u32 v14, v2, 2, 1
    v_lshl_add_u32 v13, v14, 2, v13
    s_lshl_b32 s6, s7, 3
    s_lshr_b32 s37, s37, 2
    s_add_u32 s6, s6, s37
    s_add_u32 s6, s6, 2048
    v_add_u32 v3, s6, v13
    v_and_b32 v9, 9, v2
    v_cmp_eq_u32 s[42:43], 0, v9
    s_lshr_b32 s37, s4, 2
    s_mul_i32 s37, s37, 2560
    s_add_u32 s37, s37, 17440768
    s_mov_b32 s44, 0x3db8aa3b
    s_sub_u32 s6, s3, s7
    s_sub_u32 s6, s6, 1
    s_and_b32 s6, s6, 3
    s_lshl_b32 s6, s6, 10
    s_lshl_b32 s53, s7, 12
    s_add_u32 s53, s53, 19072
    s_add_u32 s54, s53, s6
    s_add_u32 s6, s3, s7
    s_sub_u32 s6, s6, 2
    s_and_b32 s6, s6, 3
    s_lshl_b32 s6, s6, 10
    s_xor_b32 s55, s7, 1
    s_lshl_b32 s55, s55, 12
    s_add_u32 s55, s55, s6
    s_add_u32 s55, s55, 19072
    s_mov_b32 s56, s8
    s_add_u32 s56, s56, 458752
    s_addc_u32 s57, s9, 0
    s_mov_b32 s59, 0x00020000
    s_cmp_eq_u32 s4, 0
    s_cselect_b32 s58, 0x8000000, 0
    s_lshl_b32 s5, s4, 2
    s_add_u32 s5, s5, s3
    s_lshl_b32 s6, s5, 9
    s_add_u32 s6, s6, 65994752
    s_lshl_b32 s50, s5, 7
    s_add_u32 s50, s50, 18100224
    s_mul_i32 s5, s5, 7168
    s_add_u32 s5, s5, 26050560
    v_lshlrev_b32 v8, 7, v0
    v_add_u32 v8, s5, v8
    v_and_b32 v9, 3, v0
    v_lshlrev_b32 v9, 7, v9
    v_add_u32 v9, s6, v9
    v_cmp_gt_u32 vcc, 0, v0
    v_mov_b32 v10, 32768
    v_mov_b32 v11, 458752
    v_cndmask_b32 v2, v9, v8, vcc
    v_cndmask_b32 v119, v10, v11, vcc
    s_lshl_b32 s5, s4, 2
    s_add_u32 s5, s5, s3
    s_min_u32 s6, s5, 55
    s_lshl_b32 s6, s6, 7
    s_add_u32 s6, s6, 16530432
    v_mov_b32 v8, s6
    v_mov_b32 v9, 7168
    v_cmp_eq_u32 vcc, 60, v0
    s_min_u32 s6, s5, 39
    s_lshl_b32 s6, s6, 8
    s_add_u32 s6, s6, 17443072
    v_cndmask_b32 v2, v2, v8, vcc
    v_cndmask_b32 v119, v119, v9, vcc
    v_lshlrev_b32 v8, 7, v0
    v_add_u32 v8, s6, v8
    v_mov_b32 v9, 10240
    v_cmp_lt_u32 vcc, 61, v0
    s_nop 1
    v_cndmask_b32 v2, v2, v8, vcc
    v_cndmask_b32 v119, v119, v9, vcc
    v_lshlrev_b32 v0, 4, v0
    s_mul_i32 s38, s3, 6144
    s_add_u32 s38, s38, 65961984
    s_add_u32 s39, s38, 3072
    s_mov_b32 s45, 65986560
    s_mov_b32 s92, s8
    s_mov_b32 s93, s9
    s_mov_b32 s95, 0x00020000
    s_cmp_lt_u32 s3, 2
    s_cselect_b32 s94, 0x10000000, 0
    s_mov_b32 s51, 0
    buffer_load_dwordx4 v[64:67], v0, s[8:11], s38 offen offset:0
    buffer_load_dwordx4 v[68:71], v0, s[8:11], s38 offen offset:1024
    buffer_load_dwordx4 v[72:75], v0, s[8:11], s38 offen offset:2048
    buffer_load_dwordx4 v[76:79], v0, s[8:11], s39 offen offset:0
    buffer_load_dwordx4 v[80:83], v0, s[8:11], s39 offen offset:1024
    buffer_load_dwordx4 v[84:87], v0, s[8:11], s39 offen offset:2048
    buffer_load_dwordx4 v[88:91], v0, s[92:95], s45 offen offset:0
    buffer_load_dwordx4 v[92:95], v0, s[92:95], s45 offen offset:1024
    buffer_load_dwordx4 v[96:99], v0, s[92:95], s45 offen offset:2048
    buffer_load_dwordx4 v[100:103], v0, s[92:95], s45 offen offset:3072
    s_add_u32 s38, s38, 32768
    s_add_u32 s39, s39, 32768
    s_add_u32 s45, s45, 32768
.p_step:
    s_add_u32 s5, s31, 1
    s_min_u32 s5, s5, 63
    s_lshr_b32 s5, s5, 1
    s_cmp_lt_u32 s5, s51
    s_cbranch_scc1 .p_fok
    s_mov_b32 s36, 0
    v_lshrrev_b32 v104, 2, v0
    v_and_b32 v104, 127, v104
.p_fl:
    buffer_load_dword v105, v104, s[8:11], s50 offen sc1
    s_waitcnt vmcnt(0)
    v_cmp_eq_u32 vcc, 0, v105
    s_ff1_i32_b32 s51, vcc_lo
    s_min_u32 s51, s51, 32
    s_cmp_lt_u32 s5, s51
    s_cbranch_scc1 .p_fok
    s_sleep 2
    s_add_u32 s36, s36, 1
    s_cmp_lt_u32 s36, 2097152
    s_cbranch_scc1 .p_fl
    s_endpgm
.p_fok:
    s_add_u32 s34, s32, s24
    s_add_u32 s35, s32, s25
    s_lshl3_add_u32 s90, s24, s32
    s_lshl3_add_u32 s91, s25, s32
    v_add_u32 v104, s24, v5
    v_add_u32 v105, s25, v5
    v_add_u32 v106, s26, v5
    v_add_u32 v107, s27, v5
    v_add_u32 v108, s28, v5
    v_add_u32 v109, s29, v5
    v_add_u32 v110, s30, v5
    v_mov_b64 v[36:37], 0
    v_mov_b64 v[38:39], 0
    v_mov_b64 v[40:41], 0
    v_mov_b64 v[42:43], 0
    v_mov_b64 v[44:45], 0
    v_mov_b64 v[46:47], 0
    v_mov_b64 v[48:49], 0
    v_mov_b64 v[50:51], 0
    v_mov_b64 v[52:53], 0
    v_mov_b64 v[54:55], 0
    v_mov_b64 v[56:57], 0
    v_mov_b64 v[58:59], 0
    v_mov_b64 v[60:61], 0
    v_mov_b64 v[62:63], 0
    v_mov_b64 v[8:9], -1
    v_mov_b64 v[10:11], -1
    v_mov_b64 v[12:13], -1
    v_mov_b64 v[14:15], -1
    s_sleep 4
    s_cmp_lt_u32 s3, 2
    s_cbranch_scc1 .p_go
    s_sleep 8
.p_go:
    s_mov_b64 s[84:85], -1
    s_mov_b64 s[86:87], -1
    s_mov_b32 s36, 0
    buffer_load_dwordx4 v[8:11], v0, s[8:11], s90 offen sc1
    buffer_load_dwordx4 v[12:15], v0, s[8:11], s91 offen sc1
    s_branch .poll_5_0
.poll_5_r:
    s_mov_b64 exec, s[86:87]
    buffer_load_dwordx4 v[12:15], v0, s[8:11], s91 offen sc1
    s_mov_b64 exec, -1
    s_add_u32 s36, s36, 1
    s_cmp_ge_u32 s36, 2097152
    s_cbranch_scc1 .m_end
.poll_5_0:
    s_waitcnt vmcnt(1)
    v_max3_u32 v111, v8, v9, v10
    v_max_u32 v111, v111, v11
    v_cmp_eq_u32 s[84:85], -1, v111
    s_nop 0
    s_or_b64 s[82:83], s[86:87], s[84:85]
    s_cbranch_scc0 .poll_5_d
    s_mov_b64 exec, s[84:85]
    buffer_load_dwordx4 v[8:11], v0, s[8:11], s90 offen sc1
    s_mov_b64 exec, -1
    s_waitcnt vmcnt(1)
    v_max3_u32 v111, v12, v13, v14
    v_max_u32 v111, v111, v15
    v_cmp_eq_u32 s[86:87], -1, v111
    s_nop 0
    s_or_b64 s[82:83], s[84:85], s[86:87]
    s_cbranch_scc1 .poll_5_r
.poll_5_d:
    ds_write_b128 v104, v[8:11]
    ds_write_b128 v105, v[12:15]
    v_smfmac_f32_16x16x64_bf16 v[36:39], v[8:11], a[0:7], v4
    v_smfmac_f32_16x16x64_bf16 v[40:43], v[8:11], a[56:63], v4
    v_smfmac_f32_16x16x64_bf16 v[44:47], v[8:11], a[112:119], v4
    v_smfmac_f32_16x16x64_bf16 v[48:51], v[8:11], a[168:175], v4
    s_waitcnt lgkmcnt(0)
    s_barrier
    ds_read_b128 v[16:19], v106
    v_smfmac_f32_16x16x64_bf16 v[52:55], v[8:11], a[224:231], v4
    ds_read_b128 v[20:23], v107
    v_smfmac_f32_16x16x64_bf16 v[56:59], v[8:11], v[144:151], v4
    ds_read_b128 v[24:27], v108
    v_smfmac_f32_16x16x64_bf16 v[60:63], v[8:11], v[200:207], v4
    ds_read_b128 v[28:31], v109
    v_smfmac_f32_16x16x64_bf16 v[36:39], v[12:15], a[8:15], v4
    ds_read_b128 v[32:35], v110
    v_smfmac_f32_16x16x64_bf16 v[40:43], v[12:15], a[64:71], v4
    buffer_store_dwordx4 v[8:11], v6, s[56:59], s34 offen sc1
    v_smfmac_f32_16x16x64_bf16 v[44:47], v[12:15], a[120:127], v4
    buffer_store_dwordx4 v[12:15], v6, s[56:59], s35 offen sc1
    v_smfmac_f32_16x16x64_bf16 v[48:51], v[12:15], a[176:183], v4
    buffer_load_dword v1, v2, s[8:11], 0 offen
    v_smfmac_f32_16x16x64_bf16 v[52:55], v[12:15], a[232:239], v4
    v_smfmac_f32_16x16x64_bf16 v[56:59], v[12:15], v[152:159], v4
    v_smfmac_f32_16x16x64_bf16 v[60:63], v[12:15], v[208:215], v4
    s_waitcnt lgkmcnt(0)
    v_smfmac_f32_16x16x64_bf16 v[36:39], v[16:19], a[16:23], v4
    v_smfmac_f32_16x16x64_bf16 v[36:39], v[20:23], a[24:31], v4
    v_smfmac_f32_16x16x64_bf16 v[36:39], v[24:27], a[32:39], v4
    v_smfmac_f32_16x16x64_bf16 v[36:39], v[28:31], a[40:47], v4
    v_smfmac_f32_16x16x64_bf16 v[36:39], v[32:35], a[48:55], v4
    v_smfmac_f32_16x16x64_bf16 v[40:43], v[16:19], a[72:79], v4
    v_smfmac_f32_16x16x64_bf16 v[40:43], v[20:23], a[80:87], v4
    v_pk_add_f32 v[36:37], v[36:37], v[38:39]
    v_smfmac_f32_16x16x64_bf16 v[40:43], v[24:27], a[88:95], v4
    v_mov_b64 v[38:39], 0
    v_smfmac_f32_16x16x64_bf16 v[40:43], v[28:31], a[96:103], v4
    s_waitcnt vmcnt(3)
    v_smfmac_f32_16x16x64_bf16 v[40:43], v[32:35], a[104:111], v4
    ds_read_b128 v[8:11], v117 offset:0
    v_smfmac_f32_16x16x64_bf16 v[44:47], v[16:19], a[128:135], v4
    ds_read_b128 v[12:15], v117 offset:64
    v_smfmac_f32_16x16x64_bf16 v[44:47], v[20:23], a[136:143], v4
    v_pk_add_f32 v[40:41], v[40:41], v[42:43]
    v_smfmac_f32_16x16x64_bf16 v[44:47], v[24:27], a[144:151], v4
    v_cvt_pk_bf16_f32 v104, v36, v40
    v_smfmac_f32_16x16x64_bf16 v[44:47], v[28:31], a[152:159], v4
    v_cvt_pk_bf16_f32 v106, v37, v41
    v_smfmac_f32_16x16x64_bf16 v[44:47], v[32:35], a[160:167], v4
    v_mov_b64 v[36:37], 0
    v_smfmac_f32_16x16x64_bf16 v[48:51], v[16:19], a[184:191], v4
    v_mov_b64 v[40:41], 0
    v_smfmac_f32_16x16x64_bf16 v[48:51], v[20:23], a[192:199], v4
    v_pk_add_f32 v[44:45], v[44:45], v[46:47]
    v_smfmac_f32_16x16x64_bf16 v[48:51], v[24:27], a[200:207], v4
    v_mov_b64 v[42:43], 0
    v_smfmac_f32_16x16x64_bf16 v[48:51], v[28:31], a[208:215], v4
    v_mov_b64 v[46:47], 0
    v_smfmac_f32_16x16x64_bf16 v[48:51], v[32:35], a[216:223], v4
    ds_read_b128 v[108:111], v117 offset:128
    v_smfmac_f32_16x16x64_bf16 v[52:55], v[16:19], a[240:247], v4
    v_smfmac_f32_16x16x64_bf16 v[52:55], v[20:23], a[248:255], v4
    v_pk_add_f32 v[48:49], v[48:49], v[50:51]
    v_smfmac_f32_16x16x64_bf16 v[52:55], v[24:27], v[120:127], v4
    v_cvt_pk_bf16_f32 v105, v44, v48
    ds_write_b64 v112, v[104:105]
    v_smfmac_f32_16x16x64_bf16 v[52:55], v[28:31], v[128:135], v4
    v_cvt_pk_bf16_f32 v107, v45, v49
    ds_write_b64 v112, v[106:107] offset:288
    v_smfmac_f32_16x16x64_bf16 v[52:55], v[32:35], v[136:143], v4
    ds_read_b128 v[104:107], v115
    v_smfmac_f32_16x16x64_bf16 v[56:59], v[16:19], v[160:167], v4
    v_mov_b64 v[44:45], 0
    v_smfmac_f32_16x16x64_bf16 v[56:59], v[20:23], v[168:175], v4
    v_pk_add_f32 v[52:53], v[52:53], v[54:55]
    v_smfmac_f32_16x16x64_bf16 v[56:59], v[24:27], v[176:183], v4
    v_add_u32 v48, s54, v0
    v_smfmac_f32_16x16x64_bf16 v[56:59], v[28:31], v[184:191], v4
    v_add_u32 v49, s55, v0
    v_smfmac_f32_16x16x64_bf16 v[56:59], v[32:35], v[192:199], v4
    s_waitcnt lgkmcnt(0)
    v_smfmac_f32_16x16x64_bf16 v[36:39], v[104:107], v[64:71], v4
    v_add_u32 v50, s53, v0
    v_smfmac_f32_16x16x64_bf16 v[40:43], v[104:107], v[76:83], v4
    v_pk_add_f32 v[56:57], v[56:57], v[58:59]
    v_cvt_pk_bf16_f32 v52, v52, v56
    ds_write_b32 v113, v52
    v_cvt_pk_bf16_f32 v53, v53, v57
    ds_write_b32 v113, v53 offset:288
    ds_read_b64 v[56:57], v116
    v_smfmac_f32_16x16x64_bf16 v[44:47], v[104:107], v[8:15], v4
    v_add_u32 v51, s52, v115
    v_smfmac_f32_16x16x64_bf16 v[60:63], v[16:19], v[216:223], v4
    s_cmp_ge_u32 s3, 2
    v_smfmac_f32_16x16x64_bf16 v[60:63], v[20:23], v[224:231], v4
    ds_read_b128 v[16:19], v118
    v_smfmac_f32_16x16x64_bf16 v[60:63], v[24:27], v[232:239], v4
    ds_read_b128 v[20:23], v118 offset:448
    v_smfmac_f32_16x16x64_bf16 v[60:63], v[28:31], v[240:247], v4
    s_waitcnt lgkmcnt(2)
    v_smfmac_f32_16x16x32_bf16 v[36:39], v[56:57], v[72:75], v4
    v_smfmac_f32_16x16x32_bf16 v[40:43], v[56:57], v[84:87], v4
    v_smfmac_f32_16x16x32_bf16 v[44:47], v[56:57], v[108:111], v4
    v_add_f32 v52, v36, v38
    v_add_f32 v104, v37, v39
    v_smfmac_f32_16x16x64_bf16 v[60:63], v[32:35], v[248:255], v4
    v_add_f32 v53, v40, v42
    v_add_f32 v105, v41, v43
    s_nop 1
    v_add_f32 v54, v44, v46
    v_add_f32 v106, v45, v47
    ds_write_b128 v49, v[104:107]
    ds_write_b128 v48, v[52:55]
    v_pk_add_f32 v[60:61], v[60:61], v[62:63]
    v_cvt_pk_bf16_f32 v60, v60, v61
    ds_write_b16 v114, v60
    ds_write_b16_d16_hi v114, v60 offset:288
    s_waitcnt lgkmcnt(0)
    s_barrier
    s_cbranch_scc1 .p_next
    ds_read_b128 v[104:107], v51
    ds_read_b128 v[24:27], v50 offset:0
    ds_read_b128 v[28:31], v50 offset:1024
    ds_read_b128 v[32:35], v50 offset:2048
    s_waitcnt lgkmcnt(3)
    v_smfmac_f32_16x16x64_bf16 v[36:39], v[104:107], v[88:95], v4
    s_waitcnt lgkmcnt(1)
    v_pk_add_f32 v[24:25], v[24:25], v[28:29]
    v_pk_add_f32 v[26:27], v[26:27], v[30:31]
    v_smfmac_f32_16x16x64_bf16 v[40:43], v[104:107], v[96:103], v4
    s_waitcnt lgkmcnt(0)
    v_pk_add_f32 v[24:25], v[24:25], v[32:33]
    v_pk_add_f32 v[26:27], v[26:27], v[34:35]
    v_smfmac_f32_16x16x64_bf16 v[44:47], v[104:107], v[16:23], v4
    v_pk_mul_f32 v[24:25], v[24:25], s[44:45] op_sel_hi:[1,0]
    v_pk_mul_f32 v[26:27], v[26:27], s[44:45] op_sel_hi:[1,0]
    v_add_f32 v52, v36, v38
    v_fma_f32 v52, v52, s44, v24
    v_add_f32 v53, v40, v42
    v_fma_f32 v53, v53, s44, v25
    s_nop 1
    v_add_f32 v54, v44, v46
    v_fma_f32 v54, v54, s44, v26
    v_max3_f32 v108, v52, v53, v54
    s_nop 1
    v_max_f32_dpp v108, v108, v108 row_ror:8 row_mask:0xf bank_mask:0xf
    s_nop 1
    v_max_f32_dpp v108, v108, v108 row_ror:4 row_mask:0xf bank_mask:0xf
    s_nop 1
    v_max_f32_dpp v108, v108, v108 row_ror:2 row_mask:0xf bank_mask:0xf
    s_nop 1
    v_max_f32_dpp v108, v108, v108 row_ror:1 row_mask:0xf bank_mask:0xf
    v_sub_f32 v54, v54, v108
    v_pk_add_f32 v[52:53], v[52:53], v[108:109] op_sel_hi:[1,0] neg_lo:[0,1] neg_hi:[0,1]
    v_exp_f32 v54, v54
    v_exp_f32 v52, v52
    v_exp_f32 v53, v53
    v_fma_f32 v108, v54, 0.5, v52
    v_add_f32 v108, v108, v53
    v_mov_b32_dpp v55, v54 quad_perm:[1,1,3,3] row_mask:0xf bank_mask:0xf
    s_nop 0
    v_add_f32_dpp v108, v108, v108 row_ror:8 row_mask:0xf bank_mask:0xf
    s_nop 1
    v_add_f32_dpp v108, v108, v108 row_ror:4 row_mask:0xf bank_mask:0xf
    s_nop 1
    v_add_f32_dpp v108, v108, v108 row_ror:2 row_mask:0xf bank_mask:0xf
    s_nop 1
    v_add_f32_dpp v108, v108, v108 row_ror:1 row_mask:0xf bank_mask:0xf
    v_rcp_f32 v108, v108
    s_cmp_lg_u32 s33, 0
    v_pk_mul_f32 v[52:53], v[52:53], v[108:109] op_sel_hi:[1,0] clamp
    v_pk_mul_f32 v[54:55], v[54:55], v[108:109] op_sel_hi:[1,0] clamp
    v_cvt_pk_bf16_f32 v104, v52, v53
    v_cvt_pk_bf16_f32 v105, v54, v55
    s_cbranch_scc1 .p_slow
    buffer_store_dword v104, v7, s[8:11], s37 offen
    s_mov_b64 exec, s[42:43]
    buffer_store_dword v105, v3, s[8:11], s37 offen
    s_mov_b64 exec, -1
    s_branch .p_next
.p_slow:
    buffer_store_dword v104, v7, s[8:11], s37 offen sc1
    s_mov_b64 exec, s[42:43]
    buffer_store_dword v105, v3, s[8:11], s37 offen sc1
    s_mov_b64 exec, -1
.p_next:
    buffer_load_dwordx4 v[64:67], v0, s[8:11], s38 offen offset:0
    buffer_load_dwordx4 v[68:71], v0, s[8:11], s38 offen offset:1024
    buffer_load_dwordx4 v[72:75], v0, s[8:11], s38 offen offset:2048
    buffer_load_dwordx4 v[76:79], v0, s[8:11], s39 offen offset:0
    buffer_load_dwordx4 v[80:83], v0, s[8:11], s39 offen offset:1024
    buffer_load_dwordx4 v[84:87], v0, s[8:11], s39 offen offset:2048
    buffer_load_dwordx4 v[88:91], v0, s[92:95], s45 offen offset:0
    buffer_load_dwordx4 v[92:95], v0, s[92:95], s45 offen offset:1024
    buffer_load_dwordx4 v[96:99], v0, s[92:95], s45 offen offset:2048
    buffer_load_dwordx4 v[100:103], v0, s[92:95], s45 offen offset:3072
    s_add_u32 s31, s31, 1
    s_add_u32 s32, s32, 7168
    s_add_u32 s37, s37, 10240
    s_add_u32 s38, s38, 32768
    s_add_u32 s39, s39, 32768
    s_add_u32 s45, s45, 32768
    s_cmp_ge_u32 s31, 63
    s_cbranch_scc1 .m_end
    s_cmp_ge_u32 s31, 63
    s_cbranch_scc1 .p_step
    v_add_u32 v2, v2, v119
    s_branch .p_step
.o_start:
    s_sub_u32 s4, s4, 16
    s_mul_i32 s5, s3, 2304
    s_add_u32 s5, s5, 7552
    v_lshlrev_b32 v8, 4, v2
    v_lshl_add_u32 v8, v1, 2, v8
    v_add_u32 v112, s5, v8
    v_min_u32 v9, 13, v2
    v_mul_u32_u24 v8, 448, v1
    v_lshl_add_u32 v115, v9, 4, v8
    v_add_u32 v113, s5, v115
    v_mov_b32 v115, v3
    s_mov_b32 s46, s5
    v_mul_u32_u24 v8, 224, v1
    v_lshl_add_u32 v114, v9, 4, v8
    v_lshlrev_b32 v117, 3, v0
    s_lshl_b32 s6, s3, 9
    s_add_u32 s6, s6, 19072
    v_lshlrev_b32 v11, 3, v0
    v_add_u32 v118, s6, v11
    s_and_b32 s7, s3, 1
    s_mul_i32 s6, s7, 896
    s_mul_i32 s44, s4, 56
    s_add_u32 s6, s6, s44
    v_mul_u32_u24 v8, 1792, v1
    v_lshl_add_u32 v8, v2, 2, v8
    v_add_u32 v116, s6, v8
    s_mul_i32 s6, s4, 28
    v_lshlrev_b32 v8, 1, v2
    v_add_u32 v8, s6, v8
    v_lshrrev_b32 v10, 4, v8
    v_lshlrev_b32 v10, 8, v10
    v_lshl_add_u32 v10, v1, 6, v10
    v_bfe_u32 v12, v8, 3, 1
    v_lshl_add_u32 v10, v12, 5, v10
    v_and_b32 v12, 7, v8
    v_lshl_add_u32 v10, v12, 1, v10
    s_lshl_b32 s6, s7, 4
    v_add_u32 v119, s6, v10
    v_cmp_gt_u32 s[40:41], 14, v2
    s_lshl_b32 s6, s4, 2
    s_add_u32 s6, s6, s3
    s_mul_i32 s37, s3, 2560
    s_add_u32 s37, s37, 17440768
    s_mul_i32 s38, s6, 7168
    s_add_u32 s38, s38, 25591808
    s_mul_i32 s39, s6, 1792
    s_add_u32 s39, s39, 18137088
    s_lshl_b32 s42, s6, 2
    s_add_u32 s43, s42, 18118656
    s_lshl_b32 s42, s6, 7
    s_add_u32 s42, s42, 18100224
    s_mov_b32 s44, 7168
    s_min_u32 s52, s6, 55
    s_lshl_b32 s52, s52, 7
    s_add_u32 s52, s52, 16537600
    s_min_u32 s53, s6, 39
    s_lshl_b32 s53, s53, 8
    s_add_u32 s53, s53, 17461248
    s_cmp_eq_u32 s33, 0
    s_cselect_b32 s57, 0xffff, 0
    s_mov_b32 s55, 0
    s_mov_b32 s59, 0
    s_lshl_b32 s5, s6, 9
    s_add_u32 s5, s5, 65994752
    v_and_b32 v9, 3, v0
    v_lshlrev_b32 v9, 7, v9
    v_add_u32 v2, s5, v9
    v_mov_b32 v6, 32768
    s_min_u32 s5, s6, 55
    s_lshl_b32 s5, s5, 7
    s_add_u32 s5, s5, 16530432
    v_mov_b32 v8, s5
    v_mov_b32 v9, 7168
    v_cmp_eq_u32 vcc, 60, v0
    s_min_u32 s5, s6, 39
    s_lshl_b32 s5, s5, 8
    s_add_u32 s5, s5, 17443072
    v_cndmask_b32 v2, v2, v8, vcc
    v_cndmask_b32 v6, v6, v9, vcc
    v_lshlrev_b32 v8, 7, v0
    v_add_u32 v8, s5, v8
    v_mov_b32 v9, 10240
    v_cmp_lt_u32 vcc, 61, v0
    s_nop 1
    v_cndmask_b32 v2, v2, v8, vcc
    v_cndmask_b32 v6, v6, v9, vcc
    s_lshl_b32 s6, s7, 2
    s_add_u32 s6, s6, 19072
    v_add_u32 v0, s6, v11
    v_mov_b32 v3, 0
    s_mov_b32 s45, s42
    s_mov_b32 s36, 0
    buffer_load_dword v7, v3, s[8:11], s45 offen sc1
.fu_6:
    s_waitcnt vmcnt(0)
    v_readfirstlane_b32 s5, v7
    s_cmp_lg_u32 s5, 0
    s_cbranch_scc1 .fud_7
    s_sleep 1
    buffer_load_dword v7, v3, s[8:11], s45 offen sc1
    s_add_u32 s36, s36, 1
    s_cmp_lt_u32 s36, 2097152
    s_cbranch_scc1 .fu_6
    s_endpgm
.fud_7:
.o_step:
    s_add_u32 s34, s32, s24
    s_add_u32 s35, s32, s25
    s_lshl3_add_u32 s90, s24, s32
    s_lshl3_add_u32 s91, s25, s32
    v_add_u32 v104, s24, v5
    v_add_u32 v105, s25, v5
    v_add_u32 v106, s26, v5
    v_add_u32 v107, s27, v5
    v_add_u32 v108, s28, v5
    v_add_u32 v109, s29, v5
    v_add_u32 v110, s30, v5
    v_mov_b64 v[36:37], 0
    v_mov_b64 v[38:39], 0
    v_mov_b64 v[40:41], 0
    v_mov_b64 v[42:43], 0
    v_mov_b64 v[44:45], 0
    v_mov_b64 v[46:47], 0
    v_mov_b64 v[48:49], 0
    v_mov_b64 v[50:51], 0
    v_mov_b64 v[52:53], 0
    v_mov_b64 v[54:55], 0
    v_mov_b64 v[56:57], 0
    v_mov_b64 v[58:59], 0
    v_mov_b64 v[60:61], 0
    v_mov_b64 v[62:63], 0
    v_mov_b64 v[8:9], -1
    v_mov_b64 v[10:11], -1
    v_mov_b64 v[12:13], -1
    v_mov_b64 v[14:15], -1
    s_add_u32 s56, s38, 3584
    s_cmp_lt_u32 s31, 61
    s_cselect_b32 s54, s57, 0
    s_and_b32 s58, s54, 0xff
    v_mov_b64 v[96:97], -1
    v_mov_b64 v[98:99], -1
    s_sleep 0
    s_mov_b64 s[84:85], -1
    s_mov_b64 s[86:87], -1
    s_mov_b32 s36, 0
    buffer_load_dwordx4 v[8:11], v115, s[8:11], s90 offen sc1
    buffer_load_dwordx4 v[12:15], v115, s[8:11], s91 offen sc1
    s_branch .poll_8_0
.poll_8_r:
    s_mov_b64 exec, s[86:87]
    buffer_load_dwordx4 v[12:15], v115, s[8:11], s91 offen sc1
    s_mov_b64 exec, -1
    s_add_u32 s36, s36, 1
    s_cmp_ge_u32 s36, 2097152
    s_cbranch_scc1 .m_end
.poll_8_0:
    s_waitcnt vmcnt(1)
    v_max3_u32 v111, v8, v9, v10
    v_max_u32 v111, v111, v11
    v_cmp_eq_u32 s[84:85], -1, v111
    s_nop 0
    s_or_b64 s[82:83], s[86:87], s[84:85]
    s_cbranch_scc0 .poll_8_d
    s_mov_b64 exec, s[84:85]
    buffer_load_dwordx4 v[8:11], v115, s[8:11], s90 offen sc1
    s_mov_b64 exec, -1
    s_waitcnt vmcnt(1)
    v_max3_u32 v111, v12, v13, v14
    v_max_u32 v111, v111, v15
    v_cmp_eq_u32 s[86:87], -1, v111
    s_nop 0
    s_or_b64 s[82:83], s[84:85], s[86:87]
    s_cbranch_scc1 .poll_8_r
.poll_8_d:
    ds_write_b128 v104, v[8:11]
    ds_write_b128 v105, v[12:15]
    buffer_load_dwordx4 v[72:75], v114, s[8:11], s56 offen offset:0
    buffer_load_dwordx4 v[88:91], v114, s[8:11], s56 offen offset:896
    v_smfmac_f32_16x16x64_bf16 v[36:39], v[8:11], a[0:7], v4
    buffer_load_dwordx4 v[76:79], v114, s[8:11], s56 offen offset:1792
    buffer_load_dwordx4 v[92:95], v114, s[8:11], s56 offen offset:2688
    v_smfmac_f32_16x16x64_bf16 v[40:43], v[8:11], a[56:63], v4
    buffer_load_dwordx4 v[64:67], v114, s[8:11], s38 offen offset:0
    buffer_load_dwordx4 v[80:83], v114, s[8:11], s38 offen offset:896
    v_smfmac_f32_16x16x64_bf16 v[44:47], v[8:11], a[112:119], v4
    buffer_load_dwordx4 v[68:71], v114, s[8:11], s38 offen offset:1792
    buffer_load_dwordx4 v[84:87], v114, s[8:11], s38 offen offset:2688
    v_smfmac_f32_16x16x64_bf16 v[48:51], v[8:11], a[168:175], v4
    s_waitcnt lgkmcnt(0)
    s_barrier
    ds_read_b128 v[16:19], v106
    ds_read_b128 v[20:23], v107
    ds_read_b128 v[24:27], v108
    ds_read_b128 v[28:31], v109
    ds_read_b128 v[32:35], v110
    v_smfmac_f32_16x16x64_bf16 v[52:55], v[8:11], a[224:231], v4
    v_smfmac_f32_16x16x64_bf16 v[56:59], v[8:11], v[144:151], v4
    v_smfmac_f32_16x16x64_bf16 v[60:63], v[8:11], v[200:207], v4
    v_smfmac_f32_16x16x64_bf16 v[36:39], v[12:15], a[8:15], v4
    v_smfmac_f32_16x16x64_bf16 v[40:43], v[12:15], a[64:71], v4
    v_smfmac_f32_16x16x64_bf16 v[44:47], v[12:15], a[120:127], v4
    v_smfmac_f32_16x16x64_bf16 v[48:51], v[12:15], a[176:183], v4
    v_smfmac_f32_16x16x64_bf16 v[52:55], v[12:15], a[232:239], v4
    v_smfmac_f32_16x16x64_bf16 v[56:59], v[12:15], v[152:159], v4
    v_smfmac_f32_16x16x64_bf16 v[60:63], v[12:15], v[208:215], v4
    s_waitcnt lgkmcnt(4)
    v_smfmac_f32_16x16x64_bf16 v[36:39], v[16:19], a[16:23], v4
    v_smfmac_f32_16x16x64_bf16 v[40:43], v[16:19], a[72:79], v4
    v_smfmac_f32_16x16x64_bf16 v[44:47], v[16:19], a[128:135], v4
    v_smfmac_f32_16x16x64_bf16 v[48:51], v[16:19], a[184:191], v4
    v_smfmac_f32_16x16x64_bf16 v[52:55], v[16:19], a[240:247], v4
    v_smfmac_f32_16x16x64_bf16 v[56:59], v[16:19], v[160:167], v4
    v_smfmac_f32_16x16x64_bf16 v[60:63], v[16:19], v[216:223], v4
    s_waitcnt lgkmcnt(3)
    v_smfmac_f32_16x16x64_bf16 v[36:39], v[20:23], a[24:31], v4
    v_smfmac_f32_16x16x64_bf16 v[40:43], v[20:23], a[80:87], v4
    v_smfmac_f32_16x16x64_bf16 v[44:47], v[20:23], a[136:143], v4
    v_smfmac_f32_16x16x64_bf16 v[48:51], v[20:23], a[192:199], v4
    v_smfmac_f32_16x16x64_bf16 v[52:55], v[20:23], a[248:255], v4
    v_smfmac_f32_16x16x64_bf16 v[56:59], v[20:23], v[168:175], v4
    v_smfmac_f32_16x16x64_bf16 v[60:63], v[20:23], v[224:231], v4
    s_waitcnt lgkmcnt(2)
    v_smfmac_f32_16x16x64_bf16 v[36:39], v[24:27], a[32:39], v4
    v_smfmac_f32_16x16x64_bf16 v[40:43], v[24:27], a[88:95], v4
    v_smfmac_f32_16x16x64_bf16 v[44:47], v[24:27], a[144:151], v4
    v_smfmac_f32_16x16x64_bf16 v[48:51], v[24:27], a[200:207], v4
    v_smfmac_f32_16x16x64_bf16 v[52:55], v[24:27], v[120:127], v4
    v_smfmac_f32_16x16x64_bf16 v[56:59], v[24:27], v[176:183], v4
    v_smfmac_f32_16x16x64_bf16 v[60:63], v[24:27], v[232:239], v4
    s_waitcnt lgkmcnt(1)
    v_smfmac_f32_16x16x64_bf16 v[36:39], v[28:31], a[40:47], v4
    v_smfmac_f32_16x16x64_bf16 v[40:43], v[28:31], a[96:103], v4
    v_smfmac_f32_16x16x64_bf16 v[44:47], v[28:31], a[152:159], v4
    v_smfmac_f32_16x16x64_bf16 v[48:51], v[28:31], a[208:215], v4
    v_smfmac_f32_16x16x64_bf16 v[52:55], v[28:31], v[128:135], v4
    v_smfmac_f32_16x16x64_bf16 v[56:59], v[28:31], v[184:191], v4
    v_smfmac_f32_16x16x64_bf16 v[60:63], v[28:31], v[240:247], v4
    s_waitcnt lgkmcnt(0)
    v_smfmac_f32_16x16x64_bf16 v[36:39], v[32:35], a[48:55], v4
    v_smfmac_f32_16x16x64_bf16 v[40:43], v[32:35], a[104:111], v4
    v_smfmac_f32_16x16x64_bf16 v[44:47], v[32:35], a[160:167], v4
    v_smfmac_f32_16x16x64_bf16 v[48:51], v[32:35], a[216:223], v4
    v_smfmac_f32_16x16x64_bf16 v[52:55], v[32:35], v[136:143], v4
    v_smfmac_f32_16x16x64_bf16 v[56:59], v[32:35], v[192:199], v4
    v_smfmac_f32_16x16x64_bf16 v[60:63], v[32:35], v[248:255], v4
    v_mov_b64 v[104:105], 0
    v_mov_b64 v[106:107], 0
    v_mov_b64 v[108:109], 0
    v_mov_b64 v[110:111], 0
    v_pk_add_f32 v[36:37], v[36:37], v[38:39]
    v_cvt_pk_bf16_f32 v36, v36, v37
    ds_write_b32 v112, v36 offset:0
    v_pk_add_f32 v[40:41], v[40:41], v[42:43]
    v_cvt_pk_bf16_f32 v40, v40, v41
    ds_write_b32 v112, v40 offset:256
    v_pk_add_f32 v[44:45], v[44:45], v[46:47]
    v_cvt_pk_bf16_f32 v44, v44, v45
    ds_write_b32 v112, v44 offset:512
    v_pk_add_f32 v[48:49], v[48:49], v[50:51]
    v_cvt_pk_bf16_f32 v48, v48, v49
    ds_write_b32 v112, v48 offset:768
    v_pk_add_f32 v[52:53], v[52:53], v[54:55]
    v_cvt_pk_bf16_f32 v52, v52, v53
    ds_write_b32 v112, v52 offset:1024
    v_pk_add_f32 v[56:57], v[56:57], v[58:59]
    v_cvt_pk_bf16_f32 v56, v56, v57
    ds_write_b32 v112, v56 offset:1280
    v_pk_add_f32 v[60:61], v[60:61], v[62:63]
    v_cvt_pk_bf16_f32 v60, v60, v61
    ds_write_b32 v112, v60 offset:1536
    ds_read_b128 v[96:99], v113 offset:0
    ds_read_b128 v[100:103], v113 offset:224
    v_mov_b64 v[20:21], -1
    v_mov_b64 v[22:23], -1
    v_mov_b64 v[24:25], -1
    v_mov_b64 v[26:27], -1
    v_mov_b64 v[28:29], -1
    s_add_u32 s34, s32, s44
    s_add_u32 s35, s34, 458752
    s_cmp_eq_u32 s31, 62
    s_cselect_b32 s33, 1, s33
    s_waitcnt lgkmcnt(0)
    s_sleep 2
    s_mov_b64 s[84:85], -1
    s_mov_b64 s[86:87], -1
    s_mov_b64 s[88:89], -1
    s_mov_b32 s36, 0
    buffer_load_dwordx4 v[20:23], v115, s[8:11], s37 offen sc1
    buffer_load_dwordx4 v[24:27], v115, s[8:11], s37 offen offset:1024 sc1
    buffer_load_dwordx2 v[28:29], v117, s[8:11], s37 offen offset:2048 sc1
    s_branch .poll_9_0
.poll_9_r:
    s_mov_b64 exec, s[88:89]
    buffer_load_dwordx2 v[28:29], v117, s[8:11], s37 offen offset:2048 sc1
    s_mov_b64 exec, -1
    s_add_u32 s36, s36, 1
    s_cmp_ge_u32 s36, 2097152
    s_cbranch_scc1 .m_end
.poll_9_0:
    s_waitcnt vmcnt(2)
    v_max3_u32 v7, v20, v21, v22
    v_max_u32 v7, v7, v23
    v_cmp_eq_u32 s[84:85], -1, v7
    s_or_b64 s[82:83], s[86:87], s[88:89]
    s_or_b64 s[82:83], s[82:83], s[84:85]
    s_cbranch_scc0 .poll_9_d
    s_mov_b64 exec, s[84:85]
    buffer_load_dwordx4 v[20:23], v115, s[8:11], s37 offen sc1
    s_mov_b64 exec, -1
    s_waitcnt vmcnt(2)
    v_max3_u32 v7, v24, v25, v26
    v_max_u32 v7, v7, v27
    v_cmp_eq_u32 s[86:87], -1, v7
    s_or_b64 s[82:83], s[84:85], s[88:89]
    s_or_b64 s[82:83], s[82:83], s[86:87]
    s_cbranch_scc0 .poll_9_d
    s_mov_b64 exec, s[86:87]
    buffer_load_dwordx4 v[24:27], v115, s[8:11], s37 offen offset:1024 sc1
    s_mov_b64 exec, -1
    s_waitcnt vmcnt(2)
    v_max_u32 v7, v28, v29
    v_cmp_eq_u32 s[88:89], -1, v7
    s_or_b64 s[82:83], s[84:85], s[86:87]
    s_or_b64 s[82:83], s[82:83], s[88:89]
    s_cbranch_scc1 .poll_9_r
.poll_9_d:
    v_smfmac_f32_16x16x64_bf16 v[104:107], v[20:23], v[64:71], v4
    v_smfmac_f32_16x16x64_bf16 v[108:111], v[20:23], v[80:87], v4
    v_smfmac_f32_16x16x64_bf16 v[104:107], v[24:27], v[72:79], v4
    v_smfmac_f32_16x16x64_bf16 v[108:111], v[24:27], v[88:95], v4
    s_cmp_ge_u32 s3, 2
    v_smfmac_f32_16x16x32_bf16 v[104:107], v[28:29], v[96:99], v4
    v_smfmac_f32_16x16x32_bf16 v[108:111], v[28:29], v[100:103], v4
    s_nop 3
    v_pk_add_f32 v[36:37], v[104:105], v[106:107]
    s_nop 2
    v_pk_add_f32 v[38:39], v[108:109], v[110:111]
    ds_write2st64_b64 v118, v[36:37], v[38:39] offset0:0 offset1:4
    s_waitcnt lgkmcnt(0)
    s_barrier
    s_cbranch_scc1 .o_next
    ds_read2st64_b32 v[40:41], v0 offset0:0 offset1:8
    ds_read2st64_b32 v[42:43], v0 offset0:2 offset1:10
    ds_read2st64_b32 v[44:45], v0 offset0:4 offset1:12
    ds_read2st64_b32 v[46:47], v0 offset0:6 offset1:14
    s_mov_b64 exec, s[40:41]
    s_cmp_lg_u32 s33, 0
    s_waitcnt lgkmcnt(2)
    v_pk_add_f32 v[40:41], v[40:41], v[42:43]
    s_waitcnt lgkmcnt(0)
    v_pk_add_f32 v[44:45], v[44:45], v[46:47]
    v_pk_add_f32 v[40:41], v[40:41], v[44:45]
    v_cvt_pk_bf16_f32 v40, v40, v41
    v_min_u32 v40, -2, v40
    s_cbranch_scc1 .o_slow
    buffer_store_dword v40, v119, s[8:11], s34 offen
    s_mov_b64 exec, -1
    s_branch .o_next
.o_slow:
    buffer_store_dword v40, v119, s[8:11], s34 offen sc1
    buffer_store_dword v40, v116, s[8:11], s35 offen sc1
    s_mov_b64 exec, -1
.o_next:
    s_cmp_ge_u32 s31, 62
    s_cbranch_scc1 .m_end
    s_barrier
    s_add_u32 s38, s38, 458752
    s_add_u32 s31, s31, 1
    s_add_u32 s32, s32, 7168
    s_add_u32 s37, s37, 10240
    s_cmp_ge_u32 s31, 63
    s_cbranch_scc1 .o_step
    v_add_u32 v2, v2, v6
    s_branch .o_step
.y_start:
    s_sub_u32 s4, s4, 32
    s_mul_i32 s5, s3, 2304
    s_add_u32 s5, s5, 7552
    v_lshlrev_b32 v8, 4, v2
    v_lshl_add_u32 v8, v1, 2, v8
    v_add_u32 v112, s5, v8
    v_mov_b32 v115, v3
    v_add_u32 v113, s5, v3
    s_lshl_b32 s6, s4, 2
    s_add_u32 s6, s6, s3
    s_mul_i32 s39, s6, 1792
    s_add_u32 s39, s39, 18251776
    s_lshl_b32 s43, s6, 2
    s_add_u32 s43, s43, 18118912
    s_mov_b32 s32, 16982016
    v_mov_b32 v3, 0
    v_mov_b32 v7, 1
.y_step:
    s_add_u32 s34, s32, s24
    s_add_u32 s35, s32, s25
    s_lshl3_add_u32 s90, s24, s32
    s_lshl3_add_u32 s91, s25, s32
    v_add_u32 v104, s24, v5
    v_add_u32 v105, s25, v5
    v_add_u32 v106, s26, v5
    v_add_u32 v107, s27, v5
    v_add_u32 v108, s28, v5
    v_add_u32 v109, s29, v5
    v_add_u32 v110, s30, v5
    v_mov_b64 v[36:37], 0
    v_mov_b64 v[38:39], 0
    v_mov_b64 v[40:41], 0
    v_mov_b64 v[42:43], 0
    v_mov_b64 v[44:45], 0
    v_mov_b64 v[46:47], 0
    v_mov_b64 v[48:49], 0
    v_mov_b64 v[50:51], 0
    v_mov_b64 v[52:53], 0
    v_mov_b64 v[54:55], 0
    v_mov_b64 v[56:57], 0
    v_mov_b64 v[58:59], 0
    v_mov_b64 v[60:61], 0
    v_mov_b64 v[62:63], 0
    v_mov_b64 v[8:9], -1
    v_mov_b64 v[10:11], -1
    v_mov_b64 v[12:13], -1
    v_mov_b64 v[14:15], -1
    buffer_load_dwordx4 v[8:11], v6, s[8:11], s34 offen sc1
    buffer_load_dwordx4 v[12:15], v6, s[8:11], s35 offen sc1
    s_mov_b32 s36, 0
    s_waitcnt vmcnt(0)
    s_mov_b64 exec, 1
    buffer_store_dword v7, v3, s[8:11], s43 offen sc1
    s_mov_b64 exec, -1
    s_branch .y_chk
.y_retry:
    s_sleep 2
    buffer_load_dwordx4 v[8:11], v6, s[8:11], s34 offen sc1
    buffer_load_dwordx4 v[12:15], v6, s[8:11], s35 offen sc1
    s_add_u32 s36, s36, 1
    s_cmp_ge_u32 s36, 524288
    s_cbranch_scc1 .m_end
    s_waitcnt vmcnt(0)
.y_chk:
    v_max3_u32 v111, v8, v9, v10
    v_max3_u32 v111, v111, v11, v12
    v_max3_u32 v111, v111, v13, v14
    v_max_u32 v111, v111, v15
    v_cmp_eq_u32 vcc, -1, v111
    s_cbranch_vccnz .y_retry
    ds_write_b128 v104, v[8:11]
    ds_write_b128 v105, v[12:15]
    v_smfmac_f32_16x16x64_bf16 v[36:39], v[8:11], a[0:7], v4
    v_smfmac_f32_16x16x64_bf16 v[40:43], v[8:11], a[56:63], v4
    v_smfmac_f32_16x16x64_bf16 v[44:47], v[8:11], a[112:119], v4
    v_smfmac_f32_16x16x64_bf16 v[48:51], v[8:11], a[168:175], v4
    s_waitcnt lgkmcnt(0)
    s_barrier
    ds_read_b128 v[16:19], v106
    ds_read_b128 v[20:23], v107
    ds_read_b128 v[24:27], v108
    ds_read_b128 v[28:31], v109
    ds_read_b128 v[32:35], v110
    v_smfmac_f32_16x16x64_bf16 v[52:55], v[8:11], a[224:231], v4
    v_smfmac_f32_16x16x64_bf16 v[56:59], v[8:11], v[144:151], v4
    v_smfmac_f32_16x16x64_bf16 v[60:63], v[8:11], v[200:207], v4
    v_smfmac_f32_16x16x64_bf16 v[36:39], v[12:15], a[8:15], v4
    v_smfmac_f32_16x16x64_bf16 v[40:43], v[12:15], a[64:71], v4
    v_smfmac_f32_16x16x64_bf16 v[44:47], v[12:15], a[120:127], v4
    v_smfmac_f32_16x16x64_bf16 v[48:51], v[12:15], a[176:183], v4
    v_smfmac_f32_16x16x64_bf16 v[52:55], v[12:15], a[232:239], v4
    v_smfmac_f32_16x16x64_bf16 v[56:59], v[12:15], v[152:159], v4
    v_smfmac_f32_16x16x64_bf16 v[60:63], v[12:15], v[208:215], v4
    s_waitcnt lgkmcnt(4)
    v_smfmac_f32_16x16x64_bf16 v[36:39], v[16:19], a[16:23], v4
    v_smfmac_f32_16x16x64_bf16 v[40:43], v[16:19], a[72:79], v4
    v_smfmac_f32_16x16x64_bf16 v[44:47], v[16:19], a[128:135], v4
    v_smfmac_f32_16x16x64_bf16 v[48:51], v[16:19], a[184:191], v4
    v_smfmac_f32_16x16x64_bf16 v[52:55], v[16:19], a[240:247], v4
    v_smfmac_f32_16x16x64_bf16 v[56:59], v[16:19], v[160:167], v4
    v_smfmac_f32_16x16x64_bf16 v[60:63], v[16:19], v[216:223], v4
    s_waitcnt lgkmcnt(3)
    v_smfmac_f32_16x16x64_bf16 v[36:39], v[20:23], a[24:31], v4
    v_smfmac_f32_16x16x64_bf16 v[40:43], v[20:23], a[80:87], v4
    v_smfmac_f32_16x16x64_bf16 v[44:47], v[20:23], a[136:143], v4
    v_smfmac_f32_16x16x64_bf16 v[48:51], v[20:23], a[192:199], v4
    v_smfmac_f32_16x16x64_bf16 v[52:55], v[20:23], a[248:255], v4
    v_smfmac_f32_16x16x64_bf16 v[56:59], v[20:23], v[168:175], v4
    v_smfmac_f32_16x16x64_bf16 v[60:63], v[20:23], v[224:231], v4
    s_waitcnt lgkmcnt(2)
    v_smfmac_f32_16x16x64_bf16 v[36:39], v[24:27], a[32:39], v4
    v_smfmac_f32_16x16x64_bf16 v[40:43], v[24:27], a[88:95], v4
    v_smfmac_f32_16x16x64_bf16 v[44:47], v[24:27], a[144:151], v4
    v_smfmac_f32_16x16x64_bf16 v[48:51], v[24:27], a[200:207], v4
    v_smfmac_f32_16x16x64_bf16 v[52:55], v[24:27], v[120:127], v4
    v_smfmac_f32_16x16x64_bf16 v[56:59], v[24:27], v[176:183], v4
    v_smfmac_f32_16x16x64_bf16 v[60:63], v[24:27], v[232:239], v4
    s_waitcnt lgkmcnt(1)
    v_smfmac_f32_16x16x64_bf16 v[36:39], v[28:31], a[40:47], v4
    v_smfmac_f32_16x16x64_bf16 v[40:43], v[28:31], a[96:103], v4
    v_smfmac_f32_16x16x64_bf16 v[44:47], v[28:31], a[152:159], v4
    v_smfmac_f32_16x16x64_bf16 v[48:51], v[28:31], a[208:215], v4
    v_smfmac_f32_16x16x64_bf16 v[52:55], v[28:31], v[128:135], v4
    v_smfmac_f32_16x16x64_bf16 v[56:59], v[28:31], v[184:191], v4
    v_smfmac_f32_16x16x64_bf16 v[60:63], v[28:31], v[240:247], v4
    s_waitcnt lgkmcnt(0)
    s_barrier
    v_smfmac_f32_16x16x64_bf16 v[36:39], v[32:35], a[48:55], v4
    v_smfmac_f32_16x16x64_bf16 v[40:43], v[32:35], a[104:111], v4
    v_smfmac_f32_16x16x64_bf16 v[44:47], v[32:35], a[160:167], v4
    v_smfmac_f32_16x16x64_bf16 v[48:51], v[32:35], a[216:223], v4
    v_smfmac_f32_16x16x64_bf16 v[52:55], v[32:35], v[136:143], v4
    v_smfmac_f32_16x16x64_bf16 v[56:59], v[32:35], v[192:199], v4
    v_smfmac_f32_16x16x64_bf16 v[60:63], v[32:35], v[248:255], v4
    v_pk_add_f32 v[36:37], v[36:37], v[38:39]
    v_cvt_pk_bf16_f32 v36, v36, v37
    ds_write_b32 v112, v36 offset:0
    v_pk_add_f32 v[40:41], v[40:41], v[42:43]
    v_cvt_pk_bf16_f32 v40, v40, v41
    ds_write_b32 v112, v40 offset:256
    v_pk_add_f32 v[44:45], v[44:45], v[46:47]
    v_cvt_pk_bf16_f32 v44, v44, v45
    ds_write_b32 v112, v44 offset:512
    v_pk_add_f32 v[48:49], v[48:49], v[50:51]
    v_cvt_pk_bf16_f32 v48, v48, v49
    ds_write_b32 v112, v48 offset:768
    v_pk_add_f32 v[52:53], v[52:53], v[54:55]
    v_cvt_pk_bf16_f32 v52, v52, v53
    ds_write_b32 v112, v52 offset:1024
    v_pk_add_f32 v[56:57], v[56:57], v[58:59]
    v_cvt_pk_bf16_f32 v56, v56, v57
    ds_write_b32 v112, v56 offset:1280
    s_nop 1
    v_pk_add_f32 v[60:61], v[60:61], v[62:63]
    v_cvt_pk_bf16_f32 v60, v60, v61
    ds_write_b32 v112, v60 offset:1536
    s_waitcnt lgkmcnt(0)
    ds_read_b128 v[96:99], v113
    ds_read_b128 v[100:103], v113 offset:1024
    s_waitcnt lgkmcnt(0)
    buffer_store_dwordx4 v[96:99], v115, s[8:11], s39 offen sc1
    s_mov_b32 exec_hi, 0xffff
    buffer_store_dwordx4 v[100:103], v115, s[8:11], s39 offen offset:1024 sc1
    s_mov_b64 exec, -1
    s_add_u32 s39, s39, 114688
    s_add_u32 s43, s43, 256
    s_add_u32 s31, s31, 1
    s_add_u32 s32, s32, 7168
    s_cmp_lt_u32 s31, 64
    s_cbranch_scc1 .y_step
    s_waitcnt vmcnt(0)
    s_mov_b64 exec, 1
    buffer_store_dword v7, v3, s[8:11], s43 offen sc1
    s_mov_b64 exec, -1
    s_endpgm
.w_start:
    s_sub_u32 s4, s4, 32
    s_mul_i32 s5, s4, 293
    s_lshr_b32 s5, s5, 11
    s_mul_i32 s6, s5, 7
    s_sub_u32 s6, s4, s6
    s_mul_i32 s7, s6, 30
    s_min_u32 s24, s6, 2
    s_sub_u32 s7, s7, s24
    s_add_u32 s7, s7, s5
    s_cmp_lt_u32 s6, 2
    s_cselect_b32 s24, 3, 2
    s_sub_u32 s7, s7, s24
    s_lshl_b32 s4, s7, 2
    s_add_u32 s4, s4, s3
    s_mul_i32 s50, s4, 1261
    s_lshr_b32 s50, s50, 14
    s_mul_i32 s5, s50, 13
    s_sub_u32 s51, s4, s5
    s_lshr_b32 s52, s50, 2
    s_and_b32 s53, s50, 3
    s_mul_i32 s5, s51, 10
    s_mul_i32 s6, s5, 79
    s_lshr_b32 s6, s6, 10
    s_mul_i32 s6, s6, 13
    s_sub_u32 s54, s5, s6
    s_cmp_lt_u32 s54, 1
    s_cbranch_scc1 .u_nosl
    s_sleep 30
    s_cmp_lt_u32 s54, 3
    s_cbranch_scc1 .u_nosl
    s_sleep 90
.u_nosl:
    v_add_u32 v4, 0, v3
    v_add_u32 v5, 4096, v3
    v_add_u32 v6, 8192, v3
    v_add_u32 v7, 12288, v3
    v_xor_b32 v10, 16, v0
    v_lshlrev_b32 v10, 2, v10
    v_xor_b32 v11, 32, v0
    v_lshlrev_b32 v11, 2, v11
    v_add_u32 v8, 0, v2
    v_mul_u32_u24 v9, 4682, v8
    v_lshrrev_b32 v9, 16, v9
    v_mul_u32_u24 v19, 672, v9
    v_lshl_add_u32 v19, v8, 4, v19
    v_mul_u32_u24 v9, 224, v1
    v_add_u32 v12, v19, v9
    v_add_u32 v8, 16, v2
    v_mul_u32_u24 v9, 4682, v8
    v_lshrrev_b32 v9, 16, v9
    v_mul_u32_u24 v19, 672, v9
    v_lshl_add_u32 v19, v8, 4, v19
    v_mul_u32_u24 v9, 224, v1
    v_add_u32 v13, v19, v9
    v_add_u32 v8, 32, v2
    v_mul_u32_u24 v9, 4682, v8
    v_lshrrev_b32 v9, 16, v9
    v_mul_u32_u24 v19, 672, v9
    v_lshl_add_u32 v19, v8, 4, v19
    v_mul_u32_u24 v9, 224, v1
    v_add_u32 v14, v19, v9
    v_add_u32 v8, 48, v2
    v_mul_u32_u24 v9, 4682, v8
    v_lshrrev_b32 v9, 16, v9
    v_mul_u32_u24 v19, 672, v9
    v_lshl_add_u32 v19, v8, 4, v19
    v_mul_u32_u24 v9, 224, v1
    v_add_u32 v15, v19, v9
    v_add_u32 v8, 64, v2
    v_mul_u32_u24 v9, 4682, v8
    v_lshrrev_b32 v9, 16, v9
    v_mul_u32_u24 v19, 672, v9
    v_lshl_add_u32 v19, v8, 4, v19
    v_mul_u32_u24 v9, 224, v1
    v_add_u32 v16, v19, v9
    v_add_u32 v8, 80, v2
    v_mul_u32_u24 v9, 4682, v8
    v_lshrrev_b32 v9, 16, v9
    v_mul_u32_u24 v19, 672, v9
    v_lshl_add_u32 v19, v8, 4, v19
    v_mul_u32_u24 v9, 224, v1
    v_add_u32 v17, v19, v9
    v_add_u32 v8, 96, v2
    v_mul_u32_u24 v9, 4682, v8
    v_lshrrev_b32 v9, 16, v9
    v_mul_u32_u24 v19, 672, v9
    v_lshl_add_u32 v19, v8, 4, v19
    v_mul_u32_u24 v9, 224, v1
    v_add_u32 v18, v19, v9
    s_lshl_b32 s5, s54, 6
    s_add_u32 s5, s5, s50
.u_loop:
    s_lshr_b32 s6, s5, 6
    s_and_b32 s7, s5, 63
    s_mul_i32 s24, s6, 57344
    s_add_u32 s24, s24, 12845056
    s_mul_i32 s28, s7, 100352
    s_add_u32 s28, s28, 6422528
    s_add_u32 s25, s24, 14336
    s_add_u32 s26, s24, 28672
    s_add_u32 s27, s24, 43008
    s_add_u32 s29, s28, 14336
    s_add_u32 s30, s28, 28672
    s_add_u32 s31, s28, 43008
    s_add_u32 s32, s28, 57344
    s_add_u32 s33, s28, 71680
    s_add_u32 s34, s28, 86016
    buffer_load_dwordx4 a[112:115], v4, s[8:11], s24 offen offset:0
    buffer_load_dwordx4 a[116:119], v4, s[8:11], s25 offen offset:0
    buffer_load_dwordx4 a[120:123], v4, s[8:11], s26 offen offset:0
    buffer_load_dwordx4 a[124:127], v4, s[8:11], s27 offen offset:0
    buffer_load_dwordx4 a[128:131], v4, s[8:11], s28 offen offset:0
    buffer_load_dwordx4 a[132:135], v4, s[8:11], s29 offen offset:0
    buffer_load_dwordx4 a[136:139], v4, s[8:11], s30 offen offset:0
    buffer_load_dwordx4 a[140:143], v4, s[8:11], s31 offen offset:0
    buffer_load_dwordx4 a[144:147], v4, s[8:11], s32 offen offset:0
    buffer_load_dwordx4 a[148:151], v4, s[8:11], s33 offen offset:0
    buffer_load_dwordx4 a[152:155], v4, s[8:11], s34 offen offset:0
    buffer_load_dwordx4 a[156:159], v4, s[8:11], s24 offen offset:1024
    buffer_load_dwordx4 a[160:163], v4, s[8:11], s25 offen offset:1024
    buffer_load_dwordx4 a[164:167], v4, s[8:11], s26 offen offset:1024
    buffer_load_dwordx4 a[168:171], v4, s[8:11], s27 offen offset:1024
    buffer_load_dwordx4 a[172:175], v4, s[8:11], s28 offen offset:1024
    buffer_load_dwordx4 a[176:179], v4, s[8:11], s29 offen offset:1024
    buffer_load_dwordx4 a[180:183], v4, s[8:11], s30 offen offset:1024
    buffer_load_dwordx4 a[184:187], v4, s[8:11], s31 offen offset:1024
    buffer_load_dwordx4 a[188:191], v4, s[8:11], s32 offen offset:1024
    buffer_load_dwordx4 a[192:195], v4, s[8:11], s33 offen offset:1024
    buffer_load_dwordx4 a[196:199], v4, s[8:11], s34 offen offset:1024
    buffer_load_dwordx4 a[200:203], v4, s[8:11], s24 offen offset:2048
    buffer_load_dwordx4 a[204:207], v4, s[8:11], s25 offen offset:2048
    buffer_load_dwordx4 a[208:211], v4, s[8:11], s26 offen offset:2048
    buffer_load_dwordx4 a[212:215], v4, s[8:11], s27 offen offset:2048
    buffer_load_dwordx4 a[216:219], v4, s[8:11], s28 offen offset:2048
    buffer_load_dwordx4 a[220:223], v4, s[8:11], s29 offen offset:2048
    buffer_load_dwordx4 a[224:227], v4, s[8:11], s30 offen offset:2048
    buffer_load_dwordx4 a[228:231], v4, s[8:11], s31 offen offset:2048
    buffer_load_dwordx4 a[232:235], v4, s[8:11], s32 offen offset:2048
    buffer_load_dwordx4 a[236:239], v4, s[8:11], s33 offen offset:2048
    buffer_load_dwordx4 a[240:243], v4, s[8:11], s34 offen offset:2048
    s_waitcnt vmcnt(22)
    v_mfma_f32_16x16x32_bf16 v[32:35], a[112:115], a[128:131], 0
    v_mfma_f32_16x16x32_bf16 v[36:39], a[116:119], a[128:131], 0
    v_mfma_f32_16x16x32_bf16 v[40:43], a[120:123], a[128:131], 0
    v_mfma_f32_16x16x32_bf16 v[44:47], a[124:127], a[128:131], 0
    v_mfma_f32_16x16x32_bf16 v[48:51], a[112:115], a[132:135], 0
    v_mfma_f32_16x16x32_bf16 v[52:55], a[116:119], a[132:135], 0
    v_mfma_f32_16x16x32_bf16 v[56:59], a[120:123], a[132:135], 0
    v_mfma_f32_16x16x32_bf16 v[60:63], a[124:127], a[132:135], 0
    v_mfma_f32_16x16x32_bf16 v[64:67], a[112:115], a[136:139], 0
    v_mfma_f32_16x16x32_bf16 v[68:71], a[116:119], a[136:139], 0
    v_mfma_f32_16x16x32_bf16 v[72:75], a[120:123], a[136:139], 0
    v_mfma_f32_16x16x32_bf16 v[76:79], a[124:127], a[136:139], 0
    v_mfma_f32_16x16x32_bf16 v[80:83], a[112:115], a[140:143], 0
    v_mfma_f32_16x16x32_bf16 v[84:87], a[116:119], a[140:143], 0
    v_mfma_f32_16x16x32_bf16 v[88:91], a[120:123], a[140:143], 0
    v_mfma_f32_16x16x32_bf16 v[92:95], a[124:127], a[140:143], 0
    v_mfma_f32_16x16x32_bf16 v[96:99], a[112:115], a[144:147], 0
    v_mfma_f32_16x16x32_bf16 v[100:103], a[116:119], a[144:147], 0
    v_mfma_f32_16x16x32_bf16 v[104:107], a[120:123], a[144:147], 0
    v_mfma_f32_16x16x32_bf16 v[108:111], a[124:127], a[144:147], 0
    v_mfma_f32_16x16x32_bf16 v[112:115], a[112:115], a[148:151], 0
    v_mfma_f32_16x16x32_bf16 v[116:119], a[116:119], a[148:151], 0
    v_mfma_f32_16x16x32_bf16 v[120:123], a[120:123], a[148:151], 0
    v_mfma_f32_16x16x32_bf16 v[124:127], a[124:127], a[148:151], 0
    v_mfma_f32_16x16x32_bf16 v[128:131], a[112:115], a[152:155], 0
    v_mfma_f32_16x16x32_bf16 v[132:135], a[116:119], a[152:155], 0
    v_mfma_f32_16x16x32_bf16 v[136:139], a[120:123], a[152:155], 0
    v_mfma_f32_16x16x32_bf16 v[140:143], a[124:127], a[152:155], 0
    buffer_load_dwordx4 a[112:115], v4, s[8:11], s24 offen offset:3072
    buffer_load_dwordx4 a[116:119], v4, s[8:11], s25 offen offset:3072
    buffer_load_dwordx4 a[120:123], v4, s[8:11], s26 offen offset:3072
    buffer_load_dwordx4 a[124:127], v4, s[8:11], s27 offen offset:3072
    buffer_load_dwordx4 a[128:131], v4, s[8:11], s28 offen offset:3072
    buffer_load_dwordx4 a[132:135], v4, s[8:11], s29 offen offset:3072
    buffer_load_dwordx4 a[136:139], v4, s[8:11], s30 offen offset:3072
    buffer_load_dwordx4 a[140:143], v4, s[8:11], s31 offen offset:3072
    buffer_load_dwordx4 a[144:147], v4, s[8:11], s32 offen offset:3072
    buffer_load_dwordx4 a[148:151], v4, s[8:11], s33 offen offset:3072
    buffer_load_dwordx4 a[152:155], v4, s[8:11], s34 offen offset:3072
    s_waitcnt vmcnt(22)
    v_mfma_f32_16x16x32_bf16 v[32:35], a[156:159], a[172:175], v[32:35]
    v_mfma_f32_16x16x32_bf16 v[36:39], a[160:163], a[172:175], v[36:39]
    v_mfma_f32_16x16x32_bf16 v[40:43], a[164:167], a[172:175], v[40:43]
    v_mfma_f32_16x16x32_bf16 v[44:47], a[168:171], a[172:175], v[44:47]
    v_mfma_f32_16x16x32_bf16 v[48:51], a[156:159], a[176:179], v[48:51]
    v_mfma_f32_16x16x32_bf16 v[52:55], a[160:163], a[176:179], v[52:55]
    v_mfma_f32_16x16x32_bf16 v[56:59], a[164:167], a[176:179], v[56:59]
    v_mfma_f32_16x16x32_bf16 v[60:63], a[168:171], a[176:179], v[60:63]
    v_mfma_f32_16x16x32_bf16 v[64:67], a[156:159], a[180:183], v[64:67]
    v_mfma_f32_16x16x32_bf16 v[68:71], a[160:163], a[180:183], v[68:71]
    v_mfma_f32_16x16x32_bf16 v[72:75], a[164:167], a[180:183], v[72:75]
    v_mfma_f32_16x16x32_bf16 v[76:79], a[168:171], a[180:183], v[76:79]
    v_mfma_f32_16x16x32_bf16 v[80:83], a[156:159], a[184:187], v[80:83]
    v_mfma_f32_16x16x32_bf16 v[84:87], a[160:163], a[184:187], v[84:87]
    v_mfma_f32_16x16x32_bf16 v[88:91], a[164:167], a[184:187], v[88:91]
    v_mfma_f32_16x16x32_bf16 v[92:95], a[168:171], a[184:187], v[92:95]
    v_mfma_f32_16x16x32_bf16 v[96:99], a[156:159], a[188:191], v[96:99]
    v_mfma_f32_16x16x32_bf16 v[100:103], a[160:163], a[188:191], v[100:103]
    v_mfma_f32_16x16x32_bf16 v[104:107], a[164:167], a[188:191], v[104:107]
    v_mfma_f32_16x16x32_bf16 v[108:111], a[168:171], a[188:191], v[108:111]
    v_mfma_f32_16x16x32_bf16 v[112:115], a[156:159], a[192:195], v[112:115]
    v_mfma_f32_16x16x32_bf16 v[116:119], a[160:163], a[192:195], v[116:119]
    v_mfma_f32_16x16x32_bf16 v[120:123], a[164:167], a[192:195], v[120:123]
    v_mfma_f32_16x16x32_bf16 v[124:127], a[168:171], a[192:195], v[124:127]
    v_mfma_f32_16x16x32_bf16 v[128:131], a[156:159], a[196:199], v[128:131]
    v_mfma_f32_16x16x32_bf16 v[132:135], a[160:163], a[196:199], v[132:135]
    v_mfma_f32_16x16x32_bf16 v[136:139], a[164:167], a[196:199], v[136:139]
    v_mfma_f32_16x16x32_bf16 v[140:143], a[168:171], a[196:199], v[140:143]
    buffer_load_dwordx4 a[156:159], v5, s[8:11], s24 offen offset:0
    buffer_load_dwordx4 a[160:163], v5, s[8:11], s25 offen offset:0
    buffer_load_dwordx4 a[164:167], v5, s[8:11], s26 offen offset:0
    buffer_load_dwordx4 a[168:171], v5, s[8:11], s27 offen offset:0
    buffer_load_dwordx4 a[172:175], v5, s[8:11], s28 offen offset:0
    buffer_load_dwordx4 a[176:179], v5, s[8:11], s29 offen offset:0
    buffer_load_dwordx4 a[180:183], v5, s[8:11], s30 offen offset:0
    buffer_load_dwordx4 a[184:187], v5, s[8:11], s31 offen offset:0
    buffer_load_dwordx4 a[188:191], v5, s[8:11], s32 offen offset:0
    buffer_load_dwordx4 a[192:195], v5, s[8:11], s33 offen offset:0
    buffer_load_dwordx4 a[196:199], v5, s[8:11], s34 offen offset:0
    s_waitcnt vmcnt(22)
    v_mfma_f32_16x16x32_bf16 v[32:35], a[200:203], a[216:219], v[32:35]
    v_mfma_f32_16x16x32_bf16 v[36:39], a[204:207], a[216:219], v[36:39]
    v_mfma_f32_16x16x32_bf16 v[40:43], a[208:211], a[216:219], v[40:43]
    v_mfma_f32_16x16x32_bf16 v[44:47], a[212:215], a[216:219], v[44:47]
    v_mfma_f32_16x16x32_bf16 v[48:51], a[200:203], a[220:223], v[48:51]
    v_mfma_f32_16x16x32_bf16 v[52:55], a[204:207], a[220:223], v[52:55]
    v_mfma_f32_16x16x32_bf16 v[56:59], a[208:211], a[220:223], v[56:59]
    v_mfma_f32_16x16x32_bf16 v[60:63], a[212:215], a[220:223], v[60:63]
    v_mfma_f32_16x16x32_bf16 v[64:67], a[200:203], a[224:227], v[64:67]
    v_mfma_f32_16x16x32_bf16 v[68:71], a[204:207], a[224:227], v[68:71]
    v_mfma_f32_16x16x32_bf16 v[72:75], a[208:211], a[224:227], v[72:75]
    v_mfma_f32_16x16x32_bf16 v[76:79], a[212:215], a[224:227], v[76:79]
    v_mfma_f32_16x16x32_bf16 v[80:83], a[200:203], a[228:231], v[80:83]
    v_mfma_f32_16x16x32_bf16 v[84:87], a[204:207], a[228:231], v[84:87]
    v_mfma_f32_16x16x32_bf16 v[88:91], a[208:211], a[228:231], v[88:91]
    v_mfma_f32_16x16x32_bf16 v[92:95], a[212:215], a[228:231], v[92:95]
    v_mfma_f32_16x16x32_bf16 v[96:99], a[200:203], a[232:235], v[96:99]
    v_mfma_f32_16x16x32_bf16 v[100:103], a[204:207], a[232:235], v[100:103]
    v_mfma_f32_16x16x32_bf16 v[104:107], a[208:211], a[232:235], v[104:107]
    v_mfma_f32_16x16x32_bf16 v[108:111], a[212:215], a[232:235], v[108:111]
    v_mfma_f32_16x16x32_bf16 v[112:115], a[200:203], a[236:239], v[112:115]
    v_mfma_f32_16x16x32_bf16 v[116:119], a[204:207], a[236:239], v[116:119]
    v_mfma_f32_16x16x32_bf16 v[120:123], a[208:211], a[236:239], v[120:123]
    v_mfma_f32_16x16x32_bf16 v[124:127], a[212:215], a[236:239], v[124:127]
    v_mfma_f32_16x16x32_bf16 v[128:131], a[200:203], a[240:243], v[128:131]
    v_mfma_f32_16x16x32_bf16 v[132:135], a[204:207], a[240:243], v[132:135]
    v_mfma_f32_16x16x32_bf16 v[136:139], a[208:211], a[240:243], v[136:139]
    v_mfma_f32_16x16x32_bf16 v[140:143], a[212:215], a[240:243], v[140:143]
    buffer_load_dwordx4 a[200:203], v5, s[8:11], s24 offen offset:1024
    buffer_load_dwordx4 a[204:207], v5, s[8:11], s25 offen offset:1024
    buffer_load_dwordx4 a[208:211], v5, s[8:11], s26 offen offset:1024
    buffer_load_dwordx4 a[212:215], v5, s[8:11], s27 offen offset:1024
    buffer_load_dwordx4 a[216:219], v5, s[8:11], s28 offen offset:1024
    buffer_load_dwordx4 a[220:223], v5, s[8:11], s29 offen offset:1024
    buffer_load_dwordx4 a[224:227], v5, s[8:11], s30 offen offset:1024
    buffer_load_dwordx4 a[228:231], v5, s[8:11], s31 offen offset:1024
    buffer_load_dwordx4 a[232:235], v5, s[8:11], s32 offen offset:1024
    buffer_load_dwordx4 a[236:239], v5, s[8:11], s33 offen offset:1024
    buffer_load_dwordx4 a[240:243], v5, s[8:11], s34 offen offset:1024
    s_waitcnt vmcnt(22)
    v_mfma_f32_16x16x32_bf16 v[32:35], a[112:115], a[128:131], v[32:35]
    v_mfma_f32_16x16x32_bf16 v[36:39], a[116:119], a[128:131], v[36:39]
    v_mfma_f32_16x16x32_bf16 v[40:43], a[120:123], a[128:131], v[40:43]
    v_mfma_f32_16x16x32_bf16 v[44:47], a[124:127], a[128:131], v[44:47]
    v_mfma_f32_16x16x32_bf16 v[48:51], a[112:115], a[132:135], v[48:51]
    v_mfma_f32_16x16x32_bf16 v[52:55], a[116:119], a[132:135], v[52:55]
    v_mfma_f32_16x16x32_bf16 v[56:59], a[120:123], a[132:135], v[56:59]
    v_mfma_f32_16x16x32_bf16 v[60:63], a[124:127], a[132:135], v[60:63]
    v_mfma_f32_16x16x32_bf16 v[64:67], a[112:115], a[136:139], v[64:67]
    v_mfma_f32_16x16x32_bf16 v[68:71], a[116:119], a[136:139], v[68:71]
    v_mfma_f32_16x16x32_bf16 v[72:75], a[120:123], a[136:139], v[72:75]
    v_mfma_f32_16x16x32_bf16 v[76:79], a[124:127], a[136:139], v[76:79]
    v_mfma_f32_16x16x32_bf16 v[80:83], a[112:115], a[140:143], v[80:83]
    v_mfma_f32_16x16x32_bf16 v[84:87], a[116:119], a[140:143], v[84:87]
    v_mfma_f32_16x16x32_bf16 v[88:91], a[120:123], a[140:143], v[88:91]
    v_mfma_f32_16x16x32_bf16 v[92:95], a[124:127], a[140:143], v[92:95]
    v_mfma_f32_16x16x32_bf16 v[96:99], a[112:115], a[144:147], v[96:99]
    v_mfma_f32_16x16x32_bf16 v[100:103], a[116:119], a[144:147], v[100:103]
    v_mfma_f32_16x16x32_bf16 v[104:107], a[120:123], a[144:147], v[104:107]
    v_mfma_f32_16x16x32_bf16 v[108:111], a[124:127], a[144:147], v[108:111]
    v_mfma_f32_16x16x32_bf16 v[112:115], a[112:115], a[148:151], v[112:115]
    v_mfma_f32_16x16x32_bf16 v[116:119], a[116:119], a[148:151], v[116:119]
    v_mfma_f32_16x16x32_bf16 v[120:123], a[120:123], a[148:151], v[120:123]
    v_mfma_f32_16x16x32_bf16 v[124:127], a[124:127], a[148:151], v[124:127]
    v_mfma_f32_16x16x32_bf16 v[128:131], a[112:115], a[152:155], v[128:131]
    v_mfma_f32_16x16x32_bf16 v[132:135], a[116:119], a[152:155], v[132:135]
    v_mfma_f32_16x16x32_bf16 v[136:139], a[120:123], a[152:155], v[136:139]
    v_mfma_f32_16x16x32_bf16 v[140:143], a[124:127], a[152:155], v[140:143]
    buffer_load_dwordx4 a[112:115], v5, s[8:11], s24 offen offset:2048
    buffer_load_dwordx4 a[116:119], v5, s[8:11], s25 offen offset:2048
    buffer_load_dwordx4 a[120:123], v5, s[8:11], s26 offen offset:2048
    buffer_load_dwordx4 a[124:127], v5, s[8:11], s27 offen offset:2048
    buffer_load_dwordx4 a[128:131], v5, s[8:11], s28 offen offset:2048
    buffer_load_dwordx4 a[132:135], v5, s[8:11], s29 offen offset:2048
    buffer_load_dwordx4 a[136:139], v5, s[8:11], s30 offen offset:2048
    buffer_load_dwordx4 a[140:143], v5, s[8:11], s31 offen offset:2048
    buffer_load_dwordx4 a[144:147], v5, s[8:11], s32 offen offset:2048
    buffer_load_dwordx4 a[148:151], v5, s[8:11], s33 offen offset:2048
    buffer_load_dwordx4 a[152:155], v5, s[8:11], s34 offen offset:2048
    s_waitcnt vmcnt(22)
    v_mfma_f32_16x16x32_bf16 v[32:35], a[156:159], a[172:175], v[32:35]
    v_mfma_f32_16x16x32_bf16 v[36:39], a[160:163], a[172:175], v[36:39]
    v_mfma_f32_16x16x32_bf16 v[40:43], a[164:167], a[172:175], v[40:43]
    v_mfma_f32_16x16x32_bf16 v[44:47], a[168:171], a[172:175], v[44:47]
    v_mfma_f32_16x16x32_bf16 v[48:51], a[156:159], a[176:179], v[48:51]
    v_mfma_f32_16x16x32_bf16 v[52:55], a[160:163], a[176:179], v[52:55]
    v_mfma_f32_16x16x32_bf16 v[56:59], a[164:167], a[176:179], v[56:59]
    v_mfma_f32_16x16x32_bf16 v[60:63], a[168:171], a[176:179], v[60:63]
    v_mfma_f32_16x16x32_bf16 v[64:67], a[156:159], a[180:183], v[64:67]
    v_mfma_f32_16x16x32_bf16 v[68:71], a[160:163], a[180:183], v[68:71]
    v_mfma_f32_16x16x32_bf16 v[72:75], a[164:167], a[180:183], v[72:75]
    v_mfma_f32_16x16x32_bf16 v[76:79], a[168:171], a[180:183], v[76:79]
    v_mfma_f32_16x16x32_bf16 v[80:83], a[156:159], a[184:187], v[80:83]
    v_mfma_f32_16x16x32_bf16 v[84:87], a[160:163], a[184:187], v[84:87]
    v_mfma_f32_16x16x32_bf16 v[88:91], a[164:167], a[184:187], v[88:91]
    v_mfma_f32_16x16x32_bf16 v[92:95], a[168:171], a[184:187], v[92:95]
    v_mfma_f32_16x16x32_bf16 v[96:99], a[156:159], a[188:191], v[96:99]
    v_mfma_f32_16x16x32_bf16 v[100:103], a[160:163], a[188:191], v[100:103]
    v_mfma_f32_16x16x32_bf16 v[104:107], a[164:167], a[188:191], v[104:107]
    v_mfma_f32_16x16x32_bf16 v[108:111], a[168:171], a[188:191], v[108:111]
    v_mfma_f32_16x16x32_bf16 v[112:115], a[156:159], a[192:195], v[112:115]
    v_mfma_f32_16x16x32_bf16 v[116:119], a[160:163], a[192:195], v[116:119]
    v_mfma_f32_16x16x32_bf16 v[120:123], a[164:167], a[192:195], v[120:123]
    v_mfma_f32_16x16x32_bf16 v[124:127], a[168:171], a[192:195], v[124:127]
    v_mfma_f32_16x16x32_bf16 v[128:131], a[156:159], a[196:199], v[128:131]
    v_mfma_f32_16x16x32_bf16 v[132:135], a[160:163], a[196:199], v[132:135]
    v_mfma_f32_16x16x32_bf16 v[136:139], a[164:167], a[196:199], v[136:139]
    v_mfma_f32_16x16x32_bf16 v[140:143], a[168:171], a[196:199], v[140:143]
    buffer_load_dwordx4 a[156:159], v5, s[8:11], s24 offen offset:3072
    buffer_load_dwordx4 a[160:163], v5, s[8:11], s25 offen offset:3072
    buffer_load_dwordx4 a[164:167], v5, s[8:11], s26 offen offset:3072
    buffer_load_dwordx4 a[168:171], v5, s[8:11], s27 offen offset:3072
    buffer_load_dwordx4 a[172:175], v5, s[8:11], s28 offen offset:3072
    buffer_load_dwordx4 a[176:179], v5, s[8:11], s29 offen offset:3072
    buffer_load_dwordx4 a[180:183], v5, s[8:11], s30 offen offset:3072
    buffer_load_dwordx4 a[184:187], v5, s[8:11], s31 offen offset:3072
    buffer_load_dwordx4 a[188:191], v5, s[8:11], s32 offen offset:3072
    buffer_load_dwordx4 a[192:195], v5, s[8:11], s33 offen offset:3072
    buffer_load_dwordx4 a[196:199], v5, s[8:11], s34 offen offset:3072
    s_waitcnt vmcnt(22)
    v_mfma_f32_16x16x32_bf16 v[32:35], a[200:203], a[216:219], v[32:35]
    v_mfma_f32_16x16x32_bf16 v[36:39], a[204:207], a[216:219], v[36:39]
    v_mfma_f32_16x16x32_bf16 v[40:43], a[208:211], a[216:219], v[40:43]
    v_mfma_f32_16x16x32_bf16 v[44:47], a[212:215], a[216:219], v[44:47]
    v_mfma_f32_16x16x32_bf16 v[48:51], a[200:203], a[220:223], v[48:51]
    v_mfma_f32_16x16x32_bf16 v[52:55], a[204:207], a[220:223], v[52:55]
    v_mfma_f32_16x16x32_bf16 v[56:59], a[208:211], a[220:223], v[56:59]
    v_mfma_f32_16x16x32_bf16 v[60:63], a[212:215], a[220:223], v[60:63]
    v_mfma_f32_16x16x32_bf16 v[64:67], a[200:203], a[224:227], v[64:67]
    v_mfma_f32_16x16x32_bf16 v[68:71], a[204:207], a[224:227], v[68:71]
    v_mfma_f32_16x16x32_bf16 v[72:75], a[208:211], a[224:227], v[72:75]
    v_mfma_f32_16x16x32_bf16 v[76:79], a[212:215], a[224:227], v[76:79]
    v_mfma_f32_16x16x32_bf16 v[80:83], a[200:203], a[228:231], v[80:83]
    v_mfma_f32_16x16x32_bf16 v[84:87], a[204:207], a[228:231], v[84:87]
    v_mfma_f32_16x16x32_bf16 v[88:91], a[208:211], a[228:231], v[88:91]
    v_mfma_f32_16x16x32_bf16 v[92:95], a[212:215], a[228:231], v[92:95]
    v_mfma_f32_16x16x32_bf16 v[96:99], a[200:203], a[232:235], v[96:99]
    v_mfma_f32_16x16x32_bf16 v[100:103], a[204:207], a[232:235], v[100:103]
    v_mfma_f32_16x16x32_bf16 v[104:107], a[208:211], a[232:235], v[104:107]
    v_mfma_f32_16x16x32_bf16 v[108:111], a[212:215], a[232:235], v[108:111]
    v_mfma_f32_16x16x32_bf16 v[112:115], a[200:203], a[236:239], v[112:115]
    v_mfma_f32_16x16x32_bf16 v[116:119], a[204:207], a[236:239], v[116:119]
    v_mfma_f32_16x16x32_bf16 v[120:123], a[208:211], a[236:239], v[120:123]
    v_mfma_f32_16x16x32_bf16 v[124:127], a[212:215], a[236:239], v[124:127]
    v_mfma_f32_16x16x32_bf16 v[128:131], a[200:203], a[240:243], v[128:131]
    v_mfma_f32_16x16x32_bf16 v[132:135], a[204:207], a[240:243], v[132:135]
    v_mfma_f32_16x16x32_bf16 v[136:139], a[208:211], a[240:243], v[136:139]
    v_mfma_f32_16x16x32_bf16 v[140:143], a[212:215], a[240:243], v[140:143]
    buffer_load_dwordx4 a[200:203], v6, s[8:11], s24 offen offset:0
    buffer_load_dwordx4 a[204:207], v6, s[8:11], s25 offen offset:0
    buffer_load_dwordx4 a[208:211], v6, s[8:11], s26 offen offset:0
    buffer_load_dwordx4 a[212:215], v6, s[8:11], s27 offen offset:0
    buffer_load_dwordx4 a[216:219], v6, s[8:11], s28 offen offset:0
    buffer_load_dwordx4 a[220:223], v6, s[8:11], s29 offen offset:0
    buffer_load_dwordx4 a[224:227], v6, s[8:11], s30 offen offset:0
    buffer_load_dwordx4 a[228:231], v6, s[8:11], s31 offen offset:0
    buffer_load_dwordx4 a[232:235], v6, s[8:11], s32 offen offset:0
    buffer_load_dwordx4 a[236:239], v6, s[8:11], s33 offen offset:0
    buffer_load_dwordx4 a[240:243], v6, s[8:11], s34 offen offset:0
    s_waitcnt vmcnt(22)
    v_mfma_f32_16x16x32_bf16 v[32:35], a[112:115], a[128:131], v[32:35]
    v_mfma_f32_16x16x32_bf16 v[36:39], a[116:119], a[128:131], v[36:39]
    v_mfma_f32_16x16x32_bf16 v[40:43], a[120:123], a[128:131], v[40:43]
    v_mfma_f32_16x16x32_bf16 v[44:47], a[124:127], a[128:131], v[44:47]
    v_mfma_f32_16x16x32_bf16 v[48:51], a[112:115], a[132:135], v[48:51]
    v_mfma_f32_16x16x32_bf16 v[52:55], a[116:119], a[132:135], v[52:55]
    v_mfma_f32_16x16x32_bf16 v[56:59], a[120:123], a[132:135], v[56:59]
    v_mfma_f32_16x16x32_bf16 v[60:63], a[124:127], a[132:135], v[60:63]
    v_mfma_f32_16x16x32_bf16 v[64:67], a[112:115], a[136:139], v[64:67]
    v_mfma_f32_16x16x32_bf16 v[68:71], a[116:119], a[136:139], v[68:71]
    v_mfma_f32_16x16x32_bf16 v[72:75], a[120:123], a[136:139], v[72:75]
    v_mfma_f32_16x16x32_bf16 v[76:79], a[124:127], a[136:139], v[76:79]
    v_mfma_f32_16x16x32_bf16 v[80:83], a[112:115], a[140:143], v[80:83]
    v_mfma_f32_16x16x32_bf16 v[84:87], a[116:119], a[140:143], v[84:87]
    v_mfma_f32_16x16x32_bf16 v[88:91], a[120:123], a[140:143], v[88:91]
    v_mfma_f32_16x16x32_bf16 v[92:95], a[124:127], a[140:143], v[92:95]
    v_mfma_f32_16x16x32_bf16 v[96:99], a[112:115], a[144:147], v[96:99]
    v_mfma_f32_16x16x32_bf16 v[100:103], a[116:119], a[144:147], v[100:103]
    v_mfma_f32_16x16x32_bf16 v[104:107], a[120:123], a[144:147], v[104:107]
    v_mfma_f32_16x16x32_bf16 v[108:111], a[124:127], a[144:147], v[108:111]
    v_mfma_f32_16x16x32_bf16 v[112:115], a[112:115], a[148:151], v[112:115]
    v_mfma_f32_16x16x32_bf16 v[116:119], a[116:119], a[148:151], v[116:119]
    v_mfma_f32_16x16x32_bf16 v[120:123], a[120:123], a[148:151], v[120:123]
    v_mfma_f32_16x16x32_bf16 v[124:127], a[124:127], a[148:151], v[124:127]
    v_mfma_f32_16x16x32_bf16 v[128:131], a[112:115], a[152:155], v[128:131]
    v_mfma_f32_16x16x32_bf16 v[132:135], a[116:119], a[152:155], v[132:135]
    v_mfma_f32_16x16x32_bf16 v[136:139], a[120:123], a[152:155], v[136:139]
    v_mfma_f32_16x16x32_bf16 v[140:143], a[124:127], a[152:155], v[140:143]
    buffer_load_dwordx4 a[112:115], v6, s[8:11], s24 offen offset:1024
    buffer_load_dwordx4 a[116:119], v6, s[8:11], s25 offen offset:1024
    buffer_load_dwordx4 a[120:123], v6, s[8:11], s26 offen offset:1024
    buffer_load_dwordx4 a[124:127], v6, s[8:11], s27 offen offset:1024
    buffer_load_dwordx4 a[128:131], v6, s[8:11], s28 offen offset:1024
    buffer_load_dwordx4 a[132:135], v6, s[8:11], s29 offen offset:1024
    buffer_load_dwordx4 a[136:139], v6, s[8:11], s30 offen offset:1024
    buffer_load_dwordx4 a[140:143], v6, s[8:11], s31 offen offset:1024
    buffer_load_dwordx4 a[144:147], v6, s[8:11], s32 offen offset:1024
    buffer_load_dwordx4 a[148:151], v6, s[8:11], s33 offen offset:1024
    buffer_load_dwordx4 a[152:155], v6, s[8:11], s34 offen offset:1024
    s_waitcnt vmcnt(22)
    v_mfma_f32_16x16x32_bf16 v[32:35], a[156:159], a[172:175], v[32:35]
    v_mfma_f32_16x16x32_bf16 v[36:39], a[160:163], a[172:175], v[36:39]
    v_mfma_f32_16x16x32_bf16 v[40:43], a[164:167], a[172:175], v[40:43]
    v_mfma_f32_16x16x32_bf16 v[44:47], a[168:171], a[172:175], v[44:47]
    v_mfma_f32_16x16x32_bf16 v[48:51], a[156:159], a[176:179], v[48:51]
    v_mfma_f32_16x16x32_bf16 v[52:55], a[160:163], a[176:179], v[52:55]
    v_mfma_f32_16x16x32_bf16 v[56:59], a[164:167], a[176:179], v[56:59]
    v_mfma_f32_16x16x32_bf16 v[60:63], a[168:171], a[176:179], v[60:63]
    v_mfma_f32_16x16x32_bf16 v[64:67], a[156:159], a[180:183], v[64:67]
    v_mfma_f32_16x16x32_bf16 v[68:71], a[160:163], a[180:183], v[68:71]
    v_mfma_f32_16x16x32_bf16 v[72:75], a[164:167], a[180:183], v[72:75]
    v_mfma_f32_16x16x32_bf16 v[76:79], a[168:171], a[180:183], v[76:79]
    v_mfma_f32_16x16x32_bf16 v[80:83], a[156:159], a[184:187], v[80:83]
    v_mfma_f32_16x16x32_bf16 v[84:87], a[160:163], a[184:187], v[84:87]
    v_mfma_f32_16x16x32_bf16 v[88:91], a[164:167], a[184:187], v[88:91]
    v_mfma_f32_16x16x32_bf16 v[92:95], a[168:171], a[184:187], v[92:95]
    v_mfma_f32_16x16x32_bf16 v[96:99], a[156:159], a[188:191], v[96:99]
    v_mfma_f32_16x16x32_bf16 v[100:103], a[160:163], a[188:191], v[100:103]
    v_mfma_f32_16x16x32_bf16 v[104:107], a[164:167], a[188:191], v[104:107]
    v_mfma_f32_16x16x32_bf16 v[108:111], a[168:171], a[188:191], v[108:111]
    v_mfma_f32_16x16x32_bf16 v[112:115], a[156:159], a[192:195], v[112:115]
    v_mfma_f32_16x16x32_bf16 v[116:119], a[160:163], a[192:195], v[116:119]
    v_mfma_f32_16x16x32_bf16 v[120:123], a[164:167], a[192:195], v[120:123]
    v_mfma_f32_16x16x32_bf16 v[124:127], a[168:171], a[192:195], v[124:127]
    v_mfma_f32_16x16x32_bf16 v[128:131], a[156:159], a[196:199], v[128:131]
    v_mfma_f32_16x16x32_bf16 v[132:135], a[160:163], a[196:199], v[132:135]
    v_mfma_f32_16x16x32_bf16 v[136:139], a[164:167], a[196:199], v[136:139]
    v_mfma_f32_16x16x32_bf16 v[140:143], a[168:171], a[196:199], v[140:143]
    buffer_load_dwordx4 a[156:159], v6, s[8:11], s24 offen offset:2048
    buffer_load_dwordx4 a[160:163], v6, s[8:11], s25 offen offset:2048
    buffer_load_dwordx4 a[164:167], v6, s[8:11], s26 offen offset:2048
    buffer_load_dwordx4 a[168:171], v6, s[8:11], s27 offen offset:2048
    buffer_load_dwordx4 a[172:175], v6, s[8:11], s28 offen offset:2048
    buffer_load_dwordx4 a[176:179], v6, s[8:11], s29 offen offset:2048
    buffer_load_dwordx4 a[180:183], v6, s[8:11], s30 offen offset:2048
    buffer_load_dwordx4 a[184:187], v6, s[8:11], s31 offen offset:2048
    buffer_load_dwordx4 a[188:191], v6, s[8:11], s32 offen offset:2048
    buffer_load_dwordx4 a[192:195], v6, s[8:11], s33 offen offset:2048
    buffer_load_dwordx4 a[196:199], v6, s[8:11], s34 offen offset:2048
    s_waitcnt vmcnt(22)
    v_mfma_f32_16x16x32_bf16 v[32:35], a[200:203], a[216:219], v[32:35]
    v_mfma_f32_16x16x32_bf16 v[36:39], a[204:207], a[216:219], v[36:39]
    v_mfma_f32_16x16x32_bf16 v[40:43], a[208:211], a[216:219], v[40:43]
    v_mfma_f32_16x16x32_bf16 v[44:47], a[212:215], a[216:219], v[44:47]
    v_mfma_f32_16x16x32_bf16 v[48:51], a[200:203], a[220:223], v[48:51]
    v_mfma_f32_16x16x32_bf16 v[52:55], a[204:207], a[220:223], v[52:55]
    v_mfma_f32_16x16x32_bf16 v[56:59], a[208:211], a[220:223], v[56:59]
    v_mfma_f32_16x16x32_bf16 v[60:63], a[212:215], a[220:223], v[60:63]
    v_mfma_f32_16x16x32_bf16 v[64:67], a[200:203], a[224:227], v[64:67]
    v_mfma_f32_16x16x32_bf16 v[68:71], a[204:207], a[224:227], v[68:71]
    v_mfma_f32_16x16x32_bf16 v[72:75], a[208:211], a[224:227], v[72:75]
    v_mfma_f32_16x16x32_bf16 v[76:79], a[212:215], a[224:227], v[76:79]
    v_mfma_f32_16x16x32_bf16 v[80:83], a[200:203], a[228:231], v[80:83]
    v_mfma_f32_16x16x32_bf16 v[84:87], a[204:207], a[228:231], v[84:87]
    v_mfma_f32_16x16x32_bf16 v[88:91], a[208:211], a[228:231], v[88:91]
    v_mfma_f32_16x16x32_bf16 v[92:95], a[212:215], a[228:231], v[92:95]
    v_mfma_f32_16x16x32_bf16 v[96:99], a[200:203], a[232:235], v[96:99]
    v_mfma_f32_16x16x32_bf16 v[100:103], a[204:207], a[232:235], v[100:103]
    v_mfma_f32_16x16x32_bf16 v[104:107], a[208:211], a[232:235], v[104:107]
    v_mfma_f32_16x16x32_bf16 v[108:111], a[212:215], a[232:235], v[108:111]
    v_mfma_f32_16x16x32_bf16 v[112:115], a[200:203], a[236:239], v[112:115]
    v_mfma_f32_16x16x32_bf16 v[116:119], a[204:207], a[236:239], v[116:119]
    v_mfma_f32_16x16x32_bf16 v[120:123], a[208:211], a[236:239], v[120:123]
    v_mfma_f32_16x16x32_bf16 v[124:127], a[212:215], a[236:239], v[124:127]
    v_mfma_f32_16x16x32_bf16 v[128:131], a[200:203], a[240:243], v[128:131]
    v_mfma_f32_16x16x32_bf16 v[132:135], a[204:207], a[240:243], v[132:135]
    v_mfma_f32_16x16x32_bf16 v[136:139], a[208:211], a[240:243], v[136:139]
    v_mfma_f32_16x16x32_bf16 v[140:143], a[212:215], a[240:243], v[140:143]
    buffer_load_dwordx4 a[200:203], v6, s[8:11], s24 offen offset:3072
    buffer_load_dwordx4 a[204:207], v6, s[8:11], s25 offen offset:3072
    buffer_load_dwordx4 a[208:211], v6, s[8:11], s26 offen offset:3072
    buffer_load_dwordx4 a[212:215], v6, s[8:11], s27 offen offset:3072
    buffer_load_dwordx4 a[216:219], v6, s[8:11], s28 offen offset:3072
    buffer_load_dwordx4 a[220:223], v6, s[8:11], s29 offen offset:3072
    buffer_load_dwordx4 a[224:227], v6, s[8:11], s30 offen offset:3072
    buffer_load_dwordx4 a[228:231], v6, s[8:11], s31 offen offset:3072
    buffer_load_dwordx4 a[232:235], v6, s[8:11], s32 offen offset:3072
    buffer_load_dwordx4 a[236:239], v6, s[8:11], s33 offen offset:3072
    buffer_load_dwordx4 a[240:243], v6, s[8:11], s34 offen offset:3072
    s_waitcnt vmcnt(22)
    v_mfma_f32_16x16x32_bf16 v[32:35], a[112:115], a[128:131], v[32:35]
    v_mfma_f32_16x16x32_bf16 v[36:39], a[116:119], a[128:131], v[36:39]
    v_mfma_f32_16x16x32_bf16 v[40:43], a[120:123], a[128:131], v[40:43]
    v_mfma_f32_16x16x32_bf16 v[44:47], a[124:127], a[128:131], v[44:47]
    v_mfma_f32_16x16x32_bf16 v[48:51], a[112:115], a[132:135], v[48:51]
    v_mfma_f32_16x16x32_bf16 v[52:55], a[116:119], a[132:135], v[52:55]
    v_mfma_f32_16x16x32_bf16 v[56:59], a[120:123], a[132:135], v[56:59]
    v_mfma_f32_16x16x32_bf16 v[60:63], a[124:127], a[132:135], v[60:63]
    v_mfma_f32_16x16x32_bf16 v[64:67], a[112:115], a[136:139], v[64:67]
    v_mfma_f32_16x16x32_bf16 v[68:71], a[116:119], a[136:139], v[68:71]
    v_mfma_f32_16x16x32_bf16 v[72:75], a[120:123], a[136:139], v[72:75]
    v_mfma_f32_16x16x32_bf16 v[76:79], a[124:127], a[136:139], v[76:79]
    v_mfma_f32_16x16x32_bf16 v[80:83], a[112:115], a[140:143], v[80:83]
    v_mfma_f32_16x16x32_bf16 v[84:87], a[116:119], a[140:143], v[84:87]
    v_mfma_f32_16x16x32_bf16 v[88:91], a[120:123], a[140:143], v[88:91]
    v_mfma_f32_16x16x32_bf16 v[92:95], a[124:127], a[140:143], v[92:95]
    v_mfma_f32_16x16x32_bf16 v[96:99], a[112:115], a[144:147], v[96:99]
    v_mfma_f32_16x16x32_bf16 v[100:103], a[116:119], a[144:147], v[100:103]
    v_mfma_f32_16x16x32_bf16 v[104:107], a[120:123], a[144:147], v[104:107]
    v_mfma_f32_16x16x32_bf16 v[108:111], a[124:127], a[144:147], v[108:111]
    v_mfma_f32_16x16x32_bf16 v[112:115], a[112:115], a[148:151], v[112:115]
    v_mfma_f32_16x16x32_bf16 v[116:119], a[116:119], a[148:151], v[116:119]
    v_mfma_f32_16x16x32_bf16 v[120:123], a[120:123], a[148:151], v[120:123]
    v_mfma_f32_16x16x32_bf16 v[124:127], a[124:127], a[148:151], v[124:127]
    v_mfma_f32_16x16x32_bf16 v[128:131], a[112:115], a[152:155], v[128:131]
    v_mfma_f32_16x16x32_bf16 v[132:135], a[116:119], a[152:155], v[132:135]
    v_mfma_f32_16x16x32_bf16 v[136:139], a[120:123], a[152:155], v[136:139]
    v_mfma_f32_16x16x32_bf16 v[140:143], a[124:127], a[152:155], v[140:143]
    buffer_load_dwordx4 a[112:115], v7, s[8:11], s24 offen offset:0
    buffer_load_dwordx4 a[116:119], v7, s[8:11], s25 offen offset:0
    buffer_load_dwordx4 a[120:123], v7, s[8:11], s26 offen offset:0
    buffer_load_dwordx4 a[124:127], v7, s[8:11], s27 offen offset:0
    buffer_load_dwordx4 a[128:131], v7, s[8:11], s28 offen offset:0
    buffer_load_dwordx4 a[132:135], v7, s[8:11], s29 offen offset:0
    buffer_load_dwordx4 a[136:139], v7, s[8:11], s30 offen offset:0
    buffer_load_dwordx4 a[140:143], v7, s[8:11], s31 offen offset:0
    buffer_load_dwordx4 a[144:147], v7, s[8:11], s32 offen offset:0
    buffer_load_dwordx4 a[148:151], v7, s[8:11], s33 offen offset:0
    buffer_load_dwordx4 a[152:155], v7, s[8:11], s34 offen offset:0
    s_waitcnt vmcnt(22)
    v_mfma_f32_16x16x32_bf16 v[32:35], a[156:159], a[172:175], v[32:35]
    v_mfma_f32_16x16x32_bf16 v[36:39], a[160:163], a[172:175], v[36:39]
    v_mfma_f32_16x16x32_bf16 v[40:43], a[164:167], a[172:175], v[40:43]
    v_mfma_f32_16x16x32_bf16 v[44:47], a[168:171], a[172:175], v[44:47]
    v_mfma_f32_16x16x32_bf16 v[48:51], a[156:159], a[176:179], v[48:51]
    v_mfma_f32_16x16x32_bf16 v[52:55], a[160:163], a[176:179], v[52:55]
    v_mfma_f32_16x16x32_bf16 v[56:59], a[164:167], a[176:179], v[56:59]
    v_mfma_f32_16x16x32_bf16 v[60:63], a[168:171], a[176:179], v[60:63]
    v_mfma_f32_16x16x32_bf16 v[64:67], a[156:159], a[180:183], v[64:67]
    v_mfma_f32_16x16x32_bf16 v[68:71], a[160:163], a[180:183], v[68:71]
    v_mfma_f32_16x16x32_bf16 v[72:75], a[164:167], a[180:183], v[72:75]
    v_mfma_f32_16x16x32_bf16 v[76:79], a[168:171], a[180:183], v[76:79]
    v_mfma_f32_16x16x32_bf16 v[80:83], a[156:159], a[184:187], v[80:83]
    v_mfma_f32_16x16x32_bf16 v[84:87], a[160:163], a[184:187], v[84:87]
    v_mfma_f32_16x16x32_bf16 v[88:91], a[164:167], a[184:187], v[88:91]
    v_mfma_f32_16x16x32_bf16 v[92:95], a[168:171], a[184:187], v[92:95]
    v_mfma_f32_16x16x32_bf16 v[96:99], a[156:159], a[188:191], v[96:99]
    v_mfma_f32_16x16x32_bf16 v[100:103], a[160:163], a[188:191], v[100:103]
    v_mfma_f32_16x16x32_bf16 v[104:107], a[164:167], a[188:191], v[104:107]
    v_mfma_f32_16x16x32_bf16 v[108:111], a[168:171], a[188:191], v[108:111]
    v_mfma_f32_16x16x32_bf16 v[112:115], a[156:159], a[192:195], v[112:115]
    v_mfma_f32_16x16x32_bf16 v[116:119], a[160:163], a[192:195], v[116:119]
    v_mfma_f32_16x16x32_bf16 v[120:123], a[164:167], a[192:195], v[120:123]
    v_mfma_f32_16x16x32_bf16 v[124:127], a[168:171], a[192:195], v[124:127]
    v_mfma_f32_16x16x32_bf16 v[128:131], a[156:159], a[196:199], v[128:131]
    v_mfma_f32_16x16x32_bf16 v[132:135], a[160:163], a[196:199], v[132:135]
    v_mfma_f32_16x16x32_bf16 v[136:139], a[164:167], a[196:199], v[136:139]
    v_mfma_f32_16x16x32_bf16 v[140:143], a[168:171], a[196:199], v[140:143]
    buffer_load_dwordx4 a[156:159], v7, s[8:11], s24 offen offset:1024
    buffer_load_dwordx4 a[160:163], v7, s[8:11], s25 offen offset:1024
    buffer_load_dwordx4 a[164:167], v7, s[8:11], s26 offen offset:1024
    buffer_load_dwordx4 a[168:171], v7, s[8:11], s27 offen offset:1024
    buffer_load_dwordx4 a[172:175], v7, s[8:11], s28 offen offset:1024
    buffer_load_dwordx4 a[176:179], v7, s[8:11], s29 offen offset:1024
    buffer_load_dwordx4 a[180:183], v7, s[8:11], s30 offen offset:1024
    buffer_load_dwordx4 a[184:187], v7, s[8:11], s31 offen offset:1024
    buffer_load_dwordx4 a[188:191], v7, s[8:11], s32 offen offset:1024
    buffer_load_dwordx4 a[192:195], v7, s[8:11], s33 offen offset:1024
    buffer_load_dwordx4 a[196:199], v7, s[8:11], s34 offen offset:1024
    s_waitcnt vmcnt(22)
    v_mfma_f32_16x16x32_bf16 v[32:35], a[200:203], a[216:219], v[32:35]
    v_mfma_f32_16x16x32_bf16 v[36:39], a[204:207], a[216:219], v[36:39]
    v_mfma_f32_16x16x32_bf16 v[40:43], a[208:211], a[216:219], v[40:43]
    v_mfma_f32_16x16x32_bf16 v[44:47], a[212:215], a[216:219], v[44:47]
    v_mfma_f32_16x16x32_bf16 v[48:51], a[200:203], a[220:223], v[48:51]
    v_mfma_f32_16x16x32_bf16 v[52:55], a[204:207], a[220:223], v[52:55]
    v_mfma_f32_16x16x32_bf16 v[56:59], a[208:211], a[220:223], v[56:59]
    v_mfma_f32_16x16x32_bf16 v[60:63], a[212:215], a[220:223], v[60:63]
    v_mfma_f32_16x16x32_bf16 v[64:67], a[200:203], a[224:227], v[64:67]
    v_mfma_f32_16x16x32_bf16 v[68:71], a[204:207], a[224:227], v[68:71]
    v_mfma_f32_16x16x32_bf16 v[72:75], a[208:211], a[224:227], v[72:75]
    v_mfma_f32_16x16x32_bf16 v[76:79], a[212:215], a[224:227], v[76:79]
    v_mfma_f32_16x16x32_bf16 v[80:83], a[200:203], a[228:231], v[80:83]
    v_mfma_f32_16x16x32_bf16 v[84:87], a[204:207], a[228:231], v[84:87]
    v_mfma_f32_16x16x32_bf16 v[88:91], a[208:211], a[228:231], v[88:91]
    v_mfma_f32_16x16x32_bf16 v[92:95], a[212:215], a[228:231], v[92:95]
    v_mfma_f32_16x16x32_bf16 v[96:99], a[200:203], a[232:235], v[96:99]
    v_mfma_f32_16x16x32_bf16 v[100:103], a[204:207], a[232:235], v[100:103]
    v_mfma_f32_16x16x32_bf16 v[104:107], a[208:211], a[232:235], v[104:107]
    v_mfma_f32_16x16x32_bf16 v[108:111], a[212:215], a[232:235], v[108:111]
    v_mfma_f32_16x16x32_bf16 v[112:115], a[200:203], a[236:239], v[112:115]
    v_mfma_f32_16x16x32_bf16 v[116:119], a[204:207], a[236:239], v[116:119]
    v_mfma_f32_16x16x32_bf16 v[120:123], a[208:211], a[236:239], v[120:123]
    v_mfma_f32_16x16x32_bf16 v[124:127], a[212:215], a[236:239], v[124:127]
    v_mfma_f32_16x16x32_bf16 v[128:131], a[200:203], a[240:243], v[128:131]
    v_mfma_f32_16x16x32_bf16 v[132:135], a[204:207], a[240:243], v[132:135]
    v_mfma_f32_16x16x32_bf16 v[136:139], a[208:211], a[240:243], v[136:139]
    v_mfma_f32_16x16x32_bf16 v[140:143], a[212:215], a[240:243], v[140:143]
    s_waitcnt vmcnt(11)
    v_mfma_f32_16x16x32_bf16 v[32:35], a[112:115], a[128:131], v[32:35]
    v_mfma_f32_16x16x32_bf16 v[36:39], a[116:119], a[128:131], v[36:39]
    v_mfma_f32_16x16x32_bf16 v[40:43], a[120:123], a[128:131], v[40:43]
    v_mfma_f32_16x16x32_bf16 v[44:47], a[124:127], a[128:131], v[44:47]
    v_mfma_f32_16x16x32_bf16 v[48:51], a[112:115], a[132:135], v[48:51]
    v_mfma_f32_16x16x32_bf16 v[52:55], a[116:119], a[132:135], v[52:55]
    v_mfma_f32_16x16x32_bf16 v[56:59], a[120:123], a[132:135], v[56:59]
    v_mfma_f32_16x16x32_bf16 v[60:63], a[124:127], a[132:135], v[60:63]
    v_mfma_f32_16x16x32_bf16 v[64:67], a[112:115], a[136:139], v[64:67]
    v_mfma_f32_16x16x32_bf16 v[68:71], a[116:119], a[136:139], v[68:71]
    v_mfma_f32_16x16x32_bf16 v[72:75], a[120:123], a[136:139], v[72:75]
    v_mfma_f32_16x16x32_bf16 v[76:79], a[124:127], a[136:139], v[76:79]
    v_mfma_f32_16x16x32_bf16 v[80:83], a[112:115], a[140:143], v[80:83]
    v_mfma_f32_16x16x32_bf16 v[84:87], a[116:119], a[140:143], v[84:87]
    v_mfma_f32_16x16x32_bf16 v[88:91], a[120:123], a[140:143], v[88:91]
    v_mfma_f32_16x16x32_bf16 v[92:95], a[124:127], a[140:143], v[92:95]
    v_mfma_f32_16x16x32_bf16 v[96:99], a[112:115], a[144:147], v[96:99]
    v_mfma_f32_16x16x32_bf16 v[100:103], a[116:119], a[144:147], v[100:103]
    v_mfma_f32_16x16x32_bf16 v[104:107], a[120:123], a[144:147], v[104:107]
    v_mfma_f32_16x16x32_bf16 v[108:111], a[124:127], a[144:147], v[108:111]
    v_mfma_f32_16x16x32_bf16 v[112:115], a[112:115], a[148:151], v[112:115]
    v_mfma_f32_16x16x32_bf16 v[116:119], a[116:119], a[148:151], v[116:119]
    v_mfma_f32_16x16x32_bf16 v[120:123], a[120:123], a[148:151], v[120:123]
    v_mfma_f32_16x16x32_bf16 v[124:127], a[124:127], a[148:151], v[124:127]
    v_mfma_f32_16x16x32_bf16 v[128:131], a[112:115], a[152:155], v[128:131]
    v_mfma_f32_16x16x32_bf16 v[132:135], a[116:119], a[152:155], v[132:135]
    v_mfma_f32_16x16x32_bf16 v[136:139], a[120:123], a[152:155], v[136:139]
    v_mfma_f32_16x16x32_bf16 v[140:143], a[124:127], a[152:155], v[140:143]
    s_waitcnt vmcnt(0)
    v_mfma_f32_16x16x32_bf16 v[32:35], a[156:159], a[172:175], v[32:35]
    v_mfma_f32_16x16x32_bf16 v[36:39], a[160:163], a[172:175], v[36:39]
    v_mfma_f32_16x16x32_bf16 v[40:43], a[164:167], a[172:175], v[40:43]
    v_mfma_f32_16x16x32_bf16 v[44:47], a[168:171], a[172:175], v[44:47]
    v_mfma_f32_16x16x32_bf16 v[48:51], a[156:159], a[176:179], v[48:51]
    v_mfma_f32_16x16x32_bf16 v[52:55], a[160:163], a[176:179], v[52:55]
    v_mfma_f32_16x16x32_bf16 v[56:59], a[164:167], a[176:179], v[56:59]
    v_mfma_f32_16x16x32_bf16 v[60:63], a[168:171], a[176:179], v[60:63]
    v_mfma_f32_16x16x32_bf16 v[64:67], a[156:159], a[180:183], v[64:67]
    v_mfma_f32_16x16x32_bf16 v[68:71], a[160:163], a[180:183], v[68:71]
    v_mfma_f32_16x16x32_bf16 v[72:75], a[164:167], a[180:183], v[72:75]
    v_mfma_f32_16x16x32_bf16 v[76:79], a[168:171], a[180:183], v[76:79]
    v_mfma_f32_16x16x32_bf16 v[80:83], a[156:159], a[184:187], v[80:83]
    v_mfma_f32_16x16x32_bf16 v[84:87], a[160:163], a[184:187], v[84:87]
    v_mfma_f32_16x16x32_bf16 v[88:91], a[164:167], a[184:187], v[88:91]
    v_mfma_f32_16x16x32_bf16 v[92:95], a[168:171], a[184:187], v[92:95]
    v_mfma_f32_16x16x32_bf16 v[96:99], a[156:159], a[188:191], v[96:99]
    v_mfma_f32_16x16x32_bf16 v[100:103], a[160:163], a[188:191], v[100:103]
    v_mfma_f32_16x16x32_bf16 v[104:107], a[164:167], a[188:191], v[104:107]
    v_mfma_f32_16x16x32_bf16 v[108:111], a[168:171], a[188:191], v[108:111]
    v_mfma_f32_16x16x32_bf16 v[112:115], a[156:159], a[192:195], v[112:115]
    v_mfma_f32_16x16x32_bf16 v[116:119], a[160:163], a[192:195], v[116:119]
    v_mfma_f32_16x16x32_bf16 v[120:123], a[164:167], a[192:195], v[120:123]
    v_mfma_f32_16x16x32_bf16 v[124:127], a[168:171], a[192:195], v[124:127]
    v_mfma_f32_16x16x32_bf16 v[128:131], a[156:159], a[196:199], v[128:131]
    v_mfma_f32_16x16x32_bf16 v[132:135], a[160:163], a[196:199], v[132:135]
    v_mfma_f32_16x16x32_bf16 v[136:139], a[164:167], a[196:199], v[136:139]
    v_mfma_f32_16x16x32_bf16 v[140:143], a[168:171], a[196:199], v[140:143]
    s_nop 7
    s_nop 3
    s_mul_i32 s24, s6, 917504
    s_mul_i32 s25, s7, 7168
    s_add_u32 s24, s24, s25
    s_add_u32 s24, s24, 25591808
    s_add_u32 s25, s24, 458752
    v_cvt_pk_bf16_f32 v160, v32, v33
    v_cvt_pk_bf16_f32 v161, v34, v35
    v_cvt_pk_bf16_f32 v162, v36, v37
    v_cvt_pk_bf16_f32 v163, v38, v39
    buffer_store_dwordx4 v[160:163], v12, s[8:11], s24 offen sc1
    v_cvt_pk_bf16_f32 v164, v48, v49
    v_cvt_pk_bf16_f32 v165, v50, v51
    v_cvt_pk_bf16_f32 v166, v52, v53
    v_cvt_pk_bf16_f32 v167, v54, v55
    buffer_store_dwordx4 v[164:167], v13, s[8:11], s24 offen sc1
    v_cvt_pk_bf16_f32 v168, v64, v65
    v_cvt_pk_bf16_f32 v169, v66, v67
    v_cvt_pk_bf16_f32 v170, v68, v69
    v_cvt_pk_bf16_f32 v171, v70, v71
    buffer_store_dwordx4 v[168:171], v14, s[8:11], s24 offen sc1
    v_cvt_pk_bf16_f32 v172, v80, v81
    v_cvt_pk_bf16_f32 v173, v82, v83
    v_cvt_pk_bf16_f32 v174, v84, v85
    v_cvt_pk_bf16_f32 v175, v86, v87
    buffer_store_dwordx4 v[172:175], v15, s[8:11], s24 offen sc1
    v_cvt_pk_bf16_f32 v176, v96, v97
    v_cvt_pk_bf16_f32 v177, v98, v99
    v_cvt_pk_bf16_f32 v178, v100, v101
    v_cvt_pk_bf16_f32 v179, v102, v103
    buffer_store_dwordx4 v[176:179], v16, s[8:11], s24 offen sc1
    v_cvt_pk_bf16_f32 v180, v112, v113
    v_cvt_pk_bf16_f32 v181, v114, v115
    v_cvt_pk_bf16_f32 v182, v116, v117
    v_cvt_pk_bf16_f32 v183, v118, v119
    buffer_store_dwordx4 v[180:183], v17, s[8:11], s24 offen sc1
    v_cvt_pk_bf16_f32 v184, v128, v129
    v_cvt_pk_bf16_f32 v185, v130, v131
    v_cvt_pk_bf16_f32 v186, v132, v133
    v_cvt_pk_bf16_f32 v187, v134, v135
    buffer_store_dwordx4 v[184:187], v18, s[8:11], s24 offen sc1
    v_cvt_pk_bf16_f32 v188, v40, v41
    v_cvt_pk_bf16_f32 v189, v42, v43
    v_cvt_pk_bf16_f32 v190, v44, v45
    v_cvt_pk_bf16_f32 v191, v46, v47
    buffer_store_dwordx4 v[188:191], v12, s[8:11], s25 offen sc1
    s_waitcnt vmcnt(0)
    v_cvt_pk_bf16_f32 v160, v56, v57
    v_cvt_pk_bf16_f32 v161, v58, v59
    v_cvt_pk_bf16_f32 v162, v60, v61
    v_cvt_pk_bf16_f32 v163, v62, v63
    buffer_store_dwordx4 v[160:163], v13, s[8:11], s25 offen sc1
    v_cvt_pk_bf16_f32 v164, v72, v73
    v_cvt_pk_bf16_f32 v165, v74, v75
    v_cvt_pk_bf16_f32 v166, v76, v77
    v_cvt_pk_bf16_f32 v167, v78, v79
    buffer_store_dwordx4 v[164:167], v14, s[8:11], s25 offen sc1
    v_cvt_pk_bf16_f32 v168, v88, v89
    v_cvt_pk_bf16_f32 v169, v90, v91
    v_cvt_pk_bf16_f32 v170, v92, v93
    v_cvt_pk_bf16_f32 v171, v94, v95
    buffer_store_dwordx4 v[168:171], v15, s[8:11], s25 offen sc1
    v_cvt_pk_bf16_f32 v172, v104, v105
    v_cvt_pk_bf16_f32 v173, v106, v107
    v_cvt_pk_bf16_f32 v174, v108, v109
    v_cvt_pk_bf16_f32 v175, v110, v111
    buffer_store_dwordx4 v[172:175], v16, s[8:11], s25 offen sc1
    v_cvt_pk_bf16_f32 v176, v120, v121
    v_cvt_pk_bf16_f32 v177, v122, v123
    v_cvt_pk_bf16_f32 v178, v124, v125
    v_cvt_pk_bf16_f32 v179, v126, v127
    buffer_store_dwordx4 v[176:179], v17, s[8:11], s25 offen sc1
    v_cvt_pk_bf16_f32 v180, v136, v137
    v_cvt_pk_bf16_f32 v181, v138, v139
    v_cvt_pk_bf16_f32 v182, v140, v141
    v_cvt_pk_bf16_f32 v183, v142, v143
    buffer_store_dwordx4 v[180:183], v18, s[8:11], s25 offen sc1
    s_lshl_b32 s24, s7, 7
    s_lshl_b32 s25, s6, 2
    s_add_u32 s24, s24, s25
    s_add_u32 s24, s24, 18100224
    v_mov_b32 v8, 1
    v_mov_b32 v9, 0
    s_waitcnt vmcnt(0)
    s_mov_b64 exec, 1
    buffer_store_dword v8, v9, s[8:11], s24 offen sc1
    s_mov_b64 exec, -1
    s_add_u32 s5, s5, 832
    s_cmp_lt_u32 s5, 1664
    s_cbranch_scc1 .u_loop
    s_cmp_ge_u32 s6, 26
    s_cbranch_scc1 .u_done
    s_sub_u32 s5, s51, 3
    s_cmp_ge_u32 s5, 6
    s_cbranch_scc1 .u_done
    s_add_u32 s5, s5, 26
    s_lshl_b32 s5, s5, 6
    s_add_u32 s5, s5, s50
    s_branch .u_loop
.u_done:
    s_cmp_lt_u32 s51, 3
    s_cbranch_scc1 .a_done
    s_cmp_lt_u32 s51, 5
    s_cbranch_scc1 .q_done
    s_lshl_b32 s5, s53, 2
    s_add_u32 s5, s5, s51
    s_add_u32 s6, s5, 11
    s_sub_u32 s5, s5, 9
    s_cmp_ge_u32 s51, 9
    s_cselect_b32 s5, s5, s6
    s_lshl_b32 s5, s5, 4
    s_add_u32 s5, s5, s52
    s_lshr_b32 s6, s5, 4
    s_and_b32 s7, s5, 15
    s_mul_i32 s24, s6, 57344
    s_add_u32 s24, s24, 12845056
    s_mul_i32 s28, s7, 86016
    s_add_u32 s28, s28, 14680064
    s_add_u32 s25, s24, 14336
    s_add_u32 s26, s24, 28672
    s_add_u32 s27, s24, 43008
    s_add_u32 s29, s28, 14336
    s_add_u32 s30, s28, 28672
    s_add_u32 s31, s28, 43008
    s_add_u32 s32, s28, 57344
    s_add_u32 s33, s28, 71680
    buffer_load_dwordx4 a[112:115], v4, s[8:11], s24 offen offset:0
    buffer_load_dwordx4 a[116:119], v4, s[8:11], s25 offen offset:0
    buffer_load_dwordx4 a[120:123], v4, s[8:11], s26 offen offset:0
    buffer_load_dwordx4 a[124:127], v4, s[8:11], s27 offen offset:0
    buffer_load_dwordx4 a[128:131], v4, s[8:11], s28 offen offset:0
    buffer_load_dwordx4 a[132:135], v4, s[8:11], s29 offen offset:0
    buffer_load_dwordx4 a[136:139], v4, s[8:11], s30 offen offset:0
    buffer_load_dwordx4 a[140:143], v4, s[8:11], s31 offen offset:0
    buffer_load_dwordx4 a[144:147], v4, s[8:11], s32 offen offset:0
    buffer_load_dwordx4 a[148:151], v4, s[8:11], s33 offen offset:0
    buffer_load_dwordx4 a[156:159], v4, s[8:11], s24 offen offset:1024
    buffer_load_dwordx4 a[160:163], v4, s[8:11], s25 offen offset:1024
    buffer_load_dwordx4 a[164:167], v4, s[8:11], s26 offen offset:1024
    buffer_load_dwordx4 a[168:171], v4, s[8:11], s27 offen offset:1024
    buffer_load_dwordx4 a[172:175], v4, s[8:11], s28 offen offset:1024
    buffer_load_dwordx4 a[176:179], v4, s[8:11], s29 offen offset:1024
    buffer_load_dwordx4 a[180:183], v4, s[8:11], s30 offen offset:1024
    buffer_load_dwordx4 a[184:187], v4, s[8:11], s31 offen offset:1024
    buffer_load_dwordx4 a[188:191], v4, s[8:11], s32 offen offset:1024
    buffer_load_dwordx4 a[192:195], v4, s[8:11], s33 offen offset:1024
    buffer_load_dwordx4 a[200:203], v4, s[8:11], s24 offen offset:2048
    buffer_load_dwordx4 a[204:207], v4, s[8:11], s25 offen offset:2048
    buffer_load_dwordx4 a[208:211], v4, s[8:11], s26 offen offset:2048
    buffer_load_dwordx4 a[212:215], v4, s[8:11], s27 offen offset:2048
    buffer_load_dwordx4 a[216:219], v4, s[8:11], s28 offen offset:2048
    buffer_load_dwordx4 a[220:223], v4, s[8:11], s29 offen offset:2048
    buffer_load_dwordx4 a[224:227], v4, s[8:11], s30 offen offset:2048
    buffer_load_dwordx4 a[228:231], v4, s[8:11], s31 offen offset:2048
    buffer_load_dwordx4 a[232:235], v4, s[8:11], s32 offen offset:2048
    buffer_load_dwordx4 a[236:239], v4, s[8:11], s33 offen offset:2048
    s_waitcnt vmcnt(20)
    v_mfma_f32_16x16x32_bf16 v[32:35], a[128:131], a[112:115], 0
    v_mfma_f32_16x16x32_bf16 v[36:39], a[128:131], a[116:119], 0
    v_mfma_f32_16x16x32_bf16 v[40:43], a[128:131], a[120:123], 0
    v_mfma_f32_16x16x32_bf16 v[44:47], a[128:131], a[124:127], 0
    v_mfma_f32_16x16x32_bf16 v[48:51], a[132:135], a[112:115], 0
    v_mfma_f32_16x16x32_bf16 v[52:55], a[132:135], a[116:119], 0
    v_mfma_f32_16x16x32_bf16 v[56:59], a[132:135], a[120:123], 0
    v_mfma_f32_16x16x32_bf16 v[60:63], a[132:135], a[124:127], 0
    v_mfma_f32_16x16x32_bf16 v[64:67], a[136:139], a[112:115], 0
    v_mfma_f32_16x16x32_bf16 v[68:71], a[136:139], a[116:119], 0
    v_mfma_f32_16x16x32_bf16 v[72:75], a[136:139], a[120:123], 0
    v_mfma_f32_16x16x32_bf16 v[76:79], a[136:139], a[124:127], 0
    v_mfma_f32_16x16x32_bf16 v[80:83], a[140:143], a[112:115], 0
    v_mfma_f32_16x16x32_bf16 v[84:87], a[140:143], a[116:119], 0
    v_mfma_f32_16x16x32_bf16 v[88:91], a[140:143], a[120:123], 0
    v_mfma_f32_16x16x32_bf16 v[92:95], a[140:143], a[124:127], 0
    v_mfma_f32_16x16x32_bf16 v[96:99], a[112:115], a[144:147], 0
    v_mfma_f32_16x16x32_bf16 v[100:103], a[116:119], a[144:147], 0
    v_mfma_f32_16x16x32_bf16 v[104:107], a[120:123], a[144:147], 0
    v_mfma_f32_16x16x32_bf16 v[108:111], a[124:127], a[144:147], 0
    v_mfma_f32_16x16x32_bf16 v[112:115], a[112:115], a[148:151], 0
    v_mfma_f32_16x16x32_bf16 v[116:119], a[116:119], a[148:151], 0
    v_mfma_f32_16x16x32_bf16 v[120:123], a[120:123], a[148:151], 0
    v_mfma_f32_16x16x32_bf16 v[124:127], a[124:127], a[148:151], 0
    buffer_load_dwordx4 a[112:115], v4, s[8:11], s24 offen offset:3072
    buffer_load_dwordx4 a[116:119], v4, s[8:11], s25 offen offset:3072
    buffer_load_dwordx4 a[120:123], v4, s[8:11], s26 offen offset:3072
    buffer_load_dwordx4 a[124:127], v4, s[8:11], s27 offen offset:3072
    buffer_load_dwordx4 a[128:131], v4, s[8:11], s28 offen offset:3072
    buffer_load_dwordx4 a[132:135], v4, s[8:11], s29 offen offset:3072
    buffer_load_dwordx4 a[136:139], v4, s[8:11], s30 offen offset:3072
    buffer_load_dwordx4 a[140:143], v4, s[8:11], s31 offen offset:3072
    buffer_load_dwordx4 a[144:147], v4, s[8:11], s32 offen offset:3072
    buffer_load_dwordx4 a[148:151], v4, s[8:11], s33 offen offset:3072
    s_waitcnt vmcnt(20)
    v_mfma_f32_16x16x32_bf16 v[32:35], a[172:175], a[156:159], v[32:35]
    v_mfma_f32_16x16x32_bf16 v[36:39], a[172:175], a[160:163], v[36:39]
    v_mfma_f32_16x16x32_bf16 v[40:43], a[172:175], a[164:167], v[40:43]
    v_mfma_f32_16x16x32_bf16 v[44:47], a[172:175], a[168:171], v[44:47]
    v_mfma_f32_16x16x32_bf16 v[48:51], a[176:179], a[156:159], v[48:51]
    v_mfma_f32_16x16x32_bf16 v[52:55], a[176:179], a[160:163], v[52:55]
    v_mfma_f32_16x16x32_bf16 v[56:59], a[176:179], a[164:167], v[56:59]
    v_mfma_f32_16x16x32_bf16 v[60:63], a[176:179], a[168:171], v[60:63]
    v_mfma_f32_16x16x32_bf16 v[64:67], a[180:183], a[156:159], v[64:67]
    v_mfma_f32_16x16x32_bf16 v[68:71], a[180:183], a[160:163], v[68:71]
    v_mfma_f32_16x16x32_bf16 v[72:75], a[180:183], a[164:167], v[72:75]
    v_mfma_f32_16x16x32_bf16 v[76:79], a[180:183], a[168:171], v[76:79]
    v_mfma_f32_16x16x32_bf16 v[80:83], a[184:187], a[156:159], v[80:83]
    v_mfma_f32_16x16x32_bf16 v[84:87], a[184:187], a[160:163], v[84:87]
    v_mfma_f32_16x16x32_bf16 v[88:91], a[184:187], a[164:167], v[88:91]
    v_mfma_f32_16x16x32_bf16 v[92:95], a[184:187], a[168:171], v[92:95]
    v_mfma_f32_16x16x32_bf16 v[96:99], a[156:159], a[188:191], v[96:99]
    v_mfma_f32_16x16x32_bf16 v[100:103], a[160:163], a[188:191], v[100:103]
    v_mfma_f32_16x16x32_bf16 v[104:107], a[164:167], a[188:191], v[104:107]
    v_mfma_f32_16x16x32_bf16 v[108:111], a[168:171], a[188:191], v[108:111]
    v_mfma_f32_16x16x32_bf16 v[112:115], a[156:159], a[192:195], v[112:115]
    v_mfma_f32_16x16x32_bf16 v[116:119], a[160:163], a[192:195], v[116:119]
    v_mfma_f32_16x16x32_bf16 v[120:123], a[164:167], a[192:195], v[120:123]
    v_mfma_f32_16x16x32_bf16 v[124:127], a[168:171], a[192:195], v[124:127]
    buffer_load_dwordx4 a[156:159], v5, s[8:11], s24 offen offset:0
    buffer_load_dwordx4 a[160:163], v5, s[8:11], s25 offen offset:0
    buffer_load_dwordx4 a[164:167], v5, s[8:11], s26 offen offset:0
    buffer_load_dwordx4 a[168:171], v5, s[8:11], s27 offen offset:0
    buffer_load_dwordx4 a[172:175], v5, s[8:11], s28 offen offset:0
    buffer_load_dwordx4 a[176:179], v5, s[8:11], s29 offen offset:0
    buffer_load_dwordx4 a[180:183], v5, s[8:11], s30 offen offset:0
    buffer_load_dwordx4 a[184:187], v5, s[8:11], s31 offen offset:0
    buffer_load_dwordx4 a[188:191], v5, s[8:11], s32 offen offset:0
    buffer_load_dwordx4 a[192:195], v5, s[8:11], s33 offen offset:0
    s_waitcnt vmcnt(20)
    v_mfma_f32_16x16x32_bf16 v[32:35], a[216:219], a[200:203], v[32:35]
    v_mfma_f32_16x16x32_bf16 v[36:39], a[216:219], a[204:207], v[36:39]
    v_mfma_f32_16x16x32_bf16 v[40:43], a[216:219], a[208:211], v[40:43]
    v_mfma_f32_16x16x32_bf16 v[44:47], a[216:219], a[212:215], v[44:47]
    v_mfma_f32_16x16x32_bf16 v[48:51], a[220:223], a[200:203], v[48:51]
    v_mfma_f32_16x16x32_bf16 v[52:55], a[220:223], a[204:207], v[52:55]
    v_mfma_f32_16x16x32_bf16 v[56:59], a[220:223], a[208:211], v[56:59]
    v_mfma_f32_16x16x32_bf16 v[60:63], a[220:223], a[212:215], v[60:63]
    v_mfma_f32_16x16x32_bf16 v[64:67], a[224:227], a[200:203], v[64:67]
    v_mfma_f32_16x16x32_bf16 v[68:71], a[224:227], a[204:207], v[68:71]
    v_mfma_f32_16x16x32_bf16 v[72:75], a[224:227], a[208:211], v[72:75]
    v_mfma_f32_16x16x32_bf16 v[76:79], a[224:227], a[212:215], v[76:79]
    v_mfma_f32_16x16x32_bf16 v[80:83], a[228:231], a[200:203], v[80:83]
    v_mfma_f32_16x16x32_bf16 v[84:87], a[228:231], a[204:207], v[84:87]
    v_mfma_f32_16x16x32_bf16 v[88:91], a[228:231], a[208:211], v[88:91]
    v_mfma_f32_16x16x32_bf16 v[92:95], a[228:231], a[212:215], v[92:95]
    v_mfma_f32_16x16x32_bf16 v[96:99], a[200:203], a[232:235], v[96:99]
    v_mfma_f32_16x16x32_bf16 v[100:103], a[204:207], a[232:235], v[100:103]
    v_mfma_f32_16x16x32_bf16 v[104:107], a[208:211], a[232:235], v[104:107]
    v_mfma_f32_16x16x32_bf16 v[108:111], a[212:215], a[232:235], v[108:111]
    v_mfma_f32_16x16x32_bf16 v[112:115], a[200:203], a[236:239], v[112:115]
    v_mfma_f32_16x16x32_bf16 v[116:119], a[204:207], a[236:239], v[116:119]
    v_mfma_f32_16x16x32_bf16 v[120:123], a[208:211], a[236:239], v[120:123]
    v_mfma_f32_16x16x32_bf16 v[124:127], a[212:215], a[236:239], v[124:127]
    buffer_load_dwordx4 a[200:203], v5, s[8:11], s24 offen offset:1024
    buffer_load_dwordx4 a[204:207], v5, s[8:11], s25 offen offset:1024
    buffer_load_dwordx4 a[208:211], v5, s[8:11], s26 offen offset:1024
    buffer_load_dwordx4 a[212:215], v5, s[8:11], s27 offen offset:1024
    buffer_load_dwordx4 a[216:219], v5, s[8:11], s28 offen offset:1024
    buffer_load_dwordx4 a[220:223], v5, s[8:11], s29 offen offset:1024
    buffer_load_dwordx4 a[224:227], v5, s[8:11], s30 offen offset:1024
    buffer_load_dwordx4 a[228:231], v5, s[8:11], s31 offen offset:1024
    buffer_load_dwordx4 a[232:235], v5, s[8:11], s32 offen offset:1024
    buffer_load_dwordx4 a[236:239], v5, s[8:11], s33 offen offset:1024
    s_waitcnt vmcnt(20)
    v_mfma_f32_16x16x32_bf16 v[32:35], a[128:131], a[112:115], v[32:35]
    v_mfma_f32_16x16x32_bf16 v[36:39], a[128:131], a[116:119], v[36:39]
    v_mfma_f32_16x16x32_bf16 v[40:43], a[128:131], a[120:123], v[40:43]
    v_mfma_f32_16x16x32_bf16 v[44:47], a[128:131], a[124:127], v[44:47]
    v_mfma_f32_16x16x32_bf16 v[48:51], a[132:135], a[112:115], v[48:51]
    v_mfma_f32_16x16x32_bf16 v[52:55], a[132:135], a[116:119], v[52:55]
    v_mfma_f32_16x16x32_bf16 v[56:59], a[132:135], a[120:123], v[56:59]
    v_mfma_f32_16x16x32_bf16 v[60:63], a[132:135], a[124:127], v[60:63]
    v_mfma_f32_16x16x32_bf16 v[64:67], a[136:139], a[112:115], v[64:67]
    v_mfma_f32_16x16x32_bf16 v[68:71], a[136:139], a[116:119], v[68:71]
    v_mfma_f32_16x16x32_bf16 v[72:75], a[136:139], a[120:123], v[72:75]
    v_mfma_f32_16x16x32_bf16 v[76:79], a[136:139], a[124:127], v[76:79]
    v_mfma_f32_16x16x32_bf16 v[80:83], a[140:143], a[112:115], v[80:83]
    v_mfma_f32_16x16x32_bf16 v[84:87], a[140:143], a[116:119], v[84:87]
    v_mfma_f32_16x16x32_bf16 v[88:91], a[140:143], a[120:123], v[88:91]
    v_mfma_f32_16x16x32_bf16 v[92:95], a[140:143], a[124:127], v[92:95]
    v_mfma_f32_16x16x32_bf16 v[96:99], a[112:115], a[144:147], v[96:99]
    v_mfma_f32_16x16x32_bf16 v[100:103], a[116:119], a[144:147], v[100:103]
    v_mfma_f32_16x16x32_bf16 v[104:107], a[120:123], a[144:147], v[104:107]
    v_mfma_f32_16x16x32_bf16 v[108:111], a[124:127], a[144:147], v[108:111]
    v_mfma_f32_16x16x32_bf16 v[112:115], a[112:115], a[148:151], v[112:115]
    v_mfma_f32_16x16x32_bf16 v[116:119], a[116:119], a[148:151], v[116:119]
    v_mfma_f32_16x16x32_bf16 v[120:123], a[120:123], a[148:151], v[120:123]
    v_mfma_f32_16x16x32_bf16 v[124:127], a[124:127], a[148:151], v[124:127]
    buffer_load_dwordx4 a[112:115], v5, s[8:11], s24 offen offset:2048
    buffer_load_dwordx4 a[116:119], v5, s[8:11], s25 offen offset:2048
    buffer_load_dwordx4 a[120:123], v5, s[8:11], s26 offen offset:2048
    buffer_load_dwordx4 a[124:127], v5, s[8:11], s27 offen offset:2048
    buffer_load_dwordx4 a[128:131], v5, s[8:11], s28 offen offset:2048
    buffer_load_dwordx4 a[132:135], v5, s[8:11], s29 offen offset:2048
    buffer_load_dwordx4 a[136:139], v5, s[8:11], s30 offen offset:2048
    buffer_load_dwordx4 a[140:143], v5, s[8:11], s31 offen offset:2048
    buffer_load_dwordx4 a[144:147], v5, s[8:11], s32 offen offset:2048
    buffer_load_dwordx4 a[148:151], v5, s[8:11], s33 offen offset:2048
    s_waitcnt vmcnt(20)
    v_mfma_f32_16x16x32_bf16 v[32:35], a[172:175], a[156:159], v[32:35]
    v_mfma_f32_16x16x32_bf16 v[36:39], a[172:175], a[160:163], v[36:39]
    v_mfma_f32_16x16x32_bf16 v[40:43], a[172:175], a[164:167], v[40:43]
    v_mfma_f32_16x16x32_bf16 v[44:47], a[172:175], a[168:171], v[44:47]
    v_mfma_f32_16x16x32_bf16 v[48:51], a[176:179], a[156:159], v[48:51]
    v_mfma_f32_16x16x32_bf16 v[52:55], a[176:179], a[160:163], v[52:55]
    v_mfma_f32_16x16x32_bf16 v[56:59], a[176:179], a[164:167], v[56:59]
    v_mfma_f32_16x16x32_bf16 v[60:63], a[176:179], a[168:171], v[60:63]
    v_mfma_f32_16x16x32_bf16 v[64:67], a[180:183], a[156:159], v[64:67]
    v_mfma_f32_16x16x32_bf16 v[68:71], a[180:183], a[160:163], v[68:71]
    v_mfma_f32_16x16x32_bf16 v[72:75], a[180:183], a[164:167], v[72:75]
    v_mfma_f32_16x16x32_bf16 v[76:79], a[180:183], a[168:171], v[76:79]
    v_mfma_f32_16x16x32_bf16 v[80:83], a[184:187], a[156:159], v[80:83]
    v_mfma_f32_16x16x32_bf16 v[84:87], a[184:187], a[160:163], v[84:87]
    v_mfma_f32_16x16x32_bf16 v[88:91], a[184:187], a[164:167], v[88:91]
    v_mfma_f32_16x16x32_bf16 v[92:95], a[184:187], a[168:171], v[92:95]
    v_mfma_f32_16x16x32_bf16 v[96:99], a[156:159], a[188:191], v[96:99]
    v_mfma_f32_16x16x32_bf16 v[100:103], a[160:163], a[188:191], v[100:103]
    v_mfma_f32_16x16x32_bf16 v[104:107], a[164:167], a[188:191], v[104:107]
    v_mfma_f32_16x16x32_bf16 v[108:111], a[168:171], a[188:191], v[108:111]
    v_mfma_f32_16x16x32_bf16 v[112:115], a[156:159], a[192:195], v[112:115]
    v_mfma_f32_16x16x32_bf16 v[116:119], a[160:163], a[192:195], v[116:119]
    v_mfma_f32_16x16x32_bf16 v[120:123], a[164:167], a[192:195], v[120:123]
    v_mfma_f32_16x16x32_bf16 v[124:127], a[168:171], a[192:195], v[124:127]
    buffer_load_dwordx4 a[156:159], v5, s[8:11], s24 offen offset:3072
    buffer_load_dwordx4 a[160:163], v5, s[8:11], s25 offen offset:3072
    buffer_load_dwordx4 a[164:167], v5, s[8:11], s26 offen offset:3072
    buffer_load_dwordx4 a[168:171], v5, s[8:11], s27 offen offset:3072
    buffer_load_dwordx4 a[172:175], v5, s[8:11], s28 offen offset:3072
    buffer_load_dwordx4 a[176:179], v5, s[8:11], s29 offen offset:3072
    buffer_load_dwordx4 a[180:183], v5, s[8:11], s30 offen offset:3072
    buffer_load_dwordx4 a[184:187], v5, s[8:11], s31 offen offset:3072
    buffer_load_dwordx4 a[188:191], v5, s[8:11], s32 offen offset:3072
    buffer_load_dwordx4 a[192:195], v5, s[8:11], s33 offen offset:3072
    s_waitcnt vmcnt(20)
    v_mfma_f32_16x16x32_bf16 v[32:35], a[216:219], a[200:203], v[32:35]
    v_mfma_f32_16x16x32_bf16 v[36:39], a[216:219], a[204:207], v[36:39]
    v_mfma_f32_16x16x32_bf16 v[40:43], a[216:219], a[208:211], v[40:43]
    v_mfma_f32_16x16x32_bf16 v[44:47], a[216:219], a[212:215], v[44:47]
    v_mfma_f32_16x16x32_bf16 v[48:51], a[220:223], a[200:203], v[48:51]
    v_mfma_f32_16x16x32_bf16 v[52:55], a[220:223], a[204:207], v[52:55]
    v_mfma_f32_16x16x32_bf16 v[56:59], a[220:223], a[208:211], v[56:59]
    v_mfma_f32_16x16x32_bf16 v[60:63], a[220:223], a[212:215], v[60:63]
    v_mfma_f32_16x16x32_bf16 v[64:67], a[224:227], a[200:203], v[64:67]
    v_mfma_f32_16x16x32_bf16 v[68:71], a[224:227], a[204:207], v[68:71]
    v_mfma_f32_16x16x32_bf16 v[72:75], a[224:227], a[208:211], v[72:75]
    v_mfma_f32_16x16x32_bf16 v[76:79], a[224:227], a[212:215], v[76:79]
    v_mfma_f32_16x16x32_bf16 v[80:83], a[228:231], a[200:203], v[80:83]
    v_mfma_f32_16x16x32_bf16 v[84:87], a[228:231], a[204:207], v[84:87]
    v_mfma_f32_16x16x32_bf16 v[88:91], a[228:231], a[208:211], v[88:91]
    v_mfma_f32_16x16x32_bf16 v[92:95], a[228:231], a[212:215], v[92:95]
    v_mfma_f32_16x16x32_bf16 v[96:99], a[200:203], a[232:235], v[96:99]
    v_mfma_f32_16x16x32_bf16 v[100:103], a[204:207], a[232:235], v[100:103]
    v_mfma_f32_16x16x32_bf16 v[104:107], a[208:211], a[232:235], v[104:107]
    v_mfma_f32_16x16x32_bf16 v[108:111], a[212:215], a[232:235], v[108:111]
    v_mfma_f32_16x16x32_bf16 v[112:115], a[200:203], a[236:239], v[112:115]
    v_mfma_f32_16x16x32_bf16 v[116:119], a[204:207], a[236:239], v[116:119]
    v_mfma_f32_16x16x32_bf16 v[120:123], a[208:211], a[236:239], v[120:123]
    v_mfma_f32_16x16x32_bf16 v[124:127], a[212:215], a[236:239], v[124:127]
    buffer_load_dwordx4 a[200:203], v6, s[8:11], s24 offen offset:0
    buffer_load_dwordx4 a[204:207], v6, s[8:11], s25 offen offset:0
    buffer_load_dwordx4 a[208:211], v6, s[8:11], s26 offen offset:0
    buffer_load_dwordx4 a[212:215], v6, s[8:11], s27 offen offset:0
    buffer_load_dwordx4 a[216:219], v6, s[8:11], s28 offen offset:0
    buffer_load_dwordx4 a[220:223], v6, s[8:11], s29 offen offset:0
    buffer_load_dwordx4 a[224:227], v6, s[8:11], s30 offen offset:0
    buffer_load_dwordx4 a[228:231], v6, s[8:11], s31 offen offset:0
    buffer_load_dwordx4 a[232:235], v6, s[8:11], s32 offen offset:0
    buffer_load_dwordx4 a[236:239], v6, s[8:11], s33 offen offset:0
    s_waitcnt vmcnt(20)
    v_mfma_f32_16x16x32_bf16 v[32:35], a[128:131], a[112:115], v[32:35]
    v_mfma_f32_16x16x32_bf16 v[36:39], a[128:131], a[116:119], v[36:39]
    v_mfma_f32_16x16x32_bf16 v[40:43], a[128:131], a[120:123], v[40:43]
    v_mfma_f32_16x16x32_bf16 v[44:47], a[128:131], a[124:127], v[44:47]
    v_mfma_f32_16x16x32_bf16 v[48:51], a[132:135], a[112:115], v[48:51]
    v_mfma_f32_16x16x32_bf16 v[52:55], a[132:135], a[116:119], v[52:55]
    v_mfma_f32_16x16x32_bf16 v[56:59], a[132:135], a[120:123], v[56:59]
    v_mfma_f32_16x16x32_bf16 v[60:63], a[132:135], a[124:127], v[60:63]
    v_mfma_f32_16x16x32_bf16 v[64:67], a[136:139], a[112:115], v[64:67]
    v_mfma_f32_16x16x32_bf16 v[68:71], a[136:139], a[116:119], v[68:71]
    v_mfma_f32_16x16x32_bf16 v[72:75], a[136:139], a[120:123], v[72:75]
    v_mfma_f32_16x16x32_bf16 v[76:79], a[136:139], a[124:127], v[76:79]
    v_mfma_f32_16x16x32_bf16 v[80:83], a[140:143], a[112:115], v[80:83]
    v_mfma_f32_16x16x32_bf16 v[84:87], a[140:143], a[116:119], v[84:87]
    v_mfma_f32_16x16x32_bf16 v[88:91], a[140:143], a[120:123], v[88:91]
    v_mfma_f32_16x16x32_bf16 v[92:95], a[140:143], a[124:127], v[92:95]
    v_mfma_f32_16x16x32_bf16 v[96:99], a[112:115], a[144:147], v[96:99]
    v_mfma_f32_16x16x32_bf16 v[100:103], a[116:119], a[144:147], v[100:103]
    v_mfma_f32_16x16x32_bf16 v[104:107], a[120:123], a[144:147], v[104:107]
    v_mfma_f32_16x16x32_bf16 v[108:111], a[124:127], a[144:147], v[108:111]
    v_mfma_f32_16x16x32_bf16 v[112:115], a[112:115], a[148:151], v[112:115]
    v_mfma_f32_16x16x32_bf16 v[116:119], a[116:119], a[148:151], v[116:119]
    v_mfma_f32_16x16x32_bf16 v[120:123], a[120:123], a[148:151], v[120:123]
    v_mfma_f32_16x16x32_bf16 v[124:127], a[124:127], a[148:151], v[124:127]
    buffer_load_dwordx4 a[112:115], v6, s[8:11], s24 offen offset:1024
    buffer_load_dwordx4 a[116:119], v6, s[8:11], s25 offen offset:1024
    buffer_load_dwordx4 a[120:123], v6, s[8:11], s26 offen offset:1024
    buffer_load_dwordx4 a[124:127], v6, s[8:11], s27 offen offset:1024
    buffer_load_dwordx4 a[128:131], v6, s[8:11], s28 offen offset:1024
    buffer_load_dwordx4 a[132:135], v6, s[8:11], s29 offen offset:1024
    buffer_load_dwordx4 a[136:139], v6, s[8:11], s30 offen offset:1024
    buffer_load_dwordx4 a[140:143], v6, s[8:11], s31 offen offset:1024
    buffer_load_dwordx4 a[144:147], v6, s[8:11], s32 offen offset:1024
    buffer_load_dwordx4 a[148:151], v6, s[8:11], s33 offen offset:1024
    s_waitcnt vmcnt(20)
    v_mfma_f32_16x16x32_bf16 v[32:35], a[172:175], a[156:159], v[32:35]
    v_mfma_f32_16x16x32_bf16 v[36:39], a[172:175], a[160:163], v[36:39]
    v_mfma_f32_16x16x32_bf16 v[40:43], a[172:175], a[164:167], v[40:43]
    v_mfma_f32_16x16x32_bf16 v[44:47], a[172:175], a[168:171], v[44:47]
    v_mfma_f32_16x16x32_bf16 v[48:51], a[176:179], a[156:159], v[48:51]
    v_mfma_f32_16x16x32_bf16 v[52:55], a[176:179], a[160:163], v[52:55]
    v_mfma_f32_16x16x32_bf16 v[56:59], a[176:179], a[164:167], v[56:59]
    v_mfma_f32_16x16x32_bf16 v[60:63], a[176:179], a[168:171], v[60:63]
    v_mfma_f32_16x16x32_bf16 v[64:67], a[180:183], a[156:159], v[64:67]
    v_mfma_f32_16x16x32_bf16 v[68:71], a[180:183], a[160:163], v[68:71]
    v_mfma_f32_16x16x32_bf16 v[72:75], a[180:183], a[164:167], v[72:75]
    v_mfma_f32_16x16x32_bf16 v[76:79], a[180:183], a[168:171], v[76:79]
    v_mfma_f32_16x16x32_bf16 v[80:83], a[184:187], a[156:159], v[80:83]
    v_mfma_f32_16x16x32_bf16 v[84:87], a[184:187], a[160:163], v[84:87]
    v_mfma_f32_16x16x32_bf16 v[88:91], a[184:187], a[164:167], v[88:91]
    v_mfma_f32_16x16x32_bf16 v[92:95], a[184:187], a[168:171], v[92:95]
    v_mfma_f32_16x16x32_bf16 v[96:99], a[156:159], a[188:191], v[96:99]
    v_mfma_f32_16x16x32_bf16 v[100:103], a[160:163], a[188:191], v[100:103]
    v_mfma_f32_16x16x32_bf16 v[104:107], a[164:167], a[188:191], v[104:107]
    v_mfma_f32_16x16x32_bf16 v[108:111], a[168:171], a[188:191], v[108:111]
    v_mfma_f32_16x16x32_bf16 v[112:115], a[156:159], a[192:195], v[112:115]
    v_mfma_f32_16x16x32_bf16 v[116:119], a[160:163], a[192:195], v[116:119]
    v_mfma_f32_16x16x32_bf16 v[120:123], a[164:167], a[192:195], v[120:123]
    v_mfma_f32_16x16x32_bf16 v[124:127], a[168:171], a[192:195], v[124:127]
    buffer_load_dwordx4 a[156:159], v6, s[8:11], s24 offen offset:2048
    buffer_load_dwordx4 a[160:163], v6, s[8:11], s25 offen offset:2048
    buffer_load_dwordx4 a[164:167], v6, s[8:11], s26 offen offset:2048
    buffer_load_dwordx4 a[168:171], v6, s[8:11], s27 offen offset:2048
    buffer_load_dwordx4 a[172:175], v6, s[8:11], s28 offen offset:2048
    buffer_load_dwordx4 a[176:179], v6, s[8:11], s29 offen offset:2048
    buffer_load_dwordx4 a[180:183], v6, s[8:11], s30 offen offset:2048
    buffer_load_dwordx4 a[184:187], v6, s[8:11], s31 offen offset:2048
    buffer_load_dwordx4 a[188:191], v6, s[8:11], s32 offen offset:2048
    buffer_load_dwordx4 a[192:195], v6, s[8:11], s33 offen offset:2048
    s_waitcnt vmcnt(20)
    v_mfma_f32_16x16x32_bf16 v[32:35], a[216:219], a[200:203], v[32:35]
    v_mfma_f32_16x16x32_bf16 v[36:39], a[216:219], a[204:207], v[36:39]
    v_mfma_f32_16x16x32_bf16 v[40:43], a[216:219], a[208:211], v[40:43]
    v_mfma_f32_16x16x32_bf16 v[44:47], a[216:219], a[212:215], v[44:47]
    v_mfma_f32_16x16x32_bf16 v[48:51], a[220:223], a[200:203], v[48:51]
    v_mfma_f32_16x16x32_bf16 v[52:55], a[220:223], a[204:207], v[52:55]
    v_mfma_f32_16x16x32_bf16 v[56:59], a[220:223], a[208:211], v[56:59]
    v_mfma_f32_16x16x32_bf16 v[60:63], a[220:223], a[212:215], v[60:63]
    v_mfma_f32_16x16x32_bf16 v[64:67], a[224:227], a[200:203], v[64:67]
    v_mfma_f32_16x16x32_bf16 v[68:71], a[224:227], a[204:207], v[68:71]
    v_mfma_f32_16x16x32_bf16 v[72:75], a[224:227], a[208:211], v[72:75]
    v_mfma_f32_16x16x32_bf16 v[76:79], a[224:227], a[212:215], v[76:79]
    v_mfma_f32_16x16x32_bf16 v[80:83], a[228:231], a[200:203], v[80:83]
    v_mfma_f32_16x16x32_bf16 v[84:87], a[228:231], a[204:207], v[84:87]
    v_mfma_f32_16x16x32_bf16 v[88:91], a[228:231], a[208:211], v[88:91]
    v_mfma_f32_16x16x32_bf16 v[92:95], a[228:231], a[212:215], v[92:95]
    v_mfma_f32_16x16x32_bf16 v[96:99], a[200:203], a[232:235], v[96:99]
    v_mfma_f32_16x16x32_bf16 v[100:103], a[204:207], a[232:235], v[100:103]
    v_mfma_f32_16x16x32_bf16 v[104:107], a[208:211], a[232:235], v[104:107]
    v_mfma_f32_16x16x32_bf16 v[108:111], a[212:215], a[232:235], v[108:111]
    v_mfma_f32_16x16x32_bf16 v[112:115], a[200:203], a[236:239], v[112:115]
    v_mfma_f32_16x16x32_bf16 v[116:119], a[204:207], a[236:239], v[116:119]
    v_mfma_f32_16x16x32_bf16 v[120:123], a[208:211], a[236:239], v[120:123]
    v_mfma_f32_16x16x32_bf16 v[124:127], a[212:215], a[236:239], v[124:127]
    buffer_load_dwordx4 a[200:203], v6, s[8:11], s24 offen offset:3072
    buffer_load_dwordx4 a[204:207], v6, s[8:11], s25 offen offset:3072
    buffer_load_dwordx4 a[208:211], v6, s[8:11], s26 offen offset:3072
    buffer_load_dwordx4 a[212:215], v6, s[8:11], s27 offen offset:3072
    buffer_load_dwordx4 a[216:219], v6, s[8:11], s28 offen offset:3072
    buffer_load_dwordx4 a[220:223], v6, s[8:11], s29 offen offset:3072
    buffer_load_dwordx4 a[224:227], v6, s[8:11], s30 offen offset:3072
    buffer_load_dwordx4 a[228:231], v6, s[8:11], s31 offen offset:3072
    buffer_load_dwordx4 a[232:235], v6, s[8:11], s32 offen offset:3072
    buffer_load_dwordx4 a[236:239], v6, s[8:11], s33 offen offset:3072
    s_waitcnt vmcnt(20)
    v_mfma_f32_16x16x32_bf16 v[32:35], a[128:131], a[112:115], v[32:35]
    v_mfma_f32_16x16x32_bf16 v[36:39], a[128:131], a[116:119], v[36:39]
    v_mfma_f32_16x16x32_bf16 v[40:43], a[128:131], a[120:123], v[40:43]
    v_mfma_f32_16x16x32_bf16 v[44:47], a[128:131], a[124:127], v[44:47]
    v_mfma_f32_16x16x32_bf16 v[48:51], a[132:135], a[112:115], v[48:51]
    v_mfma_f32_16x16x32_bf16 v[52:55], a[132:135], a[116:119], v[52:55]
    v_mfma_f32_16x16x32_bf16 v[56:59], a[132:135], a[120:123], v[56:59]
    v_mfma_f32_16x16x32_bf16 v[60:63], a[132:135], a[124:127], v[60:63]
    v_mfma_f32_16x16x32_bf16 v[64:67], a[136:139], a[112:115], v[64:67]
    v_mfma_f32_16x16x32_bf16 v[68:71], a[136:139], a[116:119], v[68:71]
    v_mfma_f32_16x16x32_bf16 v[72:75], a[136:139], a[120:123], v[72:75]
    v_mfma_f32_16x16x32_bf16 v[76:79], a[136:139], a[124:127], v[76:79]
    v_mfma_f32_16x16x32_bf16 v[80:83], a[140:143], a[112:115], v[80:83]
    v_mfma_f32_16x16x32_bf16 v[84:87], a[140:143], a[116:119], v[84:87]
    v_mfma_f32_16x16x32_bf16 v[88:91], a[140:143], a[120:123], v[88:91]
    v_mfma_f32_16x16x32_bf16 v[92:95], a[140:143], a[124:127], v[92:95]
    v_mfma_f32_16x16x32_bf16 v[96:99], a[112:115], a[144:147], v[96:99]
    v_mfma_f32_16x16x32_bf16 v[100:103], a[116:119], a[144:147], v[100:103]
    v_mfma_f32_16x16x32_bf16 v[104:107], a[120:123], a[144:147], v[104:107]
    v_mfma_f32_16x16x32_bf16 v[108:111], a[124:127], a[144:147], v[108:111]
    v_mfma_f32_16x16x32_bf16 v[112:115], a[112:115], a[148:151], v[112:115]
    v_mfma_f32_16x16x32_bf16 v[116:119], a[116:119], a[148:151], v[116:119]
    v_mfma_f32_16x16x32_bf16 v[120:123], a[120:123], a[148:151], v[120:123]
    v_mfma_f32_16x16x32_bf16 v[124:127], a[124:127], a[148:151], v[124:127]
    buffer_load_dwordx4 a[112:115], v7, s[8:11], s24 offen offset:0
    buffer_load_dwordx4 a[116:119], v7, s[8:11], s25 offen offset:0
    buffer_load_dwordx4 a[120:123], v7, s[8:11], s26 offen offset:0
    buffer_load_dwordx4 a[124:127], v7, s[8:11], s27 offen offset:0
    buffer_load_dwordx4 a[128:131], v7, s[8:11], s28 offen offset:0
    buffer_load_dwordx4 a[132:135], v7, s[8:11], s29 offen offset:0
    buffer_load_dwordx4 a[136:139], v7, s[8:11], s30 offen offset:0
    buffer_load_dwordx4 a[140:143], v7, s[8:11], s31 offen offset:0
    buffer_load_dwordx4 a[144:147], v7, s[8:11], s32 offen offset:0
    buffer_load_dwordx4 a[148:151], v7, s[8:11], s33 offen offset:0
    s_waitcnt vmcnt(20)
    v_mfma_f32_16x16x32_bf16 v[32:35], a[172:175], a[156:159], v[32:35]
    v_mfma_f32_16x16x32_bf16 v[36:39], a[172:175], a[160:163], v[36:39]
    v_mfma_f32_16x16x32_bf16 v[40:43], a[172:175], a[164:167], v[40:43]
    v_mfma_f32_16x16x32_bf16 v[44:47], a[172:175], a[168:171], v[44:47]
    v_mfma_f32_16x16x32_bf16 v[48:51], a[176:179], a[156:159], v[48:51]
    v_mfma_f32_16x16x32_bf16 v[52:55], a[176:179], a[160:163], v[52:55]
    v_mfma_f32_16x16x32_bf16 v[56:59], a[176:179], a[164:167], v[56:59]
    v_mfma_f32_16x16x32_bf16 v[60:63], a[176:179], a[168:171], v[60:63]
    v_mfma_f32_16x16x32_bf16 v[64:67], a[180:183], a[156:159], v[64:67]
    v_mfma_f32_16x16x32_bf16 v[68:71], a[180:183], a[160:163], v[68:71]
    v_mfma_f32_16x16x32_bf16 v[72:75], a[180:183], a[164:167], v[72:75]
    v_mfma_f32_16x16x32_bf16 v[76:79], a[180:183], a[168:171], v[76:79]
    v_mfma_f32_16x16x32_bf16 v[80:83], a[184:187], a[156:159], v[80:83]
    v_mfma_f32_16x16x32_bf16 v[84:87], a[184:187], a[160:163], v[84:87]
    v_mfma_f32_16x16x32_bf16 v[88:91], a[184:187], a[164:167], v[88:91]
    v_mfma_f32_16x16x32_bf16 v[92:95], a[184:187], a[168:171], v[92:95]
    v_mfma_f32_16x16x32_bf16 v[96:99], a[156:159], a[188:191], v[96:99]
    v_mfma_f32_16x16x32_bf16 v[100:103], a[160:163], a[188:191], v[100:103]
    v_mfma_f32_16x16x32_bf16 v[104:107], a[164:167], a[188:191], v[104:107]
    v_mfma_f32_16x16x32_bf16 v[108:111], a[168:171], a[188:191], v[108:111]
    v_mfma_f32_16x16x32_bf16 v[112:115], a[156:159], a[192:195], v[112:115]
    v_mfma_f32_16x16x32_bf16 v[116:119], a[160:163], a[192:195], v[116:119]
    v_mfma_f32_16x16x32_bf16 v[120:123], a[164:167], a[192:195], v[120:123]
    v_mfma_f32_16x16x32_bf16 v[124:127], a[168:171], a[192:195], v[124:127]
    buffer_load_dwordx4 a[156:159], v7, s[8:11], s24 offen offset:1024
    buffer_load_dwordx4 a[160:163], v7, s[8:11], s25 offen offset:1024
    buffer_load_dwordx4 a[164:167], v7, s[8:11], s26 offen offset:1024
    buffer_load_dwordx4 a[168:171], v7, s[8:11], s27 offen offset:1024
    buffer_load_dwordx4 a[172:175], v7, s[8:11], s28 offen offset:1024
    buffer_load_dwordx4 a[176:179], v7, s[8:11], s29 offen offset:1024
    buffer_load_dwordx4 a[180:183], v7, s[8:11], s30 offen offset:1024
    buffer_load_dwordx4 a[184:187], v7, s[8:11], s31 offen offset:1024
    buffer_load_dwordx4 a[188:191], v7, s[8:11], s32 offen offset:1024
    buffer_load_dwordx4 a[192:195], v7, s[8:11], s33 offen offset:1024
    s_waitcnt vmcnt(20)
    v_mfma_f32_16x16x32_bf16 v[32:35], a[216:219], a[200:203], v[32:35]
    v_mfma_f32_16x16x32_bf16 v[36:39], a[216:219], a[204:207], v[36:39]
    v_mfma_f32_16x16x32_bf16 v[40:43], a[216:219], a[208:211], v[40:43]
    v_mfma_f32_16x16x32_bf16 v[44:47], a[216:219], a[212:215], v[44:47]
    v_mfma_f32_16x16x32_bf16 v[48:51], a[220:223], a[200:203], v[48:51]
    v_mfma_f32_16x16x32_bf16 v[52:55], a[220:223], a[204:207], v[52:55]
    v_mfma_f32_16x16x32_bf16 v[56:59], a[220:223], a[208:211], v[56:59]
    v_mfma_f32_16x16x32_bf16 v[60:63], a[220:223], a[212:215], v[60:63]
    v_mfma_f32_16x16x32_bf16 v[64:67], a[224:227], a[200:203], v[64:67]
    v_mfma_f32_16x16x32_bf16 v[68:71], a[224:227], a[204:207], v[68:71]
    v_mfma_f32_16x16x32_bf16 v[72:75], a[224:227], a[208:211], v[72:75]
    v_mfma_f32_16x16x32_bf16 v[76:79], a[224:227], a[212:215], v[76:79]
    v_mfma_f32_16x16x32_bf16 v[80:83], a[228:231], a[200:203], v[80:83]
    v_mfma_f32_16x16x32_bf16 v[84:87], a[228:231], a[204:207], v[84:87]
    v_mfma_f32_16x16x32_bf16 v[88:91], a[228:231], a[208:211], v[88:91]
    v_mfma_f32_16x16x32_bf16 v[92:95], a[228:231], a[212:215], v[92:95]
    v_mfma_f32_16x16x32_bf16 v[96:99], a[200:203], a[232:235], v[96:99]
    v_mfma_f32_16x16x32_bf16 v[100:103], a[204:207], a[232:235], v[100:103]
    v_mfma_f32_16x16x32_bf16 v[104:107], a[208:211], a[232:235], v[104:107]
    v_mfma_f32_16x16x32_bf16 v[108:111], a[212:215], a[232:235], v[108:111]
    v_mfma_f32_16x16x32_bf16 v[112:115], a[200:203], a[236:239], v[112:115]
    v_mfma_f32_16x16x32_bf16 v[116:119], a[204:207], a[236:239], v[116:119]
    v_mfma_f32_16x16x32_bf16 v[120:123], a[208:211], a[236:239], v[120:123]
    v_mfma_f32_16x16x32_bf16 v[124:127], a[212:215], a[236:239], v[124:127]
    s_waitcnt vmcnt(10)
    v_mfma_f32_16x16x32_bf16 v[32:35], a[128:131], a[112:115], v[32:35]
    v_mfma_f32_16x16x32_bf16 v[36:39], a[128:131], a[116:119], v[36:39]
    v_mfma_f32_16x16x32_bf16 v[40:43], a[128:131], a[120:123], v[40:43]
    v_mfma_f32_16x16x32_bf16 v[44:47], a[128:131], a[124:127], v[44:47]
    v_mfma_f32_16x16x32_bf16 v[48:51], a[132:135], a[112:115], v[48:51]
    v_mfma_f32_16x16x32_bf16 v[52:55], a[132:135], a[116:119], v[52:55]
    v_mfma_f32_16x16x32_bf16 v[56:59], a[132:135], a[120:123], v[56:59]
    v_mfma_f32_16x16x32_bf16 v[60:63], a[132:135], a[124:127], v[60:63]
    v_mfma_f32_16x16x32_bf16 v[64:67], a[136:139], a[112:115], v[64:67]
    v_mfma_f32_16x16x32_bf16 v[68:71], a[136:139], a[116:119], v[68:71]
    v_mfma_f32_16x16x32_bf16 v[72:75], a[136:139], a[120:123], v[72:75]
    v_mfma_f32_16x16x32_bf16 v[76:79], a[136:139], a[124:127], v[76:79]
    v_mfma_f32_16x16x32_bf16 v[80:83], a[140:143], a[112:115], v[80:83]
    v_mfma_f32_16x16x32_bf16 v[84:87], a[140:143], a[116:119], v[84:87]
    v_mfma_f32_16x16x32_bf16 v[88:91], a[140:143], a[120:123], v[88:91]
    v_mfma_f32_16x16x32_bf16 v[92:95], a[140:143], a[124:127], v[92:95]
    v_mfma_f32_16x16x32_bf16 v[96:99], a[112:115], a[144:147], v[96:99]
    v_mfma_f32_16x16x32_bf16 v[100:103], a[116:119], a[144:147], v[100:103]
    v_mfma_f32_16x16x32_bf16 v[104:107], a[120:123], a[144:147], v[104:107]
    v_mfma_f32_16x16x32_bf16 v[108:111], a[124:127], a[144:147], v[108:111]
    v_mfma_f32_16x16x32_bf16 v[112:115], a[112:115], a[148:151], v[112:115]
    v_mfma_f32_16x16x32_bf16 v[116:119], a[116:119], a[148:151], v[116:119]
    v_mfma_f32_16x16x32_bf16 v[120:123], a[120:123], a[148:151], v[120:123]
    v_mfma_f32_16x16x32_bf16 v[124:127], a[124:127], a[148:151], v[124:127]
    s_waitcnt vmcnt(0)
    v_mfma_f32_16x16x32_bf16 v[32:35], a[172:175], a[156:159], v[32:35]
    v_mfma_f32_16x16x32_bf16 v[36:39], a[172:175], a[160:163], v[36:39]
    v_mfma_f32_16x16x32_bf16 v[40:43], a[172:175], a[164:167], v[40:43]
    v_mfma_f32_16x16x32_bf16 v[44:47], a[172:175], a[168:171], v[44:47]
    v_mfma_f32_16x16x32_bf16 v[48:51], a[176:179], a[156:159], v[48:51]
    v_mfma_f32_16x16x32_bf16 v[52:55], a[176:179], a[160:163], v[52:55]
    v_mfma_f32_16x16x32_bf16 v[56:59], a[176:179], a[164:167], v[56:59]
    v_mfma_f32_16x16x32_bf16 v[60:63], a[176:179], a[168:171], v[60:63]
    v_mfma_f32_16x16x32_bf16 v[64:67], a[180:183], a[156:159], v[64:67]
    v_mfma_f32_16x16x32_bf16 v[68:71], a[180:183], a[160:163], v[68:71]
    v_mfma_f32_16x16x32_bf16 v[72:75], a[180:183], a[164:167], v[72:75]
    v_mfma_f32_16x16x32_bf16 v[76:79], a[180:183], a[168:171], v[76:79]
    v_mfma_f32_16x16x32_bf16 v[80:83], a[184:187], a[156:159], v[80:83]
    v_mfma_f32_16x16x32_bf16 v[84:87], a[184:187], a[160:163], v[84:87]
    v_mfma_f32_16x16x32_bf16 v[88:91], a[184:187], a[164:167], v[88:91]
    v_mfma_f32_16x16x32_bf16 v[92:95], a[184:187], a[168:171], v[92:95]
    v_mfma_f32_16x16x32_bf16 v[96:99], a[156:159], a[188:191], v[96:99]
    v_mfma_f32_16x16x32_bf16 v[100:103], a[160:163], a[188:191], v[100:103]
    v_mfma_f32_16x16x32_bf16 v[104:107], a[164:167], a[188:191], v[104:107]
    v_mfma_f32_16x16x32_bf16 v[108:111], a[168:171], a[188:191], v[108:111]
    v_mfma_f32_16x16x32_bf16 v[112:115], a[156:159], a[192:195], v[112:115]
    v_mfma_f32_16x16x32_bf16 v[116:119], a[160:163], a[192:195], v[116:119]
    v_mfma_f32_16x16x32_bf16 v[120:123], a[164:167], a[192:195], v[120:123]
    v_mfma_f32_16x16x32_bf16 v[124:127], a[168:171], a[192:195], v[124:127]
    s_nop 7
    s_nop 3
    s_lshl_b32 s24, s7, 17
    s_lshl_b32 s25, s6, 12
    s_add_u32 s24, s24, s25
    s_add_u32 s25, s24, 54951936
    s_add_u32 s26, s24, 57049088
    s_add_u32 s27, s24, 59146240
    v_cvt_pk_bf16_f32 v160, v32, v33
    v_cvt_pk_bf16_f32 v161, v34, v35
    v_cvt_pk_bf16_f32 v162, v48, v49
    v_cvt_pk_bf16_f32 v163, v50, v51
    buffer_store_dwordx4 v[160:163], v3, s[8:11], s25 offen offset:0 sc1
    v_cvt_pk_bf16_f32 v164, v36, v37
    v_cvt_pk_bf16_f32 v165, v38, v39
    v_cvt_pk_bf16_f32 v166, v52, v53
    v_cvt_pk_bf16_f32 v167, v54, v55
    buffer_store_dwordx4 v[164:167], v3, s[8:11], s25 offen offset:1024 sc1
    v_cvt_pk_bf16_f32 v168, v40, v41
    v_cvt_pk_bf16_f32 v169, v42, v43
    v_cvt_pk_bf16_f32 v170, v56, v57
    v_cvt_pk_bf16_f32 v171, v58, v59
    buffer_store_dwordx4 v[168:171], v3, s[8:11], s25 offen offset:2048 sc1
    v_cvt_pk_bf16_f32 v172, v44, v45
    v_cvt_pk_bf16_f32 v173, v46, v47
    v_cvt_pk_bf16_f32 v174, v60, v61
    v_cvt_pk_bf16_f32 v175, v62, v63
    buffer_store_dwordx4 v[172:175], v3, s[8:11], s25 offen offset:3072 sc1
    v_cvt_pk_bf16_f32 v176, v64, v65
    v_cvt_pk_bf16_f32 v177, v66, v67
    v_cvt_pk_bf16_f32 v178, v80, v81
    v_cvt_pk_bf16_f32 v179, v82, v83
    buffer_store_dwordx4 v[176:179], v3, s[8:11], s26 offen offset:0 sc1
    v_cvt_pk_bf16_f32 v180, v68, v69
    v_cvt_pk_bf16_f32 v181, v70, v71
    v_cvt_pk_bf16_f32 v182, v84, v85
    v_cvt_pk_bf16_f32 v183, v86, v87
    buffer_store_dwordx4 v[180:183], v3, s[8:11], s26 offen offset:1024 sc1
    v_cvt_pk_bf16_f32 v184, v72, v73
    v_cvt_pk_bf16_f32 v185, v74, v75
    v_cvt_pk_bf16_f32 v186, v88, v89
    v_cvt_pk_bf16_f32 v187, v90, v91
    buffer_store_dwordx4 v[184:187], v3, s[8:11], s26 offen offset:2048 sc1
    v_cvt_pk_bf16_f32 v188, v76, v77
    v_cvt_pk_bf16_f32 v189, v78, v79
    v_cvt_pk_bf16_f32 v190, v92, v93
    v_cvt_pk_bf16_f32 v191, v94, v95
    buffer_store_dwordx4 v[188:191], v3, s[8:11], s26 offen offset:3072 sc1
    v_cvt_pk_bf16_f32 v192, v96, v97
    v_cvt_pk_bf16_f32 v193, v98, v99
    v_cvt_pk_bf16_f32 v194, v100, v101
    v_cvt_pk_bf16_f32 v195, v102, v103
    buffer_store_dwordx4 v[192:195], v3, s[8:11], s27 offen offset:0 sc1
    v_cvt_pk_bf16_f32 v196, v112, v113
    v_cvt_pk_bf16_f32 v197, v114, v115
    v_cvt_pk_bf16_f32 v198, v116, v117
    v_cvt_pk_bf16_f32 v199, v118, v119
    buffer_store_dwordx4 v[196:199], v3, s[8:11], s27 offen offset:1024 sc1
    v_cvt_pk_bf16_f32 v200, v104, v105
    v_cvt_pk_bf16_f32 v201, v106, v107
    v_cvt_pk_bf16_f32 v202, v108, v109
    v_cvt_pk_bf16_f32 v203, v110, v111
    buffer_store_dwordx4 v[200:203], v3, s[8:11], s27 offen offset:2048 sc1
    v_cvt_pk_bf16_f32 v204, v120, v121
    v_cvt_pk_bf16_f32 v205, v122, v123
    v_cvt_pk_bf16_f32 v206, v124, v125
    v_cvt_pk_bf16_f32 v207, v126, v127
    buffer_store_dwordx4 v[204:207], v3, s[8:11], s27 offen offset:3072 sc1
    s_lshl_b32 s24, s5, 2
    s_add_u32 s24, s24, 18108416
    v_mov_b32 v8, 1
    v_mov_b32 v9, 0
    s_waitcnt vmcnt(0)
    s_mov_b64 exec, 1
    buffer_store_dword v8, v9, s[8:11], s24 offen sc1
    s_mov_b64 exec, -1
.q_done:
    s_lshl_b32 s5, s53, 2
    s_add_u32 s5, s5, s51
    s_sub_u32 s5, s5, 9
    s_add_u32 s55, s5, 40
    s_mul_i32 s6, s53, 6
    s_add_u32 s6, s6, s51
    s_add_u32 s6, s6, 13
    s_lshl_b32 s7, s53, 1
    s_add_u32 s7, s7, s51
    s_add_u32 s7, s7, 53
    s_cmp_lt_u32 s51, 5
    s_cselect_b32 s7, s7, 64
    s_cmp_ge_u32 s51, 9
    s_cselect_b32 s5, s5, s6
    s_cselect_b32 s55, s55, s7
.a_loop:
    s_lshl_b32 s5, s5, 4
    s_add_u32 s5, s5, s52
    s_lshr_b32 s6, s5, 4
    s_and_b32 s7, s5, 15
    s_lshr_b32 s24, s6, 1
    v_min_u32 v12, 4, v0
    v_sub_u32 v12, s24, v12
    v_max_i32 v12, 0, v12
    v_lshlrev_b32 v12, 6, v12
    s_lshl_b32 s24, s7, 2
    s_add_u32 s24, s24, 18108416
    s_mov_b32 s36, 0
.wf_10:
    buffer_load_dword v8, v12, s[8:11], s24 offen sc1
    s_waitcnt vmcnt(0)
    v_cmp_eq_u32 vcc, 0, v8
    s_cbranch_vccz .wfd_11
    s_sleep 2
    s_add_u32 s36, s36, 1
    s_cmp_lt_u32 s36, 2097152
    s_cbranch_scc1 .wf_10
    s_endpgm
.wfd_11:
    s_lshl_b32 s24, s7, 17
    s_lshl_b32 s25, s6, 11
    s_add_u32 s25, s25, s24
    s_add_u32 s25, s25, 54951936
    buffer_load_dwordx4 v[12:15], v3, s[8:11], s25 offen offset:0 sc1
    buffer_load_dwordx4 v[16:19], v3, s[8:11], s25 offen offset:1024 sc1
    s_sub_u32 s25, s6, 8
    s_max_i32 s25, s25, 0
    s_lshl_b32 s25, s25, 11
    s_add_u32 s25, s25, s24
    s_add_u32 s26, s25, 57049088
    s_add_u32 s27, s25, 59146240
    buffer_load_dwordx4 a[0:3], v3, s[8:11], s26 offen offset:0 sc1
    buffer_load_dwordx4 a[4:7], v3, s[8:11], s26 offen offset:1024 sc1
    buffer_load_dwordx4 a[72:75], v3, s[8:11], s27 offen offset:0 sc1
    buffer_load_dwordx4 a[76:79], v3, s[8:11], s27 offen offset:1024 sc1
    s_cmp_ge_u32 s6, 8
    s_cselect_b32 s40, 0, 0xf149f2ca
    s_sub_u32 s25, s6, 7
    s_max_i32 s25, s25, 0
    s_lshl_b32 s25, s25, 11
    s_add_u32 s25, s25, s24
    s_add_u32 s26, s25, 57049088
    s_add_u32 s27, s25, 59146240
    buffer_load_dwordx4 a[8:11], v3, s[8:11], s26 offen offset:0 sc1
    buffer_load_dwordx4 a[12:15], v3, s[8:11], s26 offen offset:1024 sc1
    buffer_load_dwordx4 a[80:83], v3, s[8:11], s27 offen offset:0 sc1
    buffer_load_dwordx4 a[84:87], v3, s[8:11], s27 offen offset:1024 sc1
    s_cmp_ge_u32 s6, 7
    s_cselect_b32 s41, 0, 0xf149f2ca
    s_sub_u32 s25, s6, 6
    s_max_i32 s25, s25, 0
    s_lshl_b32 s25, s25, 11
    s_add_u32 s25, s25, s24
    s_add_u32 s26, s25, 57049088
    s_add_u32 s27, s25, 59146240
    buffer_load_dwordx4 a[16:19], v3, s[8:11], s26 offen offset:0 sc1
    buffer_load_dwordx4 a[20:23], v3, s[8:11], s26 offen offset:1024 sc1
    buffer_load_dwordx4 a[88:91], v3, s[8:11], s27 offen offset:0 sc1
    buffer_load_dwordx4 a[92:95], v3, s[8:11], s27 offen offset:1024 sc1
    s_cmp_ge_u32 s6, 6
    s_cselect_b32 s42, 0, 0xf149f2ca
    s_sub_u32 s25, s6, 5
    s_max_i32 s25, s25, 0
    s_lshl_b32 s25, s25, 11
    s_add_u32 s25, s25, s24
    s_add_u32 s26, s25, 57049088
    s_add_u32 s27, s25, 59146240
    buffer_load_dwordx4 a[24:27], v3, s[8:11], s26 offen offset:0 sc1
    buffer_load_dwordx4 a[28:31], v3, s[8:11], s26 offen offset:1024 sc1
    buffer_load_dwordx4 a[96:99], v3, s[8:11], s27 offen offset:0 sc1
    buffer_load_dwordx4 a[100:103], v3, s[8:11], s27 offen offset:1024 sc1
    s_cmp_ge_u32 s6, 5
    s_cselect_b32 s43, 0, 0xf149f2ca
    s_sub_u32 s25, s6, 4
    s_max_i32 s25, s25, 0
    s_lshl_b32 s25, s25, 11
    s_add_u32 s25, s25, s24
    s_add_u32 s26, s25, 57049088
    s_add_u32 s27, s25, 59146240
    buffer_load_dwordx4 a[32:35], v3, s[8:11], s26 offen offset:0 sc1
    buffer_load_dwordx4 a[36:39], v3, s[8:11], s26 offen offset:1024 sc1
    buffer_load_dwordx4 a[104:107], v3, s[8:11], s27 offen offset:0 sc1
    buffer_load_dwordx4 a[108:111], v3, s[8:11], s27 offen offset:1024 sc1
    s_cmp_ge_u32 s6, 4
    s_cselect_b32 s44, 0, 0xf149f2ca
    s_sub_u32 s25, s6, 3
    s_max_i32 s25, s25, 0
    s_lshl_b32 s25, s25, 11
    s_add_u32 s25, s25, s24
    s_add_u32 s26, s25, 57049088
    s_add_u32 s27, s25, 59146240
    buffer_load_dwordx4 a[40:43], v3, s[8:11], s26 offen offset:0 sc1
    buffer_load_dwordx4 a[44:47], v3, s[8:11], s26 offen offset:1024 sc1
    buffer_load_dwordx4 a[112:115], v3, s[8:11], s27 offen offset:0 sc1
    buffer_load_dwordx4 a[116:119], v3, s[8:11], s27 offen offset:1024 sc1
    s_cmp_ge_u32 s6, 3
    s_cselect_b32 s45, 0, 0xf149f2ca
    s_sub_u32 s25, s6, 2
    s_max_i32 s25, s25, 0
    s_lshl_b32 s25, s25, 11
    s_add_u32 s25, s25, s24
    s_add_u32 s26, s25, 57049088
    s_add_u32 s27, s25, 59146240
    buffer_load_dwordx4 a[48:51], v3, s[8:11], s26 offen offset:0 sc1
    buffer_load_dwordx4 a[52:55], v3, s[8:11], s26 offen offset:1024 sc1
    buffer_load_dwordx4 a[120:123], v3, s[8:11], s27 offen offset:0 sc1
    buffer_load_dwordx4 a[124:127], v3, s[8:11], s27 offen offset:1024 sc1
    s_cmp_ge_u32 s6, 2
    s_cselect_b32 s46, 0, 0xf149f2ca
    s_sub_u32 s25, s6, 1
    s_max_i32 s25, s25, 0
    s_lshl_b32 s25, s25, 11
    s_add_u32 s25, s25, s24
    s_add_u32 s26, s25, 57049088
    s_add_u32 s27, s25, 59146240
    buffer_load_dwordx4 a[56:59], v3, s[8:11], s26 offen offset:0 sc1
    buffer_load_dwordx4 a[60:63], v3, s[8:11], s26 offen offset:1024 sc1
    buffer_load_dwordx4 a[128:131], v3, s[8:11], s27 offen offset:0 sc1
    buffer_load_dwordx4 a[132:135], v3, s[8:11], s27 offen offset:1024 sc1
    s_cmp_ge_u32 s6, 1
    s_cselect_b32 s47, 0, 0xf149f2ca
    s_sub_u32 s25, s6, 0
    s_max_i32 s25, s25, 0
    s_lshl_b32 s25, s25, 11
    s_add_u32 s25, s25, s24
    s_add_u32 s26, s25, 57049088
    s_add_u32 s27, s25, 59146240
    buffer_load_dwordx4 a[64:67], v3, s[8:11], s26 offen offset:0 sc1
    buffer_load_dwordx4 a[68:71], v3, s[8:11], s26 offen offset:1024 sc1
    buffer_load_dwordx4 a[136:139], v3, s[8:11], s27 offen offset:0 sc1
    buffer_load_dwordx4 a[140:143], v3, s[8:11], s27 offen offset:1024 sc1
    s_cmp_ge_u32 s6, 0
    s_cselect_b32 s48, 0, 0xf149f2ca
    v_mov_b32 v28, 0xf149f2ca
    v_lshl_add_u32 v29, v1, 2, 0
    v_cmp_lt_u32 vcc, v2, v29
    s_nop 1
    v_cndmask_b32 v20, v28, 0, vcc
    v_cndmask_b32 v24, 0, v28, vcc
    v_lshl_add_u32 v29, v1, 2, 1
    v_cmp_lt_u32 vcc, v2, v29
    s_nop 1
    v_cndmask_b32 v21, v28, 0, vcc
    v_cndmask_b32 v25, 0, v28, vcc
    v_lshl_add_u32 v29, v1, 2, 2
    v_cmp_lt_u32 vcc, v2, v29
    s_nop 1
    v_cndmask_b32 v22, v28, 0, vcc
    v_cndmask_b32 v26, 0, v28, vcc
    v_lshl_add_u32 v29, v1, 2, 3
    v_cmp_lt_u32 vcc, v2, v29
    s_nop 1
    v_cndmask_b32 v23, v28, 0, vcc
    v_cndmask_b32 v27, 0, v28, vcc
    v_min_f32 v32, s40, v20
    v_min_f32 v33, s40, v21
    v_min_f32 v34, s40, v22
    v_min_f32 v35, s40, v23
    v_mov_b32 v36, s40
    v_mov_b32 v37, s40
    v_mov_b32 v38, s40
    v_mov_b32 v39, s40
    v_mov_b32 v40, s41
    v_mov_b32 v41, s41
    v_mov_b32 v42, s41
    v_mov_b32 v43, s41
    v_mov_b32 v44, s41
    v_mov_b32 v45, s41
    v_mov_b32 v46, s41
    v_mov_b32 v47, s41
    v_mov_b32 v48, s42
    v_mov_b32 v49, s42
    v_mov_b32 v50, s42
    v_mov_b32 v51, s42
    v_mov_b32 v52, s42
    v_mov_b32 v53, s42
    v_mov_b32 v54, s42
    v_mov_b32 v55, s42
    v_mov_b32 v56, s43
    v_mov_b32 v57, s43
    v_mov_b32 v58, s43
    v_mov_b32 v59, s43
    v_mov_b32 v60, s43
    v_mov_b32 v61, s43
    v_mov_b32 v62, s43
    v_mov_b32 v63, s43
    v_mov_b32 v64, s44
    v_mov_b32 v65, s44
    v_mov_b32 v66, s44
    v_mov_b32 v67, s44
    v_mov_b32 v68, s44
    v_mov_b32 v69, s44
    v_mov_b32 v70, s44
    v_mov_b32 v71, s44
    v_mov_b32 v72, s45
    v_mov_b32 v73, s45
    v_mov_b32 v74, s45
    v_mov_b32 v75, s45
    v_mov_b32 v76, s45
    v_mov_b32 v77, s45
    v_mov_b32 v78, s45
    v_mov_b32 v79, s45
    v_mov_b32 v80, s46
    v_mov_b32 v81, s46
    v_mov_b32 v82, s46
    v_mov_b32 v83, s46
    v_mov_b32 v84, s46
    v_mov_b32 v85, s46
    v_mov_b32 v86, s46
    v_mov_b32 v87, s46
    v_mov_b32 v88, s47
    v_mov_b32 v89, s47
    v_mov_b32 v90, s47
    v_mov_b32 v91, s47
    v_mov_b32 v92, s47
    v_mov_b32 v93, s47
    v_mov_b32 v94, s47
    v_mov_b32 v95, s47
    v_mov_b32 v96, v24
    v_mov_b32 v97, v25
    v_mov_b32 v98, v26
    v_mov_b32 v99, v27
    v_min_f32 v100, s40, v20
    v_min_f32 v101, s40, v21
    v_min_f32 v102, s40, v22
    v_min_f32 v103, s40, v23
    v_mov_b32 v104, s41
    v_mov_b32 v105, s41
    v_mov_b32 v106, s41
    v_mov_b32 v107, s41
    v_mov_b32 v108, s41
    v_mov_b32 v109, s41
    v_mov_b32 v110, s41
    v_mov_b32 v111, s41
    v_mov_b32 v112, s42
    v_mov_b32 v113, s42
    v_mov_b32 v114, s42
    v_mov_b32 v115, s42
    v_mov_b32 v116, s42
    v_mov_b32 v117, s42
    v_mov_b32 v118, s42
    v_mov_b32 v119, s42
    v_mov_b32 v120, s43
    v_mov_b32 v121, s43
    v_mov_b32 v122, s43
    v_mov_b32 v123, s43
    v_mov_b32 v124, s43
    v_mov_b32 v125, s43
    v_mov_b32 v126, s43
    v_mov_b32 v127, s43
    v_mov_b32 v128, s44
    v_mov_b32 v129, s44
    v_mov_b32 v130, s44
    v_mov_b32 v131, s44
    v_mov_b32 v132, s44
    v_mov_b32 v133, s44
    v_mov_b32 v134, s44
    v_mov_b32 v135, s44
    v_mov_b32 v136, s45
    v_mov_b32 v137, s45
    v_mov_b32 v138, s45
    v_mov_b32 v139, s45
    v_mov_b32 v140, s45
    v_mov_b32 v141, s45
    v_mov_b32 v142, s45
    v_mov_b32 v143, s45
    v_mov_b32 v144, s46
    v_mov_b32 v145, s46
    v_mov_b32 v146, s46
    v_mov_b32 v147, s46
    v_mov_b32 v148, s46
    v_mov_b32 v149, s46
    v_mov_b32 v150, s46
    v_mov_b32 v151, s46
    v_mov_b32 v152, s47
    v_mov_b32 v153, s47
    v_mov_b32 v154, s47
    v_mov_b32 v155, s47
    v_mov_b32 v156, s47
    v_mov_b32 v157, s47
    v_mov_b32 v158, s47
    v_mov_b32 v159, s47
    v_mov_b32 v160, s48
    v_mov_b32 v161, s48
    v_mov_b32 v162, s48
    v_mov_b32 v163, s48
    v_mov_b32 v164, v24
    v_mov_b32 v165, v25
    v_mov_b32 v166, v26
    v_mov_b32 v167, v27
    s_waitcnt vmcnt(0)
    v_mfma_f32_16x16x32_bf16 v[32:35], a[0:3], v[12:15], v[32:35]
    v_mfma_f32_16x16x32_bf16 v[36:39], a[4:7], v[12:15], v[36:39]
    v_mfma_f32_16x16x32_bf16 v[40:43], a[8:11], v[12:15], v[40:43]
    v_mfma_f32_16x16x32_bf16 v[44:47], a[12:15], v[12:15], v[44:47]
    v_mfma_f32_16x16x32_bf16 v[48:51], a[16:19], v[12:15], v[48:51]
    v_mfma_f32_16x16x32_bf16 v[52:55], a[20:23], v[12:15], v[52:55]
    v_mfma_f32_16x16x32_bf16 v[56:59], a[24:27], v[12:15], v[56:59]
    v_mfma_f32_16x16x32_bf16 v[60:63], a[28:31], v[12:15], v[60:63]
    v_mfma_f32_16x16x32_bf16 v[64:67], a[32:35], v[12:15], v[64:67]
    v_mfma_f32_16x16x32_bf16 v[68:71], a[36:39], v[12:15], v[68:71]
    v_mfma_f32_16x16x32_bf16 v[72:75], a[40:43], v[12:15], v[72:75]
    v_mfma_f32_16x16x32_bf16 v[76:79], a[44:47], v[12:15], v[76:79]
    v_mfma_f32_16x16x32_bf16 v[80:83], a[48:51], v[12:15], v[80:83]
    v_mfma_f32_16x16x32_bf16 v[84:87], a[52:55], v[12:15], v[84:87]
    v_mfma_f32_16x16x32_bf16 v[88:91], a[56:59], v[12:15], v[88:91]
    v_mfma_f32_16x16x32_bf16 v[92:95], a[60:63], v[12:15], v[92:95]
    v_mfma_f32_16x16x32_bf16 v[96:99], a[64:67], v[12:15], v[96:99]
    v_mfma_f32_16x16x32_bf16 v[100:103], a[4:7], v[16:19], v[100:103]
    v_mfma_f32_16x16x32_bf16 v[104:107], a[8:11], v[16:19], v[104:107]
    v_mfma_f32_16x16x32_bf16 v[108:111], a[12:15], v[16:19], v[108:111]
    v_mfma_f32_16x16x32_bf16 v[112:115], a[16:19], v[16:19], v[112:115]
    v_mfma_f32_16x16x32_bf16 v[116:119], a[20:23], v[16:19], v[116:119]
    v_mfma_f32_16x16x32_bf16 v[120:123], a[24:27], v[16:19], v[120:123]
    v_mfma_f32_16x16x32_bf16 v[124:127], a[28:31], v[16:19], v[124:127]
    v_mfma_f32_16x16x32_bf16 v[128:131], a[32:35], v[16:19], v[128:131]
    v_mfma_f32_16x16x32_bf16 v[132:135], a[36:39], v[16:19], v[132:135]
    v_mfma_f32_16x16x32_bf16 v[136:139], a[40:43], v[16:19], v[136:139]
    v_mfma_f32_16x16x32_bf16 v[140:143], a[44:47], v[16:19], v[140:143]
    v_mfma_f32_16x16x32_bf16 v[144:147], a[48:51], v[16:19], v[144:147]
    v_mfma_f32_16x16x32_bf16 v[148:151], a[52:55], v[16:19], v[148:151]
    v_mfma_f32_16x16x32_bf16 v[152:155], a[56:59], v[16:19], v[152:155]
    v_mfma_f32_16x16x32_bf16 v[156:159], a[60:63], v[16:19], v[156:159]
    v_mfma_f32_16x16x32_bf16 v[160:163], a[64:67], v[16:19], v[160:163]
    v_mfma_f32_16x16x32_bf16 v[164:167], a[68:71], v[16:19], v[164:167]
    s_mov_b32 s24, 0xffff0000
    s_mov_b32 s25, 0x3e41848f
    s_mov_b32 s26, 0x3fb8aa3b
    s_nop 7
    v_cvt_pk_bf16_f32 v28, v32, v33
    v_lshlrev_b32 v32, 16, v28
    v_and_b32 v33, s24, v28
    v_mul_f32 v32, s25, v32
    v_mul_f32 v33, s25, v33
    v_cvt_pk_bf16_f32 v28, v32, v33
    v_lshlrev_b32 v32, 16, v28
    v_and_b32 v33, s24, v28
    v_max_f32 v30, v32, v33
    v_cvt_pk_bf16_f32 v28, v34, v35
    v_lshlrev_b32 v34, 16, v28
    v_and_b32 v35, s24, v28
    v_mul_f32 v34, s25, v34
    v_mul_f32 v35, s25, v35
    v_cvt_pk_bf16_f32 v28, v34, v35
    v_lshlrev_b32 v34, 16, v28
    v_and_b32 v35, s24, v28
    v_max3_f32 v30, v30, v34, v35
    v_cvt_pk_bf16_f32 v28, v36, v37
    v_lshlrev_b32 v36, 16, v28
    v_and_b32 v37, s24, v28
    v_mul_f32 v36, s25, v36
    v_mul_f32 v37, s25, v37
    v_cvt_pk_bf16_f32 v28, v36, v37
    v_lshlrev_b32 v36, 16, v28
    v_and_b32 v37, s24, v28
    v_max3_f32 v30, v30, v36, v37
    v_cvt_pk_bf16_f32 v28, v38, v39
    v_lshlrev_b32 v38, 16, v28
    v_and_b32 v39, s24, v28
    v_mul_f32 v38, s25, v38
    v_mul_f32 v39, s25, v39
    v_cvt_pk_bf16_f32 v28, v38, v39
    v_lshlrev_b32 v38, 16, v28
    v_and_b32 v39, s24, v28
    v_max3_f32 v30, v30, v38, v39
    v_cvt_pk_bf16_f32 v28, v40, v41
    v_lshlrev_b32 v40, 16, v28
    v_and_b32 v41, s24, v28
    v_mul_f32 v40, s25, v40
    v_mul_f32 v41, s25, v41
    v_cvt_pk_bf16_f32 v28, v40, v41
    v_lshlrev_b32 v40, 16, v28
    v_and_b32 v41, s24, v28
    v_max3_f32 v30, v30, v40, v41
    v_cvt_pk_bf16_f32 v28, v42, v43
    v_lshlrev_b32 v42, 16, v28
    v_and_b32 v43, s24, v28
    v_mul_f32 v42, s25, v42
    v_mul_f32 v43, s25, v43
    v_cvt_pk_bf16_f32 v28, v42, v43
    v_lshlrev_b32 v42, 16, v28
    v_and_b32 v43, s24, v28
    v_max3_f32 v30, v30, v42, v43
    v_cvt_pk_bf16_f32 v28, v44, v45
    v_lshlrev_b32 v44, 16, v28
    v_and_b32 v45, s24, v28
    v_mul_f32 v44, s25, v44
    v_mul_f32 v45, s25, v45
    v_cvt_pk_bf16_f32 v28, v44, v45
    v_lshlrev_b32 v44, 16, v28
    v_and_b32 v45, s24, v28
    v_max3_f32 v30, v30, v44, v45
    v_cvt_pk_bf16_f32 v28, v46, v47
    v_lshlrev_b32 v46, 16, v28
    v_and_b32 v47, s24, v28
    v_mul_f32 v46, s25, v46
    v_mul_f32 v47, s25, v47
    v_cvt_pk_bf16_f32 v28, v46, v47
    v_lshlrev_b32 v46, 16, v28
    v_and_b32 v47, s24, v28
    v_max3_f32 v30, v30, v46, v47
    v_cvt_pk_bf16_f32 v28, v48, v49
    v_lshlrev_b32 v48, 16, v28
    v_and_b32 v49, s24, v28
    v_mul_f32 v48, s25, v48
    v_mul_f32 v49, s25, v49
    v_cvt_pk_bf16_f32 v28, v48, v49
    v_lshlrev_b32 v48, 16, v28
    v_and_b32 v49, s24, v28
    v_max3_f32 v30, v30, v48, v49
    v_cvt_pk_bf16_f32 v28, v50, v51
    v_lshlrev_b32 v50, 16, v28
    v_and_b32 v51, s24, v28
    v_mul_f32 v50, s25, v50
    v_mul_f32 v51, s25, v51
    v_cvt_pk_bf16_f32 v28, v50, v51
    v_lshlrev_b32 v50, 16, v28
    v_and_b32 v51, s24, v28
    v_max3_f32 v30, v30, v50, v51
    v_cvt_pk_bf16_f32 v28, v52, v53
    v_lshlrev_b32 v52, 16, v28
    v_and_b32 v53, s24, v28
    v_mul_f32 v52, s25, v52
    v_mul_f32 v53, s25, v53
    v_cvt_pk_bf16_f32 v28, v52, v53
    v_lshlrev_b32 v52, 16, v28
    v_and_b32 v53, s24, v28
    v_max3_f32 v30, v30, v52, v53
    v_cvt_pk_bf16_f32 v28, v54, v55
    v_lshlrev_b32 v54, 16, v28
    v_and_b32 v55, s24, v28
    v_mul_f32 v54, s25, v54
    v_mul_f32 v55, s25, v55
    v_cvt_pk_bf16_f32 v28, v54, v55
    v_lshlrev_b32 v54, 16, v28
    v_and_b32 v55, s24, v28
    v_max3_f32 v30, v30, v54, v55
    v_cvt_pk_bf16_f32 v28, v56, v57
    v_lshlrev_b32 v56, 16, v28
    v_and_b32 v57, s24, v28
    v_mul_f32 v56, s25, v56
    v_mul_f32 v57, s25, v57
    v_cvt_pk_bf16_f32 v28, v56, v57
    v_lshlrev_b32 v56, 16, v28
    v_and_b32 v57, s24, v28
    v_max3_f32 v30, v30, v56, v57
    v_cvt_pk_bf16_f32 v28, v58, v59
    v_lshlrev_b32 v58, 16, v28
    v_and_b32 v59, s24, v28
    v_mul_f32 v58, s25, v58
    v_mul_f32 v59, s25, v59
    v_cvt_pk_bf16_f32 v28, v58, v59
    v_lshlrev_b32 v58, 16, v28
    v_and_b32 v59, s24, v28
    v_max3_f32 v30, v30, v58, v59
    v_cvt_pk_bf16_f32 v28, v60, v61
    v_lshlrev_b32 v60, 16, v28
    v_and_b32 v61, s24, v28
    v_mul_f32 v60, s25, v60
    v_mul_f32 v61, s25, v61
    v_cvt_pk_bf16_f32 v28, v60, v61
    v_lshlrev_b32 v60, 16, v28
    v_and_b32 v61, s24, v28
    v_max3_f32 v30, v30, v60, v61
    v_cvt_pk_bf16_f32 v28, v62, v63
    v_lshlrev_b32 v62, 16, v28
    v_and_b32 v63, s24, v28
    v_mul_f32 v62, s25, v62
    v_mul_f32 v63, s25, v63
    v_cvt_pk_bf16_f32 v28, v62, v63
    v_lshlrev_b32 v62, 16, v28
    v_and_b32 v63, s24, v28
    v_max3_f32 v30, v30, v62, v63
    v_cvt_pk_bf16_f32 v28, v64, v65
    v_lshlrev_b32 v64, 16, v28
    v_and_b32 v65, s24, v28
    v_mul_f32 v64, s25, v64
    v_mul_f32 v65, s25, v65
    v_cvt_pk_bf16_f32 v28, v64, v65
    v_lshlrev_b32 v64, 16, v28
    v_and_b32 v65, s24, v28
    v_max3_f32 v30, v30, v64, v65
    v_cvt_pk_bf16_f32 v28, v66, v67
    v_lshlrev_b32 v66, 16, v28
    v_and_b32 v67, s24, v28
    v_mul_f32 v66, s25, v66
    v_mul_f32 v67, s25, v67
    v_cvt_pk_bf16_f32 v28, v66, v67
    v_lshlrev_b32 v66, 16, v28
    v_and_b32 v67, s24, v28
    v_max3_f32 v30, v30, v66, v67
    v_cvt_pk_bf16_f32 v28, v68, v69
    v_lshlrev_b32 v68, 16, v28
    v_and_b32 v69, s24, v28
    v_mul_f32 v68, s25, v68
    v_mul_f32 v69, s25, v69
    v_cvt_pk_bf16_f32 v28, v68, v69
    v_lshlrev_b32 v68, 16, v28
    v_and_b32 v69, s24, v28
    v_max3_f32 v30, v30, v68, v69
    v_cvt_pk_bf16_f32 v28, v70, v71
    v_lshlrev_b32 v70, 16, v28
    v_and_b32 v71, s24, v28
    v_mul_f32 v70, s25, v70
    v_mul_f32 v71, s25, v71
    v_cvt_pk_bf16_f32 v28, v70, v71
    v_lshlrev_b32 v70, 16, v28
    v_and_b32 v71, s24, v28
    v_max3_f32 v30, v30, v70, v71
    v_cvt_pk_bf16_f32 v28, v72, v73
    v_lshlrev_b32 v72, 16, v28
    v_and_b32 v73, s24, v28
    v_mul_f32 v72, s25, v72
    v_mul_f32 v73, s25, v73
    v_cvt_pk_bf16_f32 v28, v72, v73
    v_lshlrev_b32 v72, 16, v28
    v_and_b32 v73, s24, v28
    v_max3_f32 v30, v30, v72, v73
    v_cvt_pk_bf16_f32 v28, v74, v75
    v_lshlrev_b32 v74, 16, v28
    v_and_b32 v75, s24, v28
    v_mul_f32 v74, s25, v74
    v_mul_f32 v75, s25, v75
    v_cvt_pk_bf16_f32 v28, v74, v75
    v_lshlrev_b32 v74, 16, v28
    v_and_b32 v75, s24, v28
    v_max3_f32 v30, v30, v74, v75
    v_cvt_pk_bf16_f32 v28, v76, v77
    v_lshlrev_b32 v76, 16, v28
    v_and_b32 v77, s24, v28
    v_mul_f32 v76, s25, v76
    v_mul_f32 v77, s25, v77
    v_cvt_pk_bf16_f32 v28, v76, v77
    v_lshlrev_b32 v76, 16, v28
    v_and_b32 v77, s24, v28
    v_max3_f32 v30, v30, v76, v77
    v_cvt_pk_bf16_f32 v28, v78, v79
    v_lshlrev_b32 v78, 16, v28
    v_and_b32 v79, s24, v28
    v_mul_f32 v78, s25, v78
    v_mul_f32 v79, s25, v79
    v_cvt_pk_bf16_f32 v28, v78, v79
    v_lshlrev_b32 v78, 16, v28
    v_and_b32 v79, s24, v28
    v_max3_f32 v30, v30, v78, v79
    v_cvt_pk_bf16_f32 v28, v80, v81
    v_lshlrev_b32 v80, 16, v28
    v_and_b32 v81, s24, v28
    v_mul_f32 v80, s25, v80
    v_mul_f32 v81, s25, v81
    v_cvt_pk_bf16_f32 v28, v80, v81
    v_lshlrev_b32 v80, 16, v28
    v_and_b32 v81, s24, v28
    v_max3_f32 v30, v30, v80, v81
    v_cvt_pk_bf16_f32 v28, v82, v83
    v_lshlrev_b32 v82, 16, v28
    v_and_b32 v83, s24, v28
    v_mul_f32 v82, s25, v82
    v_mul_f32 v83, s25, v83
    v_cvt_pk_bf16_f32 v28, v82, v83
    v_lshlrev_b32 v82, 16, v28
    v_and_b32 v83, s24, v28
    v_max3_f32 v30, v30, v82, v83
    v_cvt_pk_bf16_f32 v28, v84, v85
    v_lshlrev_b32 v84, 16, v28
    v_and_b32 v85, s24, v28
    v_mul_f32 v84, s25, v84
    v_mul_f32 v85, s25, v85
    v_cvt_pk_bf16_f32 v28, v84, v85
    v_lshlrev_b32 v84, 16, v28
    v_and_b32 v85, s24, v28
    v_max3_f32 v30, v30, v84, v85
    v_cvt_pk_bf16_f32 v28, v86, v87
    v_lshlrev_b32 v86, 16, v28
    v_and_b32 v87, s24, v28
    v_mul_f32 v86, s25, v86
    v_mul_f32 v87, s25, v87
    v_cvt_pk_bf16_f32 v28, v86, v87
    v_lshlrev_b32 v86, 16, v28
    v_and_b32 v87, s24, v28
    v_max3_f32 v30, v30, v86, v87
    v_cvt_pk_bf16_f32 v28, v88, v89
    v_lshlrev_b32 v88, 16, v28
    v_and_b32 v89, s24, v28
    v_mul_f32 v88, s25, v88
    v_mul_f32 v89, s25, v89
    v_cvt_pk_bf16_f32 v28, v88, v89
    v_lshlrev_b32 v88, 16, v28
    v_and_b32 v89, s24, v28
    v_max3_f32 v30, v30, v88, v89
    v_cvt_pk_bf16_f32 v28, v90, v91
    v_lshlrev_b32 v90, 16, v28
    v_and_b32 v91, s24, v28
    v_mul_f32 v90, s25, v90
    v_mul_f32 v91, s25, v91
    v_cvt_pk_bf16_f32 v28, v90, v91
    v_lshlrev_b32 v90, 16, v28
    v_and_b32 v91, s24, v28
    v_max3_f32 v30, v30, v90, v91
    v_cvt_pk_bf16_f32 v28, v92, v93
    v_lshlrev_b32 v92, 16, v28
    v_and_b32 v93, s24, v28
    v_mul_f32 v92, s25, v92
    v_mul_f32 v93, s25, v93
    v_cvt_pk_bf16_f32 v28, v92, v93
    v_lshlrev_b32 v92, 16, v28
    v_and_b32 v93, s24, v28
    v_max3_f32 v30, v30, v92, v93
    v_cvt_pk_bf16_f32 v28, v94, v95
    v_lshlrev_b32 v94, 16, v28
    v_and_b32 v95, s24, v28
    v_mul_f32 v94, s25, v94
    v_mul_f32 v95, s25, v95
    v_cvt_pk_bf16_f32 v28, v94, v95
    v_lshlrev_b32 v94, 16, v28
    v_and_b32 v95, s24, v28
    v_max3_f32 v30, v30, v94, v95
    v_cvt_pk_bf16_f32 v28, v96, v97
    v_lshlrev_b32 v96, 16, v28
    v_and_b32 v97, s24, v28
    v_mul_f32 v96, s25, v96
    v_mul_f32 v97, s25, v97
    v_cvt_pk_bf16_f32 v28, v96, v97
    v_lshlrev_b32 v96, 16, v28
    v_and_b32 v97, s24, v28
    v_max3_f32 v30, v30, v96, v97
    v_cvt_pk_bf16_f32 v28, v98, v99
    v_lshlrev_b32 v98, 16, v28
    v_and_b32 v99, s24, v28
    v_mul_f32 v98, s25, v98
    v_mul_f32 v99, s25, v99
    v_cvt_pk_bf16_f32 v28, v98, v99
    v_lshlrev_b32 v98, 16, v28
    v_and_b32 v99, s24, v28
    v_max3_f32 v30, v30, v98, v99
    ds_bpermute_b32 v29, v10, v30
    s_waitcnt lgkmcnt(0)
    v_max_f32 v30, v30, v29
    ds_bpermute_b32 v29, v11, v30
    s_waitcnt lgkmcnt(0)
    v_max_f32 v30, v30, v29
    v_mov_b32 v31, 0
    v_sub_f32 v32, v32, v30
    v_mul_f32 v32, s26, v32
    v_exp_f32 v32, v32
    v_sub_f32 v33, v33, v30
    v_mul_f32 v33, s26, v33
    v_exp_f32 v33, v33
    v_add_f32 v31, v31, v32
    v_sub_f32 v34, v34, v30
    v_mul_f32 v34, s26, v34
    v_exp_f32 v34, v34
    v_add_f32 v31, v31, v33
    v_sub_f32 v35, v35, v30
    v_mul_f32 v35, s26, v35
    v_exp_f32 v35, v35
    v_add_f32 v31, v31, v34
    v_sub_f32 v36, v36, v30
    v_mul_f32 v36, s26, v36
    v_exp_f32 v36, v36
    v_add_f32 v31, v31, v35
    v_sub_f32 v37, v37, v30
    v_mul_f32 v37, s26, v37
    v_exp_f32 v37, v37
    v_add_f32 v31, v31, v36
    v_sub_f32 v38, v38, v30
    v_mul_f32 v38, s26, v38
    v_exp_f32 v38, v38
    v_add_f32 v31, v31, v37
    v_sub_f32 v39, v39, v30
    v_mul_f32 v39, s26, v39
    v_exp_f32 v39, v39
    v_add_f32 v31, v31, v38
    v_sub_f32 v40, v40, v30
    v_mul_f32 v40, s26, v40
    v_exp_f32 v40, v40
    v_add_f32 v31, v31, v39
    v_sub_f32 v41, v41, v30
    v_mul_f32 v41, s26, v41
    v_exp_f32 v41, v41
    v_add_f32 v31, v31, v40
    v_sub_f32 v42, v42, v30
    v_mul_f32 v42, s26, v42
    v_exp_f32 v42, v42
    v_add_f32 v31, v31, v41
    v_sub_f32 v43, v43, v30
    v_mul_f32 v43, s26, v43
    v_exp_f32 v43, v43
    v_add_f32 v31, v31, v42
    v_sub_f32 v44, v44, v30
    v_mul_f32 v44, s26, v44
    v_exp_f32 v44, v44
    v_add_f32 v31, v31, v43
    v_sub_f32 v45, v45, v30
    v_mul_f32 v45, s26, v45
    v_exp_f32 v45, v45
    v_add_f32 v31, v31, v44
    v_sub_f32 v46, v46, v30
    v_mul_f32 v46, s26, v46
    v_exp_f32 v46, v46
    v_add_f32 v31, v31, v45
    v_sub_f32 v47, v47, v30
    v_mul_f32 v47, s26, v47
    v_exp_f32 v47, v47
    v_add_f32 v31, v31, v46
    v_sub_f32 v48, v48, v30
    v_mul_f32 v48, s26, v48
    v_exp_f32 v48, v48
    v_add_f32 v31, v31, v47
    v_sub_f32 v49, v49, v30
    v_mul_f32 v49, s26, v49
    v_exp_f32 v49, v49
    v_add_f32 v31, v31, v48
    v_sub_f32 v50, v50, v30
    v_mul_f32 v50, s26, v50
    v_exp_f32 v50, v50
    v_add_f32 v31, v31, v49
    v_sub_f32 v51, v51, v30
    v_mul_f32 v51, s26, v51
    v_exp_f32 v51, v51
    v_add_f32 v31, v31, v50
    v_sub_f32 v52, v52, v30
    v_mul_f32 v52, s26, v52
    v_exp_f32 v52, v52
    v_add_f32 v31, v31, v51
    v_sub_f32 v53, v53, v30
    v_mul_f32 v53, s26, v53
    v_exp_f32 v53, v53
    v_add_f32 v31, v31, v52
    v_sub_f32 v54, v54, v30
    v_mul_f32 v54, s26, v54
    v_exp_f32 v54, v54
    v_add_f32 v31, v31, v53
    v_sub_f32 v55, v55, v30
    v_mul_f32 v55, s26, v55
    v_exp_f32 v55, v55
    v_add_f32 v31, v31, v54
    v_sub_f32 v56, v56, v30
    v_mul_f32 v56, s26, v56
    v_exp_f32 v56, v56
    v_add_f32 v31, v31, v55
    v_sub_f32 v57, v57, v30
    v_mul_f32 v57, s26, v57
    v_exp_f32 v57, v57
    v_add_f32 v31, v31, v56
    v_sub_f32 v58, v58, v30
    v_mul_f32 v58, s26, v58
    v_exp_f32 v58, v58
    v_add_f32 v31, v31, v57
    v_sub_f32 v59, v59, v30
    v_mul_f32 v59, s26, v59
    v_exp_f32 v59, v59
    v_add_f32 v31, v31, v58
    v_sub_f32 v60, v60, v30
    v_mul_f32 v60, s26, v60
    v_exp_f32 v60, v60
    v_add_f32 v31, v31, v59
    v_sub_f32 v61, v61, v30
    v_mul_f32 v61, s26, v61
    v_exp_f32 v61, v61
    v_add_f32 v31, v31, v60
    v_sub_f32 v62, v62, v30
    v_mul_f32 v62, s26, v62
    v_exp_f32 v62, v62
    v_add_f32 v31, v31, v61
    v_sub_f32 v63, v63, v30
    v_mul_f32 v63, s26, v63
    v_exp_f32 v63, v63
    v_add_f32 v31, v31, v62
    v_sub_f32 v64, v64, v30
    v_mul_f32 v64, s26, v64
    v_exp_f32 v64, v64
    v_add_f32 v31, v31, v63
    v_sub_f32 v65, v65, v30
    v_mul_f32 v65, s26, v65
    v_exp_f32 v65, v65
    v_add_f32 v31, v31, v64
    v_sub_f32 v66, v66, v30
    v_mul_f32 v66, s26, v66
    v_exp_f32 v66, v66
    v_add_f32 v31, v31, v65
    v_sub_f32 v67, v67, v30
    v_mul_f32 v67, s26, v67
    v_exp_f32 v67, v67
    v_add_f32 v31, v31, v66
    v_sub_f32 v68, v68, v30
    v_mul_f32 v68, s26, v68
    v_exp_f32 v68, v68
    v_add_f32 v31, v31, v67
    v_sub_f32 v69, v69, v30
    v_mul_f32 v69, s26, v69
    v_exp_f32 v69, v69
    v_add_f32 v31, v31, v68
    v_sub_f32 v70, v70, v30
    v_mul_f32 v70, s26, v70
    v_exp_f32 v70, v70
    v_add_f32 v31, v31, v69
    v_sub_f32 v71, v71, v30
    v_mul_f32 v71, s26, v71
    v_exp_f32 v71, v71
    v_add_f32 v31, v31, v70
    v_sub_f32 v72, v72, v30
    v_mul_f32 v72, s26, v72
    v_exp_f32 v72, v72
    v_add_f32 v31, v31, v71
    v_sub_f32 v73, v73, v30
    v_mul_f32 v73, s26, v73
    v_exp_f32 v73, v73
    v_add_f32 v31, v31, v72
    v_sub_f32 v74, v74, v30
    v_mul_f32 v74, s26, v74
    v_exp_f32 v74, v74
    v_add_f32 v31, v31, v73
    v_sub_f32 v75, v75, v30
    v_mul_f32 v75, s26, v75
    v_exp_f32 v75, v75
    v_add_f32 v31, v31, v74
    v_sub_f32 v76, v76, v30
    v_mul_f32 v76, s26, v76
    v_exp_f32 v76, v76
    v_add_f32 v31, v31, v75
    v_sub_f32 v77, v77, v30
    v_mul_f32 v77, s26, v77
    v_exp_f32 v77, v77
    v_add_f32 v31, v31, v76
    v_sub_f32 v78, v78, v30
    v_mul_f32 v78, s26, v78
    v_exp_f32 v78, v78
    v_add_f32 v31, v31, v77
    v_sub_f32 v79, v79, v30
    v_mul_f32 v79, s26, v79
    v_exp_f32 v79, v79
    v_add_f32 v31, v31, v78
    v_sub_f32 v80, v80, v30
    v_mul_f32 v80, s26, v80
    v_exp_f32 v80, v80
    v_add_f32 v31, v31, v79
    v_sub_f32 v81, v81, v30
    v_mul_f32 v81, s26, v81
    v_exp_f32 v81, v81
    v_add_f32 v31, v31, v80
    v_sub_f32 v82, v82, v30
    v_mul_f32 v82, s26, v82
    v_exp_f32 v82, v82
    v_add_f32 v31, v31, v81
    v_sub_f32 v83, v83, v30
    v_mul_f32 v83, s26, v83
    v_exp_f32 v83, v83
    v_add_f32 v31, v31, v82
    v_sub_f32 v84, v84, v30
    v_mul_f32 v84, s26, v84
    v_exp_f32 v84, v84
    v_add_f32 v31, v31, v83
    v_sub_f32 v85, v85, v30
    v_mul_f32 v85, s26, v85
    v_exp_f32 v85, v85
    v_add_f32 v31, v31, v84
    v_sub_f32 v86, v86, v30
    v_mul_f32 v86, s26, v86
    v_exp_f32 v86, v86
    v_add_f32 v31, v31, v85
    v_sub_f32 v87, v87, v30
    v_mul_f32 v87, s26, v87
    v_exp_f32 v87, v87
    v_add_f32 v31, v31, v86
    v_sub_f32 v88, v88, v30
    v_mul_f32 v88, s26, v88
    v_exp_f32 v88, v88
    v_add_f32 v31, v31, v87
    v_sub_f32 v89, v89, v30
    v_mul_f32 v89, s26, v89
    v_exp_f32 v89, v89
    v_add_f32 v31, v31, v88
    v_sub_f32 v90, v90, v30
    v_mul_f32 v90, s26, v90
    v_exp_f32 v90, v90
    v_add_f32 v31, v31, v89
    v_sub_f32 v91, v91, v30
    v_mul_f32 v91, s26, v91
    v_exp_f32 v91, v91
    v_add_f32 v31, v31, v90
    v_sub_f32 v92, v92, v30
    v_mul_f32 v92, s26, v92
    v_exp_f32 v92, v92
    v_add_f32 v31, v31, v91
    v_sub_f32 v93, v93, v30
    v_mul_f32 v93, s26, v93
    v_exp_f32 v93, v93
    v_add_f32 v31, v31, v92
    v_sub_f32 v94, v94, v30
    v_mul_f32 v94, s26, v94
    v_exp_f32 v94, v94
    v_add_f32 v31, v31, v93
    v_sub_f32 v95, v95, v30
    v_mul_f32 v95, s26, v95
    v_exp_f32 v95, v95
    v_add_f32 v31, v31, v94
    v_sub_f32 v96, v96, v30
    v_mul_f32 v96, s26, v96
    v_exp_f32 v96, v96
    v_add_f32 v31, v31, v95
    v_sub_f32 v97, v97, v30
    v_mul_f32 v97, s26, v97
    v_exp_f32 v97, v97
    v_add_f32 v31, v31, v96
    v_sub_f32 v98, v98, v30
    v_mul_f32 v98, s26, v98
    v_exp_f32 v98, v98
    v_add_f32 v31, v31, v97
    v_sub_f32 v99, v99, v30
    v_mul_f32 v99, s26, v99
    v_exp_f32 v99, v99
    v_add_f32 v31, v31, v98
    s_nop 0
    v_add_f32 v31, v31, v99
    ds_bpermute_b32 v29, v10, v31
    s_waitcnt lgkmcnt(0)
    v_add_f32 v31, v31, v29
    ds_bpermute_b32 v29, v11, v31
    s_waitcnt lgkmcnt(0)
    v_add_f32 v31, v31, v29
    v_rcp_f32 v31, v31
    s_nop 0
    v_mul_f32 v32, v32, v31
    v_mul_f32 v33, v33, v31
    v_mul_f32 v34, v34, v31
    v_mul_f32 v35, v35, v31
    v_cvt_pk_bf16_f32 v168, v32, v33
    v_cvt_pk_bf16_f32 v169, v34, v35
    v_mul_f32 v36, v36, v31
    v_mul_f32 v37, v37, v31
    v_mul_f32 v38, v38, v31
    v_mul_f32 v39, v39, v31
    v_cvt_pk_bf16_f32 v170, v36, v37
    v_cvt_pk_bf16_f32 v171, v38, v39
    v_mul_f32 v40, v40, v31
    v_mul_f32 v41, v41, v31
    v_mul_f32 v42, v42, v31
    v_mul_f32 v43, v43, v31
    v_cvt_pk_bf16_f32 v172, v40, v41
    v_cvt_pk_bf16_f32 v173, v42, v43
    v_mul_f32 v44, v44, v31
    v_mul_f32 v45, v45, v31
    v_mul_f32 v46, v46, v31
    v_mul_f32 v47, v47, v31
    v_cvt_pk_bf16_f32 v174, v44, v45
    v_cvt_pk_bf16_f32 v175, v46, v47
    v_mul_f32 v48, v48, v31
    v_mul_f32 v49, v49, v31
    v_mul_f32 v50, v50, v31
    v_mul_f32 v51, v51, v31
    v_cvt_pk_bf16_f32 v176, v48, v49
    v_cvt_pk_bf16_f32 v177, v50, v51
    v_mul_f32 v52, v52, v31
    v_mul_f32 v53, v53, v31
    v_mul_f32 v54, v54, v31
    v_mul_f32 v55, v55, v31
    v_cvt_pk_bf16_f32 v178, v52, v53
    v_cvt_pk_bf16_f32 v179, v54, v55
    v_mul_f32 v56, v56, v31
    v_mul_f32 v57, v57, v31
    v_mul_f32 v58, v58, v31
    v_mul_f32 v59, v59, v31
    v_cvt_pk_bf16_f32 v180, v56, v57
    v_cvt_pk_bf16_f32 v181, v58, v59
    v_mul_f32 v60, v60, v31
    v_mul_f32 v61, v61, v31
    v_mul_f32 v62, v62, v31
    v_mul_f32 v63, v63, v31
    v_cvt_pk_bf16_f32 v182, v60, v61
    v_cvt_pk_bf16_f32 v183, v62, v63
    v_mul_f32 v64, v64, v31
    v_mul_f32 v65, v65, v31
    v_mul_f32 v66, v66, v31
    v_mul_f32 v67, v67, v31
    v_cvt_pk_bf16_f32 v184, v64, v65
    v_cvt_pk_bf16_f32 v185, v66, v67
    v_mul_f32 v68, v68, v31
    v_mul_f32 v69, v69, v31
    v_mul_f32 v70, v70, v31
    v_mul_f32 v71, v71, v31
    v_cvt_pk_bf16_f32 v186, v68, v69
    v_cvt_pk_bf16_f32 v187, v70, v71
    v_mul_f32 v72, v72, v31
    v_mul_f32 v73, v73, v31
    v_mul_f32 v74, v74, v31
    v_mul_f32 v75, v75, v31
    v_cvt_pk_bf16_f32 v188, v72, v73
    v_cvt_pk_bf16_f32 v189, v74, v75
    v_mul_f32 v76, v76, v31
    v_mul_f32 v77, v77, v31
    v_mul_f32 v78, v78, v31
    v_mul_f32 v79, v79, v31
    v_cvt_pk_bf16_f32 v190, v76, v77
    v_cvt_pk_bf16_f32 v191, v78, v79
    v_mul_f32 v80, v80, v31
    v_mul_f32 v81, v81, v31
    v_mul_f32 v82, v82, v31
    v_mul_f32 v83, v83, v31
    v_cvt_pk_bf16_f32 v192, v80, v81
    v_cvt_pk_bf16_f32 v193, v82, v83
    v_mul_f32 v84, v84, v31
    v_mul_f32 v85, v85, v31
    v_mul_f32 v86, v86, v31
    v_mul_f32 v87, v87, v31
    v_cvt_pk_bf16_f32 v194, v84, v85
    v_cvt_pk_bf16_f32 v195, v86, v87
    v_mul_f32 v88, v88, v31
    v_mul_f32 v89, v89, v31
    v_mul_f32 v90, v90, v31
    v_mul_f32 v91, v91, v31
    v_cvt_pk_bf16_f32 v196, v88, v89
    v_cvt_pk_bf16_f32 v197, v90, v91
    v_mul_f32 v92, v92, v31
    v_mul_f32 v93, v93, v31
    v_mul_f32 v94, v94, v31
    v_mul_f32 v95, v95, v31
    v_cvt_pk_bf16_f32 v198, v92, v93
    v_cvt_pk_bf16_f32 v199, v94, v95
    v_mul_f32 v96, v96, v31
    v_mul_f32 v97, v97, v31
    v_mul_f32 v98, v98, v31
    v_mul_f32 v99, v99, v31
    v_cvt_pk_bf16_f32 v200, v96, v97
    v_cvt_pk_bf16_f32 v201, v98, v99
    v_mov_b32 v202, 0
    v_mov_b32 v203, 0
    v_cvt_pk_bf16_f32 v28, v100, v101
    v_lshlrev_b32 v100, 16, v28
    v_and_b32 v101, s24, v28
    v_mul_f32 v100, s25, v100
    v_mul_f32 v101, s25, v101
    v_cvt_pk_bf16_f32 v28, v100, v101
    v_lshlrev_b32 v100, 16, v28
    v_and_b32 v101, s24, v28
    v_max_f32 v30, v100, v101
    v_cvt_pk_bf16_f32 v28, v102, v103
    v_lshlrev_b32 v102, 16, v28
    v_and_b32 v103, s24, v28
    v_mul_f32 v102, s25, v102
    v_mul_f32 v103, s25, v103
    v_cvt_pk_bf16_f32 v28, v102, v103
    v_lshlrev_b32 v102, 16, v28
    v_and_b32 v103, s24, v28
    v_max3_f32 v30, v30, v102, v103
    v_cvt_pk_bf16_f32 v28, v104, v105
    v_lshlrev_b32 v104, 16, v28
    v_and_b32 v105, s24, v28
    v_mul_f32 v104, s25, v104
    v_mul_f32 v105, s25, v105
    v_cvt_pk_bf16_f32 v28, v104, v105
    v_lshlrev_b32 v104, 16, v28
    v_and_b32 v105, s24, v28
    v_max3_f32 v30, v30, v104, v105
    v_cvt_pk_bf16_f32 v28, v106, v107
    v_lshlrev_b32 v106, 16, v28
    v_and_b32 v107, s24, v28
    v_mul_f32 v106, s25, v106
    v_mul_f32 v107, s25, v107
    v_cvt_pk_bf16_f32 v28, v106, v107
    v_lshlrev_b32 v106, 16, v28
    v_and_b32 v107, s24, v28
    v_max3_f32 v30, v30, v106, v107
    v_cvt_pk_bf16_f32 v28, v108, v109
    v_lshlrev_b32 v108, 16, v28
    v_and_b32 v109, s24, v28
    v_mul_f32 v108, s25, v108
    v_mul_f32 v109, s25, v109
    v_cvt_pk_bf16_f32 v28, v108, v109
    v_lshlrev_b32 v108, 16, v28
    v_and_b32 v109, s24, v28
    v_max3_f32 v30, v30, v108, v109
    v_cvt_pk_bf16_f32 v28, v110, v111
    v_lshlrev_b32 v110, 16, v28
    v_and_b32 v111, s24, v28
    v_mul_f32 v110, s25, v110
    v_mul_f32 v111, s25, v111
    v_cvt_pk_bf16_f32 v28, v110, v111
    v_lshlrev_b32 v110, 16, v28
    v_and_b32 v111, s24, v28
    v_max3_f32 v30, v30, v110, v111
    v_cvt_pk_bf16_f32 v28, v112, v113
    v_lshlrev_b32 v112, 16, v28
    v_and_b32 v113, s24, v28
    v_mul_f32 v112, s25, v112
    v_mul_f32 v113, s25, v113
    v_cvt_pk_bf16_f32 v28, v112, v113
    v_lshlrev_b32 v112, 16, v28
    v_and_b32 v113, s24, v28
    v_max3_f32 v30, v30, v112, v113
    v_cvt_pk_bf16_f32 v28, v114, v115
    v_lshlrev_b32 v114, 16, v28
    v_and_b32 v115, s24, v28
    v_mul_f32 v114, s25, v114
    v_mul_f32 v115, s25, v115
    v_cvt_pk_bf16_f32 v28, v114, v115
    v_lshlrev_b32 v114, 16, v28
    v_and_b32 v115, s24, v28
    v_max3_f32 v30, v30, v114, v115
    v_cvt_pk_bf16_f32 v28, v116, v117
    v_lshlrev_b32 v116, 16, v28
    v_and_b32 v117, s24, v28
    v_mul_f32 v116, s25, v116
    v_mul_f32 v117, s25, v117
    v_cvt_pk_bf16_f32 v28, v116, v117
    v_lshlrev_b32 v116, 16, v28
    v_and_b32 v117, s24, v28
    v_max3_f32 v30, v30, v116, v117
    v_cvt_pk_bf16_f32 v28, v118, v119
    v_lshlrev_b32 v118, 16, v28
    v_and_b32 v119, s24, v28
    v_mul_f32 v118, s25, v118
    v_mul_f32 v119, s25, v119
    v_cvt_pk_bf16_f32 v28, v118, v119
    v_lshlrev_b32 v118, 16, v28
    v_and_b32 v119, s24, v28
    v_max3_f32 v30, v30, v118, v119
    v_cvt_pk_bf16_f32 v28, v120, v121
    v_lshlrev_b32 v120, 16, v28
    v_and_b32 v121, s24, v28
    v_mul_f32 v120, s25, v120
    v_mul_f32 v121, s25, v121
    v_cvt_pk_bf16_f32 v28, v120, v121
    v_lshlrev_b32 v120, 16, v28
    v_and_b32 v121, s24, v28
    v_max3_f32 v30, v30, v120, v121
    v_cvt_pk_bf16_f32 v28, v122, v123
    v_lshlrev_b32 v122, 16, v28
    v_and_b32 v123, s24, v28
    v_mul_f32 v122, s25, v122
    v_mul_f32 v123, s25, v123
    v_cvt_pk_bf16_f32 v28, v122, v123
    v_lshlrev_b32 v122, 16, v28
    v_and_b32 v123, s24, v28
    v_max3_f32 v30, v30, v122, v123
    v_cvt_pk_bf16_f32 v28, v124, v125
    v_lshlrev_b32 v124, 16, v28
    v_and_b32 v125, s24, v28
    v_mul_f32 v124, s25, v124
    v_mul_f32 v125, s25, v125
    v_cvt_pk_bf16_f32 v28, v124, v125
    v_lshlrev_b32 v124, 16, v28
    v_and_b32 v125, s24, v28
    v_max3_f32 v30, v30, v124, v125
    v_cvt_pk_bf16_f32 v28, v126, v127
    v_lshlrev_b32 v126, 16, v28
    v_and_b32 v127, s24, v28
    v_mul_f32 v126, s25, v126
    v_mul_f32 v127, s25, v127
    v_cvt_pk_bf16_f32 v28, v126, v127
    v_lshlrev_b32 v126, 16, v28
    v_and_b32 v127, s24, v28
    v_max3_f32 v30, v30, v126, v127
    v_cvt_pk_bf16_f32 v28, v128, v129
    v_lshlrev_b32 v128, 16, v28
    v_and_b32 v129, s24, v28
    v_mul_f32 v128, s25, v128
    v_mul_f32 v129, s25, v129
    v_cvt_pk_bf16_f32 v28, v128, v129
    v_lshlrev_b32 v128, 16, v28
    v_and_b32 v129, s24, v28
    v_max3_f32 v30, v30, v128, v129
    v_cvt_pk_bf16_f32 v28, v130, v131
    v_lshlrev_b32 v130, 16, v28
    v_and_b32 v131, s24, v28
    v_mul_f32 v130, s25, v130
    v_mul_f32 v131, s25, v131
    v_cvt_pk_bf16_f32 v28, v130, v131
    v_lshlrev_b32 v130, 16, v28
    v_and_b32 v131, s24, v28
    v_max3_f32 v30, v30, v130, v131
    v_cvt_pk_bf16_f32 v28, v132, v133
    v_lshlrev_b32 v132, 16, v28
    v_and_b32 v133, s24, v28
    v_mul_f32 v132, s25, v132
    v_mul_f32 v133, s25, v133
    v_cvt_pk_bf16_f32 v28, v132, v133
    v_lshlrev_b32 v132, 16, v28
    v_and_b32 v133, s24, v28
    v_max3_f32 v30, v30, v132, v133
    v_cvt_pk_bf16_f32 v28, v134, v135
    v_lshlrev_b32 v134, 16, v28
    v_and_b32 v135, s24, v28
    v_mul_f32 v134, s25, v134
    v_mul_f32 v135, s25, v135
    v_cvt_pk_bf16_f32 v28, v134, v135
    v_lshlrev_b32 v134, 16, v28
    v_and_b32 v135, s24, v28
    v_max3_f32 v30, v30, v134, v135
    v_cvt_pk_bf16_f32 v28, v136, v137
    v_lshlrev_b32 v136, 16, v28
    v_and_b32 v137, s24, v28
    v_mul_f32 v136, s25, v136
    v_mul_f32 v137, s25, v137
    v_cvt_pk_bf16_f32 v28, v136, v137
    v_lshlrev_b32 v136, 16, v28
    v_and_b32 v137, s24, v28
    v_max3_f32 v30, v30, v136, v137
    v_cvt_pk_bf16_f32 v28, v138, v139
    v_lshlrev_b32 v138, 16, v28
    v_and_b32 v139, s24, v28
    v_mul_f32 v138, s25, v138
    v_mul_f32 v139, s25, v139
    v_cvt_pk_bf16_f32 v28, v138, v139
    v_lshlrev_b32 v138, 16, v28
    v_and_b32 v139, s24, v28
    v_max3_f32 v30, v30, v138, v139
    v_cvt_pk_bf16_f32 v28, v140, v141
    v_lshlrev_b32 v140, 16, v28
    v_and_b32 v141, s24, v28
    v_mul_f32 v140, s25, v140
    v_mul_f32 v141, s25, v141
    v_cvt_pk_bf16_f32 v28, v140, v141
    v_lshlrev_b32 v140, 16, v28
    v_and_b32 v141, s24, v28
    v_max3_f32 v30, v30, v140, v141
    v_cvt_pk_bf16_f32 v28, v142, v143
    v_lshlrev_b32 v142, 16, v28
    v_and_b32 v143, s24, v28
    v_mul_f32 v142, s25, v142
    v_mul_f32 v143, s25, v143
    v_cvt_pk_bf16_f32 v28, v142, v143
    v_lshlrev_b32 v142, 16, v28
    v_and_b32 v143, s24, v28
    v_max3_f32 v30, v30, v142, v143
    v_cvt_pk_bf16_f32 v28, v144, v145
    v_lshlrev_b32 v144, 16, v28
    v_and_b32 v145, s24, v28
    v_mul_f32 v144, s25, v144
    v_mul_f32 v145, s25, v145
    v_cvt_pk_bf16_f32 v28, v144, v145
    v_lshlrev_b32 v144, 16, v28
    v_and_b32 v145, s24, v28
    v_max3_f32 v30, v30, v144, v145
    v_cvt_pk_bf16_f32 v28, v146, v147
    v_lshlrev_b32 v146, 16, v28
    v_and_b32 v147, s24, v28
    v_mul_f32 v146, s25, v146
    v_mul_f32 v147, s25, v147
    v_cvt_pk_bf16_f32 v28, v146, v147
    v_lshlrev_b32 v146, 16, v28
    v_and_b32 v147, s24, v28
    v_max3_f32 v30, v30, v146, v147
    v_cvt_pk_bf16_f32 v28, v148, v149
    v_lshlrev_b32 v148, 16, v28
    v_and_b32 v149, s24, v28
    v_mul_f32 v148, s25, v148
    v_mul_f32 v149, s25, v149
    v_cvt_pk_bf16_f32 v28, v148, v149
    v_lshlrev_b32 v148, 16, v28
    v_and_b32 v149, s24, v28
    v_max3_f32 v30, v30, v148, v149
    v_cvt_pk_bf16_f32 v28, v150, v151
    v_lshlrev_b32 v150, 16, v28
    v_and_b32 v151, s24, v28
    v_mul_f32 v150, s25, v150
    v_mul_f32 v151, s25, v151
    v_cvt_pk_bf16_f32 v28, v150, v151
    v_lshlrev_b32 v150, 16, v28
    v_and_b32 v151, s24, v28
    v_max3_f32 v30, v30, v150, v151
    v_cvt_pk_bf16_f32 v28, v152, v153
    v_lshlrev_b32 v152, 16, v28
    v_and_b32 v153, s24, v28
    v_mul_f32 v152, s25, v152
    v_mul_f32 v153, s25, v153
    v_cvt_pk_bf16_f32 v28, v152, v153
    v_lshlrev_b32 v152, 16, v28
    v_and_b32 v153, s24, v28
    v_max3_f32 v30, v30, v152, v153
    v_cvt_pk_bf16_f32 v28, v154, v155
    v_lshlrev_b32 v154, 16, v28
    v_and_b32 v155, s24, v28
    v_mul_f32 v154, s25, v154
    v_mul_f32 v155, s25, v155
    v_cvt_pk_bf16_f32 v28, v154, v155
    v_lshlrev_b32 v154, 16, v28
    v_and_b32 v155, s24, v28
    v_max3_f32 v30, v30, v154, v155
    v_cvt_pk_bf16_f32 v28, v156, v157
    v_lshlrev_b32 v156, 16, v28
    v_and_b32 v157, s24, v28
    v_mul_f32 v156, s25, v156
    v_mul_f32 v157, s25, v157
    v_cvt_pk_bf16_f32 v28, v156, v157
    v_lshlrev_b32 v156, 16, v28
    v_and_b32 v157, s24, v28
    v_max3_f32 v30, v30, v156, v157
    v_cvt_pk_bf16_f32 v28, v158, v159
    v_lshlrev_b32 v158, 16, v28
    v_and_b32 v159, s24, v28
    v_mul_f32 v158, s25, v158
    v_mul_f32 v159, s25, v159
    v_cvt_pk_bf16_f32 v28, v158, v159
    v_lshlrev_b32 v158, 16, v28
    v_and_b32 v159, s24, v28
    v_max3_f32 v30, v30, v158, v159
    v_cvt_pk_bf16_f32 v28, v160, v161
    v_lshlrev_b32 v160, 16, v28
    v_and_b32 v161, s24, v28
    v_mul_f32 v160, s25, v160
    v_mul_f32 v161, s25, v161
    v_cvt_pk_bf16_f32 v28, v160, v161
    v_lshlrev_b32 v160, 16, v28
    v_and_b32 v161, s24, v28
    v_max3_f32 v30, v30, v160, v161
    v_cvt_pk_bf16_f32 v28, v162, v163
    v_lshlrev_b32 v162, 16, v28
    v_and_b32 v163, s24, v28
    v_mul_f32 v162, s25, v162
    v_mul_f32 v163, s25, v163
    v_cvt_pk_bf16_f32 v28, v162, v163
    v_lshlrev_b32 v162, 16, v28
    v_and_b32 v163, s24, v28
    v_max3_f32 v30, v30, v162, v163
    v_cvt_pk_bf16_f32 v28, v164, v165
    v_lshlrev_b32 v164, 16, v28
    v_and_b32 v165, s24, v28
    v_mul_f32 v164, s25, v164
    v_mul_f32 v165, s25, v165
    v_cvt_pk_bf16_f32 v28, v164, v165
    v_lshlrev_b32 v164, 16, v28
    v_and_b32 v165, s24, v28
    v_max3_f32 v30, v30, v164, v165
    v_cvt_pk_bf16_f32 v28, v166, v167
    v_lshlrev_b32 v166, 16, v28
    v_and_b32 v167, s24, v28
    v_mul_f32 v166, s25, v166
    v_mul_f32 v167, s25, v167
    v_cvt_pk_bf16_f32 v28, v166, v167
    v_lshlrev_b32 v166, 16, v28
    v_and_b32 v167, s24, v28
    v_max3_f32 v30, v30, v166, v167
    ds_bpermute_b32 v29, v10, v30
    s_waitcnt lgkmcnt(0)
    v_max_f32 v30, v30, v29
    ds_bpermute_b32 v29, v11, v30
    s_waitcnt lgkmcnt(0)
    v_max_f32 v30, v30, v29
    v_mov_b32 v31, 0
    v_sub_f32 v100, v100, v30
    v_mul_f32 v100, s26, v100
    v_exp_f32 v100, v100
    v_sub_f32 v101, v101, v30
    v_mul_f32 v101, s26, v101
    v_exp_f32 v101, v101
    v_add_f32 v31, v31, v100
    v_sub_f32 v102, v102, v30
    v_mul_f32 v102, s26, v102
    v_exp_f32 v102, v102
    v_add_f32 v31, v31, v101
    v_sub_f32 v103, v103, v30
    v_mul_f32 v103, s26, v103
    v_exp_f32 v103, v103
    v_add_f32 v31, v31, v102
    v_sub_f32 v104, v104, v30
    v_mul_f32 v104, s26, v104
    v_exp_f32 v104, v104
    v_add_f32 v31, v31, v103
    v_sub_f32 v105, v105, v30
    v_mul_f32 v105, s26, v105
    v_exp_f32 v105, v105
    v_add_f32 v31, v31, v104
    v_sub_f32 v106, v106, v30
    v_mul_f32 v106, s26, v106
    v_exp_f32 v106, v106
    v_add_f32 v31, v31, v105
    v_sub_f32 v107, v107, v30
    v_mul_f32 v107, s26, v107
    v_exp_f32 v107, v107
    v_add_f32 v31, v31, v106
    v_sub_f32 v108, v108, v30
    v_mul_f32 v108, s26, v108
    v_exp_f32 v108, v108
    v_add_f32 v31, v31, v107
    v_sub_f32 v109, v109, v30
    v_mul_f32 v109, s26, v109
    v_exp_f32 v109, v109
    v_add_f32 v31, v31, v108
    v_sub_f32 v110, v110, v30
    v_mul_f32 v110, s26, v110
    v_exp_f32 v110, v110
    v_add_f32 v31, v31, v109
    v_sub_f32 v111, v111, v30
    v_mul_f32 v111, s26, v111
    v_exp_f32 v111, v111
    v_add_f32 v31, v31, v110
    v_sub_f32 v112, v112, v30
    v_mul_f32 v112, s26, v112
    v_exp_f32 v112, v112
    v_add_f32 v31, v31, v111
    v_sub_f32 v113, v113, v30
    v_mul_f32 v113, s26, v113
    v_exp_f32 v113, v113
    v_add_f32 v31, v31, v112
    v_sub_f32 v114, v114, v30
    v_mul_f32 v114, s26, v114
    v_exp_f32 v114, v114
    v_add_f32 v31, v31, v113
    v_sub_f32 v115, v115, v30
    v_mul_f32 v115, s26, v115
    v_exp_f32 v115, v115
    v_add_f32 v31, v31, v114
    v_sub_f32 v116, v116, v30
    v_mul_f32 v116, s26, v116
    v_exp_f32 v116, v116
    v_add_f32 v31, v31, v115
    v_sub_f32 v117, v117, v30
    v_mul_f32 v117, s26, v117
    v_exp_f32 v117, v117
    v_add_f32 v31, v31, v116
    v_sub_f32 v118, v118, v30
    v_mul_f32 v118, s26, v118
    v_exp_f32 v118, v118
    v_add_f32 v31, v31, v117
    v_sub_f32 v119, v119, v30
    v_mul_f32 v119, s26, v119
    v_exp_f32 v119, v119
    v_add_f32 v31, v31, v118
    v_sub_f32 v120, v120, v30
    v_mul_f32 v120, s26, v120
    v_exp_f32 v120, v120
    v_add_f32 v31, v31, v119
    v_sub_f32 v121, v121, v30
    v_mul_f32 v121, s26, v121
    v_exp_f32 v121, v121
    v_add_f32 v31, v31, v120
    v_sub_f32 v122, v122, v30
    v_mul_f32 v122, s26, v122
    v_exp_f32 v122, v122
    v_add_f32 v31, v31, v121
    v_sub_f32 v123, v123, v30
    v_mul_f32 v123, s26, v123
    v_exp_f32 v123, v123
    v_add_f32 v31, v31, v122
    v_sub_f32 v124, v124, v30
    v_mul_f32 v124, s26, v124
    v_exp_f32 v124, v124
    v_add_f32 v31, v31, v123
    v_sub_f32 v125, v125, v30
    v_mul_f32 v125, s26, v125
    v_exp_f32 v125, v125
    v_add_f32 v31, v31, v124
    v_sub_f32 v126, v126, v30
    v_mul_f32 v126, s26, v126
    v_exp_f32 v126, v126
    v_add_f32 v31, v31, v125
    v_sub_f32 v127, v127, v30
    v_mul_f32 v127, s26, v127
    v_exp_f32 v127, v127
    v_add_f32 v31, v31, v126
    v_sub_f32 v128, v128, v30
    v_mul_f32 v128, s26, v128
    v_exp_f32 v128, v128
    v_add_f32 v31, v31, v127
    v_sub_f32 v129, v129, v30
    v_mul_f32 v129, s26, v129
    v_exp_f32 v129, v129
    v_add_f32 v31, v31, v128
    v_sub_f32 v130, v130, v30
    v_mul_f32 v130, s26, v130
    v_exp_f32 v130, v130
    v_add_f32 v31, v31, v129
    v_sub_f32 v131, v131, v30
    v_mul_f32 v131, s26, v131
    v_exp_f32 v131, v131
    v_add_f32 v31, v31, v130
    v_sub_f32 v132, v132, v30
    v_mul_f32 v132, s26, v132
    v_exp_f32 v132, v132
    v_add_f32 v31, v31, v131
    v_sub_f32 v133, v133, v30
    v_mul_f32 v133, s26, v133
    v_exp_f32 v133, v133
    v_add_f32 v31, v31, v132
    v_sub_f32 v134, v134, v30
    v_mul_f32 v134, s26, v134
    v_exp_f32 v134, v134
    v_add_f32 v31, v31, v133
    v_sub_f32 v135, v135, v30
    v_mul_f32 v135, s26, v135
    v_exp_f32 v135, v135
    v_add_f32 v31, v31, v134
    v_sub_f32 v136, v136, v30
    v_mul_f32 v136, s26, v136
    v_exp_f32 v136, v136
    v_add_f32 v31, v31, v135
    v_sub_f32 v137, v137, v30
    v_mul_f32 v137, s26, v137
    v_exp_f32 v137, v137
    v_add_f32 v31, v31, v136
    v_sub_f32 v138, v138, v30
    v_mul_f32 v138, s26, v138
    v_exp_f32 v138, v138
    v_add_f32 v31, v31, v137
    v_sub_f32 v139, v139, v30
    v_mul_f32 v139, s26, v139
    v_exp_f32 v139, v139
    v_add_f32 v31, v31, v138
    v_sub_f32 v140, v140, v30
    v_mul_f32 v140, s26, v140
    v_exp_f32 v140, v140
    v_add_f32 v31, v31, v139
    v_sub_f32 v141, v141, v30
    v_mul_f32 v141, s26, v141
    v_exp_f32 v141, v141
    v_add_f32 v31, v31, v140
    v_sub_f32 v142, v142, v30
    v_mul_f32 v142, s26, v142
    v_exp_f32 v142, v142
    v_add_f32 v31, v31, v141
    v_sub_f32 v143, v143, v30
    v_mul_f32 v143, s26, v143
    v_exp_f32 v143, v143
    v_add_f32 v31, v31, v142
    v_sub_f32 v144, v144, v30
    v_mul_f32 v144, s26, v144
    v_exp_f32 v144, v144
    v_add_f32 v31, v31, v143
    v_sub_f32 v145, v145, v30
    v_mul_f32 v145, s26, v145
    v_exp_f32 v145, v145
    v_add_f32 v31, v31, v144
    v_sub_f32 v146, v146, v30
    v_mul_f32 v146, s26, v146
    v_exp_f32 v146, v146
    v_add_f32 v31, v31, v145
    v_sub_f32 v147, v147, v30
    v_mul_f32 v147, s26, v147
    v_exp_f32 v147, v147
    v_add_f32 v31, v31, v146
    v_sub_f32 v148, v148, v30
    v_mul_f32 v148, s26, v148
    v_exp_f32 v148, v148
    v_add_f32 v31, v31, v147
    v_sub_f32 v149, v149, v30
    v_mul_f32 v149, s26, v149
    v_exp_f32 v149, v149
    v_add_f32 v31, v31, v148
    v_sub_f32 v150, v150, v30
    v_mul_f32 v150, s26, v150
    v_exp_f32 v150, v150
    v_add_f32 v31, v31, v149
    v_sub_f32 v151, v151, v30
    v_mul_f32 v151, s26, v151
    v_exp_f32 v151, v151
    v_add_f32 v31, v31, v150
    v_sub_f32 v152, v152, v30
    v_mul_f32 v152, s26, v152
    v_exp_f32 v152, v152
    v_add_f32 v31, v31, v151
    v_sub_f32 v153, v153, v30
    v_mul_f32 v153, s26, v153
    v_exp_f32 v153, v153
    v_add_f32 v31, v31, v152
    v_sub_f32 v154, v154, v30
    v_mul_f32 v154, s26, v154
    v_exp_f32 v154, v154
    v_add_f32 v31, v31, v153
    v_sub_f32 v155, v155, v30
    v_mul_f32 v155, s26, v155
    v_exp_f32 v155, v155
    v_add_f32 v31, v31, v154
    v_sub_f32 v156, v156, v30
    v_mul_f32 v156, s26, v156
    v_exp_f32 v156, v156
    v_add_f32 v31, v31, v155
    v_sub_f32 v157, v157, v30
    v_mul_f32 v157, s26, v157
    v_exp_f32 v157, v157
    v_add_f32 v31, v31, v156
    v_sub_f32 v158, v158, v30
    v_mul_f32 v158, s26, v158
    v_exp_f32 v158, v158
    v_add_f32 v31, v31, v157
    v_sub_f32 v159, v159, v30
    v_mul_f32 v159, s26, v159
    v_exp_f32 v159, v159
    v_add_f32 v31, v31, v158
    v_sub_f32 v160, v160, v30
    v_mul_f32 v160, s26, v160
    v_exp_f32 v160, v160
    v_add_f32 v31, v31, v159
    v_sub_f32 v161, v161, v30
    v_mul_f32 v161, s26, v161
    v_exp_f32 v161, v161
    v_add_f32 v31, v31, v160
    v_sub_f32 v162, v162, v30
    v_mul_f32 v162, s26, v162
    v_exp_f32 v162, v162
    v_add_f32 v31, v31, v161
    v_sub_f32 v163, v163, v30
    v_mul_f32 v163, s26, v163
    v_exp_f32 v163, v163
    v_add_f32 v31, v31, v162
    v_sub_f32 v164, v164, v30
    v_mul_f32 v164, s26, v164
    v_exp_f32 v164, v164
    v_add_f32 v31, v31, v163
    v_sub_f32 v165, v165, v30
    v_mul_f32 v165, s26, v165
    v_exp_f32 v165, v165
    v_add_f32 v31, v31, v164
    v_sub_f32 v166, v166, v30
    v_mul_f32 v166, s26, v166
    v_exp_f32 v166, v166
    v_add_f32 v31, v31, v165
    v_sub_f32 v167, v167, v30
    v_mul_f32 v167, s26, v167
    v_exp_f32 v167, v167
    v_add_f32 v31, v31, v166
    s_nop 0
    v_add_f32 v31, v31, v167
    ds_bpermute_b32 v29, v10, v31
    s_waitcnt lgkmcnt(0)
    v_add_f32 v31, v31, v29
    ds_bpermute_b32 v29, v11, v31
    s_waitcnt lgkmcnt(0)
    v_add_f32 v31, v31, v29
    v_rcp_f32 v31, v31
    s_nop 0
    v_mul_f32 v100, v100, v31
    v_mul_f32 v101, v101, v31
    v_mul_f32 v102, v102, v31
    v_mul_f32 v103, v103, v31
    v_cvt_pk_bf16_f32 v206, v100, v101
    v_cvt_pk_bf16_f32 v207, v102, v103
    v_mul_f32 v104, v104, v31
    v_mul_f32 v105, v105, v31
    v_mul_f32 v106, v106, v31
    v_mul_f32 v107, v107, v31
    v_cvt_pk_bf16_f32 v208, v104, v105
    v_cvt_pk_bf16_f32 v209, v106, v107
    v_mul_f32 v108, v108, v31
    v_mul_f32 v109, v109, v31
    v_mul_f32 v110, v110, v31
    v_mul_f32 v111, v111, v31
    v_cvt_pk_bf16_f32 v210, v108, v109
    v_cvt_pk_bf16_f32 v211, v110, v111
    v_mul_f32 v112, v112, v31
    v_mul_f32 v113, v113, v31
    v_mul_f32 v114, v114, v31
    v_mul_f32 v115, v115, v31
    v_cvt_pk_bf16_f32 v212, v112, v113
    v_cvt_pk_bf16_f32 v213, v114, v115
    v_mul_f32 v116, v116, v31
    v_mul_f32 v117, v117, v31
    v_mul_f32 v118, v118, v31
    v_mul_f32 v119, v119, v31
    v_cvt_pk_bf16_f32 v214, v116, v117
    v_cvt_pk_bf16_f32 v215, v118, v119
    v_mul_f32 v120, v120, v31
    v_mul_f32 v121, v121, v31
    v_mul_f32 v122, v122, v31
    v_mul_f32 v123, v123, v31
    v_cvt_pk_bf16_f32 v216, v120, v121
    v_cvt_pk_bf16_f32 v217, v122, v123
    v_mul_f32 v124, v124, v31
    v_mul_f32 v125, v125, v31
    v_mul_f32 v126, v126, v31
    v_mul_f32 v127, v127, v31
    v_cvt_pk_bf16_f32 v218, v124, v125
    v_cvt_pk_bf16_f32 v219, v126, v127
    v_mul_f32 v128, v128, v31
    v_mul_f32 v129, v129, v31
    v_mul_f32 v130, v130, v31
    v_mul_f32 v131, v131, v31
    v_cvt_pk_bf16_f32 v220, v128, v129
    v_cvt_pk_bf16_f32 v221, v130, v131
    v_mul_f32 v132, v132, v31
    v_mul_f32 v133, v133, v31
    v_mul_f32 v134, v134, v31
    v_mul_f32 v135, v135, v31
    v_cvt_pk_bf16_f32 v222, v132, v133
    v_cvt_pk_bf16_f32 v223, v134, v135
    v_mul_f32 v136, v136, v31
    v_mul_f32 v137, v137, v31
    v_mul_f32 v138, v138, v31
    v_mul_f32 v139, v139, v31
    v_cvt_pk_bf16_f32 v224, v136, v137
    v_cvt_pk_bf16_f32 v225, v138, v139
    v_mul_f32 v140, v140, v31
    v_mul_f32 v141, v141, v31
    v_mul_f32 v142, v142, v31
    v_mul_f32 v143, v143, v31
    v_cvt_pk_bf16_f32 v226, v140, v141
    v_cvt_pk_bf16_f32 v227, v142, v143
    v_mul_f32 v144, v144, v31
    v_mul_f32 v145, v145, v31
    v_mul_f32 v146, v146, v31
    v_mul_f32 v147, v147, v31
    v_cvt_pk_bf16_f32 v228, v144, v145
    v_cvt_pk_bf16_f32 v229, v146, v147
    v_mul_f32 v148, v148, v31
    v_mul_f32 v149, v149, v31
    v_mul_f32 v150, v150, v31
    v_mul_f32 v151, v151, v31
    v_cvt_pk_bf16_f32 v230, v148, v149
    v_cvt_pk_bf16_f32 v231, v150, v151
    v_mul_f32 v152, v152, v31
    v_mul_f32 v153, v153, v31
    v_mul_f32 v154, v154, v31
    v_mul_f32 v155, v155, v31
    v_cvt_pk_bf16_f32 v232, v152, v153
    v_cvt_pk_bf16_f32 v233, v154, v155
    v_mul_f32 v156, v156, v31
    v_mul_f32 v157, v157, v31
    v_mul_f32 v158, v158, v31
    v_mul_f32 v159, v159, v31
    v_cvt_pk_bf16_f32 v234, v156, v157
    v_cvt_pk_bf16_f32 v235, v158, v159
    v_mul_f32 v160, v160, v31
    v_mul_f32 v161, v161, v31
    v_mul_f32 v162, v162, v31
    v_mul_f32 v163, v163, v31
    v_cvt_pk_bf16_f32 v236, v160, v161
    v_cvt_pk_bf16_f32 v237, v162, v163
    v_mul_f32 v164, v164, v31
    v_mul_f32 v165, v165, v31
    v_mul_f32 v166, v166, v31
    v_mul_f32 v167, v167, v31
    v_cvt_pk_bf16_f32 v238, v164, v165
    v_cvt_pk_bf16_f32 v239, v166, v167
    v_mov_b32 v204, 0
    v_mov_b32 v205, 0
    s_nop 1
    v_mfma_f32_16x16x32_bf16 v[32:35], a[72:75], v[168:171], 0
    v_mfma_f32_16x16x32_bf16 v[36:39], a[76:79], v[168:171], 0
    v_mfma_f32_16x16x32_bf16 v[40:43], a[72:75], v[204:207], 0
    v_mfma_f32_16x16x32_bf16 v[44:47], a[76:79], v[204:207], 0
    v_mfma_f32_16x16x32_bf16 v[32:35], a[80:83], v[172:175], v[32:35]
    v_mfma_f32_16x16x32_bf16 v[36:39], a[84:87], v[172:175], v[36:39]
    v_mfma_f32_16x16x32_bf16 v[40:43], a[80:83], v[208:211], v[40:43]
    v_mfma_f32_16x16x32_bf16 v[44:47], a[84:87], v[208:211], v[44:47]
    v_mfma_f32_16x16x32_bf16 v[32:35], a[88:91], v[176:179], v[32:35]
    v_mfma_f32_16x16x32_bf16 v[36:39], a[92:95], v[176:179], v[36:39]
    v_mfma_f32_16x16x32_bf16 v[40:43], a[88:91], v[212:215], v[40:43]
    v_mfma_f32_16x16x32_bf16 v[44:47], a[92:95], v[212:215], v[44:47]
    v_mfma_f32_16x16x32_bf16 v[32:35], a[96:99], v[180:183], v[32:35]
    v_mfma_f32_16x16x32_bf16 v[36:39], a[100:103], v[180:183], v[36:39]
    v_mfma_f32_16x16x32_bf16 v[40:43], a[96:99], v[216:219], v[40:43]
    v_mfma_f32_16x16x32_bf16 v[44:47], a[100:103], v[216:219], v[44:47]
    v_mfma_f32_16x16x32_bf16 v[32:35], a[104:107], v[184:187], v[32:35]
    v_mfma_f32_16x16x32_bf16 v[36:39], a[108:111], v[184:187], v[36:39]
    v_mfma_f32_16x16x32_bf16 v[40:43], a[104:107], v[220:223], v[40:43]
    v_mfma_f32_16x16x32_bf16 v[44:47], a[108:111], v[220:223], v[44:47]
    v_mfma_f32_16x16x32_bf16 v[32:35], a[112:115], v[188:191], v[32:35]
    v_mfma_f32_16x16x32_bf16 v[36:39], a[116:119], v[188:191], v[36:39]
    v_mfma_f32_16x16x32_bf16 v[40:43], a[112:115], v[224:227], v[40:43]
    v_mfma_f32_16x16x32_bf16 v[44:47], a[116:119], v[224:227], v[44:47]
    v_mfma_f32_16x16x32_bf16 v[32:35], a[120:123], v[192:195], v[32:35]
    v_mfma_f32_16x16x32_bf16 v[36:39], a[124:127], v[192:195], v[36:39]
    v_mfma_f32_16x16x32_bf16 v[40:43], a[120:123], v[228:231], v[40:43]
    v_mfma_f32_16x16x32_bf16 v[44:47], a[124:127], v[228:231], v[44:47]
    v_mfma_f32_16x16x32_bf16 v[32:35], a[128:131], v[196:199], v[32:35]
    v_mfma_f32_16x16x32_bf16 v[36:39], a[132:135], v[196:199], v[36:39]
    v_mfma_f32_16x16x32_bf16 v[40:43], a[128:131], v[232:235], v[40:43]
    v_mfma_f32_16x16x32_bf16 v[44:47], a[132:135], v[232:235], v[44:47]
    v_mfma_f32_16x16x32_bf16 v[32:35], a[136:139], v[200:203], v[32:35]
    v_mfma_f32_16x16x32_bf16 v[36:39], a[140:143], v[200:203], v[36:39]
    v_mfma_f32_16x16x32_bf16 v[40:43], a[136:139], v[236:239], v[40:43]
    v_mfma_f32_16x16x32_bf16 v[44:47], a[140:143], v[236:239], v[44:47]
    s_lshl_b32 s24, s5, 11
    s_add_u32 s24, s24, 61243392
    s_nop 7
    s_nop 3
    v_cvt_pk_bf16_f32 v48, v32, v33
    v_cvt_pk_bf16_f32 v49, v34, v35
    v_cvt_pk_bf16_f32 v50, v36, v37
    v_cvt_pk_bf16_f32 v51, v38, v39
    buffer_store_dwordx4 v[48:51], v3, s[8:11], s24 offen offset:0 sc1
    v_cvt_pk_bf16_f32 v52, v40, v41
    v_cvt_pk_bf16_f32 v53, v42, v43
    v_cvt_pk_bf16_f32 v54, v44, v45
    v_cvt_pk_bf16_f32 v55, v46, v47
    buffer_store_dwordx4 v[52:55], v3, s[8:11], s24 offen offset:1024 sc1
    s_lshl_b32 s24, s5, 2
    s_add_u32 s24, s24, 18110464
    v_mov_b32 v8, 1
    v_mov_b32 v9, 0
    s_waitcnt vmcnt(0)
    s_mov_b64 exec, 1
    buffer_store_dword v8, v9, s[8:11], s24 offen sc1
    s_mov_b64 exec, -1
    s_mov_b32 s5, s55
    s_mov_b32 s55, 64
    s_cmp_lt_u32 s5, 64
    s_cbranch_scc1 .a_loop
.a_done:
    s_mul_i32 s5, s53, 3
    s_add_u32 s5, s5, s51
    s_mul_i32 s6, s53, 10
    s_add_u32 s6, s6, s51
    s_add_u32 s6, s6, 9
    s_cmp_lt_u32 s51, 3
    s_cselect_b32 s5, s5, s6
    s_lshl_b32 s5, s5, 4
    s_add_u32 s5, s5, s52
.w3_loop:
    s_lshr_b32 s6, s5, 4
    s_and_b32 s7, s5, 15
    s_mul_i32 s24, s6, 28672
    s_add_u32 s24, s24, 12845056
    s_add_u32 s25, s24, 14336
    s_mul_i32 s28, s7, 401408
    s_add_u32 s28, s28, 0
    s_mul_i32 s38, s6, 28672
    v_mul_u32_u24 v31, 896, v2
    v_lshl_add_u32 v28, v1, 5, v31
    v_lshl_add_u32 v29, v1, 4, v31
    v_lshl_add_u32 v30, v1, 3, v31
    v_mov_b32 v8, 0xf149f2ca
    v_lshl_add_u32 v9, v1, 2, 0
    v_cmp_lt_u32 vcc, v2, v9
    s_nop 1
    v_cndmask_b32 v88, 0, v8, vcc
    v_cndmask_b32 v96, 0, v8, vcc
    v_mov_b32 v92, 0
    v_lshl_add_u32 v9, v1, 2, 1
    v_cmp_lt_u32 vcc, v2, v9
    s_nop 1
    v_cndmask_b32 v89, 0, v8, vcc
    v_cndmask_b32 v97, 0, v8, vcc
    v_mov_b32 v93, 0
    v_lshl_add_u32 v9, v1, 2, 2
    v_cmp_lt_u32 vcc, v2, v9
    s_nop 1
    v_cndmask_b32 v90, 0, v8, vcc
    v_cndmask_b32 v98, 0, v8, vcc
    v_mov_b32 v94, 0
    v_lshl_add_u32 v9, v1, 2, 3
    v_cmp_lt_u32 vcc, v2, v9
    s_nop 1
    v_cndmask_b32 v91, 0, v8, vcc
    v_cndmask_b32 v99, 0, v8, vcc
    v_mov_b32 v95, 0
    s_add_u32 s29, s28, 0
    s_add_u32 s30, s28, 14336
    s_add_u32 s31, s28, 28672
    s_add_u32 s32, s28, 43008
    s_add_u32 s33, s28, 57344
    s_add_u32 s34, s28, 71680
    s_add_u32 s35, s28, 86016
    buffer_load_dwordx4 a[112:115], v4, s[8:11], s24 offen offset:0
    buffer_load_dwordx4 a[116:119], v4, s[8:11], s25 offen offset:0
    buffer_load_dwordx4 a[120:123], v4, s[8:11], s29 offen offset:0
    buffer_load_dwordx4 a[124:127], v4, s[8:11], s30 offen offset:0
    buffer_load_dwordx4 a[128:131], v4, s[8:11], s31 offen offset:0
    buffer_load_dwordx4 a[132:135], v4, s[8:11], s32 offen offset:0
    buffer_load_dwordx4 a[136:139], v4, s[8:11], s33 offen offset:0
    buffer_load_dwordx4 a[140:143], v4, s[8:11], s34 offen offset:0
    buffer_load_dwordx4 a[144:147], v4, s[8:11], s35 offen offset:0
    buffer_load_dwordx4 a[156:159], v4, s[8:11], s24 offen offset:1024
    buffer_load_dwordx4 a[160:163], v4, s[8:11], s25 offen offset:1024
    buffer_load_dwordx4 a[164:167], v4, s[8:11], s29 offen offset:1024
    buffer_load_dwordx4 a[168:171], v4, s[8:11], s30 offen offset:1024
    buffer_load_dwordx4 a[172:175], v4, s[8:11], s31 offen offset:1024
    buffer_load_dwordx4 a[176:179], v4, s[8:11], s32 offen offset:1024
    buffer_load_dwordx4 a[180:183], v4, s[8:11], s33 offen offset:1024
    buffer_load_dwordx4 a[184:187], v4, s[8:11], s34 offen offset:1024
    buffer_load_dwordx4 a[188:191], v4, s[8:11], s35 offen offset:1024
    buffer_load_dwordx4 a[200:203], v4, s[8:11], s24 offen offset:2048
    buffer_load_dwordx4 a[204:207], v4, s[8:11], s25 offen offset:2048
    buffer_load_dwordx4 a[208:211], v4, s[8:11], s29 offen offset:2048
    buffer_load_dwordx4 a[212:215], v4, s[8:11], s30 offen offset:2048
    buffer_load_dwordx4 a[216:219], v4, s[8:11], s31 offen offset:2048
    buffer_load_dwordx4 a[220:223], v4, s[8:11], s32 offen offset:2048
    buffer_load_dwordx4 a[224:227], v4, s[8:11], s33 offen offset:2048
    buffer_load_dwordx4 a[228:231], v4, s[8:11], s34 offen offset:2048
    buffer_load_dwordx4 a[232:235], v4, s[8:11], s35 offen offset:2048
    s_waitcnt vmcnt(18)
    v_mfma_f32_16x16x32_bf16 v[32:35], a[120:123], a[112:115], 0
    v_mfma_f32_16x16x32_bf16 v[36:39], a[120:123], a[116:119], 0
    v_mfma_f32_16x16x32_bf16 v[40:43], a[124:127], a[112:115], 0
    v_mfma_f32_16x16x32_bf16 v[44:47], a[124:127], a[116:119], 0
    v_mfma_f32_16x16x32_bf16 v[48:51], a[128:131], a[112:115], 0
    v_mfma_f32_16x16x32_bf16 v[52:55], a[128:131], a[116:119], 0
    v_mfma_f32_16x16x32_bf16 v[56:59], a[132:135], a[112:115], 0
    v_mfma_f32_16x16x32_bf16 v[60:63], a[132:135], a[116:119], 0
    v_mfma_f32_16x16x32_bf16 v[64:67], a[136:139], a[112:115], 0
    v_mfma_f32_16x16x32_bf16 v[68:71], a[136:139], a[116:119], 0
    v_mfma_f32_16x16x32_bf16 v[72:75], a[140:143], a[112:115], 0
    v_mfma_f32_16x16x32_bf16 v[76:79], a[140:143], a[116:119], 0
    v_mfma_f32_16x16x32_bf16 v[80:83], a[144:147], a[112:115], 0
    v_mfma_f32_16x16x32_bf16 v[84:87], a[144:147], a[116:119], 0
    buffer_load_dwordx4 a[112:115], v4, s[8:11], s24 offen offset:3072
    buffer_load_dwordx4 a[116:119], v4, s[8:11], s25 offen offset:3072
    buffer_load_dwordx4 a[120:123], v4, s[8:11], s29 offen offset:3072
    buffer_load_dwordx4 a[124:127], v4, s[8:11], s30 offen offset:3072
    buffer_load_dwordx4 a[128:131], v4, s[8:11], s31 offen offset:3072
    buffer_load_dwordx4 a[132:135], v4, s[8:11], s32 offen offset:3072
    buffer_load_dwordx4 a[136:139], v4, s[8:11], s33 offen offset:3072
    buffer_load_dwordx4 a[140:143], v4, s[8:11], s34 offen offset:3072
    buffer_load_dwordx4 a[144:147], v4, s[8:11], s35 offen offset:3072
    s_waitcnt vmcnt(18)
    v_mfma_f32_16x16x32_bf16 v[32:35], a[164:167], a[156:159], v[32:35]
    v_mfma_f32_16x16x32_bf16 v[36:39], a[164:167], a[160:163], v[36:39]
    v_mfma_f32_16x16x32_bf16 v[40:43], a[168:171], a[156:159], v[40:43]
    v_mfma_f32_16x16x32_bf16 v[44:47], a[168:171], a[160:163], v[44:47]
    v_mfma_f32_16x16x32_bf16 v[48:51], a[172:175], a[156:159], v[48:51]
    v_mfma_f32_16x16x32_bf16 v[52:55], a[172:175], a[160:163], v[52:55]
    v_mfma_f32_16x16x32_bf16 v[56:59], a[176:179], a[156:159], v[56:59]
    v_mfma_f32_16x16x32_bf16 v[60:63], a[176:179], a[160:163], v[60:63]
    v_mfma_f32_16x16x32_bf16 v[64:67], a[180:183], a[156:159], v[64:67]
    v_mfma_f32_16x16x32_bf16 v[68:71], a[180:183], a[160:163], v[68:71]
    v_mfma_f32_16x16x32_bf16 v[72:75], a[184:187], a[156:159], v[72:75]
    v_mfma_f32_16x16x32_bf16 v[76:79], a[184:187], a[160:163], v[76:79]
    v_mfma_f32_16x16x32_bf16 v[80:83], a[188:191], a[156:159], v[80:83]
    v_mfma_f32_16x16x32_bf16 v[84:87], a[188:191], a[160:163], v[84:87]
    buffer_load_dwordx4 a[156:159], v5, s[8:11], s24 offen offset:0
    buffer_load_dwordx4 a[160:163], v5, s[8:11], s25 offen offset:0
    buffer_load_dwordx4 a[164:167], v5, s[8:11], s29 offen offset:0
    buffer_load_dwordx4 a[168:171], v5, s[8:11], s30 offen offset:0
    buffer_load_dwordx4 a[172:175], v5, s[8:11], s31 offen offset:0
    buffer_load_dwordx4 a[176:179], v5, s[8:11], s32 offen offset:0
    buffer_load_dwordx4 a[180:183], v5, s[8:11], s33 offen offset:0
    buffer_load_dwordx4 a[184:187], v5, s[8:11], s34 offen offset:0
    buffer_load_dwordx4 a[188:191], v5, s[8:11], s35 offen offset:0
    s_waitcnt vmcnt(18)
    v_mfma_f32_16x16x32_bf16 v[32:35], a[208:211], a[200:203], v[32:35]
    v_mfma_f32_16x16x32_bf16 v[36:39], a[208:211], a[204:207], v[36:39]
    v_mfma_f32_16x16x32_bf16 v[40:43], a[212:215], a[200:203], v[40:43]
    v_mfma_f32_16x16x32_bf16 v[44:47], a[212:215], a[204:207], v[44:47]
    v_mfma_f32_16x16x32_bf16 v[48:51], a[216:219], a[200:203], v[48:51]
    v_mfma_f32_16x16x32_bf16 v[52:55], a[216:219], a[204:207], v[52:55]
    v_mfma_f32_16x16x32_bf16 v[56:59], a[220:223], a[200:203], v[56:59]
    v_mfma_f32_16x16x32_bf16 v[60:63], a[220:223], a[204:207], v[60:63]
    v_mfma_f32_16x16x32_bf16 v[64:67], a[224:227], a[200:203], v[64:67]
    v_mfma_f32_16x16x32_bf16 v[68:71], a[224:227], a[204:207], v[68:71]
    v_mfma_f32_16x16x32_bf16 v[72:75], a[228:231], a[200:203], v[72:75]
    v_mfma_f32_16x16x32_bf16 v[76:79], a[228:231], a[204:207], v[76:79]
    v_mfma_f32_16x16x32_bf16 v[80:83], a[232:235], a[200:203], v[80:83]
    v_mfma_f32_16x16x32_bf16 v[84:87], a[232:235], a[204:207], v[84:87]
    buffer_load_dwordx4 a[200:203], v5, s[8:11], s24 offen offset:1024
    buffer_load_dwordx4 a[204:207], v5, s[8:11], s25 offen offset:1024
    buffer_load_dwordx4 a[208:211], v5, s[8:11], s29 offen offset:1024
    buffer_load_dwordx4 a[212:215], v5, s[8:11], s30 offen offset:1024
    buffer_load_dwordx4 a[216:219], v5, s[8:11], s31 offen offset:1024
    buffer_load_dwordx4 a[220:223], v5, s[8:11], s32 offen offset:1024
    buffer_load_dwordx4 a[224:227], v5, s[8:11], s33 offen offset:1024
    buffer_load_dwordx4 a[228:231], v5, s[8:11], s34 offen offset:1024
    buffer_load_dwordx4 a[232:235], v5, s[8:11], s35 offen offset:1024
    s_waitcnt vmcnt(18)
    v_mfma_f32_16x16x32_bf16 v[32:35], a[120:123], a[112:115], v[32:35]
    v_mfma_f32_16x16x32_bf16 v[36:39], a[120:123], a[116:119], v[36:39]
    v_mfma_f32_16x16x32_bf16 v[40:43], a[124:127], a[112:115], v[40:43]
    v_mfma_f32_16x16x32_bf16 v[44:47], a[124:127], a[116:119], v[44:47]
    v_mfma_f32_16x16x32_bf16 v[48:51], a[128:131], a[112:115], v[48:51]
    v_mfma_f32_16x16x32_bf16 v[52:55], a[128:131], a[116:119], v[52:55]
    v_mfma_f32_16x16x32_bf16 v[56:59], a[132:135], a[112:115], v[56:59]
    v_mfma_f32_16x16x32_bf16 v[60:63], a[132:135], a[116:119], v[60:63]
    v_mfma_f32_16x16x32_bf16 v[64:67], a[136:139], a[112:115], v[64:67]
    v_mfma_f32_16x16x32_bf16 v[68:71], a[136:139], a[116:119], v[68:71]
    v_mfma_f32_16x16x32_bf16 v[72:75], a[140:143], a[112:115], v[72:75]
    v_mfma_f32_16x16x32_bf16 v[76:79], a[140:143], a[116:119], v[76:79]
    v_mfma_f32_16x16x32_bf16 v[80:83], a[144:147], a[112:115], v[80:83]
    v_mfma_f32_16x16x32_bf16 v[84:87], a[144:147], a[116:119], v[84:87]
    buffer_load_dwordx4 a[112:115], v5, s[8:11], s24 offen offset:2048
    buffer_load_dwordx4 a[116:119], v5, s[8:11], s25 offen offset:2048
    buffer_load_dwordx4 a[120:123], v5, s[8:11], s29 offen offset:2048
    buffer_load_dwordx4 a[124:127], v5, s[8:11], s30 offen offset:2048
    buffer_load_dwordx4 a[128:131], v5, s[8:11], s31 offen offset:2048
    buffer_load_dwordx4 a[132:135], v5, s[8:11], s32 offen offset:2048
    buffer_load_dwordx4 a[136:139], v5, s[8:11], s33 offen offset:2048
    buffer_load_dwordx4 a[140:143], v5, s[8:11], s34 offen offset:2048
    buffer_load_dwordx4 a[144:147], v5, s[8:11], s35 offen offset:2048
    s_waitcnt vmcnt(18)
    v_mfma_f32_16x16x32_bf16 v[32:35], a[164:167], a[156:159], v[32:35]
    v_mfma_f32_16x16x32_bf16 v[36:39], a[164:167], a[160:163], v[36:39]
    v_mfma_f32_16x16x32_bf16 v[40:43], a[168:171], a[156:159], v[40:43]
    v_mfma_f32_16x16x32_bf16 v[44:47], a[168:171], a[160:163], v[44:47]
    v_mfma_f32_16x16x32_bf16 v[48:51], a[172:175], a[156:159], v[48:51]
    v_mfma_f32_16x16x32_bf16 v[52:55], a[172:175], a[160:163], v[52:55]
    v_mfma_f32_16x16x32_bf16 v[56:59], a[176:179], a[156:159], v[56:59]
    v_mfma_f32_16x16x32_bf16 v[60:63], a[176:179], a[160:163], v[60:63]
    v_mfma_f32_16x16x32_bf16 v[64:67], a[180:183], a[156:159], v[64:67]
    v_mfma_f32_16x16x32_bf16 v[68:71], a[180:183], a[160:163], v[68:71]
    v_mfma_f32_16x16x32_bf16 v[72:75], a[184:187], a[156:159], v[72:75]
    v_mfma_f32_16x16x32_bf16 v[76:79], a[184:187], a[160:163], v[76:79]
    v_mfma_f32_16x16x32_bf16 v[80:83], a[188:191], a[156:159], v[80:83]
    v_mfma_f32_16x16x32_bf16 v[84:87], a[188:191], a[160:163], v[84:87]
    buffer_load_dwordx4 a[156:159], v5, s[8:11], s24 offen offset:3072
    buffer_load_dwordx4 a[160:163], v5, s[8:11], s25 offen offset:3072
    buffer_load_dwordx4 a[164:167], v5, s[8:11], s29 offen offset:3072
    buffer_load_dwordx4 a[168:171], v5, s[8:11], s30 offen offset:3072
    buffer_load_dwordx4 a[172:175], v5, s[8:11], s31 offen offset:3072
    buffer_load_dwordx4 a[176:179], v5, s[8:11], s32 offen offset:3072
    buffer_load_dwordx4 a[180:183], v5, s[8:11], s33 offen offset:3072
    buffer_load_dwordx4 a[184:187], v5, s[8:11], s34 offen offset:3072
    buffer_load_dwordx4 a[188:191], v5, s[8:11], s35 offen offset:3072
    s_waitcnt vmcnt(18)
    v_mfma_f32_16x16x32_bf16 v[32:35], a[208:211], a[200:203], v[32:35]
    v_mfma_f32_16x16x32_bf16 v[36:39], a[208:211], a[204:207], v[36:39]
    v_mfma_f32_16x16x32_bf16 v[40:43], a[212:215], a[200:203], v[40:43]
    v_mfma_f32_16x16x32_bf16 v[44:47], a[212:215], a[204:207], v[44:47]
    v_mfma_f32_16x16x32_bf16 v[48:51], a[216:219], a[200:203], v[48:51]
    v_mfma_f32_16x16x32_bf16 v[52:55], a[216:219], a[204:207], v[52:55]
    v_mfma_f32_16x16x32_bf16 v[56:59], a[220:223], a[200:203], v[56:59]
    v_mfma_f32_16x16x32_bf16 v[60:63], a[220:223], a[204:207], v[60:63]
    v_mfma_f32_16x16x32_bf16 v[64:67], a[224:227], a[200:203], v[64:67]
    v_mfma_f32_16x16x32_bf16 v[68:71], a[224:227], a[204:207], v[68:71]
    v_mfma_f32_16x16x32_bf16 v[72:75], a[228:231], a[200:203], v[72:75]
    v_mfma_f32_16x16x32_bf16 v[76:79], a[228:231], a[204:207], v[76:79]
    v_mfma_f32_16x16x32_bf16 v[80:83], a[232:235], a[200:203], v[80:83]
    v_mfma_f32_16x16x32_bf16 v[84:87], a[232:235], a[204:207], v[84:87]
    buffer_load_dwordx4 a[200:203], v6, s[8:11], s24 offen offset:0
    buffer_load_dwordx4 a[204:207], v6, s[8:11], s25 offen offset:0
    buffer_load_dwordx4 a[208:211], v6, s[8:11], s29 offen offset:0
    buffer_load_dwordx4 a[212:215], v6, s[8:11], s30 offen offset:0
    buffer_load_dwordx4 a[216:219], v6, s[8:11], s31 offen offset:0
    buffer_load_dwordx4 a[220:223], v6, s[8:11], s32 offen offset:0
    buffer_load_dwordx4 a[224:227], v6, s[8:11], s33 offen offset:0
    buffer_load_dwordx4 a[228:231], v6, s[8:11], s34 offen offset:0
    buffer_load_dwordx4 a[232:235], v6, s[8:11], s35 offen offset:0
    s_waitcnt vmcnt(18)
    v_mfma_f32_16x16x32_bf16 v[32:35], a[120:123], a[112:115], v[32:35]
    v_mfma_f32_16x16x32_bf16 v[36:39], a[120:123], a[116:119], v[36:39]
    v_mfma_f32_16x16x32_bf16 v[40:43], a[124:127], a[112:115], v[40:43]
    v_mfma_f32_16x16x32_bf16 v[44:47], a[124:127], a[116:119], v[44:47]
    v_mfma_f32_16x16x32_bf16 v[48:51], a[128:131], a[112:115], v[48:51]
    v_mfma_f32_16x16x32_bf16 v[52:55], a[128:131], a[116:119], v[52:55]
    v_mfma_f32_16x16x32_bf16 v[56:59], a[132:135], a[112:115], v[56:59]
    v_mfma_f32_16x16x32_bf16 v[60:63], a[132:135], a[116:119], v[60:63]
    v_mfma_f32_16x16x32_bf16 v[64:67], a[136:139], a[112:115], v[64:67]
    v_mfma_f32_16x16x32_bf16 v[68:71], a[136:139], a[116:119], v[68:71]
    v_mfma_f32_16x16x32_bf16 v[72:75], a[140:143], a[112:115], v[72:75]
    v_mfma_f32_16x16x32_bf16 v[76:79], a[140:143], a[116:119], v[76:79]
    v_mfma_f32_16x16x32_bf16 v[80:83], a[144:147], a[112:115], v[80:83]
    v_mfma_f32_16x16x32_bf16 v[84:87], a[144:147], a[116:119], v[84:87]
    buffer_load_dwordx4 a[112:115], v6, s[8:11], s24 offen offset:1024
    buffer_load_dwordx4 a[116:119], v6, s[8:11], s25 offen offset:1024
    buffer_load_dwordx4 a[120:123], v6, s[8:11], s29 offen offset:1024
    buffer_load_dwordx4 a[124:127], v6, s[8:11], s30 offen offset:1024
    buffer_load_dwordx4 a[128:131], v6, s[8:11], s31 offen offset:1024
    buffer_load_dwordx4 a[132:135], v6, s[8:11], s32 offen offset:1024
    buffer_load_dwordx4 a[136:139], v6, s[8:11], s33 offen offset:1024
    buffer_load_dwordx4 a[140:143], v6, s[8:11], s34 offen offset:1024
    buffer_load_dwordx4 a[144:147], v6, s[8:11], s35 offen offset:1024
    s_waitcnt vmcnt(18)
    v_mfma_f32_16x16x32_bf16 v[32:35], a[164:167], a[156:159], v[32:35]
    v_mfma_f32_16x16x32_bf16 v[36:39], a[164:167], a[160:163], v[36:39]
    v_mfma_f32_16x16x32_bf16 v[40:43], a[168:171], a[156:159], v[40:43]
    v_mfma_f32_16x16x32_bf16 v[44:47], a[168:171], a[160:163], v[44:47]
    v_mfma_f32_16x16x32_bf16 v[48:51], a[172:175], a[156:159], v[48:51]
    v_mfma_f32_16x16x32_bf16 v[52:55], a[172:175], a[160:163], v[52:55]
    v_mfma_f32_16x16x32_bf16 v[56:59], a[176:179], a[156:159], v[56:59]
    v_mfma_f32_16x16x32_bf16 v[60:63], a[176:179], a[160:163], v[60:63]
    v_mfma_f32_16x16x32_bf16 v[64:67], a[180:183], a[156:159], v[64:67]
    v_mfma_f32_16x16x32_bf16 v[68:71], a[180:183], a[160:163], v[68:71]
    v_mfma_f32_16x16x32_bf16 v[72:75], a[184:187], a[156:159], v[72:75]
    v_mfma_f32_16x16x32_bf16 v[76:79], a[184:187], a[160:163], v[76:79]
    v_mfma_f32_16x16x32_bf16 v[80:83], a[188:191], a[156:159], v[80:83]
    v_mfma_f32_16x16x32_bf16 v[84:87], a[188:191], a[160:163], v[84:87]
    buffer_load_dwordx4 a[156:159], v6, s[8:11], s24 offen offset:2048
    buffer_load_dwordx4 a[160:163], v6, s[8:11], s25 offen offset:2048
    buffer_load_dwordx4 a[164:167], v6, s[8:11], s29 offen offset:2048
    buffer_load_dwordx4 a[168:171], v6, s[8:11], s30 offen offset:2048
    buffer_load_dwordx4 a[172:175], v6, s[8:11], s31 offen offset:2048
    buffer_load_dwordx4 a[176:179], v6, s[8:11], s32 offen offset:2048
    buffer_load_dwordx4 a[180:183], v6, s[8:11], s33 offen offset:2048
    buffer_load_dwordx4 a[184:187], v6, s[8:11], s34 offen offset:2048
    buffer_load_dwordx4 a[188:191], v6, s[8:11], s35 offen offset:2048
    s_waitcnt vmcnt(18)
    v_mfma_f32_16x16x32_bf16 v[32:35], a[208:211], a[200:203], v[32:35]
    v_mfma_f32_16x16x32_bf16 v[36:39], a[208:211], a[204:207], v[36:39]
    v_mfma_f32_16x16x32_bf16 v[40:43], a[212:215], a[200:203], v[40:43]
    v_mfma_f32_16x16x32_bf16 v[44:47], a[212:215], a[204:207], v[44:47]
    v_mfma_f32_16x16x32_bf16 v[48:51], a[216:219], a[200:203], v[48:51]
    v_mfma_f32_16x16x32_bf16 v[52:55], a[216:219], a[204:207], v[52:55]
    v_mfma_f32_16x16x32_bf16 v[56:59], a[220:223], a[200:203], v[56:59]
    v_mfma_f32_16x16x32_bf16 v[60:63], a[220:223], a[204:207], v[60:63]
    v_mfma_f32_16x16x32_bf16 v[64:67], a[224:227], a[200:203], v[64:67]
    v_mfma_f32_16x16x32_bf16 v[68:71], a[224:227], a[204:207], v[68:71]
    v_mfma_f32_16x16x32_bf16 v[72:75], a[228:231], a[200:203], v[72:75]
    v_mfma_f32_16x16x32_bf16 v[76:79], a[228:231], a[204:207], v[76:79]
    v_mfma_f32_16x16x32_bf16 v[80:83], a[232:235], a[200:203], v[80:83]
    v_mfma_f32_16x16x32_bf16 v[84:87], a[232:235], a[204:207], v[84:87]
    buffer_load_dwordx4 a[200:203], v6, s[8:11], s24 offen offset:3072
    buffer_load_dwordx4 a[204:207], v6, s[8:11], s25 offen offset:3072
    buffer_load_dwordx4 a[208:211], v6, s[8:11], s29 offen offset:3072
    buffer_load_dwordx4 a[212:215], v6, s[8:11], s30 offen offset:3072
    buffer_load_dwordx4 a[216:219], v6, s[8:11], s31 offen offset:3072
    buffer_load_dwordx4 a[220:223], v6, s[8:11], s32 offen offset:3072
    buffer_load_dwordx4 a[224:227], v6, s[8:11], s33 offen offset:3072
    buffer_load_dwordx4 a[228:231], v6, s[8:11], s34 offen offset:3072
    buffer_load_dwordx4 a[232:235], v6, s[8:11], s35 offen offset:3072
    s_waitcnt vmcnt(18)
    v_mfma_f32_16x16x32_bf16 v[32:35], a[120:123], a[112:115], v[32:35]
    v_mfma_f32_16x16x32_bf16 v[36:39], a[120:123], a[116:119], v[36:39]
    v_mfma_f32_16x16x32_bf16 v[40:43], a[124:127], a[112:115], v[40:43]
    v_mfma_f32_16x16x32_bf16 v[44:47], a[124:127], a[116:119], v[44:47]
    v_mfma_f32_16x16x32_bf16 v[48:51], a[128:131], a[112:115], v[48:51]
    v_mfma_f32_16x16x32_bf16 v[52:55], a[128:131], a[116:119], v[52:55]
    v_mfma_f32_16x16x32_bf16 v[56:59], a[132:135], a[112:115], v[56:59]
    v_mfma_f32_16x16x32_bf16 v[60:63], a[132:135], a[116:119], v[60:63]
    v_mfma_f32_16x16x32_bf16 v[64:67], a[136:139], a[112:115], v[64:67]
    v_mfma_f32_16x16x32_bf16 v[68:71], a[136:139], a[116:119], v[68:71]
    v_mfma_f32_16x16x32_bf16 v[72:75], a[140:143], a[112:115], v[72:75]
    v_mfma_f32_16x16x32_bf16 v[76:79], a[140:143], a[116:119], v[76:79]
    v_mfma_f32_16x16x32_bf16 v[80:83], a[144:147], a[112:115], v[80:83]
    v_mfma_f32_16x16x32_bf16 v[84:87], a[144:147], a[116:119], v[84:87]
    buffer_load_dwordx4 a[112:115], v7, s[8:11], s24 offen offset:0
    buffer_load_dwordx4 a[116:119], v7, s[8:11], s25 offen offset:0
    buffer_load_dwordx4 a[120:123], v7, s[8:11], s29 offen offset:0
    buffer_load_dwordx4 a[124:127], v7, s[8:11], s30 offen offset:0
    buffer_load_dwordx4 a[128:131], v7, s[8:11], s31 offen offset:0
    buffer_load_dwordx4 a[132:135], v7, s[8:11], s32 offen offset:0
    buffer_load_dwordx4 a[136:139], v7, s[8:11], s33 offen offset:0
    buffer_load_dwordx4 a[140:143], v7, s[8:11], s34 offen offset:0
    buffer_load_dwordx4 a[144:147], v7, s[8:11], s35 offen offset:0
    s_waitcnt vmcnt(18)
    v_mfma_f32_16x16x32_bf16 v[32:35], a[164:167], a[156:159], v[32:35]
    v_mfma_f32_16x16x32_bf16 v[36:39], a[164:167], a[160:163], v[36:39]
    v_mfma_f32_16x16x32_bf16 v[40:43], a[168:171], a[156:159], v[40:43]
    v_mfma_f32_16x16x32_bf16 v[44:47], a[168:171], a[160:163], v[44:47]
    v_mfma_f32_16x16x32_bf16 v[48:51], a[172:175], a[156:159], v[48:51]
    v_mfma_f32_16x16x32_bf16 v[52:55], a[172:175], a[160:163], v[52:55]
    v_mfma_f32_16x16x32_bf16 v[56:59], a[176:179], a[156:159], v[56:59]
    v_mfma_f32_16x16x32_bf16 v[60:63], a[176:179], a[160:163], v[60:63]
    v_mfma_f32_16x16x32_bf16 v[64:67], a[180:183], a[156:159], v[64:67]
    v_mfma_f32_16x16x32_bf16 v[68:71], a[180:183], a[160:163], v[68:71]
    v_mfma_f32_16x16x32_bf16 v[72:75], a[184:187], a[156:159], v[72:75]
    v_mfma_f32_16x16x32_bf16 v[76:79], a[184:187], a[160:163], v[76:79]
    v_mfma_f32_16x16x32_bf16 v[80:83], a[188:191], a[156:159], v[80:83]
    v_mfma_f32_16x16x32_bf16 v[84:87], a[188:191], a[160:163], v[84:87]
    buffer_load_dwordx4 a[156:159], v7, s[8:11], s24 offen offset:1024
    buffer_load_dwordx4 a[160:163], v7, s[8:11], s25 offen offset:1024
    buffer_load_dwordx4 a[164:167], v7, s[8:11], s29 offen offset:1024
    buffer_load_dwordx4 a[168:171], v7, s[8:11], s30 offen offset:1024
    buffer_load_dwordx4 a[172:175], v7, s[8:11], s31 offen offset:1024
    buffer_load_dwordx4 a[176:179], v7, s[8:11], s32 offen offset:1024
    buffer_load_dwordx4 a[180:183], v7, s[8:11], s33 offen offset:1024
    buffer_load_dwordx4 a[184:187], v7, s[8:11], s34 offen offset:1024
    buffer_load_dwordx4 a[188:191], v7, s[8:11], s35 offen offset:1024
    s_waitcnt vmcnt(18)
    v_mfma_f32_16x16x32_bf16 v[32:35], a[208:211], a[200:203], v[32:35]
    v_mfma_f32_16x16x32_bf16 v[36:39], a[208:211], a[204:207], v[36:39]
    v_mfma_f32_16x16x32_bf16 v[40:43], a[212:215], a[200:203], v[40:43]
    v_mfma_f32_16x16x32_bf16 v[44:47], a[212:215], a[204:207], v[44:47]
    v_mfma_f32_16x16x32_bf16 v[48:51], a[216:219], a[200:203], v[48:51]
    v_mfma_f32_16x16x32_bf16 v[52:55], a[216:219], a[204:207], v[52:55]
    v_mfma_f32_16x16x32_bf16 v[56:59], a[220:223], a[200:203], v[56:59]
    v_mfma_f32_16x16x32_bf16 v[60:63], a[220:223], a[204:207], v[60:63]
    v_mfma_f32_16x16x32_bf16 v[64:67], a[224:227], a[200:203], v[64:67]
    v_mfma_f32_16x16x32_bf16 v[68:71], a[224:227], a[204:207], v[68:71]
    v_mfma_f32_16x16x32_bf16 v[72:75], a[228:231], a[200:203], v[72:75]
    v_mfma_f32_16x16x32_bf16 v[76:79], a[228:231], a[204:207], v[76:79]
    v_mfma_f32_16x16x32_bf16 v[80:83], a[232:235], a[200:203], v[80:83]
    v_mfma_f32_16x16x32_bf16 v[84:87], a[232:235], a[204:207], v[84:87]
    s_waitcnt vmcnt(9)
    v_mfma_f32_16x16x32_bf16 v[32:35], a[120:123], a[112:115], v[32:35]
    v_mfma_f32_16x16x32_bf16 v[36:39], a[120:123], a[116:119], v[36:39]
    v_mfma_f32_16x16x32_bf16 v[40:43], a[124:127], a[112:115], v[40:43]
    v_mfma_f32_16x16x32_bf16 v[44:47], a[124:127], a[116:119], v[44:47]
    v_mfma_f32_16x16x32_bf16 v[48:51], a[128:131], a[112:115], v[48:51]
    v_mfma_f32_16x16x32_bf16 v[52:55], a[128:131], a[116:119], v[52:55]
    v_mfma_f32_16x16x32_bf16 v[56:59], a[132:135], a[112:115], v[56:59]
    v_mfma_f32_16x16x32_bf16 v[60:63], a[132:135], a[116:119], v[60:63]
    v_mfma_f32_16x16x32_bf16 v[64:67], a[136:139], a[112:115], v[64:67]
    v_mfma_f32_16x16x32_bf16 v[68:71], a[136:139], a[116:119], v[68:71]
    v_mfma_f32_16x16x32_bf16 v[72:75], a[140:143], a[112:115], v[72:75]
    v_mfma_f32_16x16x32_bf16 v[76:79], a[140:143], a[116:119], v[76:79]
    v_mfma_f32_16x16x32_bf16 v[80:83], a[144:147], a[112:115], v[80:83]
    v_mfma_f32_16x16x32_bf16 v[84:87], a[144:147], a[116:119], v[84:87]
    s_waitcnt vmcnt(0)
    v_mfma_f32_16x16x32_bf16 v[32:35], a[164:167], a[156:159], v[32:35]
    v_mfma_f32_16x16x32_bf16 v[36:39], a[164:167], a[160:163], v[36:39]
    v_mfma_f32_16x16x32_bf16 v[40:43], a[168:171], a[156:159], v[40:43]
    v_mfma_f32_16x16x32_bf16 v[44:47], a[168:171], a[160:163], v[44:47]
    v_mfma_f32_16x16x32_bf16 v[48:51], a[172:175], a[156:159], v[48:51]
    v_mfma_f32_16x16x32_bf16 v[52:55], a[172:175], a[160:163], v[52:55]
    v_mfma_f32_16x16x32_bf16 v[56:59], a[176:179], a[156:159], v[56:59]
    v_mfma_f32_16x16x32_bf16 v[60:63], a[176:179], a[160:163], v[60:63]
    v_mfma_f32_16x16x32_bf16 v[64:67], a[180:183], a[156:159], v[64:67]
    v_mfma_f32_16x16x32_bf16 v[68:71], a[180:183], a[160:163], v[68:71]
    v_mfma_f32_16x16x32_bf16 v[72:75], a[184:187], a[156:159], v[72:75]
    v_mfma_f32_16x16x32_bf16 v[76:79], a[184:187], a[160:163], v[76:79]
    v_mfma_f32_16x16x32_bf16 v[80:83], a[188:191], a[156:159], v[80:83]
    v_mfma_f32_16x16x32_bf16 v[84:87], a[188:191], a[160:163], v[84:87]
    s_nop 7
    s_nop 3
    s_add_u32 s39, s38, 14336
    buffer_load_dwordx4 v[100:103], v28, s[12:15], s38 offen offset:0
    buffer_load_dwordx4 v[104:107], v28, s[12:15], s38 offen offset:16
    buffer_load_dwordx4 v[108:111], v29, s[12:15], s38 offen offset:128
    buffer_load_dwordx2 v[112:113], v30, s[12:15], s38 offen offset:192
    buffer_load_dwordx4 v[114:117], v28, s[12:15], s39 offen offset:0
    buffer_load_dwordx4 v[118:121], v28, s[12:15], s39 offen offset:16
    buffer_load_dwordx4 v[122:125], v29, s[12:15], s39 offen offset:128
    buffer_load_dwordx2 v[126:127], v30, s[12:15], s39 offen offset:192
    v_cvt_pk_bf16_f32 v128, v32, v40
    v_cvt_pk_bf16_f32 v129, v34, v42
    v_cvt_pk_bf16_f32 v130, v48, v56
    v_cvt_pk_bf16_f32 v131, v50, v58
    v_cvt_pk_bf16_f32 v132, v33, v41
    v_cvt_pk_bf16_f32 v133, v35, v43
    v_cvt_pk_bf16_f32 v134, v49, v57
    v_cvt_pk_bf16_f32 v135, v51, v59
    v_cvt_pk_bf16_f32 v136, v64, v72
    v_cvt_pk_bf16_f32 v137, v65, v73
    v_cvt_pk_bf16_f32 v138, v66, v74
    v_cvt_pk_bf16_f32 v139, v67, v75
    v_cvt_pk_bf16_f32 v140, v80, v81
    v_cvt_pk_bf16_f32 v141, v82, v83
    v_accvgpr_write_b32 a0, v128
    v_accvgpr_write_b32 a1, v129
    v_accvgpr_write_b32 a2, v130
    v_accvgpr_write_b32 a3, v131
    v_accvgpr_write_b32 a4, v132
    v_accvgpr_write_b32 a5, v133
    v_accvgpr_write_b32 a6, v134
    v_accvgpr_write_b32 a7, v135
    v_accvgpr_write_b32 a8, v136
    v_accvgpr_write_b32 a9, v137
    v_accvgpr_write_b32 a10, v138
    v_accvgpr_write_b32 a11, v139
    v_accvgpr_write_b32 a12, v140
    v_accvgpr_write_b32 a13, v141
    v_cvt_pk_bf16_f32 v128, v36, v44
    v_cvt_pk_bf16_f32 v129, v38, v46
    v_cvt_pk_bf16_f32 v130, v52, v60
    v_cvt_pk_bf16_f32 v131, v54, v62
    v_cvt_pk_bf16_f32 v132, v37, v45
    v_cvt_pk_bf16_f32 v133, v39, v47
    v_cvt_pk_bf16_f32 v134, v53, v61
    v_cvt_pk_bf16_f32 v135, v55, v63
    v_cvt_pk_bf16_f32 v136, v68, v76
    v_cvt_pk_bf16_f32 v137, v69, v77
    v_cvt_pk_bf16_f32 v138, v70, v78
    v_cvt_pk_bf16_f32 v139, v71, v79
    v_cvt_pk_bf16_f32 v140, v84, v85
    v_cvt_pk_bf16_f32 v141, v86, v87
    v_accvgpr_write_b32 a14, v128
    v_accvgpr_write_b32 a15, v129
    v_accvgpr_write_b32 a16, v130
    v_accvgpr_write_b32 a17, v131
    v_accvgpr_write_b32 a18, v132
    v_accvgpr_write_b32 a19, v133
    v_accvgpr_write_b32 a20, v134
    v_accvgpr_write_b32 a21, v135
    v_accvgpr_write_b32 a22, v136
    v_accvgpr_write_b32 a23, v137
    v_accvgpr_write_b32 a24, v138
    v_accvgpr_write_b32 a25, v139
    v_accvgpr_write_b32 a26, v140
    v_accvgpr_write_b32 a27, v141
    s_waitcnt vmcnt(0)
    s_nop 1
    v_mfma_f32_16x16x32_bf16 v[88:91], v[100:103], a[0:3], v[88:91]
    v_mfma_f32_16x16x32_bf16 v[92:95], v[100:103], a[14:17], v[92:95]
    v_mfma_f32_16x16x32_bf16 v[96:99], v[114:117], a[14:17], v[96:99]
    v_mfma_f32_16x16x32_bf16 v[88:91], v[104:107], a[4:7], v[88:91]
    v_mfma_f32_16x16x32_bf16 v[92:95], v[104:107], a[18:21], v[92:95]
    v_mfma_f32_16x16x32_bf16 v[96:99], v[118:121], a[18:21], v[96:99]
    v_mfma_f32_16x16x32_bf16 v[88:91], v[108:111], a[8:11], v[88:91]
    v_mfma_f32_16x16x32_bf16 v[92:95], v[108:111], a[22:25], v[92:95]
    v_mfma_f32_16x16x32_bf16 v[96:99], v[122:125], a[22:25], v[96:99]
    s_nop 4
    v_mfma_f32_16x16x16_bf16 v[88:91], v[112:113], a[12:13], v[88:91]
    v_mfma_f32_16x16x16_bf16 v[92:95], v[112:113], a[26:27], v[92:95]
    v_mfma_f32_16x16x16_bf16 v[96:99], v[126:127], a[26:27], v[96:99]
    s_add_u32 s29, s28, 100352
    s_add_u32 s30, s28, 114688
    s_add_u32 s31, s28, 129024
    s_add_u32 s32, s28, 143360
    s_add_u32 s33, s28, 157696
    s_add_u32 s34, s28, 172032
    s_add_u32 s35, s28, 186368
    buffer_load_dwordx4 a[112:115], v4, s[8:11], s24 offen offset:0
    buffer_load_dwordx4 a[116:119], v4, s[8:11], s25 offen offset:0
    buffer_load_dwordx4 a[120:123], v4, s[8:11], s29 offen offset:0
    buffer_load_dwordx4 a[124:127], v4, s[8:11], s30 offen offset:0
    buffer_load_dwordx4 a[128:131], v4, s[8:11], s31 offen offset:0
    buffer_load_dwordx4 a[132:135], v4, s[8:11], s32 offen offset:0
    buffer_load_dwordx4 a[136:139], v4, s[8:11], s33 offen offset:0
    buffer_load_dwordx4 a[140:143], v4, s[8:11], s34 offen offset:0
    buffer_load_dwordx4 a[144:147], v4, s[8:11], s35 offen offset:0
    buffer_load_dwordx4 a[156:159], v4, s[8:11], s24 offen offset:1024
    buffer_load_dwordx4 a[160:163], v4, s[8:11], s25 offen offset:1024
    buffer_load_dwordx4 a[164:167], v4, s[8:11], s29 offen offset:1024
    buffer_load_dwordx4 a[168:171], v4, s[8:11], s30 offen offset:1024
    buffer_load_dwordx4 a[172:175], v4, s[8:11], s31 offen offset:1024
    buffer_load_dwordx4 a[176:179], v4, s[8:11], s32 offen offset:1024
    buffer_load_dwordx4 a[180:183], v4, s[8:11], s33 offen offset:1024
    buffer_load_dwordx4 a[184:187], v4, s[8:11], s34 offen offset:1024
    buffer_load_dwordx4 a[188:191], v4, s[8:11], s35 offen offset:1024
    buffer_load_dwordx4 a[200:203], v4, s[8:11], s24 offen offset:2048
    buffer_load_dwordx4 a[204:207], v4, s[8:11], s25 offen offset:2048
    buffer_load_dwordx4 a[208:211], v4, s[8:11], s29 offen offset:2048
    buffer_load_dwordx4 a[212:215], v4, s[8:11], s30 offen offset:2048
    buffer_load_dwordx4 a[216:219], v4, s[8:11], s31 offen offset:2048
    buffer_load_dwordx4 a[220:223], v4, s[8:11], s32 offen offset:2048
    buffer_load_dwordx4 a[224:227], v4, s[8:11], s33 offen offset:2048
    buffer_load_dwordx4 a[228:231], v4, s[8:11], s34 offen offset:2048
    buffer_load_dwordx4 a[232:235], v4, s[8:11], s35 offen offset:2048
    s_waitcnt vmcnt(18)
    v_mfma_f32_16x16x32_bf16 v[32:35], a[120:123], a[112:115], 0
    v_mfma_f32_16x16x32_bf16 v[36:39], a[120:123], a[116:119], 0
    v_mfma_f32_16x16x32_bf16 v[40:43], a[124:127], a[112:115], 0
    v_mfma_f32_16x16x32_bf16 v[44:47], a[124:127], a[116:119], 0
    v_mfma_f32_16x16x32_bf16 v[48:51], a[128:131], a[112:115], 0
    v_mfma_f32_16x16x32_bf16 v[52:55], a[128:131], a[116:119], 0
    v_mfma_f32_16x16x32_bf16 v[56:59], a[132:135], a[112:115], 0
    v_mfma_f32_16x16x32_bf16 v[60:63], a[132:135], a[116:119], 0
    v_mfma_f32_16x16x32_bf16 v[64:67], a[136:139], a[112:115], 0
    v_mfma_f32_16x16x32_bf16 v[68:71], a[136:139], a[116:119], 0
    v_mfma_f32_16x16x32_bf16 v[72:75], a[140:143], a[112:115], 0
    v_mfma_f32_16x16x32_bf16 v[76:79], a[140:143], a[116:119], 0
    v_mfma_f32_16x16x32_bf16 v[80:83], a[144:147], a[112:115], 0
    v_mfma_f32_16x16x32_bf16 v[84:87], a[144:147], a[116:119], 0
    buffer_load_dwordx4 a[112:115], v4, s[8:11], s24 offen offset:3072
    buffer_load_dwordx4 a[116:119], v4, s[8:11], s25 offen offset:3072
    buffer_load_dwordx4 a[120:123], v4, s[8:11], s29 offen offset:3072
    buffer_load_dwordx4 a[124:127], v4, s[8:11], s30 offen offset:3072
    buffer_load_dwordx4 a[128:131], v4, s[8:11], s31 offen offset:3072
    buffer_load_dwordx4 a[132:135], v4, s[8:11], s32 offen offset:3072
    buffer_load_dwordx4 a[136:139], v4, s[8:11], s33 offen offset:3072
    buffer_load_dwordx4 a[140:143], v4, s[8:11], s34 offen offset:3072
    buffer_load_dwordx4 a[144:147], v4, s[8:11], s35 offen offset:3072
    s_waitcnt vmcnt(18)
    v_mfma_f32_16x16x32_bf16 v[32:35], a[164:167], a[156:159], v[32:35]
    v_mfma_f32_16x16x32_bf16 v[36:39], a[164:167], a[160:163], v[36:39]
    v_mfma_f32_16x16x32_bf16 v[40:43], a[168:171], a[156:159], v[40:43]
    v_mfma_f32_16x16x32_bf16 v[44:47], a[168:171], a[160:163], v[44:47]
    v_mfma_f32_16x16x32_bf16 v[48:51], a[172:175], a[156:159], v[48:51]
    v_mfma_f32_16x16x32_bf16 v[52:55], a[172:175], a[160:163], v[52:55]
    v_mfma_f32_16x16x32_bf16 v[56:59], a[176:179], a[156:159], v[56:59]
    v_mfma_f32_16x16x32_bf16 v[60:63], a[176:179], a[160:163], v[60:63]
    v_mfma_f32_16x16x32_bf16 v[64:67], a[180:183], a[156:159], v[64:67]
    v_mfma_f32_16x16x32_bf16 v[68:71], a[180:183], a[160:163], v[68:71]
    v_mfma_f32_16x16x32_bf16 v[72:75], a[184:187], a[156:159], v[72:75]
    v_mfma_f32_16x16x32_bf16 v[76:79], a[184:187], a[160:163], v[76:79]
    v_mfma_f32_16x16x32_bf16 v[80:83], a[188:191], a[156:159], v[80:83]
    v_mfma_f32_16x16x32_bf16 v[84:87], a[188:191], a[160:163], v[84:87]
    buffer_load_dwordx4 a[156:159], v5, s[8:11], s24 offen offset:0
    buffer_load_dwordx4 a[160:163], v5, s[8:11], s25 offen offset:0
    buffer_load_dwordx4 a[164:167], v5, s[8:11], s29 offen offset:0
    buffer_load_dwordx4 a[168:171], v5, s[8:11], s30 offen offset:0
    buffer_load_dwordx4 a[172:175], v5, s[8:11], s31 offen offset:0
    buffer_load_dwordx4 a[176:179], v5, s[8:11], s32 offen offset:0
    buffer_load_dwordx4 a[180:183], v5, s[8:11], s33 offen offset:0
    buffer_load_dwordx4 a[184:187], v5, s[8:11], s34 offen offset:0
    buffer_load_dwordx4 a[188:191], v5, s[8:11], s35 offen offset:0
    s_waitcnt vmcnt(18)
    v_mfma_f32_16x16x32_bf16 v[32:35], a[208:211], a[200:203], v[32:35]
    v_mfma_f32_16x16x32_bf16 v[36:39], a[208:211], a[204:207], v[36:39]
    v_mfma_f32_16x16x32_bf16 v[40:43], a[212:215], a[200:203], v[40:43]
    v_mfma_f32_16x16x32_bf16 v[44:47], a[212:215], a[204:207], v[44:47]
    v_mfma_f32_16x16x32_bf16 v[48:51], a[216:219], a[200:203], v[48:51]
    v_mfma_f32_16x16x32_bf16 v[52:55], a[216:219], a[204:207], v[52:55]
    v_mfma_f32_16x16x32_bf16 v[56:59], a[220:223], a[200:203], v[56:59]
    v_mfma_f32_16x16x32_bf16 v[60:63], a[220:223], a[204:207], v[60:63]
    v_mfma_f32_16x16x32_bf16 v[64:67], a[224:227], a[200:203], v[64:67]
    v_mfma_f32_16x16x32_bf16 v[68:71], a[224:227], a[204:207], v[68:71]
    v_mfma_f32_16x16x32_bf16 v[72:75], a[228:231], a[200:203], v[72:75]
    v_mfma_f32_16x16x32_bf16 v[76:79], a[228:231], a[204:207], v[76:79]
    v_mfma_f32_16x16x32_bf16 v[80:83], a[232:235], a[200:203], v[80:83]
    v_mfma_f32_16x16x32_bf16 v[84:87], a[232:235], a[204:207], v[84:87]
    buffer_load_dwordx4 a[200:203], v5, s[8:11], s24 offen offset:1024
    buffer_load_dwordx4 a[204:207], v5, s[8:11], s25 offen offset:1024
    buffer_load_dwordx4 a[208:211], v5, s[8:11], s29 offen offset:1024
    buffer_load_dwordx4 a[212:215], v5, s[8:11], s30 offen offset:1024
    buffer_load_dwordx4 a[216:219], v5, s[8:11], s31 offen offset:1024
    buffer_load_dwordx4 a[220:223], v5, s[8:11], s32 offen offset:1024
    buffer_load_dwordx4 a[224:227], v5, s[8:11], s33 offen offset:1024
    buffer_load_dwordx4 a[228:231], v5, s[8:11], s34 offen offset:1024
    buffer_load_dwordx4 a[232:235], v5, s[8:11], s35 offen offset:1024
    s_waitcnt vmcnt(18)
    v_mfma_f32_16x16x32_bf16 v[32:35], a[120:123], a[112:115], v[32:35]
    v_mfma_f32_16x16x32_bf16 v[36:39], a[120:123], a[116:119], v[36:39]
    v_mfma_f32_16x16x32_bf16 v[40:43], a[124:127], a[112:115], v[40:43]
    v_mfma_f32_16x16x32_bf16 v[44:47], a[124:127], a[116:119], v[44:47]
    v_mfma_f32_16x16x32_bf16 v[48:51], a[128:131], a[112:115], v[48:51]
    v_mfma_f32_16x16x32_bf16 v[52:55], a[128:131], a[116:119], v[52:55]
    v_mfma_f32_16x16x32_bf16 v[56:59], a[132:135], a[112:115], v[56:59]
    v_mfma_f32_16x16x32_bf16 v[60:63], a[132:135], a[116:119], v[60:63]
    v_mfma_f32_16x16x32_bf16 v[64:67], a[136:139], a[112:115], v[64:67]
    v_mfma_f32_16x16x32_bf16 v[68:71], a[136:139], a[116:119], v[68:71]
    v_mfma_f32_16x16x32_bf16 v[72:75], a[140:143], a[112:115], v[72:75]
    v_mfma_f32_16x16x32_bf16 v[76:79], a[140:143], a[116:119], v[76:79]
    v_mfma_f32_16x16x32_bf16 v[80:83], a[144:147], a[112:115], v[80:83]
    v_mfma_f32_16x16x32_bf16 v[84:87], a[144:147], a[116:119], v[84:87]
    buffer_load_dwordx4 a[112:115], v5, s[8:11], s24 offen offset:2048
    buffer_load_dwordx4 a[116:119], v5, s[8:11], s25 offen offset:2048
    buffer_load_dwordx4 a[120:123], v5, s[8:11], s29 offen offset:2048
    buffer_load_dwordx4 a[124:127], v5, s[8:11], s30 offen offset:2048
    buffer_load_dwordx4 a[128:131], v5, s[8:11], s31 offen offset:2048
    buffer_load_dwordx4 a[132:135], v5, s[8:11], s32 offen offset:2048
    buffer_load_dwordx4 a[136:139], v5, s[8:11], s33 offen offset:2048
    buffer_load_dwordx4 a[140:143], v5, s[8:11], s34 offen offset:2048
    buffer_load_dwordx4 a[144:147], v5, s[8:11], s35 offen offset:2048
    s_waitcnt vmcnt(18)
    v_mfma_f32_16x16x32_bf16 v[32:35], a[164:167], a[156:159], v[32:35]
    v_mfma_f32_16x16x32_bf16 v[36:39], a[164:167], a[160:163], v[36:39]
    v_mfma_f32_16x16x32_bf16 v[40:43], a[168:171], a[156:159], v[40:43]
    v_mfma_f32_16x16x32_bf16 v[44:47], a[168:171], a[160:163], v[44:47]
    v_mfma_f32_16x16x32_bf16 v[48:51], a[172:175], a[156:159], v[48:51]
    v_mfma_f32_16x16x32_bf16 v[52:55], a[172:175], a[160:163], v[52:55]
    v_mfma_f32_16x16x32_bf16 v[56:59], a[176:179], a[156:159], v[56:59]
    v_mfma_f32_16x16x32_bf16 v[60:63], a[176:179], a[160:163], v[60:63]
    v_mfma_f32_16x16x32_bf16 v[64:67], a[180:183], a[156:159], v[64:67]
    v_mfma_f32_16x16x32_bf16 v[68:71], a[180:183], a[160:163], v[68:71]
    v_mfma_f32_16x16x32_bf16 v[72:75], a[184:187], a[156:159], v[72:75]
    v_mfma_f32_16x16x32_bf16 v[76:79], a[184:187], a[160:163], v[76:79]
    v_mfma_f32_16x16x32_bf16 v[80:83], a[188:191], a[156:159], v[80:83]
    v_mfma_f32_16x16x32_bf16 v[84:87], a[188:191], a[160:163], v[84:87]
    buffer_load_dwordx4 a[156:159], v5, s[8:11], s24 offen offset:3072
    buffer_load_dwordx4 a[160:163], v5, s[8:11], s25 offen offset:3072
    buffer_load_dwordx4 a[164:167], v5, s[8:11], s29 offen offset:3072
    buffer_load_dwordx4 a[168:171], v5, s[8:11], s30 offen offset:3072
    buffer_load_dwordx4 a[172:175], v5, s[8:11], s31 offen offset:3072
    buffer_load_dwordx4 a[176:179], v5, s[8:11], s32 offen offset:3072
    buffer_load_dwordx4 a[180:183], v5, s[8:11], s33 offen offset:3072
    buffer_load_dwordx4 a[184:187], v5, s[8:11], s34 offen offset:3072
    buffer_load_dwordx4 a[188:191], v5, s[8:11], s35 offen offset:3072
    s_waitcnt vmcnt(18)
    v_mfma_f32_16x16x32_bf16 v[32:35], a[208:211], a[200:203], v[32:35]
    v_mfma_f32_16x16x32_bf16 v[36:39], a[208:211], a[204:207], v[36:39]
    v_mfma_f32_16x16x32_bf16 v[40:43], a[212:215], a[200:203], v[40:43]
    v_mfma_f32_16x16x32_bf16 v[44:47], a[212:215], a[204:207], v[44:47]
    v_mfma_f32_16x16x32_bf16 v[48:51], a[216:219], a[200:203], v[48:51]
    v_mfma_f32_16x16x32_bf16 v[52:55], a[216:219], a[204:207], v[52:55]
    v_mfma_f32_16x16x32_bf16 v[56:59], a[220:223], a[200:203], v[56:59]
    v_mfma_f32_16x16x32_bf16 v[60:63], a[220:223], a[204:207], v[60:63]
    v_mfma_f32_16x16x32_bf16 v[64:67], a[224:227], a[200:203], v[64:67]
    v_mfma_f32_16x16x32_bf16 v[68:71], a[224:227], a[204:207], v[68:71]
    v_mfma_f32_16x16x32_bf16 v[72:75], a[228:231], a[200:203], v[72:75]
    v_mfma_f32_16x16x32_bf16 v[76:79], a[228:231], a[204:207], v[76:79]
    v_mfma_f32_16x16x32_bf16 v[80:83], a[232:235], a[200:203], v[80:83]
    v_mfma_f32_16x16x32_bf16 v[84:87], a[232:235], a[204:207], v[84:87]
    buffer_load_dwordx4 a[200:203], v6, s[8:11], s24 offen offset:0
    buffer_load_dwordx4 a[204:207], v6, s[8:11], s25 offen offset:0
    buffer_load_dwordx4 a[208:211], v6, s[8:11], s29 offen offset:0
    buffer_load_dwordx4 a[212:215], v6, s[8:11], s30 offen offset:0
    buffer_load_dwordx4 a[216:219], v6, s[8:11], s31 offen offset:0
    buffer_load_dwordx4 a[220:223], v6, s[8:11], s32 offen offset:0
    buffer_load_dwordx4 a[224:227], v6, s[8:11], s33 offen offset:0
    buffer_load_dwordx4 a[228:231], v6, s[8:11], s34 offen offset:0
    buffer_load_dwordx4 a[232:235], v6, s[8:11], s35 offen offset:0
    s_waitcnt vmcnt(18)
    v_mfma_f32_16x16x32_bf16 v[32:35], a[120:123], a[112:115], v[32:35]
    v_mfma_f32_16x16x32_bf16 v[36:39], a[120:123], a[116:119], v[36:39]
    v_mfma_f32_16x16x32_bf16 v[40:43], a[124:127], a[112:115], v[40:43]
    v_mfma_f32_16x16x32_bf16 v[44:47], a[124:127], a[116:119], v[44:47]
    v_mfma_f32_16x16x32_bf16 v[48:51], a[128:131], a[112:115], v[48:51]
    v_mfma_f32_16x16x32_bf16 v[52:55], a[128:131], a[116:119], v[52:55]
    v_mfma_f32_16x16x32_bf16 v[56:59], a[132:135], a[112:115], v[56:59]
    v_mfma_f32_16x16x32_bf16 v[60:63], a[132:135], a[116:119], v[60:63]
    v_mfma_f32_16x16x32_bf16 v[64:67], a[136:139], a[112:115], v[64:67]
    v_mfma_f32_16x16x32_bf16 v[68:71], a[136:139], a[116:119], v[68:71]
    v_mfma_f32_16x16x32_bf16 v[72:75], a[140:143], a[112:115], v[72:75]
    v_mfma_f32_16x16x32_bf16 v[76:79], a[140:143], a[116:119], v[76:79]
    v_mfma_f32_16x16x32_bf16 v[80:83], a[144:147], a[112:115], v[80:83]
    v_mfma_f32_16x16x32_bf16 v[84:87], a[144:147], a[116:119], v[84:87]
    buffer_load_dwordx4 a[112:115], v6, s[8:11], s24 offen offset:1024
    buffer_load_dwordx4 a[116:119], v6, s[8:11], s25 offen offset:1024
    buffer_load_dwordx4 a[120:123], v6, s[8:11], s29 offen offset:1024
    buffer_load_dwordx4 a[124:127], v6, s[8:11], s30 offen offset:1024
    buffer_load_dwordx4 a[128:131], v6, s[8:11], s31 offen offset:1024
    buffer_load_dwordx4 a[132:135], v6, s[8:11], s32 offen offset:1024
    buffer_load_dwordx4 a[136:139], v6, s[8:11], s33 offen offset:1024
    buffer_load_dwordx4 a[140:143], v6, s[8:11], s34 offen offset:1024
    buffer_load_dwordx4 a[144:147], v6, s[8:11], s35 offen offset:1024
    s_waitcnt vmcnt(18)
    v_mfma_f32_16x16x32_bf16 v[32:35], a[164:167], a[156:159], v[32:35]
    v_mfma_f32_16x16x32_bf16 v[36:39], a[164:167], a[160:163], v[36:39]
    v_mfma_f32_16x16x32_bf16 v[40:43], a[168:171], a[156:159], v[40:43]
    v_mfma_f32_16x16x32_bf16 v[44:47], a[168:171], a[160:163], v[44:47]
    v_mfma_f32_16x16x32_bf16 v[48:51], a[172:175], a[156:159], v[48:51]
    v_mfma_f32_16x16x32_bf16 v[52:55], a[172:175], a[160:163], v[52:55]
    v_mfma_f32_16x16x32_bf16 v[56:59], a[176:179], a[156:159], v[56:59]
    v_mfma_f32_16x16x32_bf16 v[60:63], a[176:179], a[160:163], v[60:63]
    v_mfma_f32_16x16x32_bf16 v[64:67], a[180:183], a[156:159], v[64:67]
    v_mfma_f32_16x16x32_bf16 v[68:71], a[180:183], a[160:163], v[68:71]
    v_mfma_f32_16x16x32_bf16 v[72:75], a[184:187], a[156:159], v[72:75]
    v_mfma_f32_16x16x32_bf16 v[76:79], a[184:187], a[160:163], v[76:79]
    v_mfma_f32_16x16x32_bf16 v[80:83], a[188:191], a[156:159], v[80:83]
    v_mfma_f32_16x16x32_bf16 v[84:87], a[188:191], a[160:163], v[84:87]
    buffer_load_dwordx4 a[156:159], v6, s[8:11], s24 offen offset:2048
    buffer_load_dwordx4 a[160:163], v6, s[8:11], s25 offen offset:2048
    buffer_load_dwordx4 a[164:167], v6, s[8:11], s29 offen offset:2048
    buffer_load_dwordx4 a[168:171], v6, s[8:11], s30 offen offset:2048
    buffer_load_dwordx4 a[172:175], v6, s[8:11], s31 offen offset:2048
    buffer_load_dwordx4 a[176:179], v6, s[8:11], s32 offen offset:2048
    buffer_load_dwordx4 a[180:183], v6, s[8:11], s33 offen offset:2048
    buffer_load_dwordx4 a[184:187], v6, s[8:11], s34 offen offset:2048
    buffer_load_dwordx4 a[188:191], v6, s[8:11], s35 offen offset:2048
    s_waitcnt vmcnt(18)
    v_mfma_f32_16x16x32_bf16 v[32:35], a[208:211], a[200:203], v[32:35]
    v_mfma_f32_16x16x32_bf16 v[36:39], a[208:211], a[204:207], v[36:39]
    v_mfma_f32_16x16x32_bf16 v[40:43], a[212:215], a[200:203], v[40:43]
    v_mfma_f32_16x16x32_bf16 v[44:47], a[212:215], a[204:207], v[44:47]
    v_mfma_f32_16x16x32_bf16 v[48:51], a[216:219], a[200:203], v[48:51]
    v_mfma_f32_16x16x32_bf16 v[52:55], a[216:219], a[204:207], v[52:55]
    v_mfma_f32_16x16x32_bf16 v[56:59], a[220:223], a[200:203], v[56:59]
    v_mfma_f32_16x16x32_bf16 v[60:63], a[220:223], a[204:207], v[60:63]
    v_mfma_f32_16x16x32_bf16 v[64:67], a[224:227], a[200:203], v[64:67]
    v_mfma_f32_16x16x32_bf16 v[68:71], a[224:227], a[204:207], v[68:71]
    v_mfma_f32_16x16x32_bf16 v[72:75], a[228:231], a[200:203], v[72:75]
    v_mfma_f32_16x16x32_bf16 v[76:79], a[228:231], a[204:207], v[76:79]
    v_mfma_f32_16x16x32_bf16 v[80:83], a[232:235], a[200:203], v[80:83]
    v_mfma_f32_16x16x32_bf16 v[84:87], a[232:235], a[204:207], v[84:87]
    buffer_load_dwordx4 a[200:203], v6, s[8:11], s24 offen offset:3072
    buffer_load_dwordx4 a[204:207], v6, s[8:11], s25 offen offset:3072
    buffer_load_dwordx4 a[208:211], v6, s[8:11], s29 offen offset:3072
    buffer_load_dwordx4 a[212:215], v6, s[8:11], s30 offen offset:3072
    buffer_load_dwordx4 a[216:219], v6, s[8:11], s31 offen offset:3072
    buffer_load_dwordx4 a[220:223], v6, s[8:11], s32 offen offset:3072
    buffer_load_dwordx4 a[224:227], v6, s[8:11], s33 offen offset:3072
    buffer_load_dwordx4 a[228:231], v6, s[8:11], s34 offen offset:3072
    buffer_load_dwordx4 a[232:235], v6, s[8:11], s35 offen offset:3072
    s_waitcnt vmcnt(18)
    v_mfma_f32_16x16x32_bf16 v[32:35], a[120:123], a[112:115], v[32:35]
    v_mfma_f32_16x16x32_bf16 v[36:39], a[120:123], a[116:119], v[36:39]
    v_mfma_f32_16x16x32_bf16 v[40:43], a[124:127], a[112:115], v[40:43]
    v_mfma_f32_16x16x32_bf16 v[44:47], a[124:127], a[116:119], v[44:47]
    v_mfma_f32_16x16x32_bf16 v[48:51], a[128:131], a[112:115], v[48:51]
    v_mfma_f32_16x16x32_bf16 v[52:55], a[128:131], a[116:119], v[52:55]
    v_mfma_f32_16x16x32_bf16 v[56:59], a[132:135], a[112:115], v[56:59]
    v_mfma_f32_16x16x32_bf16 v[60:63], a[132:135], a[116:119], v[60:63]
    v_mfma_f32_16x16x32_bf16 v[64:67], a[136:139], a[112:115], v[64:67]
    v_mfma_f32_16x16x32_bf16 v[68:71], a[136:139], a[116:119], v[68:71]
    v_mfma_f32_16x16x32_bf16 v[72:75], a[140:143], a[112:115], v[72:75]
    v_mfma_f32_16x16x32_bf16 v[76:79], a[140:143], a[116:119], v[76:79]
    v_mfma_f32_16x16x32_bf16 v[80:83], a[144:147], a[112:115], v[80:83]
    v_mfma_f32_16x16x32_bf16 v[84:87], a[144:147], a[116:119], v[84:87]
    buffer_load_dwordx4 a[112:115], v7, s[8:11], s24 offen offset:0
    buffer_load_dwordx4 a[116:119], v7, s[8:11], s25 offen offset:0
    buffer_load_dwordx4 a[120:123], v7, s[8:11], s29 offen offset:0
    buffer_load_dwordx4 a[124:127], v7, s[8:11], s30 offen offset:0
    buffer_load_dwordx4 a[128:131], v7, s[8:11], s31 offen offset:0
    buffer_load_dwordx4 a[132:135], v7, s[8:11], s32 offen offset:0
    buffer_load_dwordx4 a[136:139], v7, s[8:11], s33 offen offset:0
    buffer_load_dwordx4 a[140:143], v7, s[8:11], s34 offen offset:0
    buffer_load_dwordx4 a[144:147], v7, s[8:11], s35 offen offset:0
    s_waitcnt vmcnt(18)
    v_mfma_f32_16x16x32_bf16 v[32:35], a[164:167], a[156:159], v[32:35]
    v_mfma_f32_16x16x32_bf16 v[36:39], a[164:167], a[160:163], v[36:39]
    v_mfma_f32_16x16x32_bf16 v[40:43], a[168:171], a[156:159], v[40:43]
    v_mfma_f32_16x16x32_bf16 v[44:47], a[168:171], a[160:163], v[44:47]
    v_mfma_f32_16x16x32_bf16 v[48:51], a[172:175], a[156:159], v[48:51]
    v_mfma_f32_16x16x32_bf16 v[52:55], a[172:175], a[160:163], v[52:55]
    v_mfma_f32_16x16x32_bf16 v[56:59], a[176:179], a[156:159], v[56:59]
    v_mfma_f32_16x16x32_bf16 v[60:63], a[176:179], a[160:163], v[60:63]
    v_mfma_f32_16x16x32_bf16 v[64:67], a[180:183], a[156:159], v[64:67]
    v_mfma_f32_16x16x32_bf16 v[68:71], a[180:183], a[160:163], v[68:71]
    v_mfma_f32_16x16x32_bf16 v[72:75], a[184:187], a[156:159], v[72:75]
    v_mfma_f32_16x16x32_bf16 v[76:79], a[184:187], a[160:163], v[76:79]
    v_mfma_f32_16x16x32_bf16 v[80:83], a[188:191], a[156:159], v[80:83]
    v_mfma_f32_16x16x32_bf16 v[84:87], a[188:191], a[160:163], v[84:87]
    buffer_load_dwordx4 a[156:159], v7, s[8:11], s24 offen offset:1024
    buffer_load_dwordx4 a[160:163], v7, s[8:11], s25 offen offset:1024
    buffer_load_dwordx4 a[164:167], v7, s[8:11], s29 offen offset:1024
    buffer_load_dwordx4 a[168:171], v7, s[8:11], s30 offen offset:1024
    buffer_load_dwordx4 a[172:175], v7, s[8:11], s31 offen offset:1024
    buffer_load_dwordx4 a[176:179], v7, s[8:11], s32 offen offset:1024
    buffer_load_dwordx4 a[180:183], v7, s[8:11], s33 offen offset:1024
    buffer_load_dwordx4 a[184:187], v7, s[8:11], s34 offen offset:1024
    buffer_load_dwordx4 a[188:191], v7, s[8:11], s35 offen offset:1024
    s_waitcnt vmcnt(18)
    v_mfma_f32_16x16x32_bf16 v[32:35], a[208:211], a[200:203], v[32:35]
    v_mfma_f32_16x16x32_bf16 v[36:39], a[208:211], a[204:207], v[36:39]
    v_mfma_f32_16x16x32_bf16 v[40:43], a[212:215], a[200:203], v[40:43]
    v_mfma_f32_16x16x32_bf16 v[44:47], a[212:215], a[204:207], v[44:47]
    v_mfma_f32_16x16x32_bf16 v[48:51], a[216:219], a[200:203], v[48:51]
    v_mfma_f32_16x16x32_bf16 v[52:55], a[216:219], a[204:207], v[52:55]
    v_mfma_f32_16x16x32_bf16 v[56:59], a[220:223], a[200:203], v[56:59]
    v_mfma_f32_16x16x32_bf16 v[60:63], a[220:223], a[204:207], v[60:63]
    v_mfma_f32_16x16x32_bf16 v[64:67], a[224:227], a[200:203], v[64:67]
    v_mfma_f32_16x16x32_bf16 v[68:71], a[224:227], a[204:207], v[68:71]
    v_mfma_f32_16x16x32_bf16 v[72:75], a[228:231], a[200:203], v[72:75]
    v_mfma_f32_16x16x32_bf16 v[76:79], a[228:231], a[204:207], v[76:79]
    v_mfma_f32_16x16x32_bf16 v[80:83], a[232:235], a[200:203], v[80:83]
    v_mfma_f32_16x16x32_bf16 v[84:87], a[232:235], a[204:207], v[84:87]
    s_waitcnt vmcnt(9)
    v_mfma_f32_16x16x32_bf16 v[32:35], a[120:123], a[112:115], v[32:35]
    v_mfma_f32_16x16x32_bf16 v[36:39], a[120:123], a[116:119], v[36:39]
    v_mfma_f32_16x16x32_bf16 v[40:43], a[124:127], a[112:115], v[40:43]
    v_mfma_f32_16x16x32_bf16 v[44:47], a[124:127], a[116:119], v[44:47]
    v_mfma_f32_16x16x32_bf16 v[48:51], a[128:131], a[112:115], v[48:51]
    v_mfma_f32_16x16x32_bf16 v[52:55], a[128:131], a[116:119], v[52:55]
    v_mfma_f32_16x16x32_bf16 v[56:59], a[132:135], a[112:115], v[56:59]
    v_mfma_f32_16x16x32_bf16 v[60:63], a[132:135], a[116:119], v[60:63]
    v_mfma_f32_16x16x32_bf16 v[64:67], a[136:139], a[112:115], v[64:67]
    v_mfma_f32_16x16x32_bf16 v[68:71], a[136:139], a[116:119], v[68:71]
    v_mfma_f32_16x16x32_bf16 v[72:75], a[140:143], a[112:115], v[72:75]
    v_mfma_f32_16x16x32_bf16 v[76:79], a[140:143], a[116:119], v[76:79]
    v_mfma_f32_16x16x32_bf16 v[80:83], a[144:147], a[112:115], v[80:83]
    v_mfma_f32_16x16x32_bf16 v[84:87], a[144:147], a[116:119], v[84:87]
    s_waitcnt vmcnt(0)
    v_mfma_f32_16x16x32_bf16 v[32:35], a[164:167], a[156:159], v[32:35]
    v_mfma_f32_16x16x32_bf16 v[36:39], a[164:167], a[160:163], v[36:39]
    v_mfma_f32_16x16x32_bf16 v[40:43], a[168:171], a[156:159], v[40:43]
    v_mfma_f32_16x16x32_bf16 v[44:47], a[168:171], a[160:163], v[44:47]
    v_mfma_f32_16x16x32_bf16 v[48:51], a[172:175], a[156:159], v[48:51]
    v_mfma_f32_16x16x32_bf16 v[52:55], a[172:175], a[160:163], v[52:55]
    v_mfma_f32_16x16x32_bf16 v[56:59], a[176:179], a[156:159], v[56:59]
    v_mfma_f32_16x16x32_bf16 v[60:63], a[176:179], a[160:163], v[60:63]
    v_mfma_f32_16x16x32_bf16 v[64:67], a[180:183], a[156:159], v[64:67]
    v_mfma_f32_16x16x32_bf16 v[68:71], a[180:183], a[160:163], v[68:71]
    v_mfma_f32_16x16x32_bf16 v[72:75], a[184:187], a[156:159], v[72:75]
    v_mfma_f32_16x16x32_bf16 v[76:79], a[184:187], a[160:163], v[76:79]
    v_mfma_f32_16x16x32_bf16 v[80:83], a[188:191], a[156:159], v[80:83]
    v_mfma_f32_16x16x32_bf16 v[84:87], a[188:191], a[160:163], v[84:87]
    s_nop 7
    s_nop 3
    s_add_u32 s39, s38, 14336
    buffer_load_dwordx4 v[100:103], v28, s[12:15], s38 offen offset:224
    buffer_load_dwordx4 v[104:107], v28, s[12:15], s38 offen offset:240
    buffer_load_dwordx4 v[108:111], v29, s[12:15], s38 offen offset:352
    buffer_load_dwordx2 v[112:113], v30, s[12:15], s38 offen offset:416
    buffer_load_dwordx4 v[114:117], v28, s[12:15], s39 offen offset:224
    buffer_load_dwordx4 v[118:121], v28, s[12:15], s39 offen offset:240
    buffer_load_dwordx4 v[122:125], v29, s[12:15], s39 offen offset:352
    buffer_load_dwordx2 v[126:127], v30, s[12:15], s39 offen offset:416
    v_cvt_pk_bf16_f32 v128, v32, v40
    v_cvt_pk_bf16_f32 v129, v34, v42
    v_cvt_pk_bf16_f32 v130, v48, v56
    v_cvt_pk_bf16_f32 v131, v50, v58
    v_cvt_pk_bf16_f32 v132, v33, v41
    v_cvt_pk_bf16_f32 v133, v35, v43
    v_cvt_pk_bf16_f32 v134, v49, v57
    v_cvt_pk_bf16_f32 v135, v51, v59
    v_cvt_pk_bf16_f32 v136, v64, v72
    v_cvt_pk_bf16_f32 v137, v65, v73
    v_cvt_pk_bf16_f32 v138, v66, v74
    v_cvt_pk_bf16_f32 v139, v67, v75
    v_cvt_pk_bf16_f32 v140, v80, v81
    v_cvt_pk_bf16_f32 v141, v82, v83
    v_accvgpr_write_b32 a28, v128
    v_accvgpr_write_b32 a29, v129
    v_accvgpr_write_b32 a30, v130
    v_accvgpr_write_b32 a31, v131
    v_accvgpr_write_b32 a32, v132
    v_accvgpr_write_b32 a33, v133
    v_accvgpr_write_b32 a34, v134
    v_accvgpr_write_b32 a35, v135
    v_accvgpr_write_b32 a36, v136
    v_accvgpr_write_b32 a37, v137
    v_accvgpr_write_b32 a38, v138
    v_accvgpr_write_b32 a39, v139
    v_accvgpr_write_b32 a40, v140
    v_accvgpr_write_b32 a41, v141
    v_cvt_pk_bf16_f32 v128, v36, v44
    v_cvt_pk_bf16_f32 v129, v38, v46
    v_cvt_pk_bf16_f32 v130, v52, v60
    v_cvt_pk_bf16_f32 v131, v54, v62
    v_cvt_pk_bf16_f32 v132, v37, v45
    v_cvt_pk_bf16_f32 v133, v39, v47
    v_cvt_pk_bf16_f32 v134, v53, v61
    v_cvt_pk_bf16_f32 v135, v55, v63
    v_cvt_pk_bf16_f32 v136, v68, v76
    v_cvt_pk_bf16_f32 v137, v69, v77
    v_cvt_pk_bf16_f32 v138, v70, v78
    v_cvt_pk_bf16_f32 v139, v71, v79
    v_cvt_pk_bf16_f32 v140, v84, v85
    v_cvt_pk_bf16_f32 v141, v86, v87
    v_accvgpr_write_b32 a42, v128
    v_accvgpr_write_b32 a43, v129
    v_accvgpr_write_b32 a44, v130
    v_accvgpr_write_b32 a45, v131
    v_accvgpr_write_b32 a46, v132
    v_accvgpr_write_b32 a47, v133
    v_accvgpr_write_b32 a48, v134
    v_accvgpr_write_b32 a49, v135
    v_accvgpr_write_b32 a50, v136
    v_accvgpr_write_b32 a51, v137
    v_accvgpr_write_b32 a52, v138
    v_accvgpr_write_b32 a53, v139
    v_accvgpr_write_b32 a54, v140
    v_accvgpr_write_b32 a55, v141
    s_waitcnt vmcnt(0)
    s_nop 1
    v_mfma_f32_16x16x32_bf16 v[88:91], v[100:103], a[28:31], v[88:91]
    v_mfma_f32_16x16x32_bf16 v[92:95], v[100:103], a[42:45], v[92:95]
    v_mfma_f32_16x16x32_bf16 v[96:99], v[114:117], a[42:45], v[96:99]
    v_mfma_f32_16x16x32_bf16 v[88:91], v[104:107], a[32:35], v[88:91]
    v_mfma_f32_16x16x32_bf16 v[92:95], v[104:107], a[46:49], v[92:95]
    v_mfma_f32_16x16x32_bf16 v[96:99], v[118:121], a[46:49], v[96:99]
    v_mfma_f32_16x16x32_bf16 v[88:91], v[108:111], a[36:39], v[88:91]
    v_mfma_f32_16x16x32_bf16 v[92:95], v[108:111], a[50:53], v[92:95]
    v_mfma_f32_16x16x32_bf16 v[96:99], v[122:125], a[50:53], v[96:99]
    s_nop 4
    v_mfma_f32_16x16x16_bf16 v[88:91], v[112:113], a[40:41], v[88:91]
    v_mfma_f32_16x16x16_bf16 v[92:95], v[112:113], a[54:55], v[92:95]
    v_mfma_f32_16x16x16_bf16 v[96:99], v[126:127], a[54:55], v[96:99]
    s_add_u32 s29, s28, 200704
    s_add_u32 s30, s28, 215040
    s_add_u32 s31, s28, 229376
    s_add_u32 s32, s28, 243712
    s_add_u32 s33, s28, 258048
    s_add_u32 s34, s28, 272384
    s_add_u32 s35, s28, 286720
    buffer_load_dwordx4 a[112:115], v4, s[8:11], s24 offen offset:0
    buffer_load_dwordx4 a[116:119], v4, s[8:11], s25 offen offset:0
    buffer_load_dwordx4 a[120:123], v4, s[8:11], s29 offen offset:0
    buffer_load_dwordx4 a[124:127], v4, s[8:11], s30 offen offset:0
    buffer_load_dwordx4 a[128:131], v4, s[8:11], s31 offen offset:0
    buffer_load_dwordx4 a[132:135], v4, s[8:11], s32 offen offset:0
    buffer_load_dwordx4 a[136:139], v4, s[8:11], s33 offen offset:0
    buffer_load_dwordx4 a[140:143], v4, s[8:11], s34 offen offset:0
    buffer_load_dwordx4 a[144:147], v4, s[8:11], s35 offen offset:0
    buffer_load_dwordx4 a[156:159], v4, s[8:11], s24 offen offset:1024
    buffer_load_dwordx4 a[160:163], v4, s[8:11], s25 offen offset:1024
    buffer_load_dwordx4 a[164:167], v4, s[8:11], s29 offen offset:1024
    buffer_load_dwordx4 a[168:171], v4, s[8:11], s30 offen offset:1024
    buffer_load_dwordx4 a[172:175], v4, s[8:11], s31 offen offset:1024
    buffer_load_dwordx4 a[176:179], v4, s[8:11], s32 offen offset:1024
    buffer_load_dwordx4 a[180:183], v4, s[8:11], s33 offen offset:1024
    buffer_load_dwordx4 a[184:187], v4, s[8:11], s34 offen offset:1024
    buffer_load_dwordx4 a[188:191], v4, s[8:11], s35 offen offset:1024
    buffer_load_dwordx4 a[200:203], v4, s[8:11], s24 offen offset:2048
    buffer_load_dwordx4 a[204:207], v4, s[8:11], s25 offen offset:2048
    buffer_load_dwordx4 a[208:211], v4, s[8:11], s29 offen offset:2048
    buffer_load_dwordx4 a[212:215], v4, s[8:11], s30 offen offset:2048
    buffer_load_dwordx4 a[216:219], v4, s[8:11], s31 offen offset:2048
    buffer_load_dwordx4 a[220:223], v4, s[8:11], s32 offen offset:2048
    buffer_load_dwordx4 a[224:227], v4, s[8:11], s33 offen offset:2048
    buffer_load_dwordx4 a[228:231], v4, s[8:11], s34 offen offset:2048
    buffer_load_dwordx4 a[232:235], v4, s[8:11], s35 offen offset:2048
    s_waitcnt vmcnt(18)
    v_mfma_f32_16x16x32_bf16 v[32:35], a[120:123], a[112:115], 0
    v_mfma_f32_16x16x32_bf16 v[36:39], a[120:123], a[116:119], 0
    v_mfma_f32_16x16x32_bf16 v[40:43], a[124:127], a[112:115], 0
    v_mfma_f32_16x16x32_bf16 v[44:47], a[124:127], a[116:119], 0
    v_mfma_f32_16x16x32_bf16 v[48:51], a[128:131], a[112:115], 0
    v_mfma_f32_16x16x32_bf16 v[52:55], a[128:131], a[116:119], 0
    v_mfma_f32_16x16x32_bf16 v[56:59], a[132:135], a[112:115], 0
    v_mfma_f32_16x16x32_bf16 v[60:63], a[132:135], a[116:119], 0
    v_mfma_f32_16x16x32_bf16 v[64:67], a[136:139], a[112:115], 0
    v_mfma_f32_16x16x32_bf16 v[68:71], a[136:139], a[116:119], 0
    v_mfma_f32_16x16x32_bf16 v[72:75], a[140:143], a[112:115], 0
    v_mfma_f32_16x16x32_bf16 v[76:79], a[140:143], a[116:119], 0
    v_mfma_f32_16x16x32_bf16 v[80:83], a[144:147], a[112:115], 0
    v_mfma_f32_16x16x32_bf16 v[84:87], a[144:147], a[116:119], 0
    buffer_load_dwordx4 a[112:115], v4, s[8:11], s24 offen offset:3072
    buffer_load_dwordx4 a[116:119], v4, s[8:11], s25 offen offset:3072
    buffer_load_dwordx4 a[120:123], v4, s[8:11], s29 offen offset:3072
    buffer_load_dwordx4 a[124:127], v4, s[8:11], s30 offen offset:3072
    buffer_load_dwordx4 a[128:131], v4, s[8:11], s31 offen offset:3072
    buffer_load_dwordx4 a[132:135], v4, s[8:11], s32 offen offset:3072
    buffer_load_dwordx4 a[136:139], v4, s[8:11], s33 offen offset:3072
    buffer_load_dwordx4 a[140:143], v4, s[8:11], s34 offen offset:3072
    buffer_load_dwordx4 a[144:147], v4, s[8:11], s35 offen offset:3072
    s_waitcnt vmcnt(18)
    v_mfma_f32_16x16x32_bf16 v[32:35], a[164:167], a[156:159], v[32:35]
    v_mfma_f32_16x16x32_bf16 v[36:39], a[164:167], a[160:163], v[36:39]
    v_mfma_f32_16x16x32_bf16 v[40:43], a[168:171], a[156:159], v[40:43]
    v_mfma_f32_16x16x32_bf16 v[44:47], a[168:171], a[160:163], v[44:47]
    v_mfma_f32_16x16x32_bf16 v[48:51], a[172:175], a[156:159], v[48:51]
    v_mfma_f32_16x16x32_bf16 v[52:55], a[172:175], a[160:163], v[52:55]
    v_mfma_f32_16x16x32_bf16 v[56:59], a[176:179], a[156:159], v[56:59]
    v_mfma_f32_16x16x32_bf16 v[60:63], a[176:179], a[160:163], v[60:63]
    v_mfma_f32_16x16x32_bf16 v[64:67], a[180:183], a[156:159], v[64:67]
    v_mfma_f32_16x16x32_bf16 v[68:71], a[180:183], a[160:163], v[68:71]
    v_mfma_f32_16x16x32_bf16 v[72:75], a[184:187], a[156:159], v[72:75]
    v_mfma_f32_16x16x32_bf16 v[76:79], a[184:187], a[160:163], v[76:79]
    v_mfma_f32_16x16x32_bf16 v[80:83], a[188:191], a[156:159], v[80:83]
    v_mfma_f32_16x16x32_bf16 v[84:87], a[188:191], a[160:163], v[84:87]
    buffer_load_dwordx4 a[156:159], v5, s[8:11], s24 offen offset:0
    buffer_load_dwordx4 a[160:163], v5, s[8:11], s25 offen offset:0
    buffer_load_dwordx4 a[164:167], v5, s[8:11], s29 offen offset:0
    buffer_load_dwordx4 a[168:171], v5, s[8:11], s30 offen offset:0
    buffer_load_dwordx4 a[172:175], v5, s[8:11], s31 offen offset:0
    buffer_load_dwordx4 a[176:179], v5, s[8:11], s32 offen offset:0
    buffer_load_dwordx4 a[180:183], v5, s[8:11], s33 offen offset:0
    buffer_load_dwordx4 a[184:187], v5, s[8:11], s34 offen offset:0
    buffer_load_dwordx4 a[188:191], v5, s[8:11], s35 offen offset:0
    s_waitcnt vmcnt(18)
    v_mfma_f32_16x16x32_bf16 v[32:35], a[208:211], a[200:203], v[32:35]
    v_mfma_f32_16x16x32_bf16 v[36:39], a[208:211], a[204:207], v[36:39]
    v_mfma_f32_16x16x32_bf16 v[40:43], a[212:215], a[200:203], v[40:43]
    v_mfma_f32_16x16x32_bf16 v[44:47], a[212:215], a[204:207], v[44:47]
    v_mfma_f32_16x16x32_bf16 v[48:51], a[216:219], a[200:203], v[48:51]
    v_mfma_f32_16x16x32_bf16 v[52:55], a[216:219], a[204:207], v[52:55]
    v_mfma_f32_16x16x32_bf16 v[56:59], a[220:223], a[200:203], v[56:59]
    v_mfma_f32_16x16x32_bf16 v[60:63], a[220:223], a[204:207], v[60:63]
    v_mfma_f32_16x16x32_bf16 v[64:67], a[224:227], a[200:203], v[64:67]
    v_mfma_f32_16x16x32_bf16 v[68:71], a[224:227], a[204:207], v[68:71]
    v_mfma_f32_16x16x32_bf16 v[72:75], a[228:231], a[200:203], v[72:75]
    v_mfma_f32_16x16x32_bf16 v[76:79], a[228:231], a[204:207], v[76:79]
    v_mfma_f32_16x16x32_bf16 v[80:83], a[232:235], a[200:203], v[80:83]
    v_mfma_f32_16x16x32_bf16 v[84:87], a[232:235], a[204:207], v[84:87]
    buffer_load_dwordx4 a[200:203], v5, s[8:11], s24 offen offset:1024
    buffer_load_dwordx4 a[204:207], v5, s[8:11], s25 offen offset:1024
    buffer_load_dwordx4 a[208:211], v5, s[8:11], s29 offen offset:1024
    buffer_load_dwordx4 a[212:215], v5, s[8:11], s30 offen offset:1024
    buffer_load_dwordx4 a[216:219], v5, s[8:11], s31 offen offset:1024
    buffer_load_dwordx4 a[220:223], v5, s[8:11], s32 offen offset:1024
    buffer_load_dwordx4 a[224:227], v5, s[8:11], s33 offen offset:1024
    buffer_load_dwordx4 a[228:231], v5, s[8:11], s34 offen offset:1024
    buffer_load_dwordx4 a[232:235], v5, s[8:11], s35 offen offset:1024
    s_waitcnt vmcnt(18)
    v_mfma_f32_16x16x32_bf16 v[32:35], a[120:123], a[112:115], v[32:35]
    v_mfma_f32_16x16x32_bf16 v[36:39], a[120:123], a[116:119], v[36:39]
    v_mfma_f32_16x16x32_bf16 v[40:43], a[124:127], a[112:115], v[40:43]
    v_mfma_f32_16x16x32_bf16 v[44:47], a[124:127], a[116:119], v[44:47]
    v_mfma_f32_16x16x32_bf16 v[48:51], a[128:131], a[112:115], v[48:51]
    v_mfma_f32_16x16x32_bf16 v[52:55], a[128:131], a[116:119], v[52:55]
    v_mfma_f32_16x16x32_bf16 v[56:59], a[132:135], a[112:115], v[56:59]
    v_mfma_f32_16x16x32_bf16 v[60:63], a[132:135], a[116:119], v[60:63]
    v_mfma_f32_16x16x32_bf16 v[64:67], a[136:139], a[112:115], v[64:67]
    v_mfma_f32_16x16x32_bf16 v[68:71], a[136:139], a[116:119], v[68:71]
    v_mfma_f32_16x16x32_bf16 v[72:75], a[140:143], a[112:115], v[72:75]
    v_mfma_f32_16x16x32_bf16 v[76:79], a[140:143], a[116:119], v[76:79]
    v_mfma_f32_16x16x32_bf16 v[80:83], a[144:147], a[112:115], v[80:83]
    v_mfma_f32_16x16x32_bf16 v[84:87], a[144:147], a[116:119], v[84:87]
    buffer_load_dwordx4 a[112:115], v5, s[8:11], s24 offen offset:2048
    buffer_load_dwordx4 a[116:119], v5, s[8:11], s25 offen offset:2048
    buffer_load_dwordx4 a[120:123], v5, s[8:11], s29 offen offset:2048
    buffer_load_dwordx4 a[124:127], v5, s[8:11], s30 offen offset:2048
    buffer_load_dwordx4 a[128:131], v5, s[8:11], s31 offen offset:2048
    buffer_load_dwordx4 a[132:135], v5, s[8:11], s32 offen offset:2048
    buffer_load_dwordx4 a[136:139], v5, s[8:11], s33 offen offset:2048
    buffer_load_dwordx4 a[140:143], v5, s[8:11], s34 offen offset:2048
    buffer_load_dwordx4 a[144:147], v5, s[8:11], s35 offen offset:2048
    s_waitcnt vmcnt(18)
    v_mfma_f32_16x16x32_bf16 v[32:35], a[164:167], a[156:159], v[32:35]
    v_mfma_f32_16x16x32_bf16 v[36:39], a[164:167], a[160:163], v[36:39]
    v_mfma_f32_16x16x32_bf16 v[40:43], a[168:171], a[156:159], v[40:43]
    v_mfma_f32_16x16x32_bf16 v[44:47], a[168:171], a[160:163], v[44:47]
    v_mfma_f32_16x16x32_bf16 v[48:51], a[172:175], a[156:159], v[48:51]
    v_mfma_f32_16x16x32_bf16 v[52:55], a[172:175], a[160:163], v[52:55]
    v_mfma_f32_16x16x32_bf16 v[56:59], a[176:179], a[156:159], v[56:59]
    v_mfma_f32_16x16x32_bf16 v[60:63], a[176:179], a[160:163], v[60:63]
    v_mfma_f32_16x16x32_bf16 v[64:67], a[180:183], a[156:159], v[64:67]
    v_mfma_f32_16x16x32_bf16 v[68:71], a[180:183], a[160:163], v[68:71]
    v_mfma_f32_16x16x32_bf16 v[72:75], a[184:187], a[156:159], v[72:75]
    v_mfma_f32_16x16x32_bf16 v[76:79], a[184:187], a[160:163], v[76:79]
    v_mfma_f32_16x16x32_bf16 v[80:83], a[188:191], a[156:159], v[80:83]
    v_mfma_f32_16x16x32_bf16 v[84:87], a[188:191], a[160:163], v[84:87]
    buffer_load_dwordx4 a[156:159], v5, s[8:11], s24 offen offset:3072
    buffer_load_dwordx4 a[160:163], v5, s[8:11], s25 offen offset:3072
    buffer_load_dwordx4 a[164:167], v5, s[8:11], s29 offen offset:3072
    buffer_load_dwordx4 a[168:171], v5, s[8:11], s30 offen offset:3072
    buffer_load_dwordx4 a[172:175], v5, s[8:11], s31 offen offset:3072
    buffer_load_dwordx4 a[176:179], v5, s[8:11], s32 offen offset:3072
    buffer_load_dwordx4 a[180:183], v5, s[8:11], s33 offen offset:3072
    buffer_load_dwordx4 a[184:187], v5, s[8:11], s34 offen offset:3072
    buffer_load_dwordx4 a[188:191], v5, s[8:11], s35 offen offset:3072
    s_waitcnt vmcnt(18)
    v_mfma_f32_16x16x32_bf16 v[32:35], a[208:211], a[200:203], v[32:35]
    v_mfma_f32_16x16x32_bf16 v[36:39], a[208:211], a[204:207], v[36:39]
    v_mfma_f32_16x16x32_bf16 v[40:43], a[212:215], a[200:203], v[40:43]
    v_mfma_f32_16x16x32_bf16 v[44:47], a[212:215], a[204:207], v[44:47]
    v_mfma_f32_16x16x32_bf16 v[48:51], a[216:219], a[200:203], v[48:51]
    v_mfma_f32_16x16x32_bf16 v[52:55], a[216:219], a[204:207], v[52:55]
    v_mfma_f32_16x16x32_bf16 v[56:59], a[220:223], a[200:203], v[56:59]
    v_mfma_f32_16x16x32_bf16 v[60:63], a[220:223], a[204:207], v[60:63]
    v_mfma_f32_16x16x32_bf16 v[64:67], a[224:227], a[200:203], v[64:67]
    v_mfma_f32_16x16x32_bf16 v[68:71], a[224:227], a[204:207], v[68:71]
    v_mfma_f32_16x16x32_bf16 v[72:75], a[228:231], a[200:203], v[72:75]
    v_mfma_f32_16x16x32_bf16 v[76:79], a[228:231], a[204:207], v[76:79]
    v_mfma_f32_16x16x32_bf16 v[80:83], a[232:235], a[200:203], v[80:83]
    v_mfma_f32_16x16x32_bf16 v[84:87], a[232:235], a[204:207], v[84:87]
    buffer_load_dwordx4 a[200:203], v6, s[8:11], s24 offen offset:0
    buffer_load_dwordx4 a[204:207], v6, s[8:11], s25 offen offset:0
    buffer_load_dwordx4 a[208:211], v6, s[8:11], s29 offen offset:0
    buffer_load_dwordx4 a[212:215], v6, s[8:11], s30 offen offset:0
    buffer_load_dwordx4 a[216:219], v6, s[8:11], s31 offen offset:0
    buffer_load_dwordx4 a[220:223], v6, s[8:11], s32 offen offset:0
    buffer_load_dwordx4 a[224:227], v6, s[8:11], s33 offen offset:0
    buffer_load_dwordx4 a[228:231], v6, s[8:11], s34 offen offset:0
    buffer_load_dwordx4 a[232:235], v6, s[8:11], s35 offen offset:0
    s_waitcnt vmcnt(18)
    v_mfma_f32_16x16x32_bf16 v[32:35], a[120:123], a[112:115], v[32:35]
    v_mfma_f32_16x16x32_bf16 v[36:39], a[120:123], a[116:119], v[36:39]
    v_mfma_f32_16x16x32_bf16 v[40:43], a[124:127], a[112:115], v[40:43]
    v_mfma_f32_16x16x32_bf16 v[44:47], a[124:127], a[116:119], v[44:47]
    v_mfma_f32_16x16x32_bf16 v[48:51], a[128:131], a[112:115], v[48:51]
    v_mfma_f32_16x16x32_bf16 v[52:55], a[128:131], a[116:119], v[52:55]
    v_mfma_f32_16x16x32_bf16 v[56:59], a[132:135], a[112:115], v[56:59]
    v_mfma_f32_16x16x32_bf16 v[60:63], a[132:135], a[116:119], v[60:63]
    v_mfma_f32_16x16x32_bf16 v[64:67], a[136:139], a[112:115], v[64:67]
    v_mfma_f32_16x16x32_bf16 v[68:71], a[136:139], a[116:119], v[68:71]
    v_mfma_f32_16x16x32_bf16 v[72:75], a[140:143], a[112:115], v[72:75]
    v_mfma_f32_16x16x32_bf16 v[76:79], a[140:143], a[116:119], v[76:79]
    v_mfma_f32_16x16x32_bf16 v[80:83], a[144:147], a[112:115], v[80:83]
    v_mfma_f32_16x16x32_bf16 v[84:87], a[144:147], a[116:119], v[84:87]
    buffer_load_dwordx4 a[112:115], v6, s[8:11], s24 offen offset:1024
    buffer_load_dwordx4 a[116:119], v6, s[8:11], s25 offen offset:1024
    buffer_load_dwordx4 a[120:123], v6, s[8:11], s29 offen offset:1024
    buffer_load_dwordx4 a[124:127], v6, s[8:11], s30 offen offset:1024
    buffer_load_dwordx4 a[128:131], v6, s[8:11], s31 offen offset:1024
    buffer_load_dwordx4 a[132:135], v6, s[8:11], s32 offen offset:1024
    buffer_load_dwordx4 a[136:139], v6, s[8:11], s33 offen offset:1024
    buffer_load_dwordx4 a[140:143], v6, s[8:11], s34 offen offset:1024
    buffer_load_dwordx4 a[144:147], v6, s[8:11], s35 offen offset:1024
    s_waitcnt vmcnt(18)
    v_mfma_f32_16x16x32_bf16 v[32:35], a[164:167], a[156:159], v[32:35]
    v_mfma_f32_16x16x32_bf16 v[36:39], a[164:167], a[160:163], v[36:39]
    v_mfma_f32_16x16x32_bf16 v[40:43], a[168:171], a[156:159], v[40:43]
    v_mfma_f32_16x16x32_bf16 v[44:47], a[168:171], a[160:163], v[44:47]
    v_mfma_f32_16x16x32_bf16 v[48:51], a[172:175], a[156:159], v[48:51]
    v_mfma_f32_16x16x32_bf16 v[52:55], a[172:175], a[160:163], v[52:55]
    v_mfma_f32_16x16x32_bf16 v[56:59], a[176:179], a[156:159], v[56:59]
    v_mfma_f32_16x16x32_bf16 v[60:63], a[176:179], a[160:163], v[60:63]
    v_mfma_f32_16x16x32_bf16 v[64:67], a[180:183], a[156:159], v[64:67]
    v_mfma_f32_16x16x32_bf16 v[68:71], a[180:183], a[160:163], v[68:71]
    v_mfma_f32_16x16x32_bf16 v[72:75], a[184:187], a[156:159], v[72:75]
    v_mfma_f32_16x16x32_bf16 v[76:79], a[184:187], a[160:163], v[76:79]
    v_mfma_f32_16x16x32_bf16 v[80:83], a[188:191], a[156:159], v[80:83]
    v_mfma_f32_16x16x32_bf16 v[84:87], a[188:191], a[160:163], v[84:87]
    buffer_load_dwordx4 a[156:159], v6, s[8:11], s24 offen offset:2048
    buffer_load_dwordx4 a[160:163], v6, s[8:11], s25 offen offset:2048
    buffer_load_dwordx4 a[164:167], v6, s[8:11], s29 offen offset:2048
    buffer_load_dwordx4 a[168:171], v6, s[8:11], s30 offen offset:2048
    buffer_load_dwordx4 a[172:175], v6, s[8:11], s31 offen offset:2048
    buffer_load_dwordx4 a[176:179], v6, s[8:11], s32 offen offset:2048
    buffer_load_dwordx4 a[180:183], v6, s[8:11], s33 offen offset:2048
    buffer_load_dwordx4 a[184:187], v6, s[8:11], s34 offen offset:2048
    buffer_load_dwordx4 a[188:191], v6, s[8:11], s35 offen offset:2048
    s_waitcnt vmcnt(18)
    v_mfma_f32_16x16x32_bf16 v[32:35], a[208:211], a[200:203], v[32:35]
    v_mfma_f32_16x16x32_bf16 v[36:39], a[208:211], a[204:207], v[36:39]
    v_mfma_f32_16x16x32_bf16 v[40:43], a[212:215], a[200:203], v[40:43]
    v_mfma_f32_16x16x32_bf16 v[44:47], a[212:215], a[204:207], v[44:47]
    v_mfma_f32_16x16x32_bf16 v[48:51], a[216:219], a[200:203], v[48:51]
    v_mfma_f32_16x16x32_bf16 v[52:55], a[216:219], a[204:207], v[52:55]
    v_mfma_f32_16x16x32_bf16 v[56:59], a[220:223], a[200:203], v[56:59]
    v_mfma_f32_16x16x32_bf16 v[60:63], a[220:223], a[204:207], v[60:63]
    v_mfma_f32_16x16x32_bf16 v[64:67], a[224:227], a[200:203], v[64:67]
    v_mfma_f32_16x16x32_bf16 v[68:71], a[224:227], a[204:207], v[68:71]
    v_mfma_f32_16x16x32_bf16 v[72:75], a[228:231], a[200:203], v[72:75]
    v_mfma_f32_16x16x32_bf16 v[76:79], a[228:231], a[204:207], v[76:79]
    v_mfma_f32_16x16x32_bf16 v[80:83], a[232:235], a[200:203], v[80:83]
    v_mfma_f32_16x16x32_bf16 v[84:87], a[232:235], a[204:207], v[84:87]
    buffer_load_dwordx4 a[200:203], v6, s[8:11], s24 offen offset:3072
    buffer_load_dwordx4 a[204:207], v6, s[8:11], s25 offen offset:3072
    buffer_load_dwordx4 a[208:211], v6, s[8:11], s29 offen offset:3072
    buffer_load_dwordx4 a[212:215], v6, s[8:11], s30 offen offset:3072
    buffer_load_dwordx4 a[216:219], v6, s[8:11], s31 offen offset:3072
    buffer_load_dwordx4 a[220:223], v6, s[8:11], s32 offen offset:3072
    buffer_load_dwordx4 a[224:227], v6, s[8:11], s33 offen offset:3072
    buffer_load_dwordx4 a[228:231], v6, s[8:11], s34 offen offset:3072
    buffer_load_dwordx4 a[232:235], v6, s[8:11], s35 offen offset:3072
    s_waitcnt vmcnt(18)
    v_mfma_f32_16x16x32_bf16 v[32:35], a[120:123], a[112:115], v[32:35]
    v_mfma_f32_16x16x32_bf16 v[36:39], a[120:123], a[116:119], v[36:39]
    v_mfma_f32_16x16x32_bf16 v[40:43], a[124:127], a[112:115], v[40:43]
    v_mfma_f32_16x16x32_bf16 v[44:47], a[124:127], a[116:119], v[44:47]
    v_mfma_f32_16x16x32_bf16 v[48:51], a[128:131], a[112:115], v[48:51]
    v_mfma_f32_16x16x32_bf16 v[52:55], a[128:131], a[116:119], v[52:55]
    v_mfma_f32_16x16x32_bf16 v[56:59], a[132:135], a[112:115], v[56:59]
    v_mfma_f32_16x16x32_bf16 v[60:63], a[132:135], a[116:119], v[60:63]
    v_mfma_f32_16x16x32_bf16 v[64:67], a[136:139], a[112:115], v[64:67]
    v_mfma_f32_16x16x32_bf16 v[68:71], a[136:139], a[116:119], v[68:71]
    v_mfma_f32_16x16x32_bf16 v[72:75], a[140:143], a[112:115], v[72:75]
    v_mfma_f32_16x16x32_bf16 v[76:79], a[140:143], a[116:119], v[76:79]
    v_mfma_f32_16x16x32_bf16 v[80:83], a[144:147], a[112:115], v[80:83]
    v_mfma_f32_16x16x32_bf16 v[84:87], a[144:147], a[116:119], v[84:87]
    buffer_load_dwordx4 a[112:115], v7, s[8:11], s24 offen offset:0
    buffer_load_dwordx4 a[116:119], v7, s[8:11], s25 offen offset:0
    buffer_load_dwordx4 a[120:123], v7, s[8:11], s29 offen offset:0
    buffer_load_dwordx4 a[124:127], v7, s[8:11], s30 offen offset:0
    buffer_load_dwordx4 a[128:131], v7, s[8:11], s31 offen offset:0
    buffer_load_dwordx4 a[132:135], v7, s[8:11], s32 offen offset:0
    buffer_load_dwordx4 a[136:139], v7, s[8:11], s33 offen offset:0
    buffer_load_dwordx4 a[140:143], v7, s[8:11], s34 offen offset:0
    buffer_load_dwordx4 a[144:147], v7, s[8:11], s35 offen offset:0
    s_waitcnt vmcnt(18)
    v_mfma_f32_16x16x32_bf16 v[32:35], a[164:167], a[156:159], v[32:35]
    v_mfma_f32_16x16x32_bf16 v[36:39], a[164:167], a[160:163], v[36:39]
    v_mfma_f32_16x16x32_bf16 v[40:43], a[168:171], a[156:159], v[40:43]
    v_mfma_f32_16x16x32_bf16 v[44:47], a[168:171], a[160:163], v[44:47]
    v_mfma_f32_16x16x32_bf16 v[48:51], a[172:175], a[156:159], v[48:51]
    v_mfma_f32_16x16x32_bf16 v[52:55], a[172:175], a[160:163], v[52:55]
    v_mfma_f32_16x16x32_bf16 v[56:59], a[176:179], a[156:159], v[56:59]
    v_mfma_f32_16x16x32_bf16 v[60:63], a[176:179], a[160:163], v[60:63]
    v_mfma_f32_16x16x32_bf16 v[64:67], a[180:183], a[156:159], v[64:67]
    v_mfma_f32_16x16x32_bf16 v[68:71], a[180:183], a[160:163], v[68:71]
    v_mfma_f32_16x16x32_bf16 v[72:75], a[184:187], a[156:159], v[72:75]
    v_mfma_f32_16x16x32_bf16 v[76:79], a[184:187], a[160:163], v[76:79]
    v_mfma_f32_16x16x32_bf16 v[80:83], a[188:191], a[156:159], v[80:83]
    v_mfma_f32_16x16x32_bf16 v[84:87], a[188:191], a[160:163], v[84:87]
    buffer_load_dwordx4 a[156:159], v7, s[8:11], s24 offen offset:1024
    buffer_load_dwordx4 a[160:163], v7, s[8:11], s25 offen offset:1024
    buffer_load_dwordx4 a[164:167], v7, s[8:11], s29 offen offset:1024
    buffer_load_dwordx4 a[168:171], v7, s[8:11], s30 offen offset:1024
    buffer_load_dwordx4 a[172:175], v7, s[8:11], s31 offen offset:1024
    buffer_load_dwordx4 a[176:179], v7, s[8:11], s32 offen offset:1024
    buffer_load_dwordx4 a[180:183], v7, s[8:11], s33 offen offset:1024
    buffer_load_dwordx4 a[184:187], v7, s[8:11], s34 offen offset:1024
    buffer_load_dwordx4 a[188:191], v7, s[8:11], s35 offen offset:1024
    s_waitcnt vmcnt(18)
    v_mfma_f32_16x16x32_bf16 v[32:35], a[208:211], a[200:203], v[32:35]
    v_mfma_f32_16x16x32_bf16 v[36:39], a[208:211], a[204:207], v[36:39]
    v_mfma_f32_16x16x32_bf16 v[40:43], a[212:215], a[200:203], v[40:43]
    v_mfma_f32_16x16x32_bf16 v[44:47], a[212:215], a[204:207], v[44:47]
    v_mfma_f32_16x16x32_bf16 v[48:51], a[216:219], a[200:203], v[48:51]
    v_mfma_f32_16x16x32_bf16 v[52:55], a[216:219], a[204:207], v[52:55]
    v_mfma_f32_16x16x32_bf16 v[56:59], a[220:223], a[200:203], v[56:59]
    v_mfma_f32_16x16x32_bf16 v[60:63], a[220:223], a[204:207], v[60:63]
    v_mfma_f32_16x16x32_bf16 v[64:67], a[224:227], a[200:203], v[64:67]
    v_mfma_f32_16x16x32_bf16 v[68:71], a[224:227], a[204:207], v[68:71]
    v_mfma_f32_16x16x32_bf16 v[72:75], a[228:231], a[200:203], v[72:75]
    v_mfma_f32_16x16x32_bf16 v[76:79], a[228:231], a[204:207], v[76:79]
    v_mfma_f32_16x16x32_bf16 v[80:83], a[232:235], a[200:203], v[80:83]
    v_mfma_f32_16x16x32_bf16 v[84:87], a[232:235], a[204:207], v[84:87]
    s_waitcnt vmcnt(9)
    v_mfma_f32_16x16x32_bf16 v[32:35], a[120:123], a[112:115], v[32:35]
    v_mfma_f32_16x16x32_bf16 v[36:39], a[120:123], a[116:119], v[36:39]
    v_mfma_f32_16x16x32_bf16 v[40:43], a[124:127], a[112:115], v[40:43]
    v_mfma_f32_16x16x32_bf16 v[44:47], a[124:127], a[116:119], v[44:47]
    v_mfma_f32_16x16x32_bf16 v[48:51], a[128:131], a[112:115], v[48:51]
    v_mfma_f32_16x16x32_bf16 v[52:55], a[128:131], a[116:119], v[52:55]
    v_mfma_f32_16x16x32_bf16 v[56:59], a[132:135], a[112:115], v[56:59]
    v_mfma_f32_16x16x32_bf16 v[60:63], a[132:135], a[116:119], v[60:63]
    v_mfma_f32_16x16x32_bf16 v[64:67], a[136:139], a[112:115], v[64:67]
    v_mfma_f32_16x16x32_bf16 v[68:71], a[136:139], a[116:119], v[68:71]
    v_mfma_f32_16x16x32_bf16 v[72:75], a[140:143], a[112:115], v[72:75]
    v_mfma_f32_16x16x32_bf16 v[76:79], a[140:143], a[116:119], v[76:79]
    v_mfma_f32_16x16x32_bf16 v[80:83], a[144:147], a[112:115], v[80:83]
    v_mfma_f32_16x16x32_bf16 v[84:87], a[144:147], a[116:119], v[84:87]
    s_waitcnt vmcnt(0)
    v_mfma_f32_16x16x32_bf16 v[32:35], a[164:167], a[156:159], v[32:35]
    v_mfma_f32_16x16x32_bf16 v[36:39], a[164:167], a[160:163], v[36:39]
    v_mfma_f32_16x16x32_bf16 v[40:43], a[168:171], a[156:159], v[40:43]
    v_mfma_f32_16x16x32_bf16 v[44:47], a[168:171], a[160:163], v[44:47]
    v_mfma_f32_16x16x32_bf16 v[48:51], a[172:175], a[156:159], v[48:51]
    v_mfma_f32_16x16x32_bf16 v[52:55], a[172:175], a[160:163], v[52:55]
    v_mfma_f32_16x16x32_bf16 v[56:59], a[176:179], a[156:159], v[56:59]
    v_mfma_f32_16x16x32_bf16 v[60:63], a[176:179], a[160:163], v[60:63]
    v_mfma_f32_16x16x32_bf16 v[64:67], a[180:183], a[156:159], v[64:67]
    v_mfma_f32_16x16x32_bf16 v[68:71], a[180:183], a[160:163], v[68:71]
    v_mfma_f32_16x16x32_bf16 v[72:75], a[184:187], a[156:159], v[72:75]
    v_mfma_f32_16x16x32_bf16 v[76:79], a[184:187], a[160:163], v[76:79]
    v_mfma_f32_16x16x32_bf16 v[80:83], a[188:191], a[156:159], v[80:83]
    v_mfma_f32_16x16x32_bf16 v[84:87], a[188:191], a[160:163], v[84:87]
    s_nop 7
    s_nop 3
    s_add_u32 s39, s38, 14336
    buffer_load_dwordx4 v[100:103], v28, s[12:15], s38 offen offset:448
    buffer_load_dwordx4 v[104:107], v28, s[12:15], s38 offen offset:464
    buffer_load_dwordx4 v[108:111], v29, s[12:15], s38 offen offset:576
    buffer_load_dwordx2 v[112:113], v30, s[12:15], s38 offen offset:640
    buffer_load_dwordx4 v[114:117], v28, s[12:15], s39 offen offset:448
    buffer_load_dwordx4 v[118:121], v28, s[12:15], s39 offen offset:464
    buffer_load_dwordx4 v[122:125], v29, s[12:15], s39 offen offset:576
    buffer_load_dwordx2 v[126:127], v30, s[12:15], s39 offen offset:640
    v_cvt_pk_bf16_f32 v128, v32, v40
    v_cvt_pk_bf16_f32 v129, v34, v42
    v_cvt_pk_bf16_f32 v130, v48, v56
    v_cvt_pk_bf16_f32 v131, v50, v58
    v_cvt_pk_bf16_f32 v132, v33, v41
    v_cvt_pk_bf16_f32 v133, v35, v43
    v_cvt_pk_bf16_f32 v134, v49, v57
    v_cvt_pk_bf16_f32 v135, v51, v59
    v_cvt_pk_bf16_f32 v136, v64, v72
    v_cvt_pk_bf16_f32 v137, v65, v73
    v_cvt_pk_bf16_f32 v138, v66, v74
    v_cvt_pk_bf16_f32 v139, v67, v75
    v_cvt_pk_bf16_f32 v140, v80, v81
    v_cvt_pk_bf16_f32 v141, v82, v83
    v_accvgpr_write_b32 a56, v128
    v_accvgpr_write_b32 a57, v129
    v_accvgpr_write_b32 a58, v130
    v_accvgpr_write_b32 a59, v131
    v_accvgpr_write_b32 a60, v132
    v_accvgpr_write_b32 a61, v133
    v_accvgpr_write_b32 a62, v134
    v_accvgpr_write_b32 a63, v135
    v_accvgpr_write_b32 a64, v136
    v_accvgpr_write_b32 a65, v137
    v_accvgpr_write_b32 a66, v138
    v_accvgpr_write_b32 a67, v139
    v_accvgpr_write_b32 a68, v140
    v_accvgpr_write_b32 a69, v141
    v_cvt_pk_bf16_f32 v128, v36, v44
    v_cvt_pk_bf16_f32 v129, v38, v46
    v_cvt_pk_bf16_f32 v130, v52, v60
    v_cvt_pk_bf16_f32 v131, v54, v62
    v_cvt_pk_bf16_f32 v132, v37, v45
    v_cvt_pk_bf16_f32 v133, v39, v47
    v_cvt_pk_bf16_f32 v134, v53, v61
    v_cvt_pk_bf16_f32 v135, v55, v63
    v_cvt_pk_bf16_f32 v136, v68, v76
    v_cvt_pk_bf16_f32 v137, v69, v77
    v_cvt_pk_bf16_f32 v138, v70, v78
    v_cvt_pk_bf16_f32 v139, v71, v79
    v_cvt_pk_bf16_f32 v140, v84, v85
    v_cvt_pk_bf16_f32 v141, v86, v87
    v_accvgpr_write_b32 a70, v128
    v_accvgpr_write_b32 a71, v129
    v_accvgpr_write_b32 a72, v130
    v_accvgpr_write_b32 a73, v131
    v_accvgpr_write_b32 a74, v132
    v_accvgpr_write_b32 a75, v133
    v_accvgpr_write_b32 a76, v134
    v_accvgpr_write_b32 a77, v135
    v_accvgpr_write_b32 a78, v136
    v_accvgpr_write_b32 a79, v137
    v_accvgpr_write_b32 a80, v138
    v_accvgpr_write_b32 a81, v139
    v_accvgpr_write_b32 a82, v140
    v_accvgpr_write_b32 a83, v141
    s_waitcnt vmcnt(0)
    s_nop 1
    v_mfma_f32_16x16x32_bf16 v[88:91], v[100:103], a[56:59], v[88:91]
    v_mfma_f32_16x16x32_bf16 v[92:95], v[100:103], a[70:73], v[92:95]
    v_mfma_f32_16x16x32_bf16 v[96:99], v[114:117], a[70:73], v[96:99]
    v_mfma_f32_16x16x32_bf16 v[88:91], v[104:107], a[60:63], v[88:91]
    v_mfma_f32_16x16x32_bf16 v[92:95], v[104:107], a[74:77], v[92:95]
    v_mfma_f32_16x16x32_bf16 v[96:99], v[118:121], a[74:77], v[96:99]
    v_mfma_f32_16x16x32_bf16 v[88:91], v[108:111], a[64:67], v[88:91]
    v_mfma_f32_16x16x32_bf16 v[92:95], v[108:111], a[78:81], v[92:95]
    v_mfma_f32_16x16x32_bf16 v[96:99], v[122:125], a[78:81], v[96:99]
    s_nop 4
    v_mfma_f32_16x16x16_bf16 v[88:91], v[112:113], a[68:69], v[88:91]
    v_mfma_f32_16x16x16_bf16 v[92:95], v[112:113], a[82:83], v[92:95]
    v_mfma_f32_16x16x16_bf16 v[96:99], v[126:127], a[82:83], v[96:99]
    s_add_u32 s29, s28, 301056
    s_add_u32 s30, s28, 315392
    s_add_u32 s31, s28, 329728
    s_add_u32 s32, s28, 344064
    s_add_u32 s33, s28, 358400
    s_add_u32 s34, s28, 372736
    s_add_u32 s35, s28, 387072
    buffer_load_dwordx4 a[112:115], v4, s[8:11], s24 offen offset:0
    buffer_load_dwordx4 a[116:119], v4, s[8:11], s25 offen offset:0
    buffer_load_dwordx4 a[120:123], v4, s[8:11], s29 offen offset:0
    buffer_load_dwordx4 a[124:127], v4, s[8:11], s30 offen offset:0
    buffer_load_dwordx4 a[128:131], v4, s[8:11], s31 offen offset:0
    buffer_load_dwordx4 a[132:135], v4, s[8:11], s32 offen offset:0
    buffer_load_dwordx4 a[136:139], v4, s[8:11], s33 offen offset:0
    buffer_load_dwordx4 a[140:143], v4, s[8:11], s34 offen offset:0
    buffer_load_dwordx4 a[144:147], v4, s[8:11], s35 offen offset:0
    buffer_load_dwordx4 a[156:159], v4, s[8:11], s24 offen offset:1024
    buffer_load_dwordx4 a[160:163], v4, s[8:11], s25 offen offset:1024
    buffer_load_dwordx4 a[164:167], v4, s[8:11], s29 offen offset:1024
    buffer_load_dwordx4 a[168:171], v4, s[8:11], s30 offen offset:1024
    buffer_load_dwordx4 a[172:175], v4, s[8:11], s31 offen offset:1024
    buffer_load_dwordx4 a[176:179], v4, s[8:11], s32 offen offset:1024
    buffer_load_dwordx4 a[180:183], v4, s[8:11], s33 offen offset:1024
    buffer_load_dwordx4 a[184:187], v4, s[8:11], s34 offen offset:1024
    buffer_load_dwordx4 a[188:191], v4, s[8:11], s35 offen offset:1024
    buffer_load_dwordx4 a[200:203], v4, s[8:11], s24 offen offset:2048
    buffer_load_dwordx4 a[204:207], v4, s[8:11], s25 offen offset:2048
    buffer_load_dwordx4 a[208:211], v4, s[8:11], s29 offen offset:2048
    buffer_load_dwordx4 a[212:215], v4, s[8:11], s30 offen offset:2048
    buffer_load_dwordx4 a[216:219], v4, s[8:11], s31 offen offset:2048
    buffer_load_dwordx4 a[220:223], v4, s[8:11], s32 offen offset:2048
    buffer_load_dwordx4 a[224:227], v4, s[8:11], s33 offen offset:2048
    buffer_load_dwordx4 a[228:231], v4, s[8:11], s34 offen offset:2048
    buffer_load_dwordx4 a[232:235], v4, s[8:11], s35 offen offset:2048
    s_waitcnt vmcnt(18)
    v_mfma_f32_16x16x32_bf16 v[32:35], a[120:123], a[112:115], 0
    v_mfma_f32_16x16x32_bf16 v[36:39], a[120:123], a[116:119], 0
    v_mfma_f32_16x16x32_bf16 v[40:43], a[124:127], a[112:115], 0
    v_mfma_f32_16x16x32_bf16 v[44:47], a[124:127], a[116:119], 0
    v_mfma_f32_16x16x32_bf16 v[48:51], a[128:131], a[112:115], 0
    v_mfma_f32_16x16x32_bf16 v[52:55], a[128:131], a[116:119], 0
    v_mfma_f32_16x16x32_bf16 v[56:59], a[132:135], a[112:115], 0
    v_mfma_f32_16x16x32_bf16 v[60:63], a[132:135], a[116:119], 0
    v_mfma_f32_16x16x32_bf16 v[64:67], a[136:139], a[112:115], 0
    v_mfma_f32_16x16x32_bf16 v[68:71], a[136:139], a[116:119], 0
    v_mfma_f32_16x16x32_bf16 v[72:75], a[140:143], a[112:115], 0
    v_mfma_f32_16x16x32_bf16 v[76:79], a[140:143], a[116:119], 0
    v_mfma_f32_16x16x32_bf16 v[80:83], a[144:147], a[112:115], 0
    v_mfma_f32_16x16x32_bf16 v[84:87], a[144:147], a[116:119], 0
    buffer_load_dwordx4 a[112:115], v4, s[8:11], s24 offen offset:3072
    buffer_load_dwordx4 a[116:119], v4, s[8:11], s25 offen offset:3072
    buffer_load_dwordx4 a[120:123], v4, s[8:11], s29 offen offset:3072
    buffer_load_dwordx4 a[124:127], v4, s[8:11], s30 offen offset:3072
    buffer_load_dwordx4 a[128:131], v4, s[8:11], s31 offen offset:3072
    buffer_load_dwordx4 a[132:135], v4, s[8:11], s32 offen offset:3072
    buffer_load_dwordx4 a[136:139], v4, s[8:11], s33 offen offset:3072
    buffer_load_dwordx4 a[140:143], v4, s[8:11], s34 offen offset:3072
    buffer_load_dwordx4 a[144:147], v4, s[8:11], s35 offen offset:3072
    s_waitcnt vmcnt(18)
    v_mfma_f32_16x16x32_bf16 v[32:35], a[164:167], a[156:159], v[32:35]
    v_mfma_f32_16x16x32_bf16 v[36:39], a[164:167], a[160:163], v[36:39]
    v_mfma_f32_16x16x32_bf16 v[40:43], a[168:171], a[156:159], v[40:43]
    v_mfma_f32_16x16x32_bf16 v[44:47], a[168:171], a[160:163], v[44:47]
    v_mfma_f32_16x16x32_bf16 v[48:51], a[172:175], a[156:159], v[48:51]
    v_mfma_f32_16x16x32_bf16 v[52:55], a[172:175], a[160:163], v[52:55]
    v_mfma_f32_16x16x32_bf16 v[56:59], a[176:179], a[156:159], v[56:59]
    v_mfma_f32_16x16x32_bf16 v[60:63], a[176:179], a[160:163], v[60:63]
    v_mfma_f32_16x16x32_bf16 v[64:67], a[180:183], a[156:159], v[64:67]
    v_mfma_f32_16x16x32_bf16 v[68:71], a[180:183], a[160:163], v[68:71]
    v_mfma_f32_16x16x32_bf16 v[72:75], a[184:187], a[156:159], v[72:75]
    v_mfma_f32_16x16x32_bf16 v[76:79], a[184:187], a[160:163], v[76:79]
    v_mfma_f32_16x16x32_bf16 v[80:83], a[188:191], a[156:159], v[80:83]
    v_mfma_f32_16x16x32_bf16 v[84:87], a[188:191], a[160:163], v[84:87]
    buffer_load_dwordx4 a[156:159], v5, s[8:11], s24 offen offset:0
    buffer_load_dwordx4 a[160:163], v5, s[8:11], s25 offen offset:0
    buffer_load_dwordx4 a[164:167], v5, s[8:11], s29 offen offset:0
    buffer_load_dwordx4 a[168:171], v5, s[8:11], s30 offen offset:0
    buffer_load_dwordx4 a[172:175], v5, s[8:11], s31 offen offset:0
    buffer_load_dwordx4 a[176:179], v5, s[8:11], s32 offen offset:0
    buffer_load_dwordx4 a[180:183], v5, s[8:11], s33 offen offset:0
    buffer_load_dwordx4 a[184:187], v5, s[8:11], s34 offen offset:0
    buffer_load_dwordx4 a[188:191], v5, s[8:11], s35 offen offset:0
    s_waitcnt vmcnt(18)
    v_mfma_f32_16x16x32_bf16 v[32:35], a[208:211], a[200:203], v[32:35]
    v_mfma_f32_16x16x32_bf16 v[36:39], a[208:211], a[204:207], v[36:39]
    v_mfma_f32_16x16x32_bf16 v[40:43], a[212:215], a[200:203], v[40:43]
    v_mfma_f32_16x16x32_bf16 v[44:47], a[212:215], a[204:207], v[44:47]
    v_mfma_f32_16x16x32_bf16 v[48:51], a[216:219], a[200:203], v[48:51]
    v_mfma_f32_16x16x32_bf16 v[52:55], a[216:219], a[204:207], v[52:55]
    v_mfma_f32_16x16x32_bf16 v[56:59], a[220:223], a[200:203], v[56:59]
    v_mfma_f32_16x16x32_bf16 v[60:63], a[220:223], a[204:207], v[60:63]
    v_mfma_f32_16x16x32_bf16 v[64:67], a[224:227], a[200:203], v[64:67]
    v_mfma_f32_16x16x32_bf16 v[68:71], a[224:227], a[204:207], v[68:71]
    v_mfma_f32_16x16x32_bf16 v[72:75], a[228:231], a[200:203], v[72:75]
    v_mfma_f32_16x16x32_bf16 v[76:79], a[228:231], a[204:207], v[76:79]
    v_mfma_f32_16x16x32_bf16 v[80:83], a[232:235], a[200:203], v[80:83]
    v_mfma_f32_16x16x32_bf16 v[84:87], a[232:235], a[204:207], v[84:87]
    buffer_load_dwordx4 a[200:203], v5, s[8:11], s24 offen offset:1024
    buffer_load_dwordx4 a[204:207], v5, s[8:11], s25 offen offset:1024
    buffer_load_dwordx4 a[208:211], v5, s[8:11], s29 offen offset:1024
    buffer_load_dwordx4 a[212:215], v5, s[8:11], s30 offen offset:1024
    buffer_load_dwordx4 a[216:219], v5, s[8:11], s31 offen offset:1024
    buffer_load_dwordx4 a[220:223], v5, s[8:11], s32 offen offset:1024
    buffer_load_dwordx4 a[224:227], v5, s[8:11], s33 offen offset:1024
    buffer_load_dwordx4 a[228:231], v5, s[8:11], s34 offen offset:1024
    buffer_load_dwordx4 a[232:235], v5, s[8:11], s35 offen offset:1024
    s_waitcnt vmcnt(18)
    v_mfma_f32_16x16x32_bf16 v[32:35], a[120:123], a[112:115], v[32:35]
    v_mfma_f32_16x16x32_bf16 v[36:39], a[120:123], a[116:119], v[36:39]
    v_mfma_f32_16x16x32_bf16 v[40:43], a[124:127], a[112:115], v[40:43]
    v_mfma_f32_16x16x32_bf16 v[44:47], a[124:127], a[116:119], v[44:47]
    v_mfma_f32_16x16x32_bf16 v[48:51], a[128:131], a[112:115], v[48:51]
    v_mfma_f32_16x16x32_bf16 v[52:55], a[128:131], a[116:119], v[52:55]
    v_mfma_f32_16x16x32_bf16 v[56:59], a[132:135], a[112:115], v[56:59]
    v_mfma_f32_16x16x32_bf16 v[60:63], a[132:135], a[116:119], v[60:63]
    v_mfma_f32_16x16x32_bf16 v[64:67], a[136:139], a[112:115], v[64:67]
    v_mfma_f32_16x16x32_bf16 v[68:71], a[136:139], a[116:119], v[68:71]
    v_mfma_f32_16x16x32_bf16 v[72:75], a[140:143], a[112:115], v[72:75]
    v_mfma_f32_16x16x32_bf16 v[76:79], a[140:143], a[116:119], v[76:79]
    v_mfma_f32_16x16x32_bf16 v[80:83], a[144:147], a[112:115], v[80:83]
    v_mfma_f32_16x16x32_bf16 v[84:87], a[144:147], a[116:119], v[84:87]
    buffer_load_dwordx4 a[112:115], v5, s[8:11], s24 offen offset:2048
    buffer_load_dwordx4 a[116:119], v5, s[8:11], s25 offen offset:2048
    buffer_load_dwordx4 a[120:123], v5, s[8:11], s29 offen offset:2048
    buffer_load_dwordx4 a[124:127], v5, s[8:11], s30 offen offset:2048
    buffer_load_dwordx4 a[128:131], v5, s[8:11], s31 offen offset:2048
    buffer_load_dwordx4 a[132:135], v5, s[8:11], s32 offen offset:2048
    buffer_load_dwordx4 a[136:139], v5, s[8:11], s33 offen offset:2048
    buffer_load_dwordx4 a[140:143], v5, s[8:11], s34 offen offset:2048
    buffer_load_dwordx4 a[144:147], v5, s[8:11], s35 offen offset:2048
    s_waitcnt vmcnt(18)
    v_mfma_f32_16x16x32_bf16 v[32:35], a[164:167], a[156:159], v[32:35]
    v_mfma_f32_16x16x32_bf16 v[36:39], a[164:167], a[160:163], v[36:39]
    v_mfma_f32_16x16x32_bf16 v[40:43], a[168:171], a[156:159], v[40:43]
    v_mfma_f32_16x16x32_bf16 v[44:47], a[168:171], a[160:163], v[44:47]
    v_mfma_f32_16x16x32_bf16 v[48:51], a[172:175], a[156:159], v[48:51]
    v_mfma_f32_16x16x32_bf16 v[52:55], a[172:175], a[160:163], v[52:55]
    v_mfma_f32_16x16x32_bf16 v[56:59], a[176:179], a[156:159], v[56:59]
    v_mfma_f32_16x16x32_bf16 v[60:63], a[176:179], a[160:163], v[60:63]
    v_mfma_f32_16x16x32_bf16 v[64:67], a[180:183], a[156:159], v[64:67]
    v_mfma_f32_16x16x32_bf16 v[68:71], a[180:183], a[160:163], v[68:71]
    v_mfma_f32_16x16x32_bf16 v[72:75], a[184:187], a[156:159], v[72:75]
    v_mfma_f32_16x16x32_bf16 v[76:79], a[184:187], a[160:163], v[76:79]
    v_mfma_f32_16x16x32_bf16 v[80:83], a[188:191], a[156:159], v[80:83]
    v_mfma_f32_16x16x32_bf16 v[84:87], a[188:191], a[160:163], v[84:87]
    buffer_load_dwordx4 a[156:159], v5, s[8:11], s24 offen offset:3072
    buffer_load_dwordx4 a[160:163], v5, s[8:11], s25 offen offset:3072
    buffer_load_dwordx4 a[164:167], v5, s[8:11], s29 offen offset:3072
    buffer_load_dwordx4 a[168:171], v5, s[8:11], s30 offen offset:3072
    buffer_load_dwordx4 a[172:175], v5, s[8:11], s31 offen offset:3072
    buffer_load_dwordx4 a[176:179], v5, s[8:11], s32 offen offset:3072
    buffer_load_dwordx4 a[180:183], v5, s[8:11], s33 offen offset:3072
    buffer_load_dwordx4 a[184:187], v5, s[8:11], s34 offen offset:3072
    buffer_load_dwordx4 a[188:191], v5, s[8:11], s35 offen offset:3072
    s_waitcnt vmcnt(18)
    v_mfma_f32_16x16x32_bf16 v[32:35], a[208:211], a[200:203], v[32:35]
    v_mfma_f32_16x16x32_bf16 v[36:39], a[208:211], a[204:207], v[36:39]
    v_mfma_f32_16x16x32_bf16 v[40:43], a[212:215], a[200:203], v[40:43]
    v_mfma_f32_16x16x32_bf16 v[44:47], a[212:215], a[204:207], v[44:47]
    v_mfma_f32_16x16x32_bf16 v[48:51], a[216:219], a[200:203], v[48:51]
    v_mfma_f32_16x16x32_bf16 v[52:55], a[216:219], a[204:207], v[52:55]
    v_mfma_f32_16x16x32_bf16 v[56:59], a[220:223], a[200:203], v[56:59]
    v_mfma_f32_16x16x32_bf16 v[60:63], a[220:223], a[204:207], v[60:63]
    v_mfma_f32_16x16x32_bf16 v[64:67], a[224:227], a[200:203], v[64:67]
    v_mfma_f32_16x16x32_bf16 v[68:71], a[224:227], a[204:207], v[68:71]
    v_mfma_f32_16x16x32_bf16 v[72:75], a[228:231], a[200:203], v[72:75]
    v_mfma_f32_16x16x32_bf16 v[76:79], a[228:231], a[204:207], v[76:79]
    v_mfma_f32_16x16x32_bf16 v[80:83], a[232:235], a[200:203], v[80:83]
    v_mfma_f32_16x16x32_bf16 v[84:87], a[232:235], a[204:207], v[84:87]
    buffer_load_dwordx4 a[200:203], v6, s[8:11], s24 offen offset:0
    buffer_load_dwordx4 a[204:207], v6, s[8:11], s25 offen offset:0
    buffer_load_dwordx4 a[208:211], v6, s[8:11], s29 offen offset:0
    buffer_load_dwordx4 a[212:215], v6, s[8:11], s30 offen offset:0
    buffer_load_dwordx4 a[216:219], v6, s[8:11], s31 offen offset:0
    buffer_load_dwordx4 a[220:223], v6, s[8:11], s32 offen offset:0
    buffer_load_dwordx4 a[224:227], v6, s[8:11], s33 offen offset:0
    buffer_load_dwordx4 a[228:231], v6, s[8:11], s34 offen offset:0
    buffer_load_dwordx4 a[232:235], v6, s[8:11], s35 offen offset:0
    s_waitcnt vmcnt(18)
    v_mfma_f32_16x16x32_bf16 v[32:35], a[120:123], a[112:115], v[32:35]
    v_mfma_f32_16x16x32_bf16 v[36:39], a[120:123], a[116:119], v[36:39]
    v_mfma_f32_16x16x32_bf16 v[40:43], a[124:127], a[112:115], v[40:43]
    v_mfma_f32_16x16x32_bf16 v[44:47], a[124:127], a[116:119], v[44:47]
    v_mfma_f32_16x16x32_bf16 v[48:51], a[128:131], a[112:115], v[48:51]
    v_mfma_f32_16x16x32_bf16 v[52:55], a[128:131], a[116:119], v[52:55]
    v_mfma_f32_16x16x32_bf16 v[56:59], a[132:135], a[112:115], v[56:59]
    v_mfma_f32_16x16x32_bf16 v[60:63], a[132:135], a[116:119], v[60:63]
    v_mfma_f32_16x16x32_bf16 v[64:67], a[136:139], a[112:115], v[64:67]
    v_mfma_f32_16x16x32_bf16 v[68:71], a[136:139], a[116:119], v[68:71]
    v_mfma_f32_16x16x32_bf16 v[72:75], a[140:143], a[112:115], v[72:75]
    v_mfma_f32_16x16x32_bf16 v[76:79], a[140:143], a[116:119], v[76:79]
    v_mfma_f32_16x16x32_bf16 v[80:83], a[144:147], a[112:115], v[80:83]
    v_mfma_f32_16x16x32_bf16 v[84:87], a[144:147], a[116:119], v[84:87]
    buffer_load_dwordx4 a[112:115], v6, s[8:11], s24 offen offset:1024
    buffer_load_dwordx4 a[116:119], v6, s[8:11], s25 offen offset:1024
    buffer_load_dwordx4 a[120:123], v6, s[8:11], s29 offen offset:1024
    buffer_load_dwordx4 a[124:127], v6, s[8:11], s30 offen offset:1024
    buffer_load_dwordx4 a[128:131], v6, s[8:11], s31 offen offset:1024
    buffer_load_dwordx4 a[132:135], v6, s[8:11], s32 offen offset:1024
    buffer_load_dwordx4 a[136:139], v6, s[8:11], s33 offen offset:1024
    buffer_load_dwordx4 a[140:143], v6, s[8:11], s34 offen offset:1024
    buffer_load_dwordx4 a[144:147], v6, s[8:11], s35 offen offset:1024
    s_waitcnt vmcnt(18)
    v_mfma_f32_16x16x32_bf16 v[32:35], a[164:167], a[156:159], v[32:35]
    v_mfma_f32_16x16x32_bf16 v[36:39], a[164:167], a[160:163], v[36:39]
    v_mfma_f32_16x16x32_bf16 v[40:43], a[168:171], a[156:159], v[40:43]
    v_mfma_f32_16x16x32_bf16 v[44:47], a[168:171], a[160:163], v[44:47]
    v_mfma_f32_16x16x32_bf16 v[48:51], a[172:175], a[156:159], v[48:51]
    v_mfma_f32_16x16x32_bf16 v[52:55], a[172:175], a[160:163], v[52:55]
    v_mfma_f32_16x16x32_bf16 v[56:59], a[176:179], a[156:159], v[56:59]
    v_mfma_f32_16x16x32_bf16 v[60:63], a[176:179], a[160:163], v[60:63]
    v_mfma_f32_16x16x32_bf16 v[64:67], a[180:183], a[156:159], v[64:67]
    v_mfma_f32_16x16x32_bf16 v[68:71], a[180:183], a[160:163], v[68:71]
    v_mfma_f32_16x16x32_bf16 v[72:75], a[184:187], a[156:159], v[72:75]
    v_mfma_f32_16x16x32_bf16 v[76:79], a[184:187], a[160:163], v[76:79]
    v_mfma_f32_16x16x32_bf16 v[80:83], a[188:191], a[156:159], v[80:83]
    v_mfma_f32_16x16x32_bf16 v[84:87], a[188:191], a[160:163], v[84:87]
    buffer_load_dwordx4 a[156:159], v6, s[8:11], s24 offen offset:2048
    buffer_load_dwordx4 a[160:163], v6, s[8:11], s25 offen offset:2048
    buffer_load_dwordx4 a[164:167], v6, s[8:11], s29 offen offset:2048
    buffer_load_dwordx4 a[168:171], v6, s[8:11], s30 offen offset:2048
    buffer_load_dwordx4 a[172:175], v6, s[8:11], s31 offen offset:2048
    buffer_load_dwordx4 a[176:179], v6, s[8:11], s32 offen offset:2048
    buffer_load_dwordx4 a[180:183], v6, s[8:11], s33 offen offset:2048
    buffer_load_dwordx4 a[184:187], v6, s[8:11], s34 offen offset:2048
    buffer_load_dwordx4 a[188:191], v6, s[8:11], s35 offen offset:2048
    s_waitcnt vmcnt(18)
    v_mfma_f32_16x16x32_bf16 v[32:35], a[208:211], a[200:203], v[32:35]
    v_mfma_f32_16x16x32_bf16 v[36:39], a[208:211], a[204:207], v[36:39]
    v_mfma_f32_16x16x32_bf16 v[40:43], a[212:215], a[200:203], v[40:43]
    v_mfma_f32_16x16x32_bf16 v[44:47], a[212:215], a[204:207], v[44:47]
    v_mfma_f32_16x16x32_bf16 v[48:51], a[216:219], a[200:203], v[48:51]
    v_mfma_f32_16x16x32_bf16 v[52:55], a[216:219], a[204:207], v[52:55]
    v_mfma_f32_16x16x32_bf16 v[56:59], a[220:223], a[200:203], v[56:59]
    v_mfma_f32_16x16x32_bf16 v[60:63], a[220:223], a[204:207], v[60:63]
    v_mfma_f32_16x16x32_bf16 v[64:67], a[224:227], a[200:203], v[64:67]
    v_mfma_f32_16x16x32_bf16 v[68:71], a[224:227], a[204:207], v[68:71]
    v_mfma_f32_16x16x32_bf16 v[72:75], a[228:231], a[200:203], v[72:75]
    v_mfma_f32_16x16x32_bf16 v[76:79], a[228:231], a[204:207], v[76:79]
    v_mfma_f32_16x16x32_bf16 v[80:83], a[232:235], a[200:203], v[80:83]
    v_mfma_f32_16x16x32_bf16 v[84:87], a[232:235], a[204:207], v[84:87]
    buffer_load_dwordx4 a[200:203], v6, s[8:11], s24 offen offset:3072
    buffer_load_dwordx4 a[204:207], v6, s[8:11], s25 offen offset:3072
    buffer_load_dwordx4 a[208:211], v6, s[8:11], s29 offen offset:3072
    buffer_load_dwordx4 a[212:215], v6, s[8:11], s30 offen offset:3072
    buffer_load_dwordx4 a[216:219], v6, s[8:11], s31 offen offset:3072
    buffer_load_dwordx4 a[220:223], v6, s[8:11], s32 offen offset:3072
    buffer_load_dwordx4 a[224:227], v6, s[8:11], s33 offen offset:3072
    buffer_load_dwordx4 a[228:231], v6, s[8:11], s34 offen offset:3072
    buffer_load_dwordx4 a[232:235], v6, s[8:11], s35 offen offset:3072
    s_waitcnt vmcnt(18)
    v_mfma_f32_16x16x32_bf16 v[32:35], a[120:123], a[112:115], v[32:35]
    v_mfma_f32_16x16x32_bf16 v[36:39], a[120:123], a[116:119], v[36:39]
    v_mfma_f32_16x16x32_bf16 v[40:43], a[124:127], a[112:115], v[40:43]
    v_mfma_f32_16x16x32_bf16 v[44:47], a[124:127], a[116:119], v[44:47]
    v_mfma_f32_16x16x32_bf16 v[48:51], a[128:131], a[112:115], v[48:51]
    v_mfma_f32_16x16x32_bf16 v[52:55], a[128:131], a[116:119], v[52:55]
    v_mfma_f32_16x16x32_bf16 v[56:59], a[132:135], a[112:115], v[56:59]
    v_mfma_f32_16x16x32_bf16 v[60:63], a[132:135], a[116:119], v[60:63]
    v_mfma_f32_16x16x32_bf16 v[64:67], a[136:139], a[112:115], v[64:67]
    v_mfma_f32_16x16x32_bf16 v[68:71], a[136:139], a[116:119], v[68:71]
    v_mfma_f32_16x16x32_bf16 v[72:75], a[140:143], a[112:115], v[72:75]
    v_mfma_f32_16x16x32_bf16 v[76:79], a[140:143], a[116:119], v[76:79]
    v_mfma_f32_16x16x32_bf16 v[80:83], a[144:147], a[112:115], v[80:83]
    v_mfma_f32_16x16x32_bf16 v[84:87], a[144:147], a[116:119], v[84:87]
    buffer_load_dwordx4 a[112:115], v7, s[8:11], s24 offen offset:0
    buffer_load_dwordx4 a[116:119], v7, s[8:11], s25 offen offset:0
    buffer_load_dwordx4 a[120:123], v7, s[8:11], s29 offen offset:0
    buffer_load_dwordx4 a[124:127], v7, s[8:11], s30 offen offset:0
    buffer_load_dwordx4 a[128:131], v7, s[8:11], s31 offen offset:0
    buffer_load_dwordx4 a[132:135], v7, s[8:11], s32 offen offset:0
    buffer_load_dwordx4 a[136:139], v7, s[8:11], s33 offen offset:0
    buffer_load_dwordx4 a[140:143], v7, s[8:11], s34 offen offset:0
    buffer_load_dwordx4 a[144:147], v7, s[8:11], s35 offen offset:0
    s_waitcnt vmcnt(18)
    v_mfma_f32_16x16x32_bf16 v[32:35], a[164:167], a[156:159], v[32:35]
    v_mfma_f32_16x16x32_bf16 v[36:39], a[164:167], a[160:163], v[36:39]
    v_mfma_f32_16x16x32_bf16 v[40:43], a[168:171], a[156:159], v[40:43]
    v_mfma_f32_16x16x32_bf16 v[44:47], a[168:171], a[160:163], v[44:47]
    v_mfma_f32_16x16x32_bf16 v[48:51], a[172:175], a[156:159], v[48:51]
    v_mfma_f32_16x16x32_bf16 v[52:55], a[172:175], a[160:163], v[52:55]
    v_mfma_f32_16x16x32_bf16 v[56:59], a[176:179], a[156:159], v[56:59]
    v_mfma_f32_16x16x32_bf16 v[60:63], a[176:179], a[160:163], v[60:63]
    v_mfma_f32_16x16x32_bf16 v[64:67], a[180:183], a[156:159], v[64:67]
    v_mfma_f32_16x16x32_bf16 v[68:71], a[180:183], a[160:163], v[68:71]
    v_mfma_f32_16x16x32_bf16 v[72:75], a[184:187], a[156:159], v[72:75]
    v_mfma_f32_16x16x32_bf16 v[76:79], a[184:187], a[160:163], v[76:79]
    v_mfma_f32_16x16x32_bf16 v[80:83], a[188:191], a[156:159], v[80:83]
    v_mfma_f32_16x16x32_bf16 v[84:87], a[188:191], a[160:163], v[84:87]
    buffer_load_dwordx4 a[156:159], v7, s[8:11], s24 offen offset:1024
    buffer_load_dwordx4 a[160:163], v7, s[8:11], s25 offen offset:1024
    buffer_load_dwordx4 a[164:167], v7, s[8:11], s29 offen offset:1024
    buffer_load_dwordx4 a[168:171], v7, s[8:11], s30 offen offset:1024
    buffer_load_dwordx4 a[172:175], v7, s[8:11], s31 offen offset:1024
    buffer_load_dwordx4 a[176:179], v7, s[8:11], s32 offen offset:1024
    buffer_load_dwordx4 a[180:183], v7, s[8:11], s33 offen offset:1024
    buffer_load_dwordx4 a[184:187], v7, s[8:11], s34 offen offset:1024
    buffer_load_dwordx4 a[188:191], v7, s[8:11], s35 offen offset:1024
    s_waitcnt vmcnt(18)
    v_mfma_f32_16x16x32_bf16 v[32:35], a[208:211], a[200:203], v[32:35]
    v_mfma_f32_16x16x32_bf16 v[36:39], a[208:211], a[204:207], v[36:39]
    v_mfma_f32_16x16x32_bf16 v[40:43], a[212:215], a[200:203], v[40:43]
    v_mfma_f32_16x16x32_bf16 v[44:47], a[212:215], a[204:207], v[44:47]
    v_mfma_f32_16x16x32_bf16 v[48:51], a[216:219], a[200:203], v[48:51]
    v_mfma_f32_16x16x32_bf16 v[52:55], a[216:219], a[204:207], v[52:55]
    v_mfma_f32_16x16x32_bf16 v[56:59], a[220:223], a[200:203], v[56:59]
    v_mfma_f32_16x16x32_bf16 v[60:63], a[220:223], a[204:207], v[60:63]
    v_mfma_f32_16x16x32_bf16 v[64:67], a[224:227], a[200:203], v[64:67]
    v_mfma_f32_16x16x32_bf16 v[68:71], a[224:227], a[204:207], v[68:71]
    v_mfma_f32_16x16x32_bf16 v[72:75], a[228:231], a[200:203], v[72:75]
    v_mfma_f32_16x16x32_bf16 v[76:79], a[228:231], a[204:207], v[76:79]
    v_mfma_f32_16x16x32_bf16 v[80:83], a[232:235], a[200:203], v[80:83]
    v_mfma_f32_16x16x32_bf16 v[84:87], a[232:235], a[204:207], v[84:87]
    s_waitcnt vmcnt(9)
    v_mfma_f32_16x16x32_bf16 v[32:35], a[120:123], a[112:115], v[32:35]
    v_mfma_f32_16x16x32_bf16 v[36:39], a[120:123], a[116:119], v[36:39]
    v_mfma_f32_16x16x32_bf16 v[40:43], a[124:127], a[112:115], v[40:43]
    v_mfma_f32_16x16x32_bf16 v[44:47], a[124:127], a[116:119], v[44:47]
    v_mfma_f32_16x16x32_bf16 v[48:51], a[128:131], a[112:115], v[48:51]
    v_mfma_f32_16x16x32_bf16 v[52:55], a[128:131], a[116:119], v[52:55]
    v_mfma_f32_16x16x32_bf16 v[56:59], a[132:135], a[112:115], v[56:59]
    v_mfma_f32_16x16x32_bf16 v[60:63], a[132:135], a[116:119], v[60:63]
    v_mfma_f32_16x16x32_bf16 v[64:67], a[136:139], a[112:115], v[64:67]
    v_mfma_f32_16x16x32_bf16 v[68:71], a[136:139], a[116:119], v[68:71]
    v_mfma_f32_16x16x32_bf16 v[72:75], a[140:143], a[112:115], v[72:75]
    v_mfma_f32_16x16x32_bf16 v[76:79], a[140:143], a[116:119], v[76:79]
    v_mfma_f32_16x16x32_bf16 v[80:83], a[144:147], a[112:115], v[80:83]
    v_mfma_f32_16x16x32_bf16 v[84:87], a[144:147], a[116:119], v[84:87]
    s_waitcnt vmcnt(0)
    v_mfma_f32_16x16x32_bf16 v[32:35], a[164:167], a[156:159], v[32:35]
    v_mfma_f32_16x16x32_bf16 v[36:39], a[164:167], a[160:163], v[36:39]
    v_mfma_f32_16x16x32_bf16 v[40:43], a[168:171], a[156:159], v[40:43]
    v_mfma_f32_16x16x32_bf16 v[44:47], a[168:171], a[160:163], v[44:47]
    v_mfma_f32_16x16x32_bf16 v[48:51], a[172:175], a[156:159], v[48:51]
    v_mfma_f32_16x16x32_bf16 v[52:55], a[172:175], a[160:163], v[52:55]
    v_mfma_f32_16x16x32_bf16 v[56:59], a[176:179], a[156:159], v[56:59]
    v_mfma_f32_16x16x32_bf16 v[60:63], a[176:179], a[160:163], v[60:63]
    v_mfma_f32_16x16x32_bf16 v[64:67], a[180:183], a[156:159], v[64:67]
    v_mfma_f32_16x16x32_bf16 v[68:71], a[180:183], a[160:163], v[68:71]
    v_mfma_f32_16x16x32_bf16 v[72:75], a[184:187], a[156:159], v[72:75]
    v_mfma_f32_16x16x32_bf16 v[76:79], a[184:187], a[160:163], v[76:79]
    v_mfma_f32_16x16x32_bf16 v[80:83], a[188:191], a[156:159], v[80:83]
    v_mfma_f32_16x16x32_bf16 v[84:87], a[188:191], a[160:163], v[84:87]
    s_nop 7
    s_nop 3
    s_add_u32 s39, s38, 14336
    buffer_load_dwordx4 v[100:103], v28, s[12:15], s38 offen offset:672
    buffer_load_dwordx4 v[104:107], v28, s[12:15], s38 offen offset:688
    buffer_load_dwordx4 v[108:111], v29, s[12:15], s38 offen offset:800
    buffer_load_dwordx2 v[112:113], v30, s[12:15], s38 offen offset:864
    buffer_load_dwordx4 v[114:117], v28, s[12:15], s39 offen offset:672
    buffer_load_dwordx4 v[118:121], v28, s[12:15], s39 offen offset:688
    buffer_load_dwordx4 v[122:125], v29, s[12:15], s39 offen offset:800
    buffer_load_dwordx2 v[126:127], v30, s[12:15], s39 offen offset:864
    v_cvt_pk_bf16_f32 v128, v32, v40
    v_cvt_pk_bf16_f32 v129, v34, v42
    v_cvt_pk_bf16_f32 v130, v48, v56
    v_cvt_pk_bf16_f32 v131, v50, v58
    v_cvt_pk_bf16_f32 v132, v33, v41
    v_cvt_pk_bf16_f32 v133, v35, v43
    v_cvt_pk_bf16_f32 v134, v49, v57
    v_cvt_pk_bf16_f32 v135, v51, v59
    v_cvt_pk_bf16_f32 v136, v64, v72
    v_cvt_pk_bf16_f32 v137, v65, v73
    v_cvt_pk_bf16_f32 v138, v66, v74
    v_cvt_pk_bf16_f32 v139, v67, v75
    v_cvt_pk_bf16_f32 v140, v80, v81
    v_cvt_pk_bf16_f32 v141, v82, v83
    v_accvgpr_write_b32 a84, v128
    v_accvgpr_write_b32 a85, v129
    v_accvgpr_write_b32 a86, v130
    v_accvgpr_write_b32 a87, v131
    v_accvgpr_write_b32 a88, v132
    v_accvgpr_write_b32 a89, v133
    v_accvgpr_write_b32 a90, v134
    v_accvgpr_write_b32 a91, v135
    v_accvgpr_write_b32 a92, v136
    v_accvgpr_write_b32 a93, v137
    v_accvgpr_write_b32 a94, v138
    v_accvgpr_write_b32 a95, v139
    v_accvgpr_write_b32 a96, v140
    v_accvgpr_write_b32 a97, v141
    v_cvt_pk_bf16_f32 v128, v36, v44
    v_cvt_pk_bf16_f32 v129, v38, v46
    v_cvt_pk_bf16_f32 v130, v52, v60
    v_cvt_pk_bf16_f32 v131, v54, v62
    v_cvt_pk_bf16_f32 v132, v37, v45
    v_cvt_pk_bf16_f32 v133, v39, v47
    v_cvt_pk_bf16_f32 v134, v53, v61
    v_cvt_pk_bf16_f32 v135, v55, v63
    v_cvt_pk_bf16_f32 v136, v68, v76
    v_cvt_pk_bf16_f32 v137, v69, v77
    v_cvt_pk_bf16_f32 v138, v70, v78
    v_cvt_pk_bf16_f32 v139, v71, v79
    v_cvt_pk_bf16_f32 v140, v84, v85
    v_cvt_pk_bf16_f32 v141, v86, v87
    v_accvgpr_write_b32 a98, v128
    v_accvgpr_write_b32 a99, v129
    v_accvgpr_write_b32 a100, v130
    v_accvgpr_write_b32 a101, v131
    v_accvgpr_write_b32 a102, v132
    v_accvgpr_write_b32 a103, v133
    v_accvgpr_write_b32 a104, v134
    v_accvgpr_write_b32 a105, v135
    v_accvgpr_write_b32 a106, v136
    v_accvgpr_write_b32 a107, v137
    v_accvgpr_write_b32 a108, v138
    v_accvgpr_write_b32 a109, v139
    v_accvgpr_write_b32 a110, v140
    v_accvgpr_write_b32 a111, v141
    s_waitcnt vmcnt(0)
    s_nop 1
    v_mfma_f32_16x16x32_bf16 v[88:91], v[100:103], a[84:87], v[88:91]
    v_mfma_f32_16x16x32_bf16 v[92:95], v[100:103], a[98:101], v[92:95]
    v_mfma_f32_16x16x32_bf16 v[96:99], v[114:117], a[98:101], v[96:99]
    v_mfma_f32_16x16x32_bf16 v[88:91], v[104:107], a[88:91], v[88:91]
    v_mfma_f32_16x16x32_bf16 v[92:95], v[104:107], a[102:105], v[92:95]
    v_mfma_f32_16x16x32_bf16 v[96:99], v[118:121], a[102:105], v[96:99]
    v_mfma_f32_16x16x32_bf16 v[88:91], v[108:111], a[92:95], v[88:91]
    v_mfma_f32_16x16x32_bf16 v[92:95], v[108:111], a[106:109], v[92:95]
    v_mfma_f32_16x16x32_bf16 v[96:99], v[122:125], a[106:109], v[96:99]
    s_nop 4
    v_mfma_f32_16x16x16_bf16 v[88:91], v[112:113], a[96:97], v[88:91]
    v_mfma_f32_16x16x16_bf16 v[92:95], v[112:113], a[110:111], v[92:95]
    v_mfma_f32_16x16x16_bf16 v[96:99], v[126:127], a[110:111], v[96:99]
    s_cmp_ge_u32 s7, 14
    s_cbranch_scc1 .w3_nopre
    v_lshlrev_b32 v9, 2, v2
    s_lshl_b32 s24, s6, 6
    s_add_u32 s24, s24, 18110464
    s_mov_b32 s36, 0
.wf_12:
    buffer_load_dword v8, v9, s[8:11], s24 offen sc1
    s_waitcnt vmcnt(0)
    v_cmp_eq_u32 vcc, 0, v8
    s_cbranch_vccz .wfd_13
    s_sleep 2
    s_add_u32 s36, s36, 1
    s_cmp_lt_u32 s36, 2097152
    s_cbranch_scc1 .wf_12
    s_endpgm
.wfd_13:
    v_lshlrev_b32 v9, 7, v0
    s_lshr_b32 s24, s6, 1
    s_lshl_b32 s24, s24, 2
    s_add_u32 s24, s24, 18100224
    s_mov_b32 s36, 0
.wf_14:
    buffer_load_dword v8, v9, s[8:11], s24 offen sc1
    s_waitcnt vmcnt(0)
    v_cmp_eq_u32 vcc, 0, v8
    s_cbranch_vccz .wfd_15
    s_sleep 2
    s_add_u32 s36, s36, 1
    s_cmp_lt_u32 s36, 2097152
    s_cbranch_scc1 .wf_14
    s_endpgm
.wfd_15:
    s_lshl_b32 s24, s6, 15
    s_add_u32 s24, s24, 61243392
    s_lshl_b32 s25, s7, 11
    s_add_u32 s25, s25, 16056320
    buffer_load_dwordx4 v[128:131], v3, s[8:11], s24 offen offset:0 sc1
    buffer_load_dwordx4 v[132:135], v3, s[8:11], s24 offen offset:1024 sc1
    buffer_load_dwordx4 v[136:139], v3, s[8:11], s25 offen offset:0
    buffer_load_dwordx4 v[140:143], v3, s[8:11], s25 offen offset:1024
    s_add_u32 s24, s24, 2048
    s_add_u32 s25, s25, 28672
    buffer_load_dwordx4 v[144:147], v3, s[8:11], s24 offen offset:0 sc1
    buffer_load_dwordx4 v[148:151], v3, s[8:11], s24 offen offset:1024 sc1
    buffer_load_dwordx4 v[152:155], v3, s[8:11], s25 offen offset:0
    buffer_load_dwordx4 v[156:159], v3, s[8:11], s25 offen offset:1024
    s_add_u32 s24, s24, 2048
    s_add_u32 s25, s25, 28672
    buffer_load_dwordx4 v[160:163], v3, s[8:11], s24 offen offset:0 sc1
    buffer_load_dwordx4 v[164:167], v3, s[8:11], s24 offen offset:1024 sc1
    buffer_load_dwordx4 v[168:171], v3, s[8:11], s25 offen offset:0
    buffer_load_dwordx4 v[172:175], v3, s[8:11], s25 offen offset:1024
    s_add_u32 s24, s24, 2048
    s_add_u32 s25, s25, 28672
    buffer_load_dwordx4 v[176:179], v3, s[8:11], s24 offen offset:0 sc1
    buffer_load_dwordx4 v[180:183], v3, s[8:11], s24 offen offset:1024 sc1
    buffer_load_dwordx4 v[184:187], v3, s[8:11], s25 offen offset:0
    buffer_load_dwordx4 v[188:191], v3, s[8:11], s25 offen offset:1024
    s_add_u32 s24, s24, 2048
    s_add_u32 s25, s25, 28672
    buffer_load_dwordx4 v[192:195], v3, s[8:11], s24 offen offset:0 sc1
    buffer_load_dwordx4 v[196:199], v3, s[8:11], s24 offen offset:1024 sc1
    buffer_load_dwordx4 v[200:203], v3, s[8:11], s25 offen offset:0
    buffer_load_dwordx4 v[204:207], v3, s[8:11], s25 offen offset:1024
    s_add_u32 s24, s24, 2048
    s_add_u32 s25, s25, 28672
    buffer_load_dwordx4 v[208:211], v3, s[8:11], s24 offen offset:0 sc1
    buffer_load_dwordx4 v[212:215], v3, s[8:11], s24 offen offset:1024 sc1
    buffer_load_dwordx4 v[216:219], v3, s[8:11], s25 offen offset:0
    buffer_load_dwordx4 v[220:223], v3, s[8:11], s25 offen offset:1024
    s_add_u32 s24, s24, 2048
    s_add_u32 s25, s25, 28672
    buffer_load_dwordx4 v[224:227], v3, s[8:11], s24 offen offset:0 sc1
    buffer_load_dwordx4 v[228:231], v3, s[8:11], s24 offen offset:1024 sc1
    buffer_load_dwordx4 v[232:235], v3, s[8:11], s25 offen offset:0
    buffer_load_dwordx4 v[236:239], v3, s[8:11], s25 offen offset:1024
    s_add_u32 s24, s24, 2048
    s_add_u32 s25, s25, 28672
    buffer_load_dwordx4 v[240:243], v3, s[8:11], s24 offen offset:0 sc1
    buffer_load_dwordx4 v[244:247], v3, s[8:11], s24 offen offset:1024 sc1
    buffer_load_dwordx4 v[248:251], v3, s[8:11], s25 offen offset:0
    buffer_load_dwordx4 v[252:255], v3, s[8:11], s25 offen offset:1024
    s_add_u32 s24, s24, 2048
    s_add_u32 s25, s25, 28672
    s_waitcnt vmcnt(28)
    v_mfma_f32_16x16x32_bf16 v[12:15], v[136:139], v[128:131], 0
    v_mfma_f32_16x16x32_bf16 v[16:19], v[140:143], v[128:131], 0
    v_mfma_f32_16x16x32_bf16 v[20:23], v[136:139], v[132:135], 0
    v_mfma_f32_16x16x32_bf16 v[24:27], v[140:143], v[132:135], 0
    s_waitcnt vmcnt(24)
    v_mfma_f32_16x16x32_bf16 v[12:15], v[152:155], v[144:147], v[12:15]
    v_mfma_f32_16x16x32_bf16 v[16:19], v[156:159], v[144:147], v[16:19]
    v_mfma_f32_16x16x32_bf16 v[20:23], v[152:155], v[148:151], v[20:23]
    v_mfma_f32_16x16x32_bf16 v[24:27], v[156:159], v[148:151], v[24:27]
    s_waitcnt vmcnt(20)
    v_mfma_f32_16x16x32_bf16 v[12:15], v[168:171], v[160:163], v[12:15]
    v_mfma_f32_16x16x32_bf16 v[16:19], v[172:175], v[160:163], v[16:19]
    v_mfma_f32_16x16x32_bf16 v[20:23], v[168:171], v[164:167], v[20:23]
    v_mfma_f32_16x16x32_bf16 v[24:27], v[172:175], v[164:167], v[24:27]
    s_waitcnt vmcnt(16)
    v_mfma_f32_16x16x32_bf16 v[12:15], v[184:187], v[176:179], v[12:15]
    v_mfma_f32_16x16x32_bf16 v[16:19], v[188:191], v[176:179], v[16:19]
    v_mfma_f32_16x16x32_bf16 v[20:23], v[184:187], v[180:183], v[20:23]
    v_mfma_f32_16x16x32_bf16 v[24:27], v[188:191], v[180:183], v[24:27]
    s_waitcnt vmcnt(12)
    v_mfma_f32_16x16x32_bf16 v[12:15], v[200:203], v[192:195], v[12:15]
    v_mfma_f32_16x16x32_bf16 v[16:19], v[204:207], v[192:195], v[16:19]
    v_mfma_f32_16x16x32_bf16 v[20:23], v[200:203], v[196:199], v[20:23]
    v_mfma_f32_16x16x32_bf16 v[24:27], v[204:207], v[196:199], v[24:27]
    s_waitcnt vmcnt(8)
    v_mfma_f32_16x16x32_bf16 v[12:15], v[216:219], v[208:211], v[12:15]
    v_mfma_f32_16x16x32_bf16 v[16:19], v[220:223], v[208:211], v[16:19]
    v_mfma_f32_16x16x32_bf16 v[20:23], v[216:219], v[212:215], v[20:23]
    v_mfma_f32_16x16x32_bf16 v[24:27], v[220:223], v[212:215], v[24:27]
    s_waitcnt vmcnt(4)
    v_mfma_f32_16x16x32_bf16 v[12:15], v[232:235], v[224:227], v[12:15]
    v_mfma_f32_16x16x32_bf16 v[16:19], v[236:239], v[224:227], v[16:19]
    v_mfma_f32_16x16x32_bf16 v[20:23], v[232:235], v[228:231], v[20:23]
    v_mfma_f32_16x16x32_bf16 v[24:27], v[236:239], v[228:231], v[24:27]
    s_waitcnt vmcnt(0)
    v_mfma_f32_16x16x32_bf16 v[12:15], v[248:251], v[240:243], v[12:15]
    v_mfma_f32_16x16x32_bf16 v[16:19], v[252:255], v[240:243], v[16:19]
    v_mfma_f32_16x16x32_bf16 v[20:23], v[248:251], v[244:247], v[20:23]
    v_mfma_f32_16x16x32_bf16 v[24:27], v[252:255], v[244:247], v[24:27]
    buffer_load_dwordx4 v[128:131], v3, s[8:11], s24 offen offset:0 sc1
    buffer_load_dwordx4 v[132:135], v3, s[8:11], s24 offen offset:1024 sc1
    buffer_load_dwordx4 v[136:139], v3, s[8:11], s25 offen offset:0
    buffer_load_dwordx4 v[140:143], v3, s[8:11], s25 offen offset:1024
    s_add_u32 s24, s24, 2048
    s_add_u32 s25, s25, 28672
    buffer_load_dwordx4 v[144:147], v3, s[8:11], s24 offen offset:0 sc1
    buffer_load_dwordx4 v[148:151], v3, s[8:11], s24 offen offset:1024 sc1
    buffer_load_dwordx4 v[152:155], v3, s[8:11], s25 offen offset:0
    buffer_load_dwordx4 v[156:159], v3, s[8:11], s25 offen offset:1024
    s_add_u32 s24, s24, 2048
    s_add_u32 s25, s25, 28672
    buffer_load_dwordx4 v[160:163], v3, s[8:11], s24 offen offset:0 sc1
    buffer_load_dwordx4 v[164:167], v3, s[8:11], s24 offen offset:1024 sc1
    buffer_load_dwordx4 v[168:171], v3, s[8:11], s25 offen offset:0
    buffer_load_dwordx4 v[172:175], v3, s[8:11], s25 offen offset:1024
    s_add_u32 s24, s24, 2048
    s_add_u32 s25, s25, 28672
    buffer_load_dwordx4 v[176:179], v3, s[8:11], s24 offen offset:0 sc1
    buffer_load_dwordx4 v[180:183], v3, s[8:11], s24 offen offset:1024 sc1
    buffer_load_dwordx4 v[184:187], v3, s[8:11], s25 offen offset:0
    buffer_load_dwordx4 v[188:191], v3, s[8:11], s25 offen offset:1024
    s_add_u32 s24, s24, 2048
    s_add_u32 s25, s25, 28672
    buffer_load_dwordx4 v[192:195], v3, s[8:11], s24 offen offset:0 sc1
    buffer_load_dwordx4 v[196:199], v3, s[8:11], s24 offen offset:1024 sc1
    buffer_load_dwordx4 v[200:203], v3, s[8:11], s25 offen offset:0
    buffer_load_dwordx4 v[204:207], v3, s[8:11], s25 offen offset:1024
    s_add_u32 s24, s24, 2048
    s_add_u32 s25, s25, 28672
    buffer_load_dwordx4 v[208:211], v3, s[8:11], s24 offen offset:0 sc1
    buffer_load_dwordx4 v[212:215], v3, s[8:11], s24 offen offset:1024 sc1
    buffer_load_dwordx4 v[216:219], v3, s[8:11], s25 offen offset:0
    buffer_load_dwordx4 v[220:223], v3, s[8:11], s25 offen offset:1024
    s_add_u32 s24, s24, 2048
    s_add_u32 s25, s25, 28672
    buffer_load_dwordx4 v[224:227], v3, s[8:11], s24 offen offset:0 sc1
    buffer_load_dwordx4 v[228:231], v3, s[8:11], s24 offen offset:1024 sc1
    buffer_load_dwordx4 v[232:235], v3, s[8:11], s25 offen offset:0
    buffer_load_dwordx4 v[236:239], v3, s[8:11], s25 offen offset:1024
    s_add_u32 s24, s24, 2048
    s_add_u32 s25, s25, 28672
    buffer_load_dwordx4 v[240:243], v3, s[8:11], s24 offen offset:0 sc1
    buffer_load_dwordx4 v[244:247], v3, s[8:11], s24 offen offset:1024 sc1
    buffer_load_dwordx4 v[248:251], v3, s[8:11], s25 offen offset:0
    buffer_load_dwordx4 v[252:255], v3, s[8:11], s25 offen offset:1024
    s_add_u32 s24, s24, 2048
    s_add_u32 s25, s25, 28672
    s_waitcnt vmcnt(28)
    v_mfma_f32_16x16x32_bf16 v[12:15], v[136:139], v[128:131], v[12:15]
    v_mfma_f32_16x16x32_bf16 v[16:19], v[140:143], v[128:131], v[16:19]
    v_mfma_f32_16x16x32_bf16 v[20:23], v[136:139], v[132:135], v[20:23]
    v_mfma_f32_16x16x32_bf16 v[24:27], v[140:143], v[132:135], v[24:27]
    s_waitcnt vmcnt(24)
    v_mfma_f32_16x16x32_bf16 v[12:15], v[152:155], v[144:147], v[12:15]
    v_mfma_f32_16x16x32_bf16 v[16:19], v[156:159], v[144:147], v[16:19]
    v_mfma_f32_16x16x32_bf16 v[20:23], v[152:155], v[148:151], v[20:23]
    v_mfma_f32_16x16x32_bf16 v[24:27], v[156:159], v[148:151], v[24:27]
    s_waitcnt vmcnt(20)
    v_mfma_f32_16x16x32_bf16 v[12:15], v[168:171], v[160:163], v[12:15]
    v_mfma_f32_16x16x32_bf16 v[16:19], v[172:175], v[160:163], v[16:19]
    v_mfma_f32_16x16x32_bf16 v[20:23], v[168:171], v[164:167], v[20:23]
    v_mfma_f32_16x16x32_bf16 v[24:27], v[172:175], v[164:167], v[24:27]
    s_waitcnt vmcnt(16)
    v_mfma_f32_16x16x32_bf16 v[12:15], v[184:187], v[176:179], v[12:15]
    v_mfma_f32_16x16x32_bf16 v[16:19], v[188:191], v[176:179], v[16:19]
    v_mfma_f32_16x16x32_bf16 v[20:23], v[184:187], v[180:183], v[20:23]
    v_mfma_f32_16x16x32_bf16 v[24:27], v[188:191], v[180:183], v[24:27]
    s_waitcnt vmcnt(12)
    v_mfma_f32_16x16x32_bf16 v[12:15], v[200:203], v[192:195], v[12:15]
    v_mfma_f32_16x16x32_bf16 v[16:19], v[204:207], v[192:195], v[16:19]
    v_mfma_f32_16x16x32_bf16 v[20:23], v[200:203], v[196:199], v[20:23]
    v_mfma_f32_16x16x32_bf16 v[24:27], v[204:207], v[196:199], v[24:27]
    s_waitcnt vmcnt(8)
    v_mfma_f32_16x16x32_bf16 v[12:15], v[216:219], v[208:211], v[12:15]
    v_mfma_f32_16x16x32_bf16 v[16:19], v[220:223], v[208:211], v[16:19]
    v_mfma_f32_16x16x32_bf16 v[20:23], v[216:219], v[212:215], v[20:23]
    v_mfma_f32_16x16x32_bf16 v[24:27], v[220:223], v[212:215], v[24:27]
    s_waitcnt vmcnt(4)
    v_mfma_f32_16x16x32_bf16 v[12:15], v[232:235], v[224:227], v[12:15]
    v_mfma_f32_16x16x32_bf16 v[16:19], v[236:239], v[224:227], v[16:19]
    v_mfma_f32_16x16x32_bf16 v[20:23], v[232:235], v[228:231], v[20:23]
    v_mfma_f32_16x16x32_bf16 v[24:27], v[236:239], v[228:231], v[24:27]
    s_waitcnt vmcnt(0)
    v_mfma_f32_16x16x32_bf16 v[12:15], v[248:251], v[240:243], v[12:15]
    v_mfma_f32_16x16x32_bf16 v[16:19], v[252:255], v[240:243], v[16:19]
    v_mfma_f32_16x16x32_bf16 v[20:23], v[248:251], v[244:247], v[20:23]
    v_mfma_f32_16x16x32_bf16 v[24:27], v[252:255], v[244:247], v[24:27]
    s_lshl_b32 s24, s7, 5
    v_lshrrev_b32 v8, 2, v2
    v_lshlrev_b32 v8, 3, v8
    v_and_b32 v9, 3, v2
    v_add3_u32 v8, v8, v9, s24
    v_add_u32 v8, 0, v8
    v_mul_u32_u24 v9, 2341, v8
    v_lshrrev_b32 v9, 16, v9
    v_mul_u32_u24 v31, 28, v9
    v_sub_u32 v8, v8, v31
    v_and_b32 v31, 1, v8
    v_lshrrev_b32 v8, 1, v8
    v_mul_u32_u24 v30, 28672, v9
    v_lshl_add_u32 v30, v8, 4, v30
    v_mul_u32_u24 v29, 896, v31
    v_mul_u32_u24 v28, 224, v1
    v_add3_u32 v32, v30, v29, v28
    v_mul_u32_u24 v31, 14, v31
    v_mul_u32_u24 v9, 448, v9
    v_add3_u32 v8, v8, v9, v31
    v_lshlrev_b32 v9, 4, v8
    v_mul_u32_u24 v8, 448, v1
    v_add_u32 v34, v8, v9
    v_lshrrev_b32 v8, 2, v2
    v_lshlrev_b32 v8, 3, v8
    v_and_b32 v9, 3, v2
    v_add3_u32 v8, v8, v9, s24
    v_add_u32 v8, 4, v8
    v_mul_u32_u24 v9, 2341, v8
    v_lshrrev_b32 v9, 16, v9
    v_mul_u32_u24 v31, 28, v9
    v_sub_u32 v8, v8, v31
    v_and_b32 v31, 1, v8
    v_lshrrev_b32 v8, 1, v8
    v_mul_u32_u24 v30, 28672, v9
    v_lshl_add_u32 v30, v8, 4, v30
    v_mul_u32_u24 v29, 896, v31
    v_mul_u32_u24 v28, 224, v1
    v_add3_u32 v33, v30, v29, v28
    v_mul_u32_u24 v31, 14, v31
    v_mul_u32_u24 v9, 448, v9
    v_add3_u32 v8, v8, v9, v31
    v_lshlrev_b32 v9, 4, v8
    v_mul_u32_u24 v8, 448, v1
    v_add_u32 v35, v8, v9
    s_mul_i32 s24, s6, 458752
    s_add_u32 s24, s24, 25591808
    buffer_load_dwordx4 a[112:115], v32, s[8:11], s24 offen offset:0 sc1
    buffer_load_dwordx4 a[116:119], v33, s[8:11], s24 offen offset:0 sc1
    buffer_load_dwordx4 a[120:123], v32, s[8:11], s24 offen offset:1792 sc1
    buffer_load_dwordx4 a[124:127], v33, s[8:11], s24 offen offset:1792 sc1
    s_add_u32 s24, s24, 3584
    buffer_load_dwordx4 a[128:131], v32, s[8:11], s24 offen offset:0 sc1
    buffer_load_dwordx4 a[132:135], v33, s[8:11], s24 offen offset:0 sc1
    buffer_load_dwordx4 a[136:139], v32, s[8:11], s24 offen offset:1792 sc1
    buffer_load_dwordx4 a[140:143], v33, s[8:11], s24 offen offset:1792 sc1
    s_add_u32 s24, s24, 3584
    buffer_load_dwordx4 a[144:147], v32, s[8:11], s24 offen offset:0 sc1
    buffer_load_dwordx4 a[148:151], v33, s[8:11], s24 offen offset:0 sc1
    buffer_load_dwordx4 a[152:155], v32, s[8:11], s24 offen offset:1792 sc1
    buffer_load_dwordx4 a[156:159], v33, s[8:11], s24 offen offset:1792 sc1
    s_add_u32 s24, s24, 3584
    buffer_load_dwordx4 a[160:163], v32, s[8:11], s24 offen offset:0 sc1
    buffer_load_dwordx4 a[164:167], v33, s[8:11], s24 offen offset:0 sc1
    buffer_load_dwordx4 a[168:171], v32, s[8:11], s24 offen offset:1792 sc1
    buffer_load_dwordx4 a[172:175], v33, s[8:11], s24 offen offset:1792 sc1
    s_add_u32 s24, s24, 3584
    buffer_load_dwordx4 a[176:179], v32, s[8:11], s24 offen offset:0 sc1
    buffer_load_dwordx4 a[180:183], v33, s[8:11], s24 offen offset:0 sc1
    buffer_load_dwordx4 a[184:187], v32, s[8:11], s24 offen offset:1792 sc1
    buffer_load_dwordx4 a[188:191], v33, s[8:11], s24 offen offset:1792 sc1
    s_add_u32 s24, s24, 3584
    buffer_load_dwordx4 a[192:195], v32, s[8:11], s24 offen offset:0 sc1
    buffer_load_dwordx4 a[196:199], v33, s[8:11], s24 offen offset:0 sc1
    buffer_load_dwordx4 a[200:203], v32, s[8:11], s24 offen offset:1792 sc1
    buffer_load_dwordx4 a[204:207], v33, s[8:11], s24 offen offset:1792 sc1
    s_add_u32 s24, s24, 3584
    buffer_load_dwordx4 a[208:211], v32, s[8:11], s24 offen offset:0 sc1
    buffer_load_dwordx4 a[212:215], v33, s[8:11], s24 offen offset:0 sc1
    buffer_load_dwordx4 a[216:219], v32, s[8:11], s24 offen offset:1792 sc1
    buffer_load_dwordx4 a[220:223], v33, s[8:11], s24 offen offset:1792 sc1
    s_add_u32 s24, s24, 3584
    buffer_load_dwordx4 a[224:227], v32, s[8:11], s24 offen offset:0 sc1
    buffer_load_dwordx4 a[228:231], v33, s[8:11], s24 offen offset:0 sc1
    buffer_load_dwordx4 a[232:235], v32, s[8:11], s24 offen offset:1792 sc1
    buffer_load_dwordx4 a[236:239], v33, s[8:11], s24 offen offset:1792 sc1
    s_add_u32 s24, s24, 3584
.w3_nopre:
    v_and_b32 v9, 7, v2
    v_mul_u32_u24 v31, 896, v9
    v_lshl_add_u32 v28, v1, 5, v31
    v_lshl_add_u32 v29, v1, 4, v31
    v_lshl_add_u32 v30, v1, 3, v31
    s_sub_u32 s24, s6, 2
    s_max_i32 s24, s24, 0
    s_mul_i32 s24, s24, 7168
    s_add_u32 s24, s24, 16982016
    s_mov_b32 s36, 0
    v_mov_b32 v9, 0
.w3_pre:
    buffer_load_dword v8, v9, s[8:11], s24 offen sc1
    s_waitcnt vmcnt(0)
    v_cmp_eq_u32 vcc, -1, v8
    s_cbranch_vccz .w3_pred
    s_sleep 32
    s_add_u32 s36, s36, 1
    s_cmp_lt_u32 s36, 262144
    s_cbranch_scc1 .w3_pre
    s_endpgm
.w3_pred:
    s_mul_i32 s24, s6, 7168
    s_add_u32 s24, s24, 16982016
    s_mov_b32 s36, 0
.w3_poll:
    buffer_load_dwordx4 v[128:131], v28, s[8:11], s24 offen offset:0 sc1
    buffer_load_dwordx4 v[132:135], v28, s[8:11], s24 offen offset:16 sc1
    buffer_load_dwordx4 v[136:139], v29, s[8:11], s24 offen offset:128 sc1
    buffer_load_dwordx2 v[140:141], v30, s[8:11], s24 offen offset:192 sc1
    buffer_load_dwordx4 v[142:145], v28, s[8:11], s24 offen offset:224 sc1
    buffer_load_dwordx4 v[146:149], v28, s[8:11], s24 offen offset:240 sc1
    buffer_load_dwordx4 v[150:153], v29, s[8:11], s24 offen offset:352 sc1
    buffer_load_dwordx2 v[154:155], v30, s[8:11], s24 offen offset:416 sc1
    buffer_load_dwordx4 v[156:159], v28, s[8:11], s24 offen offset:448 sc1
    buffer_load_dwordx4 v[160:163], v28, s[8:11], s24 offen offset:464 sc1
    buffer_load_dwordx4 v[164:167], v29, s[8:11], s24 offen offset:576 sc1
    buffer_load_dwordx2 v[168:169], v30, s[8:11], s24 offen offset:640 sc1
    buffer_load_dwordx4 v[170:173], v28, s[8:11], s24 offen offset:672 sc1
    buffer_load_dwordx4 v[174:177], v28, s[8:11], s24 offen offset:688 sc1
    buffer_load_dwordx4 v[178:181], v29, s[8:11], s24 offen offset:800 sc1
    buffer_load_dwordx2 v[182:183], v30, s[8:11], s24 offen offset:864 sc1
    s_waitcnt vmcnt(0)
    v_max_u32 v8, v128, v129
    v_max3_u32 v8, v8, v130, v131
    v_max3_u32 v8, v8, v132, v133
    v_max3_u32 v8, v8, v134, v135
    v_max3_u32 v8, v8, v136, v137
    v_max3_u32 v8, v8, v138, v139
    v_max3_u32 v8, v8, v140, v141
    v_max3_u32 v8, v8, v142, v143
    v_max3_u32 v8, v8, v144, v145
    v_max3_u32 v8, v8, v146, v147
    v_max3_u32 v8, v8, v148, v149
    v_max3_u32 v8, v8, v150, v151
    v_max3_u32 v8, v8, v152, v153
    v_max3_u32 v8, v8, v154, v155
    v_max3_u32 v8, v8, v156, v157
    v_max3_u32 v8, v8, v158, v159
    v_max3_u32 v8, v8, v160, v161
    v_max3_u32 v8, v8, v162, v163
    v_max3_u32 v8, v8, v164, v165
    v_max3_u32 v8, v8, v166, v167
    v_max3_u32 v8, v8, v168, v169
    v_max3_u32 v8, v8, v170, v171
    v_max3_u32 v8, v8, v172, v173
    v_max3_u32 v8, v8, v174, v175
    v_max3_u32 v8, v8, v176, v177
    v_max3_u32 v8, v8, v178, v179
    v_max3_u32 v8, v8, v180, v181
    v_max3_u32 v8, v8, v182, v183
    v_cmp_eq_u32 vcc, -1, v8
    s_cbranch_vccz .w3_got
    s_sleep 2
    s_add_u32 s36, s36, 1
    s_cmp_lt_u32 s36, 2097152
    s_cbranch_scc1 .w3_poll
    s_endpgm
.w3_got:
    v_mov_b32 v8, 0xf149f2ca
    v_cmp_gt_u32 vcc, 2, v1
    s_nop 1
    v_cndmask_b32 v40, v8, 0, vcc
    v_cndmask_b32 v41, v8, 0, vcc
    v_cndmask_b32 v42, v8, 0, vcc
    v_cndmask_b32 v43, v8, 0, vcc
    v_cndmask_b32 v44, v8, 0, vcc
    v_cndmask_b32 v45, v8, 0, vcc
    v_cndmask_b32 v46, v8, 0, vcc
    v_cndmask_b32 v47, v8, 0, vcc
    s_nop 1
    v_mfma_f32_16x16x32_bf16 v[40:43], v[128:131], a[0:3], v[40:43]
    v_mfma_f32_16x16x32_bf16 v[44:47], v[128:131], a[14:17], v[44:47]
    v_mfma_f32_16x16x32_bf16 v[40:43], v[132:135], a[4:7], v[40:43]
    v_mfma_f32_16x16x32_bf16 v[44:47], v[132:135], a[18:21], v[44:47]
    v_mfma_f32_16x16x32_bf16 v[40:43], v[136:139], a[8:11], v[40:43]
    v_mfma_f32_16x16x32_bf16 v[44:47], v[136:139], a[22:25], v[44:47]
    s_nop 4
    v_mfma_f32_16x16x16_bf16 v[40:43], v[140:141], a[12:13], v[40:43]
    v_mfma_f32_16x16x16_bf16 v[44:47], v[140:141], a[26:27], v[44:47]
    s_nop 4
    v_mfma_f32_16x16x32_bf16 v[40:43], v[142:145], a[28:31], v[40:43]
    v_mfma_f32_16x16x32_bf16 v[44:47], v[142:145], a[42:45], v[44:47]
    v_mfma_f32_16x16x32_bf16 v[40:43], v[146:149], a[32:35], v[40:43]
    v_mfma_f32_16x16x32_bf16 v[44:47], v[146:149], a[46:49], v[44:47]
    v_mfma_f32_16x16x32_bf16 v[40:43], v[150:153], a[36:39], v[40:43]
    v_mfma_f32_16x16x32_bf16 v[44:47], v[150:153], a[50:53], v[44:47]
    s_nop 4
    v_mfma_f32_16x16x16_bf16 v[40:43], v[154:155], a[40:41], v[40:43]
    v_mfma_f32_16x16x16_bf16 v[44:47], v[154:155], a[54:55], v[44:47]
    s_nop 4
    v_mfma_f32_16x16x32_bf16 v[40:43], v[156:159], a[56:59], v[40:43]
    v_mfma_f32_16x16x32_bf16 v[44:47], v[156:159], a[70:73], v[44:47]
    v_mfma_f32_16x16x32_bf16 v[40:43], v[160:163], a[60:63], v[40:43]
    v_mfma_f32_16x16x32_bf16 v[44:47], v[160:163], a[74:77], v[44:47]
    v_mfma_f32_16x16x32_bf16 v[40:43], v[164:167], a[64:67], v[40:43]
    v_mfma_f32_16x16x32_bf16 v[44:47], v[164:167], a[78:81], v[44:47]
    s_nop 4
    v_mfma_f32_16x16x16_bf16 v[40:43], v[168:169], a[68:69], v[40:43]
    v_mfma_f32_16x16x16_bf16 v[44:47], v[168:169], a[82:83], v[44:47]
    s_nop 4
    v_mfma_f32_16x16x32_bf16 v[40:43], v[170:173], a[84:87], v[40:43]
    v_mfma_f32_16x16x32_bf16 v[44:47], v[170:173], a[98:101], v[44:47]
    v_mfma_f32_16x16x32_bf16 v[40:43], v[174:177], a[88:91], v[40:43]
    v_mfma_f32_16x16x32_bf16 v[44:47], v[174:177], a[102:105], v[44:47]
    v_mfma_f32_16x16x32_bf16 v[40:43], v[178:181], a[92:95], v[40:43]
    v_mfma_f32_16x16x32_bf16 v[44:47], v[178:181], a[106:109], v[44:47]
    s_nop 4
    v_mfma_f32_16x16x16_bf16 v[40:43], v[182:183], a[96:97], v[40:43]
    v_mfma_f32_16x16x16_bf16 v[44:47], v[182:183], a[110:111], v[44:47]
    s_nop 4
    s_mov_b32 s26, 0x3db8aa3b
    s_nop 7
    v_max_f32 v30, v40, v41
    v_max3_f32 v30, v30, v42, v43
    v_max3_f32 v30, v30, v88, v89
    v_max3_f32 v30, v30, v90, v91
    ds_bpermute_b32 v29, v10, v30
    s_waitcnt lgkmcnt(0)
    v_max_f32 v30, v30, v29
    ds_bpermute_b32 v29, v11, v30
    s_waitcnt lgkmcnt(0)
    v_max_f32 v30, v30, v29
    v_sub_f32 v40, v40, v30
    v_mul_f32 v40, s26, v40
    v_exp_f32 v40, v40
    v_sub_f32 v41, v41, v30
    v_mul_f32 v41, s26, v41
    v_exp_f32 v41, v41
    v_sub_f32 v42, v42, v30
    v_mul_f32 v42, s26, v42
    v_exp_f32 v42, v42
    v_sub_f32 v43, v43, v30
    v_mul_f32 v43, s26, v43
    v_exp_f32 v43, v43
    v_sub_f32 v88, v88, v30
    v_mul_f32 v88, s26, v88
    v_exp_f32 v88, v88
    v_sub_f32 v89, v89, v30
    v_mul_f32 v89, s26, v89
    v_exp_f32 v89, v89
    v_sub_f32 v90, v90, v30
    v_mul_f32 v90, s26, v90
    v_exp_f32 v90, v90
    v_sub_f32 v91, v91, v30
    v_mul_f32 v91, s26, v91
    v_exp_f32 v91, v91
    s_nop 0
    v_add_f32 v31, v40, v41
    v_add_f32 v31, v31, v42
    v_add_f32 v31, v31, v43
    v_add_f32 v31, v31, v88
    v_add_f32 v31, v31, v89
    v_add_f32 v31, v31, v90
    v_add_f32 v31, v31, v91
    ds_bpermute_b32 v29, v10, v31
    s_waitcnt lgkmcnt(0)
    v_add_f32 v31, v31, v29
    ds_bpermute_b32 v29, v11, v31
    s_waitcnt lgkmcnt(0)
    v_add_f32 v31, v31, v29
    v_rcp_f32 v31, v31
    s_nop 0
    v_mul_f32 v40, v40, v31
    v_mul_f32 v41, v41, v31
    v_mul_f32 v42, v42, v31
    v_mul_f32 v43, v43, v31
    v_mul_f32 v88, v88, v31
    v_mul_f32 v89, v89, v31
    v_mul_f32 v90, v90, v31
    v_mul_f32 v91, v91, v31
    v_cvt_pk_bf16_f32 v48, v40, v41
    v_cvt_pk_bf16_f32 v49, v42, v43
    v_cvt_pk_bf16_f32 v50, v88, v89
    v_cvt_pk_bf16_f32 v51, v90, v91
    v_mov_b32 v52, 0
    v_mov_b32 v53, 0
    v_max_f32 v30, v44, v45
    v_max3_f32 v30, v30, v46, v47
    v_max3_f32 v30, v30, v92, v93
    v_max3_f32 v30, v30, v94, v95
    v_max3_f32 v30, v30, v96, v97
    v_max3_f32 v30, v30, v98, v99
    ds_bpermute_b32 v29, v10, v30
    s_waitcnt lgkmcnt(0)
    v_max_f32 v30, v30, v29
    ds_bpermute_b32 v29, v11, v30
    s_waitcnt lgkmcnt(0)
    v_max_f32 v30, v30, v29
    v_sub_f32 v44, v44, v30
    v_mul_f32 v44, s26, v44
    v_exp_f32 v44, v44
    v_sub_f32 v45, v45, v30
    v_mul_f32 v45, s26, v45
    v_exp_f32 v45, v45
    v_sub_f32 v46, v46, v30
    v_mul_f32 v46, s26, v46
    v_exp_f32 v46, v46
    v_sub_f32 v47, v47, v30
    v_mul_f32 v47, s26, v47
    v_exp_f32 v47, v47
    v_sub_f32 v92, v92, v30
    v_mul_f32 v92, s26, v92
    v_exp_f32 v92, v92
    v_sub_f32 v93, v93, v30
    v_mul_f32 v93, s26, v93
    v_exp_f32 v93, v93
    v_sub_f32 v94, v94, v30
    v_mul_f32 v94, s26, v94
    v_exp_f32 v94, v94
    v_sub_f32 v95, v95, v30
    v_mul_f32 v95, s26, v95
    v_exp_f32 v95, v95
    v_sub_f32 v96, v96, v30
    v_mul_f32 v96, s26, v96
    v_exp_f32 v96, v96
    v_sub_f32 v97, v97, v30
    v_mul_f32 v97, s26, v97
    v_exp_f32 v97, v97
    v_sub_f32 v98, v98, v30
    v_mul_f32 v98, s26, v98
    v_exp_f32 v98, v98
    v_sub_f32 v99, v99, v30
    v_mul_f32 v99, s26, v99
    v_exp_f32 v99, v99
    s_nop 0
    v_add_f32 v31, v44, v45
    v_add_f32 v31, v31, v46
    v_add_f32 v31, v31, v47
    v_add_f32 v31, v31, v92
    v_add_f32 v31, v31, v93
    v_add_f32 v31, v31, v94
    v_add_f32 v31, v31, v95
    v_add_f32 v31, v31, v96
    v_add_f32 v31, v31, v97
    v_add_f32 v31, v31, v98
    v_add_f32 v31, v31, v99
    ds_bpermute_b32 v29, v10, v31
    s_waitcnt lgkmcnt(0)
    v_add_f32 v31, v31, v29
    ds_bpermute_b32 v29, v11, v31
    s_waitcnt lgkmcnt(0)
    v_add_f32 v31, v31, v29
    v_rcp_f32 v31, v31
    s_nop 0
    v_mul_f32 v44, v44, v31
    v_mul_f32 v45, v45, v31
    v_mul_f32 v46, v46, v31
    v_mul_f32 v47, v47, v31
    v_mul_f32 v92, v92, v31
    v_mul_f32 v93, v93, v31
    v_mul_f32 v94, v94, v31
    v_mul_f32 v95, v95, v31
    v_mul_f32 v96, v96, v31
    v_mul_f32 v97, v97, v31
    v_mul_f32 v98, v98, v31
    v_mul_f32 v99, v99, v31
    v_cvt_pk_bf16_f32 v54, v44, v45
    v_cvt_pk_bf16_f32 v55, v46, v47
    v_cvt_pk_bf16_f32 v56, v92, v93
    v_cvt_pk_bf16_f32 v57, v94, v95
    v_cvt_pk_bf16_f32 v58, v96, v97
    v_cvt_pk_bf16_f32 v59, v98, v99
    s_lshl_b32 s24, s5, 11
    s_add_u32 s24, s24, 63340544
    s_lshl_b32 s25, s6, 13
    s_lshl_b32 s26, s7, 4
    s_add_u32 s25, s25, s26
    s_add_u32 s25, s25, 65437696
    s_add_u32 s26, s25, 4096
    v_lshlrev_b32 v9, 8, v2
    v_lshl_add_u32 v9, v1, 3, v9
    buffer_store_dwordx4 v[50:53], v3, s[8:11], s24 offen offset:0 sc1
    buffer_store_dwordx4 v[56:59], v3, s[8:11], s24 offen offset:1024 sc1
    s_mov_b32 exec_hi, 0
    buffer_store_dwordx2 v[48:49], v9, s[8:11], s25 offen sc1
    buffer_store_dwordx2 v[54:55], v9, s[8:11], s26 offen sc1
    s_mov_b64 exec, -1
    s_lshl_b32 s24, s5, 2
    s_add_u32 s24, s24, 18114560
    v_mov_b32 v8, 1
    v_mov_b32 v9, 0
    s_waitcnt vmcnt(0)
    s_mov_b64 exec, 1
    buffer_store_dword v8, v9, s[8:11], s24 offen sc1
    s_mov_b64 exec, -1
    s_cmp_ge_u32 s7, 14
    s_cbranch_scc1 .w3_next
    v_lshlrev_b32 v9, 2, v2
    s_lshl_b32 s25, s6, 7
    s_add_u32 s25, s25, 16515072
    buffer_load_dword v28, v9, s[8:11], s25 offen
    buffer_load_dword v29, v9, s[8:11], s25 offen offset:64
    s_lshl_b32 s24, s6, 6
    s_add_u32 s24, s24, 18114560
    s_lshl_b32 s25, s6, 8
    s_add_u32 s25, s25, 18119168
    v_lshlrev_b32 v30, 2, v0
    s_mov_b32 s36, 0
.wf2_16:
    buffer_load_dword v8, v9, s[8:11], s24 offen sc1
    buffer_load_dword v31, v30, s[8:11], s25 offen sc1
    s_waitcnt vmcnt(0)
    v_min_u32 v8, v8, v31
    v_cmp_eq_u32 vcc, 0, v8
    s_cbranch_vccz .wf2d_17
    s_sleep 1
    s_add_u32 s36, s36, 1
    s_cmp_lt_u32 s36, 2097152
    s_cbranch_scc1 .wf2_16
    s_endpgm
.wf2d_17:
    s_lshl_b32 s24, s6, 15
    s_add_u32 s24, s24, 63340544
    buffer_load_dwordx4 v[128:131], v3, s[8:11], s24 offen offset:0 sc1
    buffer_load_dwordx4 v[132:135], v3, s[8:11], s24 offen offset:1024 sc1
    buffer_load_dwordx4 v[136:139], v3, s[8:11], s24 offen offset:2048 sc1
    buffer_load_dwordx4 v[140:143], v3, s[8:11], s24 offen offset:3072 sc1
    s_add_u32 s24, s24, 4096
    buffer_load_dwordx4 v[144:147], v3, s[8:11], s24 offen offset:0 sc1
    buffer_load_dwordx4 v[148:151], v3, s[8:11], s24 offen offset:1024 sc1
    buffer_load_dwordx4 v[152:155], v3, s[8:11], s24 offen offset:2048 sc1
    buffer_load_dwordx4 v[156:159], v3, s[8:11], s24 offen offset:3072 sc1
    s_add_u32 s24, s24, 4096
    buffer_load_dwordx4 v[160:163], v3, s[8:11], s24 offen offset:0 sc1
    buffer_load_dwordx4 v[164:167], v3, s[8:11], s24 offen offset:1024 sc1
    buffer_load_dwordx4 v[168:171], v3, s[8:11], s24 offen offset:2048 sc1
    buffer_load_dwordx4 v[172:175], v3, s[8:11], s24 offen offset:3072 sc1
    s_add_u32 s24, s24, 4096
    buffer_load_dwordx4 v[176:179], v3, s[8:11], s24 offen offset:0 sc1
    buffer_load_dwordx4 v[180:183], v3, s[8:11], s24 offen offset:1024 sc1
    buffer_load_dwordx4 v[184:187], v3, s[8:11], s24 offen offset:2048 sc1
    buffer_load_dwordx4 v[188:191], v3, s[8:11], s24 offen offset:3072 sc1
    s_add_u32 s24, s24, 4096
    buffer_load_dwordx4 v[192:195], v3, s[8:11], s24 offen offset:0 sc1
    buffer_load_dwordx4 v[196:199], v3, s[8:11], s24 offen offset:1024 sc1
    buffer_load_dwordx4 v[200:203], v3, s[8:11], s24 offen offset:2048 sc1
    buffer_load_dwordx4 v[204:207], v3, s[8:11], s24 offen offset:3072 sc1
    s_add_u32 s24, s24, 4096
    buffer_load_dwordx4 v[208:211], v3, s[8:11], s24 offen offset:0 sc1
    buffer_load_dwordx4 v[212:215], v3, s[8:11], s24 offen offset:1024 sc1
    buffer_load_dwordx4 v[216:219], v3, s[8:11], s24 offen offset:2048 sc1
    buffer_load_dwordx4 v[220:223], v3, s[8:11], s24 offen offset:3072 sc1
    s_add_u32 s24, s24, 4096
    buffer_load_dwordx4 v[224:227], v3, s[8:11], s24 offen offset:0 sc1
    buffer_load_dwordx4 v[228:231], v3, s[8:11], s24 offen offset:1024 sc1
    buffer_load_dwordx4 v[232:235], v3, s[8:11], s24 offen offset:2048 sc1
    buffer_load_dwordx4 v[236:239], v3, s[8:11], s24 offen offset:3072 sc1
    s_add_u32 s24, s24, 4096
    buffer_load_dwordx4 v[240:243], v3, s[8:11], s24 offen offset:0 sc1
    buffer_load_dwordx4 v[244:247], v3, s[8:11], s24 offen offset:1024 sc1
    buffer_load_dwordx4 v[248:251], v3, s[8:11], s24 offen offset:2048 sc1
    buffer_load_dwordx4 v[252:255], v3, s[8:11], s24 offen offset:3072 sc1
    s_add_u32 s24, s24, 4096
    s_lshl_b32 s25, s6, 13
    s_add_u32 s25, s25, 65437696
    s_add_u32 s26, s25, 4096
    v_lshlrev_b32 v9, 8, v2
    v_lshl_add_u32 v9, v1, 4, v9
    buffer_load_dwordx4 v[40:43], v9, s[8:11], s25 offen offset:0 sc1
    buffer_load_dwordx4 v[44:47], v9, s[8:11], s26 offen offset:0 sc1
    buffer_load_dwordx4 v[48:51], v9, s[8:11], s25 offen offset:64 sc1
    buffer_load_dwordx4 v[52:55], v9, s[8:11], s26 offen offset:64 sc1
    buffer_load_dwordx4 v[56:59], v9, s[8:11], s25 offen offset:128 sc1
    buffer_load_dwordx4 v[60:63], v9, s[8:11], s26 offen offset:128 sc1
    buffer_load_dwordx4 v[64:67], v9, s[8:11], s25 offen offset:192 sc1
    buffer_load_dwordx4 v[68:71], v9, s[8:11], s26 offen offset:192 sc1
    s_mul_i32 s24, s6, 114688
    s_add_u32 s24, s24, 18251776
    s_add_u32 s25, s24, 3584
    buffer_load_dwordx4 v[72:75], v34, s[8:11], s24 offen offset:0 sc1
    buffer_load_dwordx4 v[76:79], v35, s[8:11], s24 offen offset:0 sc1
    buffer_load_dwordx4 v[80:83], v34, s[8:11], s24 offen offset:1792 sc1
    buffer_load_dwordx4 v[84:87], v35, s[8:11], s24 offen offset:1792 sc1
    buffer_load_dwordx4 v[88:91], v34, s[8:11], s25 offen offset:0 sc1
    buffer_load_dwordx4 v[92:95], v35, s[8:11], s25 offen offset:0 sc1
    buffer_load_dwordx4 v[96:99], v34, s[8:11], s25 offen offset:1792 sc1
    buffer_load_dwordx4 v[100:103], v35, s[8:11], s25 offen offset:1792 sc1
    s_waitcnt vmcnt(46)
    v_mfma_f32_16x16x32_bf16 v[104:107], a[112:115], v[128:131], 0
    v_mfma_f32_16x16x32_bf16 v[108:111], a[116:119], v[128:131], 0
    v_mfma_f32_16x16x32_bf16 v[112:115], a[112:115], v[132:135], 0
    v_mfma_f32_16x16x32_bf16 v[116:119], a[116:119], v[132:135], 0
    s_waitcnt vmcnt(44)
    v_mfma_f32_16x16x32_bf16 v[104:107], a[120:123], v[136:139], v[104:107]
    v_mfma_f32_16x16x32_bf16 v[108:111], a[124:127], v[136:139], v[108:111]
    v_mfma_f32_16x16x32_bf16 v[112:115], a[120:123], v[140:143], v[112:115]
    v_mfma_f32_16x16x32_bf16 v[116:119], a[124:127], v[140:143], v[116:119]
    s_waitcnt vmcnt(42)
    v_mfma_f32_16x16x32_bf16 v[104:107], a[128:131], v[144:147], v[104:107]
    v_mfma_f32_16x16x32_bf16 v[108:111], a[132:135], v[144:147], v[108:111]
    v_mfma_f32_16x16x32_bf16 v[112:115], a[128:131], v[148:151], v[112:115]
    v_mfma_f32_16x16x32_bf16 v[116:119], a[132:135], v[148:151], v[116:119]
    s_waitcnt vmcnt(40)
    v_mfma_f32_16x16x32_bf16 v[104:107], a[136:139], v[152:155], v[104:107]
    v_mfma_f32_16x16x32_bf16 v[108:111], a[140:143], v[152:155], v[108:111]
    v_mfma_f32_16x16x32_bf16 v[112:115], a[136:139], v[156:159], v[112:115]
    v_mfma_f32_16x16x32_bf16 v[116:119], a[140:143], v[156:159], v[116:119]
    s_waitcnt vmcnt(38)
    v_mfma_f32_16x16x32_bf16 v[104:107], a[144:147], v[160:163], v[104:107]
    v_mfma_f32_16x16x32_bf16 v[108:111], a[148:151], v[160:163], v[108:111]
    v_mfma_f32_16x16x32_bf16 v[112:115], a[144:147], v[164:167], v[112:115]
    v_mfma_f32_16x16x32_bf16 v[116:119], a[148:151], v[164:167], v[116:119]
    s_waitcnt vmcnt(36)
    v_mfma_f32_16x16x32_bf16 v[104:107], a[152:155], v[168:171], v[104:107]
    v_mfma_f32_16x16x32_bf16 v[108:111], a[156:159], v[168:171], v[108:111]
    v_mfma_f32_16x16x32_bf16 v[112:115], a[152:155], v[172:175], v[112:115]
    v_mfma_f32_16x16x32_bf16 v[116:119], a[156:159], v[172:175], v[116:119]
    s_waitcnt vmcnt(34)
    v_mfma_f32_16x16x32_bf16 v[104:107], a[160:163], v[176:179], v[104:107]
    v_mfma_f32_16x16x32_bf16 v[108:111], a[164:167], v[176:179], v[108:111]
    v_mfma_f32_16x16x32_bf16 v[112:115], a[160:163], v[180:183], v[112:115]
    v_mfma_f32_16x16x32_bf16 v[116:119], a[164:167], v[180:183], v[116:119]
    s_waitcnt vmcnt(32)
    v_mfma_f32_16x16x32_bf16 v[104:107], a[168:171], v[184:187], v[104:107]
    v_mfma_f32_16x16x32_bf16 v[108:111], a[172:175], v[184:187], v[108:111]
    v_mfma_f32_16x16x32_bf16 v[112:115], a[168:171], v[188:191], v[112:115]
    v_mfma_f32_16x16x32_bf16 v[116:119], a[172:175], v[188:191], v[116:119]
    s_waitcnt vmcnt(30)
    v_mfma_f32_16x16x32_bf16 v[104:107], a[176:179], v[192:195], v[104:107]
    v_mfma_f32_16x16x32_bf16 v[108:111], a[180:183], v[192:195], v[108:111]
    v_mfma_f32_16x16x32_bf16 v[112:115], a[176:179], v[196:199], v[112:115]
    v_mfma_f32_16x16x32_bf16 v[116:119], a[180:183], v[196:199], v[116:119]
    s_waitcnt vmcnt(28)
    v_mfma_f32_16x16x32_bf16 v[104:107], a[184:187], v[200:203], v[104:107]
    v_mfma_f32_16x16x32_bf16 v[108:111], a[188:191], v[200:203], v[108:111]
    v_mfma_f32_16x16x32_bf16 v[112:115], a[184:187], v[204:207], v[112:115]
    v_mfma_f32_16x16x32_bf16 v[116:119], a[188:191], v[204:207], v[116:119]
    s_waitcnt vmcnt(26)
    v_mfma_f32_16x16x32_bf16 v[104:107], a[192:195], v[208:211], v[104:107]
    v_mfma_f32_16x16x32_bf16 v[108:111], a[196:199], v[208:211], v[108:111]
    v_mfma_f32_16x16x32_bf16 v[112:115], a[192:195], v[212:215], v[112:115]
    v_mfma_f32_16x16x32_bf16 v[116:119], a[196:199], v[212:215], v[116:119]
    s_waitcnt vmcnt(24)
    v_mfma_f32_16x16x32_bf16 v[104:107], a[200:203], v[216:219], v[104:107]
    v_mfma_f32_16x16x32_bf16 v[108:111], a[204:207], v[216:219], v[108:111]
    v_mfma_f32_16x16x32_bf16 v[112:115], a[200:203], v[220:223], v[112:115]
    v_mfma_f32_16x16x32_bf16 v[116:119], a[204:207], v[220:223], v[116:119]
    s_waitcnt vmcnt(22)
    v_mfma_f32_16x16x32_bf16 v[104:107], a[208:211], v[224:227], v[104:107]
    v_mfma_f32_16x16x32_bf16 v[108:111], a[212:215], v[224:227], v[108:111]
    v_mfma_f32_16x16x32_bf16 v[112:115], a[208:211], v[228:231], v[112:115]
    v_mfma_f32_16x16x32_bf16 v[116:119], a[212:215], v[228:231], v[116:119]
    s_waitcnt vmcnt(20)
    v_mfma_f32_16x16x32_bf16 v[104:107], a[216:219], v[232:235], v[104:107]
    v_mfma_f32_16x16x32_bf16 v[108:111], a[220:223], v[232:235], v[108:111]
    v_mfma_f32_16x16x32_bf16 v[112:115], a[216:219], v[236:239], v[112:115]
    v_mfma_f32_16x16x32_bf16 v[116:119], a[220:223], v[236:239], v[116:119]
    s_waitcnt vmcnt(18)
    v_mfma_f32_16x16x32_bf16 v[104:107], a[224:227], v[240:243], v[104:107]
    v_mfma_f32_16x16x32_bf16 v[108:111], a[228:231], v[240:243], v[108:111]
    v_mfma_f32_16x16x32_bf16 v[112:115], a[224:227], v[244:247], v[112:115]
    v_mfma_f32_16x16x32_bf16 v[116:119], a[228:231], v[244:247], v[116:119]
    s_waitcnt vmcnt(16)
    v_mfma_f32_16x16x32_bf16 v[104:107], a[232:235], v[248:251], v[104:107]
    v_mfma_f32_16x16x32_bf16 v[108:111], a[236:239], v[248:251], v[108:111]
    v_mfma_f32_16x16x32_bf16 v[112:115], a[232:235], v[252:255], v[112:115]
    v_mfma_f32_16x16x32_bf16 v[116:119], a[236:239], v[252:255], v[116:119]
    s_waitcnt vmcnt(6)
    v_mfma_f32_16x16x32_bf16 v[104:107], v[72:75], v[40:43], v[104:107]
    v_mfma_f32_16x16x32_bf16 v[108:111], v[76:79], v[40:43], v[108:111]
    v_mfma_f32_16x16x32_bf16 v[112:115], v[72:75], v[44:47], v[112:115]
    v_mfma_f32_16x16x32_bf16 v[116:119], v[76:79], v[44:47], v[116:119]
    s_waitcnt vmcnt(4)
    v_mfma_f32_16x16x32_bf16 v[104:107], v[80:83], v[48:51], v[104:107]
    v_mfma_f32_16x16x32_bf16 v[108:111], v[84:87], v[48:51], v[108:111]
    v_mfma_f32_16x16x32_bf16 v[112:115], v[80:83], v[52:55], v[112:115]
    v_mfma_f32_16x16x32_bf16 v[116:119], v[84:87], v[52:55], v[116:119]
    s_waitcnt vmcnt(2)
    v_mfma_f32_16x16x32_bf16 v[104:107], v[88:91], v[56:59], v[104:107]
    v_mfma_f32_16x16x32_bf16 v[108:111], v[92:95], v[56:59], v[108:111]
    v_mfma_f32_16x16x32_bf16 v[112:115], v[88:91], v[60:63], v[112:115]
    v_mfma_f32_16x16x32_bf16 v[116:119], v[92:95], v[60:63], v[116:119]
    s_waitcnt vmcnt(0)
    v_mfma_f32_16x16x32_bf16 v[104:107], v[96:99], v[64:67], v[104:107]
    v_mfma_f32_16x16x32_bf16 v[108:111], v[100:103], v[64:67], v[108:111]
    v_mfma_f32_16x16x32_bf16 v[112:115], v[96:99], v[68:71], v[112:115]
    v_mfma_f32_16x16x32_bf16 v[116:119], v[100:103], v[68:71], v[116:119]
    s_mov_b32 s24, 0xffff0000
    s_mul_i32 s25, s6, 28672
    s_lshl_b32 s26, s7, 6
    s_add_u32 s25, s25, s26
    s_add_u32 s26, s25, 14336
    v_mul_u32_u24 v9, 896, v2
    v_lshl_add_u32 v9, v1, 4, v9
    s_nop 7
    v_sub_f32 v30, 1.0, v28
    v_sub_f32 v31, 1.0, v29
    v_cvt_pk_bf16_f32 v8, v30, v31
    v_lshlrev_b32 v30, 16, v8
    v_and_b32 v31, s24, v8
    v_cvt_pk_bf16_f32 v8, v12, v13
    v_lshlrev_b32 v12, 16, v8
    v_and_b32 v13, s24, v8
    v_cvt_pk_bf16_f32 v8, v104, v105
    v_lshlrev_b32 v104, 16, v8
    v_and_b32 v105, s24, v8
    v_mul_f32 v12, v12, v28
    v_mul_f32 v13, v13, v28
    v_mul_f32 v104, v104, v30
    v_mul_f32 v105, v105, v30
    v_cvt_pk_bf16_f32 v8, v12, v13
    v_lshlrev_b32 v12, 16, v8
    v_and_b32 v13, s24, v8
    v_cvt_pk_bf16_f32 v8, v104, v105
    v_lshlrev_b32 v104, 16, v8
    v_and_b32 v105, s24, v8
    v_add_f32 v12, v12, v104
    v_add_f32 v13, v13, v105
    v_cvt_pk_bf16_f32 v40, v12, v13
    v_cvt_pk_bf16_f32 v8, v14, v15
    v_lshlrev_b32 v14, 16, v8
    v_and_b32 v15, s24, v8
    v_cvt_pk_bf16_f32 v8, v106, v107
    v_lshlrev_b32 v106, 16, v8
    v_and_b32 v107, s24, v8
    v_mul_f32 v14, v14, v28
    v_mul_f32 v15, v15, v28
    v_mul_f32 v106, v106, v30
    v_mul_f32 v107, v107, v30
    v_cvt_pk_bf16_f32 v8, v14, v15
    v_lshlrev_b32 v14, 16, v8
    v_and_b32 v15, s24, v8
    v_cvt_pk_bf16_f32 v8, v106, v107
    v_lshlrev_b32 v106, 16, v8
    v_and_b32 v107, s24, v8
    v_add_f32 v14, v14, v106
    v_add_f32 v15, v15, v107
    v_cvt_pk_bf16_f32 v41, v14, v15
    v_cvt_pk_bf16_f32 v8, v16, v17
    v_lshlrev_b32 v16, 16, v8
    v_and_b32 v17, s24, v8
    v_cvt_pk_bf16_f32 v8, v108, v109
    v_lshlrev_b32 v108, 16, v8
    v_and_b32 v109, s24, v8
    v_mul_f32 v16, v16, v28
    v_mul_f32 v17, v17, v28
    v_mul_f32 v108, v108, v30
    v_mul_f32 v109, v109, v30
    v_cvt_pk_bf16_f32 v8, v16, v17
    v_lshlrev_b32 v16, 16, v8
    v_and_b32 v17, s24, v8
    v_cvt_pk_bf16_f32 v8, v108, v109
    v_lshlrev_b32 v108, 16, v8
    v_and_b32 v109, s24, v8
    v_add_f32 v16, v16, v108
    v_add_f32 v17, v17, v109
    v_cvt_pk_bf16_f32 v42, v16, v17
    v_cvt_pk_bf16_f32 v8, v18, v19
    v_lshlrev_b32 v18, 16, v8
    v_and_b32 v19, s24, v8
    v_cvt_pk_bf16_f32 v8, v110, v111
    v_lshlrev_b32 v110, 16, v8
    v_and_b32 v111, s24, v8
    v_mul_f32 v18, v18, v28
    v_mul_f32 v19, v19, v28
    v_mul_f32 v110, v110, v30
    v_mul_f32 v111, v111, v30
    v_cvt_pk_bf16_f32 v8, v18, v19
    v_lshlrev_b32 v18, 16, v8
    v_and_b32 v19, s24, v8
    v_cvt_pk_bf16_f32 v8, v110, v111
    v_lshlrev_b32 v110, 16, v8
    v_and_b32 v111, s24, v8
    v_add_f32 v18, v18, v110
    v_add_f32 v19, v19, v111
    v_cvt_pk_bf16_f32 v43, v18, v19
    buffer_store_dwordx4 v[40:43], v9, s[16:19], s25 offen
    v_cvt_pk_bf16_f32 v8, v20, v21
    v_lshlrev_b32 v20, 16, v8
    v_and_b32 v21, s24, v8
    v_cvt_pk_bf16_f32 v8, v112, v113
    v_lshlrev_b32 v112, 16, v8
    v_and_b32 v113, s24, v8
    v_mul_f32 v20, v20, v29
    v_mul_f32 v21, v21, v29
    v_mul_f32 v112, v112, v31
    v_mul_f32 v113, v113, v31
    v_cvt_pk_bf16_f32 v8, v20, v21
    v_lshlrev_b32 v20, 16, v8
    v_and_b32 v21, s24, v8
    v_cvt_pk_bf16_f32 v8, v112, v113
    v_lshlrev_b32 v112, 16, v8
    v_and_b32 v113, s24, v8
    v_add_f32 v20, v20, v112
    v_add_f32 v21, v21, v113
    v_cvt_pk_bf16_f32 v44, v20, v21
    v_cvt_pk_bf16_f32 v8, v22, v23
    v_lshlrev_b32 v22, 16, v8
    v_and_b32 v23, s24, v8
    v_cvt_pk_bf16_f32 v8, v114, v115
    v_lshlrev_b32 v114, 16, v8
    v_and_b32 v115, s24, v8
    v_mul_f32 v22, v22, v29
    v_mul_f32 v23, v23, v29
    v_mul_f32 v114, v114, v31
    v_mul_f32 v115, v115, v31
    v_cvt_pk_bf16_f32 v8, v22, v23
    v_lshlrev_b32 v22, 16, v8
    v_and_b32 v23, s24, v8
    v_cvt_pk_bf16_f32 v8, v114, v115
    v_lshlrev_b32 v114, 16, v8
    v_and_b32 v115, s24, v8
    v_add_f32 v22, v22, v114
    v_add_f32 v23, v23, v115
    v_cvt_pk_bf16_f32 v45, v22, v23
    v_cvt_pk_bf16_f32 v8, v24, v25
    v_lshlrev_b32 v24, 16, v8
    v_and_b32 v25, s24, v8
    v_cvt_pk_bf16_f32 v8, v116, v117
    v_lshlrev_b32 v116, 16, v8
    v_and_b32 v117, s24, v8
    v_mul_f32 v24, v24, v29
    v_mul_f32 v25, v25, v29
    v_mul_f32 v116, v116, v31
    v_mul_f32 v117, v117, v31
    v_cvt_pk_bf16_f32 v8, v24, v25
    v_lshlrev_b32 v24, 16, v8
    v_and_b32 v25, s24, v8
    v_cvt_pk_bf16_f32 v8, v116, v117
    v_lshlrev_b32 v116, 16, v8
    v_and_b32 v117, s24, v8
    v_add_f32 v24, v24, v116
    v_add_f32 v25, v25, v117
    v_cvt_pk_bf16_f32 v46, v24, v25
    v_cvt_pk_bf16_f32 v8, v26, v27
    v_lshlrev_b32 v26, 16, v8
    v_and_b32 v27, s24, v8
    v_cvt_pk_bf16_f32 v8, v118, v119
    v_lshlrev_b32 v118, 16, v8
    v_and_b32 v119, s24, v8
    v_mul_f32 v26, v26, v29
    v_mul_f32 v27, v27, v29
    v_mul_f32 v118, v118, v31
    v_mul_f32 v119, v119, v31
    v_cvt_pk_bf16_f32 v8, v26, v27
    v_lshlrev_b32 v26, 16, v8
    v_and_b32 v27, s24, v8
    v_cvt_pk_bf16_f32 v8, v118, v119
    v_lshlrev_b32 v118, 16, v8
    v_and_b32 v119, s24, v8
    v_add_f32 v26, v26, v118
    v_add_f32 v27, v27, v119
    v_cvt_pk_bf16_f32 v47, v26, v27
    buffer_store_dwordx4 v[44:47], v9, s[16:19], s26 offen
.w3_next:
    s_add_u32 s5, s5, 832
    s_cmp_lt_u32 s5, 1024
    s_cbranch_scc1 .w3_loop
.m_end:
    s_endpgm
.section .rodata,"a"
.p2align 6
.amdhsa_kernel gated_mix__sliding_block__memory_aug_recurrent_mem_tr__prompt_kernel
  .amdhsa_next_free_vgpr 512
  .amdhsa_next_free_sgpr 102
  .amdhsa_accum_offset 256
  .amdhsa_group_segment_fixed_size 0
  .amdhsa_kernarg_size 112
  .amdhsa_user_sgpr_count 2
  .amdhsa_user_sgpr_kernarg_segment_ptr 1
  .amdhsa_system_sgpr_workgroup_id_x 1
.end_amdhsa_kernel
```
